```python
import torch

def _softmax(x, axis=-1):
    return torch.softmax(x, dim=axis)

def _gelu(x):
    return torch.nn.functional.gelu(x, approximate='tanh')

def _silu(x):
    return torch.nn.functional.silu(x)

def _sigmoid(x):
    return torch.sigmoid(x)

def _layernorm(x, axis=-1, eps=1e-05):
    m = x.mean(dim=axis, keepdim=True)
    v = x.var(dim=axis, keepdim=True, unbiased=False)
    return (x - m) / torch.sqrt(v + eps)

def _scatter_add(tgt, idx, src, axis=0):
    return tgt.clone().index_add_(axis, idx, src)

def _segment_sum(src, seg, n):
    out = torch.zeros((n,) + src.shape[1:], dtype=src.dtype)
    return out.index_add_(0, seg, src)

def _pad(x, pw):
    flat = tuple((v for pair in reversed(pw) for v in pair))
    return torch.nn.functional.pad(x, flat)
kernel_name = 'adaLN_cond__mha_block_cached__glu_gated_bilinear__prompt'

def setup_inputs():

    _w = lambda a: (lambda t: t.to(torch.bfloat16) if t.is_floating_point() else t)(torch.as_tensor(a))

    def _A_setup():
        B, Sq, D = (1, 2048, 512)
        H, Sk, Dh = (32, 2048, 128)
        return {'x': _w((lambda *s: torch.randn(*s, dtype=torch.bfloat16) * 0.1)(B, Sq, D)), 'k_cache': _w((lambda *s: torch.randn(*s, dtype=torch.bfloat16) * 0.8)(B, H, Sk, Dh)), 'v_cache': _w((lambda *s: torch.randn(*s, dtype=torch.bfloat16) * 3.2)(B, H, Sk, Dh)), 'wq': _w((lambda *s: torch.randn(*s, dtype=torch.bfloat16) * 0.8)(D, H * Dh) * D ** (-0.5)), 'wo': _w((lambda *s: torch.randn(*s, dtype=torch.bfloat16) * 3.2)(H * Dh, D) * (H * Dh) ** (-0.5))}
    _A_in = _A_setup()

    def _B_setup():
        B, S, D, F = (1, 2048, 512, 1792)
        return {'x': _w((lambda *s: torch.randn(*s, dtype=torch.bfloat16) * 0.1)(B, S, D)), 'w_gate': _w((lambda *s: torch.randn(*s, dtype=torch.bfloat16) * 3.2)(D, F) * D ** (-0.5)), 'w_up': _w((lambda *s: torch.randn(*s, dtype=torch.bfloat16) * 3.2)(D, F) * D ** (-0.5)), 'w_down': _w((lambda *s: torch.randn(*s, dtype=torch.bfloat16) * 3.2)(F, D) * F ** (-0.5))}
    _B_in = _B_setup()
    return {'A_x': _A_in['x'], 'A_k_cache': _A_in['k_cache'], 'A_v_cache': _A_in['v_cache'], 'A_wq': _A_in['wq'], 'A_wo': _A_in['wo'], 'B_x': _B_in['x'], 'B_w_gate': _B_in['w_gate'], 'B_w_up': _B_in['w_up'], 'B_w_down': _B_in['w_down'], 'c': _w((lambda *s: torch.randn(*s, dtype=torch.bfloat16) * 0.8)(1, 512) * 8.0), 'w_mod': _w((lambda *s: torch.randn(*s, dtype=torch.bfloat16) * 0.8)(512, 6 * 512) * 512 ** (-0.5) * 8.0)}

def reference(A_x, A_k_cache, A_v_cache, A_wq, A_wo, B_x, B_w_gate, B_w_up, B_w_down, c, w_mod):

    def _A_ref(x, k_cache, v_cache, wq, wo):
        B, Sq, D = x.shape
        H, Dh = (32, 128)
        q = (lambda x, *d: x.permute(*d))((x @ wq).reshape(B, Sq, H, Dh), 0, 2, 1, 3)
        scores = torch.einsum('bhqd,bhkd->bhqk', q, k_cache) * Dh ** (-0.5)
        p = _softmax(scores, axis=-1)
        o = torch.einsum('bhqk,bhkd->bhqd', p, v_cache)
        return (lambda x, *d: x.permute(*d))(o, 0, 2, 1, 3).reshape(B, Sq, H * Dh) @ wo

    def _B_ref(x, w_gate, w_up, w_down):
        g = torch.einsum('bsd,df->bsf', x, w_gate)
        u = torch.einsum('bsd,df->bsf', x, w_up)
        h = g * u
        return torch.einsum('bsf,fd->bsd', h, w_down)
    x = A_x
    mod = (_silu(c) @ w_mod).reshape(c.shape[0], 6, 1, -1)
    sa, ca, ga, sb, cb, gb = (mod[:, 0].clone(), mod[:, 1].clone(), mod[:, 2].clone(), mod[:, 3].clone(), mod[:, 4].clone(), mod[:, 5].clone())
    h = _layernorm(x, axis=-1) * (1 + ca) + sa
    x = x + ga * _A_ref(h, A_k_cache, A_v_cache, A_wq, A_wo)
    h = _layernorm(x, axis=-1) * (1 + cb) + sb
    x = x + gb * _B_ref(h, B_w_gate, B_w_up, B_w_down)
    return x
```

```asm
; @launch grid=(256,1,1) block=(256,1,1) lds=163840
.amdgcn_target "amdgcn-amd-amdhsa--gfx950"
.text
code_begin:
.text
.globl adaLN_cond__mha_block_cached__glu_gated_bilinear__prompt_kernel
.p2align 8
.type adaLN_cond__mha_block_cached__glu_gated_bilinear__prompt_kernel,@function
adaLN_cond__mha_block_cached__glu_gated_bilinear__prompt_kernel:
s_cmp_ge_u32 s2, 256
s_cbranch_scc1 adaLN_cond__mha_block_cached__glu_gated_bilinear__prompt_kernel_end
s_load_dwordx4 s[4:7], s[0:1], 8
s_load_dwordx2 s[40:41], s[0:1], 24
s_load_dwordx2 s[42:43], s[0:1], 104
s_getpc_b64 s[50:51]
adaLN_cond__mha_block_cached__glu_gated_bilinear__prompt_kernel_pc:
s_sub_u32 s50, s50, adaLN_cond__mha_block_cached__glu_gated_bilinear__prompt_kernel_pc - code_begin
s_subb_u32 s51, s51, 0
s_lshr_b32 s52, s2, 3
s_lshl_b32 s52, s52, 14
v_lshlrev_b32 v80, 6, v0
v_add_u32 v80, s52, v80
v_min_u32 v80, adaLN_cond__mha_block_cached__glu_gated_bilinear__prompt_kernel_end - code_begin, v80
global_load_dword v80, v80, s[50:51]
s_load_dwordx2 s[80:81], s[0:1], 0
s_load_dwordx2 s[82:83], s[0:1], 88
s_load_dwordx4 s[56:59], s[0:1], 72
s_load_dwordx2 s[60:61], s[0:1], 96
s_memrealtime s[86:87]
s_load_dwordx2 s[64:65], s[0:1], 32
s_load_dwordx2 s[68:69], s[0:1], 48
s_load_dwordx2 s[72:73], s[0:1], 56
s_load_dwordx2 s[76:77], s[0:1], 64
v_lshrrev_b32 v1, 6, v0
v_and_b32 v2, 63, v0
v_readfirstlane_b32 s28, v1
s_and_b32 s44, s2, 7
s_lshl_b32 s44, s44, 2
s_lshr_b32 s45, s2, 3
s_and_b32 s46, s45, 3
s_add_u32 s44, s44, s46
s_lshr_b32 s45, s45, 2
s_lshl_b32 s45, s45, 2
s_add_u32 s45, s45, s28
v_and_b32 v3, 15, v2
v_lshrrev_b32 v4, 4, v2
v_lshlrev_b32 v5, 2, v4
v_xor_b32 v5, v5, v3
v_lshlrev_b32 v5, 4, v5
v_lshl_add_u32 v0, v4, 13, v5
v_lshlrev_b32 v14, 4, v2
s_lshl_b32 s48, s28, 13
s_lshl_b32 s49, s28, 10
s_waitcnt lgkmcnt(0)
s_lshl_b32 s46, s44, 8
s_add_u32 s16, s40, s46
s_addc_u32 s17, s41, 0
s_mov_b32 s18, 0
s_mov_b32 s19, 0x20000
s_sub_u32 s18, 4194304, s46
s_lshl_b32 s46, s45, 16
s_add_u32 s46, s46, 1048576
s_add_u32 s20, s42, s46
s_addc_u32 s21, s43, 0
s_mov_b32 s22, 65536
s_mov_b32 s23, 0x20000
s_mov_b32 s62, 256
s_mov_b32 s63, 0x20000
s_cmp_lg_u32 s2, 255
s_cbranch_scc1 adaLN_cond__mha_block_cached__glu_gated_bilinear__prompt_kernel_f1
s_cmp_lg_u32 s28, 0
s_cbranch_scc1 adaLN_cond__mha_block_cached__glu_gated_bilinear__prompt_kernel_f1
s_or_b32 s50, s86, 0x80000000
s_mov_b64 exec, 1
v_mov_b32 v12, 0
v_mov_b32 v11, s50
buffer_store_dword v11, v12, s[60:63], 0 offen sc1
s_mov_b64 exec, -1
adaLN_cond__mha_block_cached__glu_gated_bilinear__prompt_kernel_f1:
s_cmp_lt_u32 s2, 128
s_cbranch_scc1 adaLN_cond__mha_block_cached__glu_gated_bilinear__prompt_kernel_fm0
s_and_b32 s50, s2, 1
s_lshl_b32 s50, s50, 6
s_bfe_u32 s51, s2, 0x20001
s_lshl_b32 s51, s51, 4
s_add_u32 s50, s50, s51
s_bfe_u32 s51, s2, 0x40003
s_add_u32 s47, s50, s51
s_mov_b32 s8, s80
s_mov_b32 s9, s81
s_mov_b32 s10, 2097152
s_mov_b32 s11, 0x20000
s_lshl_b32 s50, s47, 14
s_lshl_b32 s51, s28, 8
s_add_u32 s50, s50, s51
v_lshlrev_b32 v5, 10, v3
v_lshl_add_u32 v5, v4, 4, v5
buffer_load_dwordx4 v[16:19], v5, s[8:11], s50 offen offset:0
buffer_load_dwordx4 v[20:23], v5, s[8:11], s50 offen offset:64
buffer_load_dwordx4 v[24:27], v5, s[8:11], s50 offen offset:128
buffer_load_dwordx4 v[28:31], v5, s[8:11], s50 offen offset:192
s_branch adaLN_cond__mha_block_cached__glu_gated_bilinear__prompt_kernel_fj0
adaLN_cond__mha_block_cached__glu_gated_bilinear__prompt_kernel_fm0:
s_mov_b32 s8, s56
s_mov_b32 s9, s57
s_mov_b32 s10, 1024
s_mov_b32 s11, 0x20000
s_mov_b32 s12, s58
s_mov_b32 s13, s59
s_mov_b32 s14, 3145728
s_mov_b32 s15, 0x20000
v_lshrrev_b32 v5, 2, v2
s_lshl_b32 s50, s28, 4
v_add_u32 v5, s50, v5
s_mov_b32 s51, 6144
v_mul_lo_u32 v6, v5, s51
v_and_b32 v7, 3, v2
v_lshl_add_u32 v6, v7, 4, v6
v_lshlrev_b32 v5, 1, v5
s_and_b32 s50, s2, 31
s_lshr_b32 s51, s2, 5
s_cmp_lt_u32 s2, 64
s_cbranch_scc1 adaLN_cond__mha_block_cached__glu_gated_bilinear__prompt_kernel_fa0
s_sub_u32 s50, s2, 32
s_lshl_b32 s52, s50, 6
s_add_u32 s52, s52, 1572864
buffer_load_ushort v68, v5, s[8:11], 0 offen offset:512
buffer_load_ushort v69, v5, s[8:11], 0 offen offset:640
buffer_load_ushort v70, v5, s[8:11], 0 offen offset:768
buffer_load_ushort v71, v5, s[8:11], 0 offen offset:896
buffer_load_dwordx4 v[32:35], v6, s[12:15], s52 offen nt
s_add_u32 s52, s52, 393216
buffer_load_dwordx4 v[36:39], v6, s[12:15], s52 offen nt
s_add_u32 s52, s52, 393216
buffer_load_dwordx4 v[40:43], v6, s[12:15], s52 offen nt
s_add_u32 s52, s52, 393216
buffer_load_dwordx4 v[44:47], v6, s[12:15], s52 offen nt
s_add_u32 s52, s52, 393216
s_mov_b32 s51, 0
adaLN_cond__mha_block_cached__glu_gated_bilinear__prompt_kernel_fa0:
s_mov_b32 s47, s50
s_lshl_b32 s52, s50, 6
s_mul_i32 s53, s51, 1572864
s_add_u32 s52, s52, s53
s_lshl_b32 s53, s51, 9
buffer_load_ushort v64, v5, s[8:11], s53 offen offset:0
buffer_load_ushort v65, v5, s[8:11], s53 offen offset:128
buffer_load_ushort v66, v5, s[8:11], s53 offen offset:256
buffer_load_ushort v67, v5, s[8:11], s53 offen offset:384
buffer_load_dwordx4 v[16:19], v6, s[12:15], s52 offen nt
s_add_u32 s52, s52, 393216
buffer_load_dwordx4 v[20:23], v6, s[12:15], s52 offen nt
s_add_u32 s52, s52, 393216
buffer_load_dwordx4 v[24:27], v6, s[12:15], s52 offen nt
s_add_u32 s52, s52, 393216
buffer_load_dwordx4 v[28:31], v6, s[12:15], s52 offen nt
adaLN_cond__mha_block_cached__glu_gated_bilinear__prompt_kernel_fj0:
s_mul_i32 s57, s28, 262144
s_mul_i32 s58, s28, 8192
s_add_u32 m0, s58, 16384
s_add_u32 s50, s57, 0
buffer_load_dwordx4 v0, s[16:19], s50 offen offset:0 nt lds
s_add_u32 s50, s57, 31744
buffer_load_dwordx4 v0, s[16:19], s50 offen offset:1024 nt lds
s_add_u32 s50, s57, 63488
buffer_load_dwordx4 v0, s[16:19], s50 offen offset:2048 nt lds
s_add_u32 s50, s57, 95232
buffer_load_dwordx4 v0, s[16:19], s50 offen offset:3072 nt lds
s_add_u32 m0, s58, 20480
s_add_u32 s50, s57, 131072
buffer_load_dwordx4 v0, s[16:19], s50 offen offset:0 nt lds
s_add_u32 s50, s57, 162816
buffer_load_dwordx4 v0, s[16:19], s50 offen offset:1024 nt lds
s_add_u32 s50, s57, 194560
buffer_load_dwordx4 v0, s[16:19], s50 offen offset:2048 nt lds
s_add_u32 s50, s57, 226304
buffer_load_dwordx4 v0, s[16:19], s50 offen offset:3072 nt lds
v_add_u32 v6, 0, v4
v_xor_b32 v6, v6, v3
v_lshlrev_b32 v6, 4, v6
v_lshl_add_u32 v156, v4, 8, v6
v_add_u32 v6, 4, v4
v_xor_b32 v6, v6, v3
v_lshlrev_b32 v6, 4, v6
v_lshl_add_u32 v157, v4, 8, v6
v_add_u32 v6, 8, v4
v_xor_b32 v6, v6, v3
v_lshlrev_b32 v6, 4, v6
v_lshl_add_u32 v158, v4, 8, v6
v_add_u32 v6, 12, v4
v_xor_b32 v6, v6, v3
v_lshlrev_b32 v6, 4, v6
v_lshl_add_u32 v159, v4, 8, v6
v_and_b32 v1, 3, v2
v_bfe_u32 v6, v2, 2, 2
v_lshrrev_b32 v7, 5, v2
v_lshlrev_b32 v8, 5, v7
v_add_u32 v15, 147456, v8
v_lshl_add_u32 v7, v7, 3, v6
v_lshlrev_b32 v7, 8, v7
v_and_b32 v8, 1, v4
v_lshl_add_u32 v7, v8, 3, v7
v_add_u32 v7, 0x4000, v7
v_lshlrev_b32 v6, 2, v6
v_and_b32 v8, 1, v1
v_lshlrev_b32 v8, 1, v8
v_lshrrev_b32 v9, 1, v1
v_add_u32 v8, v8, v9
v_add_u32 v5, 0, v8
v_xor_b32 v5, v5, v6
v_lshl_add_u32 v172, v5, 4, v7
v_add_u32 v5, 4, v8
v_xor_b32 v5, v5, v6
v_lshl_add_u32 v173, v5, 4, v7
v_add_u32 v5, 8, v8
v_xor_b32 v5, v5, v6
v_lshl_add_u32 v174, v5, 4, v7
v_add_u32 v5, 12, v8
v_xor_b32 v5, v5, v6
v_lshl_add_u32 v175, v5, 4, v7
v_add_u32 v5, 0, v4
v_lshlrev_b32 v5, 1, v5
v_xor_b32 v5, v5, v3
v_lshlrev_b32 v5, 4, v5
v_lshl_add_u32 v6, v4, 8, v5
v_add_u32 v5, 4, v4
v_lshlrev_b32 v5, 1, v5
v_xor_b32 v5, v5, v3
v_lshlrev_b32 v5, 4, v5
v_lshl_add_u32 v7, v4, 8, v5
s_add_u32 s53, s28, 6
s_and_b32 s53, s53, 7
s_lshl_b32 s30, s53, 13
s_add_u32 s53, s28, 3
s_and_b32 s53, s53, 7
s_lshl_b32 s53, s53, 13
s_add_u32 s32, s53, 65536
s_add_u32 s53, s28, 10
s_and_b32 s53, s53, 7
s_lshl_b32 s31, s53, 13
s_add_u32 s53, s28, 7
s_and_b32 s53, s53, 7
s_lshl_b32 s53, s53, 13
s_add_u32 s33, s53, 65536
s_add_u32 s34, s48, 49152
s_add_u32 s35, s34, 4096
s_add_u32 s36, s48, 24576
s_add_u32 s37, s36, 4096
s_mov_b32 s66, 4194304
s_mov_b32 s67, 0x20000
s_mov_b32 s70, 1835008
s_mov_b32 s71, 0x20000
s_mov_b32 s74, 1835008
s_mov_b32 s75, 0x20000
s_mov_b32 s78, 1835008
s_mov_b32 s79, 0x20000
s_cmp_lt_u32 s2, 128
s_cbranch_scc1 adaLN_cond__mha_block_cached__glu_gated_bilinear__prompt_kernel_fm1
v_lshlrev_b32 v5, 4, v3
v_lshrrev_b32 v8, 1, v4
v_lshl_add_u32 v5, v8, 10, v5
v_and_b32 v8, 1, v4
v_lshl_add_u32 v5, v8, 9, v5
s_lshr_b32 s50, s47, 1
s_lshl_b32 s50, s50, 15
s_and_b32 s51, s47, 1
s_lshl_b32 s51, s51, 8
s_add_u32 s50, s50, s51
s_lshl_b32 s51, s28, 13
s_add_u32 s47, s50, s51
s_add_u32 s52, s42, 1048576
s_addc_u32 s53, s43, 0
s_mov_b32 s54, 2097152
s_mov_b32 s55, 0x20000
v_lshlrev_b32 v12, 3, v3
s_lshl_b32 s50, s28, 7
v_add_u32 v13, s50, v12
s_waitcnt vmcnt(8)
s_mul_i32 s57, s28, 262144
s_mul_i32 s58, s28, 8192
s_add_u32 m0, s58, 49152
s_add_u32 s56, s57, 1048576
buffer_load_dwordx4 v0, s[16:19], s56 offen offset:0 nt lds
s_add_u32 s56, s57, 1080320
buffer_load_dwordx4 v0, s[16:19], s56 offen offset:1024 nt lds
s_add_u32 s56, s57, 1112064
buffer_load_dwordx4 v0, s[16:19], s56 offen offset:2048 nt lds
s_add_u32 s56, s57, 1143808
buffer_load_dwordx4 v0, s[16:19], s56 offen offset:3072 nt lds
v_lshlrev_b32 v32, 16, v16
v_and_b32 v33, 0xffff0000, v16
v_lshlrev_b32 v34, 16, v17
v_and_b32 v35, 0xffff0000, v17
v_lshlrev_b32 v36, 16, v18
v_and_b32 v37, 0xffff0000, v18
v_lshlrev_b32 v38, 16, v19
v_and_b32 v39, 0xffff0000, v19
v_lshlrev_b32 v40, 16, v20
v_and_b32 v41, 0xffff0000, v20
v_lshlrev_b32 v42, 16, v21
v_and_b32 v43, 0xffff0000, v21
v_lshlrev_b32 v44, 16, v22
v_and_b32 v45, 0xffff0000, v22
v_lshlrev_b32 v46, 16, v23
v_and_b32 v47, 0xffff0000, v23
v_lshlrev_b32 v48, 16, v24
v_and_b32 v49, 0xffff0000, v24
v_lshlrev_b32 v50, 16, v25
v_and_b32 v51, 0xffff0000, v25
v_lshlrev_b32 v52, 16, v26
v_and_b32 v53, 0xffff0000, v26
v_lshlrev_b32 v54, 16, v27
v_and_b32 v55, 0xffff0000, v27
v_lshlrev_b32 v56, 16, v28
v_and_b32 v57, 0xffff0000, v28
v_lshlrev_b32 v58, 16, v29
v_and_b32 v59, 0xffff0000, v29
v_lshlrev_b32 v60, 16, v30
v_and_b32 v61, 0xffff0000, v30
v_lshlrev_b32 v62, 16, v31
v_and_b32 v63, 0xffff0000, v31
v_pk_add_f32 v[8:9], v[32:33], v[34:35]
v_pk_mul_f32 v[10:11], v[32:33], v[32:33]
v_pk_fma_f32 v[10:11], v[34:35], v[34:35], v[10:11]
v_pk_add_f32 v[8:9], v[8:9], v[36:37]
v_pk_fma_f32 v[10:11], v[36:37], v[36:37], v[10:11]
v_pk_add_f32 v[8:9], v[8:9], v[38:39]
v_pk_fma_f32 v[10:11], v[38:39], v[38:39], v[10:11]
v_pk_add_f32 v[8:9], v[8:9], v[40:41]
v_pk_fma_f32 v[10:11], v[40:41], v[40:41], v[10:11]
v_pk_add_f32 v[8:9], v[8:9], v[42:43]
v_pk_fma_f32 v[10:11], v[42:43], v[42:43], v[10:11]
v_pk_add_f32 v[8:9], v[8:9], v[44:45]
v_pk_fma_f32 v[10:11], v[44:45], v[44:45], v[10:11]
v_pk_add_f32 v[8:9], v[8:9], v[46:47]
v_pk_fma_f32 v[10:11], v[46:47], v[46:47], v[10:11]
v_pk_add_f32 v[8:9], v[8:9], v[48:49]
v_pk_fma_f32 v[10:11], v[48:49], v[48:49], v[10:11]
v_pk_add_f32 v[8:9], v[8:9], v[50:51]
v_pk_fma_f32 v[10:11], v[50:51], v[50:51], v[10:11]
v_pk_add_f32 v[8:9], v[8:9], v[52:53]
v_pk_fma_f32 v[10:11], v[52:53], v[52:53], v[10:11]
v_pk_add_f32 v[8:9], v[8:9], v[54:55]
v_pk_fma_f32 v[10:11], v[54:55], v[54:55], v[10:11]
v_pk_add_f32 v[8:9], v[8:9], v[56:57]
v_pk_fma_f32 v[10:11], v[56:57], v[56:57], v[10:11]
v_pk_add_f32 v[8:9], v[8:9], v[58:59]
v_pk_fma_f32 v[10:11], v[58:59], v[58:59], v[10:11]
v_pk_add_f32 v[8:9], v[8:9], v[60:61]
v_pk_fma_f32 v[10:11], v[60:61], v[60:61], v[10:11]
v_pk_add_f32 v[8:9], v[8:9], v[62:63]
v_pk_fma_f32 v[10:11], v[62:63], v[62:63], v[10:11]
v_add_f32 v8, v8, v9
v_add_f32 v9, v10, v11
v_mov_b32 v10, v8
v_mov_b32 v11, v9
s_nop 0
v_permlane32_swap_b32 v8, v10
v_permlane32_swap_b32 v9, v11
v_add_f32 v8, v8, v10
v_add_f32 v9, v9, v11
v_mov_b32 v10, v8
v_mov_b32 v11, v9
s_nop 0
v_permlane16_swap_b32 v8, v10
v_permlane16_swap_b32 v9, v11
v_add_f32 v8, v8, v10
v_add_f32 v9, v9, v11
v_mov_b32 v82, 0
buffer_load_dword v81, v82, s[60:63], 0 offen sc1
ds_write_b64 v13, v[8:9]
s_waitcnt lgkmcnt(0)
s_barrier
ds_read_b64 v[16:17], v12 offset:0
ds_read_b64 v[18:19], v12 offset:128
ds_read_b64 v[20:21], v12 offset:256
ds_read_b64 v[22:23], v12 offset:384
s_waitcnt lgkmcnt(0)
v_pk_add_f32 v[16:17], v[16:17], v[18:19]
v_pk_add_f32 v[20:21], v[20:21], v[22:23]
v_pk_add_f32 v[16:17], v[16:17], v[20:21]
v_mul_f32 v8, 0x3b000000, v16
v_mov_b32 v9, 0x3727c5ac
v_fmac_f32 v9, 0x3b000000, v17
v_fma_f32 v9, -v8, v8, v9
v_max_f32 v9, 0x3727c5ac, v9
v_rsq_f32 v9, v9
s_add_u32 s50, s47, 4096
v_mul_f32 v10, v8, v9
v_mov_b32 v8, v9
v_sub_f32 v10, 0, v10
v_mov_b32 v11, v10
v_pk_fma_f32 v[32:33], v[32:33], v[8:9], v[10:11]
v_pk_fma_f32 v[34:35], v[34:35], v[8:9], v[10:11]
v_pk_fma_f32 v[36:37], v[36:37], v[8:9], v[10:11]
v_pk_fma_f32 v[38:39], v[38:39], v[8:9], v[10:11]
v_pk_fma_f32 v[40:41], v[40:41], v[8:9], v[10:11]
v_pk_fma_f32 v[42:43], v[42:43], v[8:9], v[10:11]
v_pk_fma_f32 v[44:45], v[44:45], v[8:9], v[10:11]
v_pk_fma_f32 v[46:47], v[46:47], v[8:9], v[10:11]
v_pk_fma_f32 v[48:49], v[48:49], v[8:9], v[10:11]
v_pk_fma_f32 v[50:51], v[50:51], v[8:9], v[10:11]
v_pk_fma_f32 v[52:53], v[52:53], v[8:9], v[10:11]
v_pk_fma_f32 v[54:55], v[54:55], v[8:9], v[10:11]
v_pk_fma_f32 v[56:57], v[56:57], v[8:9], v[10:11]
v_pk_fma_f32 v[58:59], v[58:59], v[8:9], v[10:11]
v_pk_fma_f32 v[60:61], v[60:61], v[8:9], v[10:11]
v_pk_fma_f32 v[62:63], v[62:63], v[8:9], v[10:11]
v_cvt_pk_f16_f32 v16, v32, v33
v_cvt_pk_f16_f32 v17, v34, v35
v_cvt_pk_f16_f32 v18, v36, v37
v_cvt_pk_f16_f32 v19, v38, v39
v_cvt_pk_f16_f32 v20, v40, v41
v_cvt_pk_f16_f32 v21, v42, v43
v_cvt_pk_f16_f32 v22, v44, v45
v_cvt_pk_f16_f32 v23, v46, v47
v_cvt_pk_f16_f32 v24, v48, v49
v_cvt_pk_f16_f32 v25, v50, v51
v_cvt_pk_f16_f32 v26, v52, v53
v_cvt_pk_f16_f32 v27, v54, v55
v_cvt_pk_f16_f32 v28, v56, v57
v_cvt_pk_f16_f32 v29, v58, v59
v_cvt_pk_f16_f32 v30, v60, v61
v_cvt_pk_f16_f32 v31, v62, v63
buffer_store_dwordx4 v[16:19], v5, s[52:55], s47 offen offset:0 sc1
buffer_store_dwordx4 v[20:23], v5, s[52:55], s47 offen offset:2048 sc1
buffer_store_dwordx4 v[24:27], v5, s[52:55], s50 offen offset:0 sc1
buffer_store_dwordx4 v[28:31], v5, s[52:55], s50 offen offset:2048 sc1
s_mov_b32 s53, 0
s_waitcnt vmcnt(0)
s_branch adaLN_cond__mha_block_cached__glu_gated_bilinear__prompt_kernel_fu0
adaLN_cond__mha_block_cached__glu_gated_bilinear__prompt_kernel_ft0:
s_waitcnt vmcnt(0)
adaLN_cond__mha_block_cached__glu_gated_bilinear__prompt_kernel_fu0:
v_readfirstlane_b32 s39, v81
s_add_u32 s53, s53, 1
s_cmp_gt_u32 s53, 200000
s_cbranch_scc1 adaLN_cond__mha_block_cached__glu_gated_bilinear__prompt_kernel_ftd0
s_nop 1
s_cmp_lg_u32 s39, 0
s_cbranch_scc1 adaLN_cond__mha_block_cached__glu_gated_bilinear__prompt_kernel_ftd0
buffer_load_dword v81, v82, s[60:63], 0 offen sc1
s_branch adaLN_cond__mha_block_cached__glu_gated_bilinear__prompt_kernel_ft0
adaLN_cond__mha_block_cached__glu_gated_bilinear__prompt_kernel_ftd0:
s_barrier
s_cmp_lg_u32 s28, 0
s_cbranch_scc1 adaLN_cond__mha_block_cached__glu_gated_bilinear__prompt_kernel_fl1
s_add_u32 s52, s42, 131072
s_addc_u32 s53, s43, 0
s_mov_b32 s54, 16384
s_mov_b32 s55, 0x20000
s_lshl_b32 s50, s2, 6
s_mov_b64 exec, 1
v_mov_b32 v5, s50
v_mov_b32 v9, s39
buffer_store_dword v9, v5, s[52:55], 0 offen sc1
s_mov_b64 exec, -1
adaLN_cond__mha_block_cached__glu_gated_bilinear__prompt_kernel_fl1:
s_lshl_b32 s46, s44, 19
s_add_u32 s8, s4, s46
s_addc_u32 s9, s5, 0
s_mov_b32 s10, 524288
s_mov_b32 s11, 0x20000
s_add_u32 s12, s6, s46
s_addc_u32 s13, s7, 0
s_mov_b32 s14, 524288
s_mov_b32 s15, 0x20000
s_add_u32 m0, s58, 53248
s_add_u32 s56, s57, 1179648
buffer_load_dwordx4 v0, s[16:19], s56 offen offset:0 nt lds
s_add_u32 s56, s57, 1211392
buffer_load_dwordx4 v0, s[16:19], s56 offen offset:1024 nt lds
s_add_u32 s56, s57, 1243136
buffer_load_dwordx4 v0, s[16:19], s56 offen offset:2048 nt lds
s_add_u32 s56, s57, 1274880
buffer_load_dwordx4 v0, s[16:19], s56 offen offset:3072 nt lds
s_mul_i32 s57, s28, 262144
s_mul_i32 s58, s28, 8192
s_add_u32 m0, s58, 81920
s_add_u32 s56, s57, 2097152
buffer_load_dwordx4 v0, s[16:19], s56 offen offset:0 nt lds
s_add_u32 s56, s57, 2128896
buffer_load_dwordx4 v0, s[16:19], s56 offen offset:1024 nt lds
s_add_u32 s56, s57, 2160640
buffer_load_dwordx4 v0, s[16:19], s56 offen offset:2048 nt lds
s_add_u32 s56, s57, 2192384
buffer_load_dwordx4 v0, s[16:19], s56 offen offset:3072 nt lds
s_add_u32 m0, s58, 86016
s_add_u32 s56, s57, 2228224
buffer_load_dwordx4 v0, s[16:19], s56 offen offset:0 nt lds
s_add_u32 s56, s57, 2259968
buffer_load_dwordx4 v0, s[16:19], s56 offen offset:1024 nt lds
s_add_u32 s56, s57, 2291712
buffer_load_dwordx4 v0, s[16:19], s56 offen offset:2048 nt lds
s_add_u32 s56, s57, 2323456
buffer_load_dwordx4 v0, s[16:19], s56 offen offset:3072 nt lds
s_mul_i32 s57, s28, 262144
s_mul_i32 s58, s28, 8192
s_add_u32 m0, s58, 114688
s_add_u32 s56, s57, 3145728
buffer_load_dwordx4 v0, s[16:19], s56 offen offset:0 nt lds
s_add_u32 s56, s57, 3177472
buffer_load_dwordx4 v0, s[16:19], s56 offen offset:1024 nt lds
s_add_u32 s56, s57, 3209216
buffer_load_dwordx4 v0, s[16:19], s56 offen offset:2048 nt lds
s_add_u32 s56, s57, 3240960
buffer_load_dwordx4 v0, s[16:19], s56 offen offset:3072 nt lds
s_add_u32 m0, s58, 118784
s_add_u32 s56, s57, 3276800
buffer_load_dwordx4 v0, s[16:19], s56 offen offset:0 nt lds
s_add_u32 s56, s57, 3308544
buffer_load_dwordx4 v0, s[16:19], s56 offen offset:1024 nt lds
s_add_u32 s56, s57, 3340288
buffer_load_dwordx4 v0, s[16:19], s56 offen offset:2048 nt lds
s_add_u32 s56, s57, 3372032
buffer_load_dwordx4 v0, s[16:19], s56 offen offset:3072 nt lds
s_lshl_b32 s46, s28, 12
s_mov_b32 m0, s46
s_nop 0
buffer_load_dwordx4 v156, s[8:11], s46 offen offset:0 nt lds
buffer_load_dwordx4 v157, s[8:11], s46 offen offset:1024 nt lds
buffer_load_dwordx4 v158, s[8:11], s46 offen offset:2048 nt lds
buffer_load_dwordx4 v159, s[8:11], s46 offen offset:3072 nt lds
adaLN_cond__mha_block_cached__glu_gated_bilinear__prompt_kernel_fw1:
s_branch adaLN_cond__mha_block_cached__glu_gated_bilinear__prompt_kernel_fj1
adaLN_cond__mha_block_cached__glu_gated_bilinear__prompt_kernel_fm1:
v_and_b32 v5, 3, v2
v_lshlrev_b32 v12, 5, v5
v_and_b32 v5, 1, v4
v_lshl_add_u32 v12, v5, 3, v12
v_lshrrev_b32 v5, 5, v2
v_lshl_add_u32 v12, v5, 4, v12
s_lshl_b32 s50, s28, 7
s_add_u32 s50, s50, 155648
v_add_u32 v12, s50, v12
s_mov_b32 s50, 0xbfb8aa3b
v_mov_b32 v48, 0
v_mov_b32 v49, 0
v_mov_b32 v50, 0
v_mov_b32 v51, 0
v_mov_b32 v52, 0
v_mov_b32 v53, 0
v_mov_b32 v54, 0
v_mov_b32 v55, 0
s_cmp_lt_u32 s2, 64
s_cbranch_scc1 adaLN_cond__mha_block_cached__glu_gated_bilinear__prompt_kernel_fa1
s_waitcnt vmcnt(20)
v_lshlrev_b32 v68, 16, v68
v_lshlrev_b32 v69, 16, v69
v_lshlrev_b32 v70, 16, v70
v_lshlrev_b32 v71, 16, v71
v_mul_f32 v76, s50, v68
v_mul_f32 v77, s50, v69
v_mul_f32 v78, s50, v70
v_mul_f32 v79, s50, v71
v_exp_f32 v76, v76
v_exp_f32 v77, v77
v_exp_f32 v78, v78
v_exp_f32 v79, v79
s_nop 0
v_add_f32 v76, 1.0, v76
v_add_f32 v77, 1.0, v77
v_add_f32 v78, 1.0, v78
v_add_f32 v79, 1.0, v79
v_rcp_f32 v76, v76
v_rcp_f32 v77, v77
v_rcp_f32 v78, v78
v_rcp_f32 v79, v79
s_nop 0
v_mul_f32 v68, v68, v76
v_mul_f32 v69, v69, v77
v_mul_f32 v70, v70, v78
v_mul_f32 v71, v71, v79
v_cvt_pk_bf16_f32 v68, v68, v68
v_and_b32 v68, 0xffff0000, v68
v_cvt_pk_bf16_f32 v69, v69, v69
v_and_b32 v69, 0xffff0000, v69
v_cvt_pk_bf16_f32 v70, v70, v70
v_and_b32 v70, 0xffff0000, v70
v_cvt_pk_bf16_f32 v71, v71, v71
v_and_b32 v71, 0xffff0000, v71
s_waitcnt vmcnt(19)
v_lshlrev_b32 v8, 16, v32
v_and_b32 v9, 0xffff0000, v32
v_fmac_f32 v48, v8, v68
v_fmac_f32 v49, v9, v68
v_lshlrev_b32 v8, 16, v33
v_and_b32 v9, 0xffff0000, v33
v_fmac_f32 v50, v8, v68
v_fmac_f32 v51, v9, v68
v_lshlrev_b32 v8, 16, v34
v_and_b32 v9, 0xffff0000, v34
v_fmac_f32 v52, v8, v68
v_fmac_f32 v53, v9, v68
v_lshlrev_b32 v8, 16, v35
v_and_b32 v9, 0xffff0000, v35
v_fmac_f32 v54, v8, v68
v_fmac_f32 v55, v9, v68
s_waitcnt vmcnt(18)
v_lshlrev_b32 v8, 16, v36
v_and_b32 v9, 0xffff0000, v36
v_fmac_f32 v48, v8, v69
v_fmac_f32 v49, v9, v69
v_lshlrev_b32 v8, 16, v37
v_and_b32 v9, 0xffff0000, v37
v_fmac_f32 v50, v8, v69
v_fmac_f32 v51, v9, v69
v_lshlrev_b32 v8, 16, v38
v_and_b32 v9, 0xffff0000, v38
v_fmac_f32 v52, v8, v69
v_fmac_f32 v53, v9, v69
v_lshlrev_b32 v8, 16, v39
v_and_b32 v9, 0xffff0000, v39
v_fmac_f32 v54, v8, v69
v_fmac_f32 v55, v9, v69
s_waitcnt vmcnt(17)
v_lshlrev_b32 v8, 16, v40
v_and_b32 v9, 0xffff0000, v40
v_fmac_f32 v48, v8, v70
v_fmac_f32 v49, v9, v70
v_lshlrev_b32 v8, 16, v41
v_and_b32 v9, 0xffff0000, v41
v_fmac_f32 v50, v8, v70
v_fmac_f32 v51, v9, v70
v_lshlrev_b32 v8, 16, v42
v_and_b32 v9, 0xffff0000, v42
v_fmac_f32 v52, v8, v70
v_fmac_f32 v53, v9, v70
v_lshlrev_b32 v8, 16, v43
v_and_b32 v9, 0xffff0000, v43
v_fmac_f32 v54, v8, v70
v_fmac_f32 v55, v9, v70
s_waitcnt vmcnt(16)
v_lshlrev_b32 v8, 16, v44
v_and_b32 v9, 0xffff0000, v44
v_fmac_f32 v48, v8, v71
v_fmac_f32 v49, v9, v71
v_lshlrev_b32 v8, 16, v45
v_and_b32 v9, 0xffff0000, v45
v_fmac_f32 v50, v8, v71
v_fmac_f32 v51, v9, v71
v_lshlrev_b32 v8, 16, v46
v_and_b32 v9, 0xffff0000, v46
v_fmac_f32 v52, v8, v71
v_fmac_f32 v53, v9, v71
v_lshlrev_b32 v8, 16, v47
v_and_b32 v9, 0xffff0000, v47
v_fmac_f32 v54, v8, v71
v_fmac_f32 v55, v9, v71
adaLN_cond__mha_block_cached__glu_gated_bilinear__prompt_kernel_fa1:
s_waitcnt vmcnt(12)
v_lshlrev_b32 v64, 16, v64
v_lshlrev_b32 v65, 16, v65
v_lshlrev_b32 v66, 16, v66
v_lshlrev_b32 v67, 16, v67
v_mul_f32 v72, s50, v64
v_mul_f32 v73, s50, v65
v_mul_f32 v74, s50, v66
v_mul_f32 v75, s50, v67
v_exp_f32 v72, v72
v_exp_f32 v73, v73
v_exp_f32 v74, v74
v_exp_f32 v75, v75
s_nop 0
v_add_f32 v72, 1.0, v72
v_add_f32 v73, 1.0, v73
v_add_f32 v74, 1.0, v74
v_add_f32 v75, 1.0, v75
v_rcp_f32 v72, v72
v_rcp_f32 v73, v73
v_rcp_f32 v74, v74
v_rcp_f32 v75, v75
s_nop 0
v_mul_f32 v64, v64, v72
v_mul_f32 v65, v65, v73
v_mul_f32 v66, v66, v74
v_mul_f32 v67, v67, v75
v_cvt_pk_bf16_f32 v64, v64, v64
v_and_b32 v64, 0xffff0000, v64
v_cvt_pk_bf16_f32 v65, v65, v65
v_and_b32 v65, 0xffff0000, v65
v_cvt_pk_bf16_f32 v66, v66, v66
v_and_b32 v66, 0xffff0000, v66
v_cvt_pk_bf16_f32 v67, v67, v67
v_and_b32 v67, 0xffff0000, v67
s_waitcnt vmcnt(11)
v_lshlrev_b32 v8, 16, v16
v_and_b32 v9, 0xffff0000, v16
v_fmac_f32 v48, v8, v64
v_fmac_f32 v49, v9, v64
v_lshlrev_b32 v8, 16, v17
v_and_b32 v9, 0xffff0000, v17
v_fmac_f32 v50, v8, v64
v_fmac_f32 v51, v9, v64
v_lshlrev_b32 v8, 16, v18
v_and_b32 v9, 0xffff0000, v18
v_fmac_f32 v52, v8, v64
v_fmac_f32 v53, v9, v64
v_lshlrev_b32 v8, 16, v19
v_and_b32 v9, 0xffff0000, v19
v_fmac_f32 v54, v8, v64
v_fmac_f32 v55, v9, v64
s_waitcnt vmcnt(10)
v_lshlrev_b32 v8, 16, v20
v_and_b32 v9, 0xffff0000, v20
v_fmac_f32 v48, v8, v65
v_fmac_f32 v49, v9, v65
v_lshlrev_b32 v8, 16, v21
v_and_b32 v9, 0xffff0000, v21
v_fmac_f32 v50, v8, v65
v_fmac_f32 v51, v9, v65
v_lshlrev_b32 v8, 16, v22
v_and_b32 v9, 0xffff0000, v22
v_fmac_f32 v52, v8, v65
v_fmac_f32 v53, v9, v65
v_lshlrev_b32 v8, 16, v23
v_and_b32 v9, 0xffff0000, v23
v_fmac_f32 v54, v8, v65
v_fmac_f32 v55, v9, v65
s_waitcnt vmcnt(9)
v_lshlrev_b32 v8, 16, v24
v_and_b32 v9, 0xffff0000, v24
v_fmac_f32 v48, v8, v66
v_fmac_f32 v49, v9, v66
v_lshlrev_b32 v8, 16, v25
v_and_b32 v9, 0xffff0000, v25
v_fmac_f32 v50, v8, v66
v_fmac_f32 v51, v9, v66
v_lshlrev_b32 v8, 16, v26
v_and_b32 v9, 0xffff0000, v26
v_fmac_f32 v52, v8, v66
v_fmac_f32 v53, v9, v66
v_lshlrev_b32 v8, 16, v27
v_and_b32 v9, 0xffff0000, v27
v_fmac_f32 v54, v8, v66
v_fmac_f32 v55, v9, v66
s_waitcnt vmcnt(8)
v_mov_b32 v82, 0
buffer_load_dword v81, v82, s[60:63], 0 offen sc1
v_lshlrev_b32 v8, 16, v28
v_and_b32 v9, 0xffff0000, v28
v_fmac_f32 v48, v8, v67
v_fmac_f32 v49, v9, v67
v_lshlrev_b32 v8, 16, v29
v_and_b32 v9, 0xffff0000, v29
v_fmac_f32 v50, v8, v67
v_fmac_f32 v51, v9, v67
v_lshlrev_b32 v8, 16, v30
v_and_b32 v9, 0xffff0000, v30
v_fmac_f32 v52, v8, v67
v_fmac_f32 v53, v9, v67
v_lshlrev_b32 v8, 16, v31
v_and_b32 v9, 0xffff0000, v31
v_fmac_f32 v54, v8, v67
v_fmac_f32 v55, v9, v67
s_nop 1
v_permlane32_swap_b32 v48, v52
v_permlane32_swap_b32 v49, v53
v_permlane32_swap_b32 v50, v54
v_permlane32_swap_b32 v51, v55
v_add_f32 v48, v48, v52
v_add_f32 v49, v49, v53
v_add_f32 v50, v50, v54
v_add_f32 v51, v51, v55
s_nop 0
v_permlane16_swap_b32 v48, v50
v_permlane16_swap_b32 v49, v51
v_add_f32 v48, v48, v50
v_add_f32 v49, v49, v51
s_nop 1
v_add_f32_dpp v48, v48, v48 row_ror:4 row_mask:0xf bank_mask:0xf
v_add_f32_dpp v49, v49, v49 row_ror:4 row_mask:0xf bank_mask:0xf
s_nop 1
v_add_f32_dpp v48, v48, v48 row_ror:8 row_mask:0xf bank_mask:0xf
v_add_f32_dpp v49, v49, v49 row_ror:8 row_mask:0xf bank_mask:0xf
ds_write_b64 v12, v[48:49]
v_and_b32 v5, 31, v2
v_lshlrev_b32 v5, 2, v5
s_waitcnt lgkmcnt(0)
s_barrier
s_cmp_eq_u32 s28, 0
s_cbranch_scc1 adaLN_cond__mha_block_cached__glu_gated_bilinear__prompt_kernel_fm2
s_lshl_b32 s46, s44, 19
s_add_u32 s8, s4, s46
s_addc_u32 s9, s5, 0
s_mov_b32 s10, 524288
s_mov_b32 s11, 0x20000
s_add_u32 s12, s6, s46
s_addc_u32 s13, s7, 0
s_mov_b32 s14, 524288
s_mov_b32 s15, 0x20000
s_mul_i32 s57, s28, 262144
s_mul_i32 s58, s28, 8192
s_add_u32 m0, s58, 49152
s_add_u32 s56, s57, 1048576
buffer_load_dwordx4 v0, s[16:19], s56 offen offset:0 nt lds
s_add_u32 s56, s57, 1080320
buffer_load_dwordx4 v0, s[16:19], s56 offen offset:1024 nt lds
s_add_u32 s56, s57, 1112064
buffer_load_dwordx4 v0, s[16:19], s56 offen offset:2048 nt lds
s_add_u32 s56, s57, 1143808
buffer_load_dwordx4 v0, s[16:19], s56 offen offset:3072 nt lds
s_add_u32 m0, s58, 53248
s_add_u32 s56, s57, 1179648
buffer_load_dwordx4 v0, s[16:19], s56 offen offset:0 nt lds
s_add_u32 s56, s57, 1211392
buffer_load_dwordx4 v0, s[16:19], s56 offen offset:1024 nt lds
s_add_u32 s56, s57, 1243136
buffer_load_dwordx4 v0, s[16:19], s56 offen offset:2048 nt lds
s_add_u32 s56, s57, 1274880
buffer_load_dwordx4 v0, s[16:19], s56 offen offset:3072 nt lds
s_mul_i32 s57, s28, 262144
s_mul_i32 s58, s28, 8192
s_add_u32 m0, s58, 81920
s_add_u32 s56, s57, 2097152
buffer_load_dwordx4 v0, s[16:19], s56 offen offset:0 nt lds
s_add_u32 s56, s57, 2128896
buffer_load_dwordx4 v0, s[16:19], s56 offen offset:1024 nt lds
s_add_u32 s56, s57, 2160640
buffer_load_dwordx4 v0, s[16:19], s56 offen offset:2048 nt lds
s_add_u32 s56, s57, 2192384
buffer_load_dwordx4 v0, s[16:19], s56 offen offset:3072 nt lds
s_add_u32 m0, s58, 86016
s_add_u32 s56, s57, 2228224
buffer_load_dwordx4 v0, s[16:19], s56 offen offset:0 nt lds
s_add_u32 s56, s57, 2259968
buffer_load_dwordx4 v0, s[16:19], s56 offen offset:1024 nt lds
s_add_u32 s56, s57, 2291712
buffer_load_dwordx4 v0, s[16:19], s56 offen offset:2048 nt lds
s_add_u32 s56, s57, 2323456
buffer_load_dwordx4 v0, s[16:19], s56 offen offset:3072 nt lds
s_mul_i32 s57, s28, 262144
s_mul_i32 s58, s28, 8192
s_add_u32 m0, s58, 114688
s_add_u32 s56, s57, 3145728
buffer_load_dwordx4 v0, s[16:19], s56 offen offset:0 nt lds
s_add_u32 s56, s57, 3177472
buffer_load_dwordx4 v0, s[16:19], s56 offen offset:1024 nt lds
s_add_u32 s56, s57, 3209216
buffer_load_dwordx4 v0, s[16:19], s56 offen offset:2048 nt lds
s_add_u32 s56, s57, 3240960
buffer_load_dwordx4 v0, s[16:19], s56 offen offset:3072 nt lds
s_add_u32 m0, s58, 118784
s_add_u32 s56, s57, 3276800
buffer_load_dwordx4 v0, s[16:19], s56 offen offset:0 nt lds
s_add_u32 s56, s57, 3308544
buffer_load_dwordx4 v0, s[16:19], s56 offen offset:1024 nt lds
s_add_u32 s56, s57, 3340288
buffer_load_dwordx4 v0, s[16:19], s56 offen offset:2048 nt lds
s_add_u32 s56, s57, 3372032
buffer_load_dwordx4 v0, s[16:19], s56 offen offset:3072 nt lds
s_lshl_b32 s46, s28, 12
s_mov_b32 m0, s46
s_nop 0
buffer_load_dwordx4 v156, s[8:11], s46 offen offset:0 nt lds
buffer_load_dwordx4 v157, s[8:11], s46 offen offset:1024 nt lds
buffer_load_dwordx4 v158, s[8:11], s46 offen offset:2048 nt lds
buffer_load_dwordx4 v159, s[8:11], s46 offen offset:3072 nt lds
adaLN_cond__mha_block_cached__glu_gated_bilinear__prompt_kernel_fw2:
s_mov_b32 s53, 0
s_waitcnt vmcnt(0)
s_branch adaLN_cond__mha_block_cached__glu_gated_bilinear__prompt_kernel_fu1
adaLN_cond__mha_block_cached__glu_gated_bilinear__prompt_kernel_ft1:
s_waitcnt vmcnt(0)
adaLN_cond__mha_block_cached__glu_gated_bilinear__prompt_kernel_fu1:
v_readfirstlane_b32 s39, v81
s_add_u32 s53, s53, 1
s_cmp_gt_u32 s53, 200000
s_cbranch_scc1 adaLN_cond__mha_block_cached__glu_gated_bilinear__prompt_kernel_ftd1
s_nop 1
s_cmp_lg_u32 s39, 0
s_cbranch_scc1 adaLN_cond__mha_block_cached__glu_gated_bilinear__prompt_kernel_ftd1
buffer_load_dword v81, v82, s[60:63], 0 offen sc1
s_branch adaLN_cond__mha_block_cached__glu_gated_bilinear__prompt_kernel_ft1
adaLN_cond__mha_block_cached__glu_gated_bilinear__prompt_kernel_ftd1:
s_branch adaLN_cond__mha_block_cached__glu_gated_bilinear__prompt_kernel_fj1
adaLN_cond__mha_block_cached__glu_gated_bilinear__prompt_kernel_fm2:
v_add_u32 v8, 155648, v5
ds_read_b32 v16, v8 offset:0
ds_read_b32 v17, v8 offset:128
ds_read_b32 v18, v8 offset:256
ds_read_b32 v19, v8 offset:384
s_mov_b32 s52, s42
s_mov_b32 s53, s43
s_mov_b32 s54, 65536
s_mov_b32 s55, 0x20000
s_lshl_b32 s50, s47, 7
v_add_u32 v5, s50, v5
s_lshr_b32 s51, s2, 5
s_lshl_b32 s51, s51, 12
s_add_u32 s51, s51, 24576
s_waitcnt lgkmcnt(0)
v_add_f32 v16, v16, v17
v_add_f32 v18, v18, v19
v_add_f32 v16, v16, v18
s_cmp_lt_u32 s2, 64
s_cbranch_scc1 adaLN_cond__mha_block_cached__glu_gated_bilinear__prompt_kernel_fa2
s_lshr_b32 s50, s47, 4
s_cmp_eq_u32 s50, 4
s_cselect_b32 s50, 1.0, 0
s_mov_b32 s51, 0
v_cvt_pk_bf16_f32 v16, v16, v16
v_and_b32 v16, 0xffff0000, v16
v_add_f32 v16, s50, v16
v_cvt_pk_bf16_f32 v16, v16, v16
v_and_b32 v16, 0xffff0000, v16
adaLN_cond__mha_block_cached__glu_gated_bilinear__prompt_kernel_fa2:
s_mov_b32 exec_hi, 0
buffer_store_dword v16, v5, s[52:55], s51 offen sc1
s_mov_b64 exec, -1
s_mov_b32 s53, 0
s_waitcnt vmcnt(0)
s_branch adaLN_cond__mha_block_cached__glu_gated_bilinear__prompt_kernel_fu2
adaLN_cond__mha_block_cached__glu_gated_bilinear__prompt_kernel_ft2:
s_waitcnt vmcnt(0)
adaLN_cond__mha_block_cached__glu_gated_bilinear__prompt_kernel_fu2:
v_readfirstlane_b32 s39, v81
s_add_u32 s53, s53, 1
s_cmp_gt_u32 s53, 200000
s_cbranch_scc1 adaLN_cond__mha_block_cached__glu_gated_bilinear__prompt_kernel_ftd2
s_nop 1
s_cmp_lg_u32 s39, 0
s_cbranch_scc1 adaLN_cond__mha_block_cached__glu_gated_bilinear__prompt_kernel_ftd2
buffer_load_dword v81, v82, s[60:63], 0 offen sc1
s_branch adaLN_cond__mha_block_cached__glu_gated_bilinear__prompt_kernel_ft2
adaLN_cond__mha_block_cached__glu_gated_bilinear__prompt_kernel_ftd2:
s_add_u32 s52, s42, 131072
s_addc_u32 s53, s43, 0
s_mov_b32 s54, 16384
s_mov_b32 s55, 0x20000
s_lshl_b32 s50, s2, 6
s_mov_b64 exec, 1
v_mov_b32 v5, s50
v_mov_b32 v9, s39
buffer_store_dword v9, v5, s[52:55], 0 offen sc1
s_mov_b64 exec, -1
s_lshl_b32 s46, s44, 19
s_add_u32 s8, s4, s46
s_addc_u32 s9, s5, 0
s_mov_b32 s10, 524288
s_mov_b32 s11, 0x20000
s_add_u32 s12, s6, s46
s_addc_u32 s13, s7, 0
s_mov_b32 s14, 524288
s_mov_b32 s15, 0x20000
s_mul_i32 s57, s28, 262144
s_mul_i32 s58, s28, 8192
s_add_u32 m0, s58, 49152
s_add_u32 s56, s57, 1048576
buffer_load_dwordx4 v0, s[16:19], s56 offen offset:0 nt lds
s_add_u32 s56, s57, 1080320
buffer_load_dwordx4 v0, s[16:19], s56 offen offset:1024 nt lds
s_add_u32 s56, s57, 1112064
buffer_load_dwordx4 v0, s[16:19], s56 offen offset:2048 nt lds
s_add_u32 s56, s57, 1143808
buffer_load_dwordx4 v0, s[16:19], s56 offen offset:3072 nt lds
s_add_u32 m0, s58, 53248
s_add_u32 s56, s57, 1179648
buffer_load_dwordx4 v0, s[16:19], s56 offen offset:0 nt lds
s_add_u32 s56, s57, 1211392
buffer_load_dwordx4 v0, s[16:19], s56 offen offset:1024 nt lds
s_add_u32 s56, s57, 1243136
buffer_load_dwordx4 v0, s[16:19], s56 offen offset:2048 nt lds
s_add_u32 s56, s57, 1274880
buffer_load_dwordx4 v0, s[16:19], s56 offen offset:3072 nt lds
s_mul_i32 s57, s28, 262144
s_mul_i32 s58, s28, 8192
s_add_u32 m0, s58, 81920
s_add_u32 s56, s57, 2097152
buffer_load_dwordx4 v0, s[16:19], s56 offen offset:0 nt lds
s_add_u32 s56, s57, 2128896
buffer_load_dwordx4 v0, s[16:19], s56 offen offset:1024 nt lds
s_add_u32 s56, s57, 2160640
buffer_load_dwordx4 v0, s[16:19], s56 offen offset:2048 nt lds
s_add_u32 s56, s57, 2192384
buffer_load_dwordx4 v0, s[16:19], s56 offen offset:3072 nt lds
s_add_u32 m0, s58, 86016
s_add_u32 s56, s57, 2228224
buffer_load_dwordx4 v0, s[16:19], s56 offen offset:0 nt lds
s_add_u32 s56, s57, 2259968
buffer_load_dwordx4 v0, s[16:19], s56 offen offset:1024 nt lds
s_add_u32 s56, s57, 2291712
buffer_load_dwordx4 v0, s[16:19], s56 offen offset:2048 nt lds
s_add_u32 s56, s57, 2323456
buffer_load_dwordx4 v0, s[16:19], s56 offen offset:3072 nt lds
s_mul_i32 s57, s28, 262144
s_mul_i32 s58, s28, 8192
s_add_u32 m0, s58, 114688
s_add_u32 s56, s57, 3145728
buffer_load_dwordx4 v0, s[16:19], s56 offen offset:0 nt lds
s_add_u32 s56, s57, 3177472
buffer_load_dwordx4 v0, s[16:19], s56 offen offset:1024 nt lds
s_add_u32 s56, s57, 3209216
buffer_load_dwordx4 v0, s[16:19], s56 offen offset:2048 nt lds
s_add_u32 s56, s57, 3240960
buffer_load_dwordx4 v0, s[16:19], s56 offen offset:3072 nt lds
s_add_u32 m0, s58, 118784
s_add_u32 s56, s57, 3276800
buffer_load_dwordx4 v0, s[16:19], s56 offen offset:0 nt lds
s_add_u32 s56, s57, 3308544
buffer_load_dwordx4 v0, s[16:19], s56 offen offset:1024 nt lds
s_add_u32 s56, s57, 3340288
buffer_load_dwordx4 v0, s[16:19], s56 offen offset:2048 nt lds
s_add_u32 s56, s57, 3372032
buffer_load_dwordx4 v0, s[16:19], s56 offen offset:3072 nt lds
s_lshl_b32 s46, s28, 12
s_mov_b32 m0, s46
s_nop 0
buffer_load_dwordx4 v156, s[8:11], s46 offen offset:0 nt lds
buffer_load_dwordx4 v157, s[8:11], s46 offen offset:1024 nt lds
buffer_load_dwordx4 v158, s[8:11], s46 offen offset:2048 nt lds
buffer_load_dwordx4 v159, s[8:11], s46 offen offset:3072 nt lds
adaLN_cond__mha_block_cached__glu_gated_bilinear__prompt_kernel_fw3:
adaLN_cond__mha_block_cached__glu_gated_bilinear__prompt_kernel_fj1:
s_lshr_b32 s50, s45, 2
s_and_b32 s51, s50, 3
s_lshl_b32 s51, s51, 1
s_lshr_b32 s50, s50, 2
s_add_u32 s50, s50, s51
s_add_u32 s50, s50, 128
v_lshlrev_b32 v8, 3, v3
v_add_u32 v8, s50, v8
v_lshlrev_b32 v8, 6, v8
v_lshlrev_b32 v10, 6, v2
s_add_u32 s52, s42, 131072
s_addc_u32 s53, s43, 0
s_mov_b32 s54, 16384
s_mov_b32 s55, 0x20000
s_add_u32 s24, s42, 24576
s_addc_u32 s25, s43, 0
s_mov_b32 s26, 8192
s_mov_b32 s27, 0x20000
s_cmp_lg_u32 s28, 3
s_cbranch_scc1 adaLN_cond__mha_block_cached__glu_gated_bilinear__prompt_kernel_pd4
s_mov_b32 s50, 0
adaLN_cond__mha_block_cached__glu_gated_bilinear__prompt_kernel_pl4:
buffer_load_dword v5, v8, s[52:55], 0 offen sc1
buffer_load_dword v9, v10, s[52:55], 0 offen sc1
s_add_u32 s50, s50, 1
s_waitcnt vmcnt(0)
v_cmp_eq_u32 vcc, s39, v5
v_cmp_eq_u32 s[56:57], s39, v9
s_cmp_gt_u32 s50, 200000
s_cbranch_scc1 adaLN_cond__mha_block_cached__glu_gated_bilinear__prompt_kernel_pd4
s_and_b64 vcc, vcc, s[56:57]
s_cmp_eq_u64 vcc, -1
s_cbranch_scc1 adaLN_cond__mha_block_cached__glu_gated_bilinear__prompt_kernel_pd4
s_branch adaLN_cond__mha_block_cached__glu_gated_bilinear__prompt_kernel_pl4
adaLN_cond__mha_block_cached__glu_gated_bilinear__prompt_kernel_pd4:
s_waitcnt vmcnt(28)
s_barrier
s_add_u32 s50, s49, 0
buffer_load_dwordx4 v[16:19], v14, s[24:27], s50 offen sc1
s_add_u32 s50, s49, 4096
buffer_load_dwordx4 v[20:23], v14, s[24:27], s50 offen sc1
s_mov_b32 s51, 0
buffer_load_dwordx4 v[176:179], v14, s[20:23], s51 offen offset:0 sc1
s_mov_b32 s51, 32768
buffer_load_dwordx4 v[180:183], v14, s[20:23], s51 offen offset:0 sc1
s_mov_b32 s51, 0
buffer_load_dwordx4 v[184:187], v14, s[20:23], s51 offen offset:1024 sc1
s_mov_b32 s51, 32768
buffer_load_dwordx4 v[188:191], v14, s[20:23], s51 offen offset:1024 sc1
s_mov_b32 s51, 0
buffer_load_dwordx4 v[192:195], v14, s[20:23], s51 offen offset:2048 sc1
s_mov_b32 s51, 32768
buffer_load_dwordx4 v[196:199], v14, s[20:23], s51 offen offset:2048 sc1
s_mov_b32 s51, 0
buffer_load_dwordx4 v[200:203], v14, s[20:23], s51 offen offset:3072 sc1
s_mov_b32 s51, 32768
buffer_load_dwordx4 v[204:207], v14, s[20:23], s51 offen offset:3072 sc1
s_mov_b32 s51, 4096
buffer_load_dwordx4 v[208:211], v14, s[20:23], s51 offen offset:0 sc1
s_mov_b32 s51, 36864
buffer_load_dwordx4 v[212:215], v14, s[20:23], s51 offen offset:0 sc1
s_mov_b32 s51, 4096
buffer_load_dwordx4 v[216:219], v14, s[20:23], s51 offen offset:1024 sc1
s_mov_b32 s51, 36864
buffer_load_dwordx4 v[220:223], v14, s[20:23], s51 offen offset:1024 sc1
s_lshl_b32 s46, s44, 19
s_add_u32 s8, s4, s46
s_addc_u32 s9, s5, 0
s_mov_b32 s10, 524288
s_mov_b32 s11, 0x20000
s_add_u32 s12, s6, s46
s_addc_u32 s13, s7, 0
s_mov_b32 s14, 524288
s_mov_b32 s15, 0x20000
s_waitcnt vmcnt(12)
s_cmp_ge_u32 s28, 2
s_cselect_b32 s50, 1.0, 0
s_xor_b32 s51, s49, 2048
s_add_u32 s51, s51, 147456
v_add_u32 v5, s51, v14
v_add_f32 v16, v16, v20
v_add_f32 v17, v17, v21
v_add_f32 v18, v18, v22
v_add_f32 v19, v19, v23
v_cvt_pk_bf16_f32 v16, v16, v16
v_and_b32 v16, 0xffff0000, v16
v_cvt_pk_bf16_f32 v17, v17, v17
v_and_b32 v17, 0xffff0000, v17
v_cvt_pk_bf16_f32 v18, v18, v18
v_and_b32 v18, 0xffff0000, v18
v_cvt_pk_bf16_f32 v19, v19, v19
v_and_b32 v19, 0xffff0000, v19
v_add_f32 v16, s50, v16
v_add_f32 v17, s50, v17
v_add_f32 v18, s50, v18
v_add_f32 v19, s50, v19
v_cvt_pk_bf16_f32 v16, v16, v16
v_and_b32 v16, 0xffff0000, v16
v_cvt_pk_bf16_f32 v17, v17, v17
v_and_b32 v17, 0xffff0000, v17
v_cvt_pk_bf16_f32 v18, v18, v18
v_and_b32 v18, 0xffff0000, v18
v_cvt_pk_bf16_f32 v19, v19, v19
v_and_b32 v19, 0xffff0000, v19
v_mul_f32 v16, 0x3e0293ee, v16
v_mul_f32 v17, 0x3e0293ee, v17
v_mul_f32 v18, 0x3e0293ee, v18
v_mul_f32 v19, 0x3e0293ee, v19
ds_write_b128 v5, v[16:19]
s_waitcnt lgkmcnt(0)
s_barrier
ds_read_b128 v[144:147], v15 offset:0
ds_read_b128 v[148:151], v15 offset:2048
ds_read_b128 v[152:155], v15 offset:16
ds_read_b128 v[160:163], v15 offset:2064
ds_read_b128 v[164:167], v15 offset:64
ds_read_b128 v[168:171], v15 offset:2112
ds_read_b64_tr_b16 a[192:193], v172 offset:0
ds_read_b64_tr_b16 a[194:195], v172 offset:1024
ds_read_b64_tr_b16 a[196:197], v173 offset:0
ds_read_b64_tr_b16 a[198:199], v173 offset:1024
ds_read_b64_tr_b16 a[200:201], v174 offset:0
ds_read_b64_tr_b16 a[202:203], v174 offset:1024
ds_read_b64_tr_b16 a[204:205], v175 offset:0
ds_read_b64_tr_b16 a[206:207], v175 offset:1024
ds_read_b64_tr_b16 a[208:209], v172 offset:4096
ds_read_b64_tr_b16 a[210:211], v172 offset:5120
ds_read_b64_tr_b16 a[212:213], v173 offset:4096
ds_read_b64_tr_b16 a[214:215], v173 offset:5120
s_waitcnt vmcnt(10)
s_waitcnt lgkmcnt(15)
v_fma_mix_f32 v8, v176, v144, v148 op_sel_hi:[1,0,0]
v_fma_mix_f32 v9, v176, v145, v149 op_sel:[1,0,0] op_sel_hi:[1,0,0]
v_cvt_pk_bf16_f32 v176, v8, v9
v_fma_mix_f32 v10, v177, v146, v150 op_sel_hi:[1,0,0]
v_fma_mix_f32 v11, v177, v147, v151 op_sel:[1,0,0] op_sel_hi:[1,0,0]
v_cvt_pk_bf16_f32 v177, v10, v11
v_fma_mix_f32 v12, v180, v144, v148 op_sel_hi:[1,0,0]
v_fma_mix_f32 v13, v180, v145, v149 op_sel:[1,0,0] op_sel_hi:[1,0,0]
v_cvt_pk_bf16_f32 v180, v12, v13
v_fma_mix_f32 v8, v181, v146, v150 op_sel_hi:[1,0,0]
v_fma_mix_f32 v9, v181, v147, v151 op_sel:[1,0,0] op_sel_hi:[1,0,0]
v_cvt_pk_bf16_f32 v181, v8, v9
ds_read_b128 v[144:147], v15 offset:80
ds_read_b128 v[148:151], v15 offset:2128
s_waitcnt lgkmcnt(15)
v_fma_mix_f32 v10, v178, v152, v160 op_sel_hi:[1,0,0]
v_fma_mix_f32 v11, v178, v153, v161 op_sel:[1,0,0] op_sel_hi:[1,0,0]
v_cvt_pk_bf16_f32 v178, v10, v11
v_fma_mix_f32 v12, v179, v154, v162 op_sel_hi:[1,0,0]
v_fma_mix_f32 v13, v179, v155, v163 op_sel:[1,0,0] op_sel_hi:[1,0,0]
v_cvt_pk_bf16_f32 v179, v12, v13
v_fma_mix_f32 v8, v182, v152, v160 op_sel_hi:[1,0,0]
v_fma_mix_f32 v9, v182, v153, v161 op_sel:[1,0,0] op_sel_hi:[1,0,0]
v_cvt_pk_bf16_f32 v182, v8, v9
v_fma_mix_f32 v10, v183, v154, v162 op_sel_hi:[1,0,0]
v_fma_mix_f32 v11, v183, v155, v163 op_sel:[1,0,0] op_sel_hi:[1,0,0]
v_cvt_pk_bf16_f32 v183, v10, v11
s_nop 1
s_waitcnt lgkmcnt(12)
v_mfma_f32_32x32x16_bf16 v[16:31], a[192:195], v[176:179], 0
s_mov_b32 s51, 4096
ds_read_b64_tr_b16 a[216:217], v174 offset:4096
ds_read_b128 v[152:155], v15 offset:128
buffer_load_dwordx4 v[224:227], v14, s[20:23], s51 offen offset:2048 sc1
s_waitcnt vmcnt(9)
v_fma_mix_f32 v12, v184, v164, v168 op_sel_hi:[1,0,0]
v_fma_mix_f32 v13, v184, v165, v169 op_sel:[1,0,0] op_sel_hi:[1,0,0]
v_cvt_pk_bf16_f32 v184, v12, v13
v_mfma_f32_32x32x16_bf16 v[80:95], a[192:195], v[180:183], 0
s_waitcnt lgkmcnt(12)
s_mov_b32 s51, 36864
ds_read_b64_tr_b16 a[218:219], v174 offset:5120
ds_read_b128 v[160:163], v15 offset:2176
v_fma_mix_f32 v8, v185, v166, v170 op_sel_hi:[1,0,0]
v_fma_mix_f32 v9, v185, v167, v171 op_sel:[1,0,0] op_sel_hi:[1,0,0]
v_cvt_pk_bf16_f32 v185, v8, v9
v_mfma_f32_32x32x16_bf16 v[32:47], a[196:199], v[176:179], 0
ds_read_b64_tr_b16 a[220:221], v175 offset:4096
buffer_load_dwordx4 v[228:231], v14, s[20:23], s51 offen offset:2048 sc1
v_fma_mix_f32 v10, v188, v164, v168 op_sel_hi:[1,0,0]
v_fma_mix_f32 v11, v188, v165, v169 op_sel:[1,0,0] op_sel_hi:[1,0,0]
v_cvt_pk_bf16_f32 v188, v10, v11
v_mfma_f32_32x32x16_bf16 v[96:111], a[196:199], v[180:183], 0
s_waitcnt lgkmcnt(5)
s_mov_b32 s51, 4096
ds_read_b64_tr_b16 a[222:223], v175 offset:5120
v_fma_mix_f32 v12, v189, v166, v170 op_sel_hi:[1,0,0]
v_fma_mix_f32 v13, v189, v167, v171 op_sel:[1,0,0] op_sel_hi:[1,0,0]
v_cvt_pk_bf16_f32 v189, v12, v13
v_mfma_f32_32x32x16_bf16 v[48:63], a[200:203], v[176:179], 0
ds_read_b64_tr_b16 a[224:225], v172 offset:8192
ds_read_b128 v[164:167], v15 offset:144
buffer_load_dwordx4 v[232:235], v14, s[20:23], s51 offen offset:3072 sc1
v_fma_mix_f32 v8, v186, v144, v148 op_sel_hi:[1,0,0]
v_fma_mix_f32 v9, v186, v145, v149 op_sel:[1,0,0] op_sel_hi:[1,0,0]
v_cvt_pk_bf16_f32 v186, v8, v9
v_fma_mix_f32 v10, v187, v146, v150 op_sel_hi:[1,0,0]
v_mfma_f32_32x32x16_bf16 v[112:127], a[200:203], v[180:183], 0
s_mov_b32 s51, 36864
ds_read_b64_tr_b16 a[226:227], v172 offset:9216
ds_read_b128 v[168:171], v15 offset:2192
v_fma_mix_f32 v11, v187, v147, v151 op_sel:[1,0,0] op_sel_hi:[1,0,0]
v_cvt_pk_bf16_f32 v187, v10, v11
v_fma_mix_f32 v12, v190, v144, v148 op_sel_hi:[1,0,0]
v_fma_mix_f32 v13, v190, v145, v149 op_sel:[1,0,0] op_sel_hi:[1,0,0]
v_mfma_f32_32x32x16_bf16 v[64:79], a[204:207], v[176:179], 0
ds_read_b64_tr_b16 a[228:229], v173 offset:8192
buffer_load_dwordx4 v[236:239], v14, s[20:23], s51 offen offset:3072 sc1
v_cvt_pk_bf16_f32 v190, v12, v13
v_fma_mix_f32 v8, v191, v146, v150 op_sel_hi:[1,0,0]
v_fma_mix_f32 v9, v191, v147, v151 op_sel:[1,0,0] op_sel_hi:[1,0,0]
v_cvt_pk_bf16_f32 v191, v8, v9
v_mfma_f32_32x32x16_bf16 v[128:143], a[204:207], v[180:183], 0
ds_read_b64_tr_b16 a[230:231], v173 offset:9216
v_mfma_f32_32x32x16_bf16 v[16:31], a[208:211], v[184:187], v[16:31]
ds_read_b64_tr_b16 a[232:233], v174 offset:8192
ds_read_b128 v[144:147], v15 offset:192
s_waitcnt vmcnt(10)
s_waitcnt lgkmcnt(6)
v_fma_mix_f32 v10, v192, v152, v160 op_sel_hi:[1,0,0]
v_fma_mix_f32 v11, v192, v153, v161 op_sel:[1,0,0] op_sel_hi:[1,0,0]
v_cvt_pk_bf16_f32 v192, v10, v11
v_mfma_f32_32x32x16_bf16 v[80:95], a[208:211], v[188:191], v[80:95]
ds_read_b64_tr_b16 a[234:235], v174 offset:9216
ds_read_b128 v[148:151], v15 offset:2240
v_fma_mix_f32 v12, v193, v154, v162 op_sel_hi:[1,0,0]
v_fma_mix_f32 v13, v193, v155, v163 op_sel:[1,0,0] op_sel_hi:[1,0,0]
v_cvt_pk_bf16_f32 v193, v12, v13
v_mfma_f32_32x32x16_bf16 v[32:47], a[212:215], v[184:187], v[32:47]
ds_read_b64_tr_b16 a[236:237], v175 offset:8192
v_fma_mix_f32 v8, v196, v152, v160 op_sel_hi:[1,0,0]
v_fma_mix_f32 v9, v196, v153, v161 op_sel:[1,0,0] op_sel_hi:[1,0,0]
v_cvt_pk_bf16_f32 v196, v8, v9
v_mfma_f32_32x32x16_bf16 v[96:111], a[212:215], v[188:191], v[96:111]
ds_read_b64_tr_b16 a[238:239], v175 offset:9216
v_fma_mix_f32 v10, v197, v154, v162 op_sel_hi:[1,0,0]
v_fma_mix_f32 v11, v197, v155, v163 op_sel:[1,0,0] op_sel_hi:[1,0,0]
v_cvt_pk_bf16_f32 v197, v10, v11
v_mfma_f32_32x32x16_bf16 v[48:63], a[216:219], v[184:187], v[48:63]
ds_read_b64_tr_b16 a[240:241], v172 offset:12288
ds_read_b128 v[152:155], v15 offset:208
s_waitcnt lgkmcnt(6)
v_fma_mix_f32 v12, v194, v164, v168 op_sel_hi:[1,0,0]
v_fma_mix_f32 v13, v194, v165, v169 op_sel:[1,0,0] op_sel_hi:[1,0,0]
v_cvt_pk_bf16_f32 v194, v12, v13
v_fma_mix_f32 v8, v195, v166, v170 op_sel_hi:[1,0,0]
v_mfma_f32_32x32x16_bf16 v[112:127], a[216:219], v[188:191], v[112:127]
ds_read_b64_tr_b16 a[242:243], v172 offset:13312
ds_read_b128 v[160:163], v15 offset:2256
v_fma_mix_f32 v9, v195, v167, v171 op_sel:[1,0,0] op_sel_hi:[1,0,0]
v_cvt_pk_bf16_f32 v195, v8, v9
v_fma_mix_f32 v10, v198, v164, v168 op_sel_hi:[1,0,0]
v_fma_mix_f32 v11, v198, v165, v169 op_sel:[1,0,0] op_sel_hi:[1,0,0]
v_mfma_f32_32x32x16_bf16 v[64:79], a[220:223], v[184:187], v[64:79]
ds_read_b64_tr_b16 a[244:245], v173 offset:12288
v_cvt_pk_bf16_f32 v198, v10, v11
v_fma_mix_f32 v12, v199, v166, v170 op_sel_hi:[1,0,0]
v_fma_mix_f32 v13, v199, v167, v171 op_sel:[1,0,0] op_sel_hi:[1,0,0]
v_cvt_pk_bf16_f32 v199, v12, v13
v_mfma_f32_32x32x16_bf16 v[128:143], a[220:223], v[188:191], v[128:143]
ds_read_b64_tr_b16 a[246:247], v173 offset:13312
v_mfma_f32_32x32x16_bf16 v[16:31], a[224:227], v[192:195], v[16:31]
s_mov_b32 s51, 8192
ds_read_b64_tr_b16 a[248:249], v174 offset:12288
ds_read_b128 v[164:167], v15 offset:256
buffer_load_dwordx4 v[240:243], v14, s[20:23], s51 offen offset:0 sc1
s_waitcnt vmcnt(9)
s_waitcnt lgkmcnt(6)
v_fma_mix_f32 v8, v200, v144, v148 op_sel_hi:[1,0,0]
v_fma_mix_f32 v9, v200, v145, v149 op_sel:[1,0,0] op_sel_hi:[1,0,0]
v_cvt_pk_bf16_f32 v200, v8, v9
v_mfma_f32_32x32x16_bf16 v[80:95], a[224:227], v[196:199], v[80:95]
s_mov_b32 s51, 40960
ds_read_b64_tr_b16 a[250:251], v174 offset:13312
ds_read_b128 v[168:171], v15 offset:2304
v_fma_mix_f32 v10, v201, v146, v150 op_sel_hi:[1,0,0]
v_fma_mix_f32 v11, v201, v147, v151 op_sel:[1,0,0] op_sel_hi:[1,0,0]
v_cvt_pk_bf16_f32 v201, v10, v11
v_mfma_f32_32x32x16_bf16 v[32:47], a[228:231], v[192:195], v[32:47]
ds_read_b64_tr_b16 a[252:253], v175 offset:12288
buffer_load_dwordx4 v[244:247], v14, s[20:23], s51 offen offset:0 sc1
v_fma_mix_f32 v12, v204, v144, v148 op_sel_hi:[1,0,0]
v_fma_mix_f32 v13, v204, v145, v149 op_sel:[1,0,0] op_sel_hi:[1,0,0]
v_cvt_pk_bf16_f32 v204, v12, v13
v_mfma_f32_32x32x16_bf16 v[96:111], a[228:231], v[196:199], v[96:111]
s_mov_b32 s51, 8192
ds_read_b64_tr_b16 a[254:255], v175 offset:13312
v_fma_mix_f32 v8, v205, v146, v150 op_sel_hi:[1,0,0]
v_fma_mix_f32 v9, v205, v147, v151 op_sel:[1,0,0] op_sel_hi:[1,0,0]
v_cvt_pk_bf16_f32 v205, v8, v9
v_mfma_f32_32x32x16_bf16 v[48:63], a[232:235], v[192:195], v[48:63]
ds_read_b64_tr_b16 a[192:193], v172 offset:16384
ds_read_b128 v[144:147], v15 offset:272
buffer_load_dwordx4 v[248:251], v14, s[20:23], s51 offen offset:1024 sc1
s_waitcnt lgkmcnt(6)
v_fma_mix_f32 v10, v202, v152, v160 op_sel_hi:[1,0,0]
v_fma_mix_f32 v11, v202, v153, v161 op_sel:[1,0,0] op_sel_hi:[1,0,0]
v_cvt_pk_bf16_f32 v202, v10, v11
v_fma_mix_f32 v12, v203, v154, v162 op_sel_hi:[1,0,0]
v_mfma_f32_32x32x16_bf16 v[112:127], a[232:235], v[196:199], v[112:127]
s_mov_b32 s51, 40960
ds_read_b64_tr_b16 a[194:195], v172 offset:17408
ds_read_b128 v[148:151], v15 offset:2320
v_fma_mix_f32 v13, v203, v155, v163 op_sel:[1,0,0] op_sel_hi:[1,0,0]
v_cvt_pk_bf16_f32 v203, v12, v13
v_fma_mix_f32 v8, v206, v152, v160 op_sel_hi:[1,0,0]
v_fma_mix_f32 v9, v206, v153, v161 op_sel:[1,0,0] op_sel_hi:[1,0,0]
v_mfma_f32_32x32x16_bf16 v[64:79], a[236:239], v[192:195], v[64:79]
ds_read_b64_tr_b16 a[196:197], v173 offset:16384
buffer_load_dwordx4 v[252:255], v14, s[20:23], s51 offen offset:1024 sc1
v_cvt_pk_bf16_f32 v206, v8, v9
v_fma_mix_f32 v10, v207, v154, v162 op_sel_hi:[1,0,0]
v_fma_mix_f32 v11, v207, v155, v163 op_sel:[1,0,0] op_sel_hi:[1,0,0]
v_cvt_pk_bf16_f32 v207, v10, v11
v_mfma_f32_32x32x16_bf16 v[128:143], a[236:239], v[196:199], v[128:143]
ds_read_b64_tr_b16 a[198:199], v173 offset:17408
v_mfma_f32_32x32x16_bf16 v[16:31], a[240:243], v[200:203], v[16:31]
ds_read_b64_tr_b16 a[200:201], v174 offset:16384
ds_read_b128 v[152:155], v15 offset:320
s_waitcnt vmcnt(10)
s_waitcnt lgkmcnt(6)
v_fma_mix_f32 v12, v208, v164, v168 op_sel_hi:[1,0,0]
v_fma_mix_f32 v13, v208, v165, v169 op_sel:[1,0,0] op_sel_hi:[1,0,0]
v_cvt_pk_bf16_f32 v208, v12, v13
v_mfma_f32_32x32x16_bf16 v[80:95], a[240:243], v[204:207], v[80:95]
ds_read_b64_tr_b16 a[202:203], v174 offset:17408
ds_read_b128 v[160:163], v15 offset:2368
v_fma_mix_f32 v8, v209, v166, v170 op_sel_hi:[1,0,0]
v_fma_mix_f32 v9, v209, v167, v171 op_sel:[1,0,0] op_sel_hi:[1,0,0]
v_cvt_pk_bf16_f32 v209, v8, v9
v_mfma_f32_32x32x16_bf16 v[32:47], a[244:247], v[200:203], v[32:47]
ds_read_b64_tr_b16 a[204:205], v175 offset:16384
v_fma_mix_f32 v10, v212, v164, v168 op_sel_hi:[1,0,0]
v_fma_mix_f32 v11, v212, v165, v169 op_sel:[1,0,0] op_sel_hi:[1,0,0]
v_cvt_pk_bf16_f32 v212, v10, v11
v_mfma_f32_32x32x16_bf16 v[96:111], a[244:247], v[204:207], v[96:111]
ds_read_b64_tr_b16 a[206:207], v175 offset:17408
v_fma_mix_f32 v12, v213, v166, v170 op_sel_hi:[1,0,0]
v_fma_mix_f32 v13, v213, v167, v171 op_sel:[1,0,0] op_sel_hi:[1,0,0]
v_cvt_pk_bf16_f32 v213, v12, v13
v_mfma_f32_32x32x16_bf16 v[48:63], a[248:251], v[200:203], v[48:63]
ds_read_b64_tr_b16 a[208:209], v172 offset:20480
ds_read_b128 v[164:167], v15 offset:336
s_waitcnt lgkmcnt(6)
v_fma_mix_f32 v8, v210, v144, v148 op_sel_hi:[1,0,0]
v_fma_mix_f32 v9, v210, v145, v149 op_sel:[1,0,0] op_sel_hi:[1,0,0]
v_cvt_pk_bf16_f32 v210, v8, v9
v_fma_mix_f32 v10, v211, v146, v150 op_sel_hi:[1,0,0]
v_mfma_f32_32x32x16_bf16 v[112:127], a[248:251], v[204:207], v[112:127]
ds_read_b64_tr_b16 a[210:211], v172 offset:21504
ds_read_b128 v[168:171], v15 offset:2384
v_fma_mix_f32 v11, v211, v147, v151 op_sel:[1,0,0] op_sel_hi:[1,0,0]
v_cvt_pk_bf16_f32 v211, v10, v11
v_fma_mix_f32 v12, v214, v144, v148 op_sel_hi:[1,0,0]
v_fma_mix_f32 v13, v214, v145, v149 op_sel:[1,0,0] op_sel_hi:[1,0,0]
v_mfma_f32_32x32x16_bf16 v[64:79], a[252:255], v[200:203], v[64:79]
ds_read_b64_tr_b16 a[212:213], v173 offset:20480
v_cvt_pk_bf16_f32 v214, v12, v13
v_fma_mix_f32 v8, v215, v146, v150 op_sel_hi:[1,0,0]
v_fma_mix_f32 v9, v215, v147, v151 op_sel:[1,0,0] op_sel_hi:[1,0,0]
v_cvt_pk_bf16_f32 v215, v8, v9
v_mfma_f32_32x32x16_bf16 v[128:143], a[252:255], v[204:207], v[128:143]
ds_read_b64_tr_b16 a[214:215], v173 offset:21504
v_mfma_f32_32x32x16_bf16 v[16:31], a[192:195], v[208:211], v[16:31]
s_mov_b32 s51, 8192
ds_read_b64_tr_b16 a[216:217], v174 offset:20480
ds_read_b128 v[144:147], v15 offset:384
buffer_load_dwordx4 v[176:179], v14, s[20:23], s51 offen offset:2048 sc1
s_waitcnt vmcnt(9)
s_waitcnt lgkmcnt(6)
v_fma_mix_f32 v10, v216, v152, v160 op_sel_hi:[1,0,0]
v_fma_mix_f32 v11, v216, v153, v161 op_sel:[1,0,0] op_sel_hi:[1,0,0]
v_cvt_pk_bf16_f32 v216, v10, v11
v_mfma_f32_32x32x16_bf16 v[80:95], a[192:195], v[212:215], v[80:95]
s_mov_b32 s51, 40960
ds_read_b64_tr_b16 a[218:219], v174 offset:21504
ds_read_b128 v[148:151], v15 offset:2432
v_fma_mix_f32 v12, v217, v154, v162 op_sel_hi:[1,0,0]
v_fma_mix_f32 v13, v217, v155, v163 op_sel:[1,0,0] op_sel_hi:[1,0,0]
v_cvt_pk_bf16_f32 v217, v12, v13
v_mfma_f32_32x32x16_bf16 v[32:47], a[196:199], v[208:211], v[32:47]
ds_read_b64_tr_b16 a[220:221], v175 offset:20480
buffer_load_dwordx4 v[180:183], v14, s[20:23], s51 offen offset:2048 sc1
v_fma_mix_f32 v8, v220, v152, v160 op_sel_hi:[1,0,0]
v_fma_mix_f32 v9, v220, v153, v161 op_sel:[1,0,0] op_sel_hi:[1,0,0]
v_cvt_pk_bf16_f32 v220, v8, v9
v_mfma_f32_32x32x16_bf16 v[96:111], a[196:199], v[212:215], v[96:111]
s_mov_b32 s51, 8192
ds_read_b64_tr_b16 a[222:223], v175 offset:21504
v_fma_mix_f32 v10, v221, v154, v162 op_sel_hi:[1,0,0]
v_fma_mix_f32 v11, v221, v155, v163 op_sel:[1,0,0] op_sel_hi:[1,0,0]
v_cvt_pk_bf16_f32 v221, v10, v11
v_mfma_f32_32x32x16_bf16 v[48:63], a[200:203], v[208:211], v[48:63]
ds_read_b64_tr_b16 a[224:225], v172 offset:24576
ds_read_b128 v[152:155], v15 offset:400
buffer_load_dwordx4 v[184:187], v14, s[20:23], s51 offen offset:3072 sc1
s_waitcnt lgkmcnt(6)
v_fma_mix_f32 v12, v218, v164, v168 op_sel_hi:[1,0,0]
v_fma_mix_f32 v13, v218, v165, v169 op_sel:[1,0,0] op_sel_hi:[1,0,0]
v_cvt_pk_bf16_f32 v218, v12, v13
v_fma_mix_f32 v8, v219, v166, v170 op_sel_hi:[1,0,0]
v_mfma_f32_32x32x16_bf16 v[112:127], a[200:203], v[212:215], v[112:127]
s_mov_b32 s51, 40960
ds_read_b64_tr_b16 a[226:227], v172 offset:25600
ds_read_b128 v[160:163], v15 offset:2448
v_fma_mix_f32 v9, v219, v167, v171 op_sel:[1,0,0] op_sel_hi:[1,0,0]
v_cvt_pk_bf16_f32 v219, v8, v9
v_fma_mix_f32 v10, v222, v164, v168 op_sel_hi:[1,0,0]
v_fma_mix_f32 v11, v222, v165, v169 op_sel:[1,0,0] op_sel_hi:[1,0,0]
v_mfma_f32_32x32x16_bf16 v[64:79], a[204:207], v[208:211], v[64:79]
ds_read_b64_tr_b16 a[228:229], v173 offset:24576
buffer_load_dwordx4 v[188:191], v14, s[20:23], s51 offen offset:3072 sc1
v_cvt_pk_bf16_f32 v222, v10, v11
v_fma_mix_f32 v12, v223, v166, v170 op_sel_hi:[1,0,0]
v_fma_mix_f32 v13, v223, v167, v171 op_sel:[1,0,0] op_sel_hi:[1,0,0]
v_cvt_pk_bf16_f32 v223, v12, v13
v_mfma_f32_32x32x16_bf16 v[128:143], a[204:207], v[212:215], v[128:143]
ds_read_b64_tr_b16 a[230:231], v173 offset:25600
v_mfma_f32_32x32x16_bf16 v[16:31], a[208:211], v[216:219], v[16:31]
s_mov_b32 s51, 12288
ds_read_b64_tr_b16 a[232:233], v174 offset:24576
ds_read_b128 v[164:167], v15 offset:448
s_waitcnt vmcnt(10)
s_waitcnt lgkmcnt(6)
v_fma_mix_f32 v8, v224, v144, v148 op_sel_hi:[1,0,0]
v_fma_mix_f32 v9, v224, v145, v149 op_sel:[1,0,0] op_sel_hi:[1,0,0]
v_cvt_pk_bf16_f32 v224, v8, v9
v_mfma_f32_32x32x16_bf16 v[80:95], a[208:211], v[220:223], v[80:95]
ds_read_b64_tr_b16 a[234:235], v174 offset:25600
ds_read_b128 v[168:171], v15 offset:2496
buffer_load_dwordx4 v[192:195], v14, s[20:23], s51 offen offset:0 sc1
v_fma_mix_f32 v10, v225, v146, v150 op_sel_hi:[1,0,0]
v_fma_mix_f32 v11, v225, v147, v151 op_sel:[1,0,0] op_sel_hi:[1,0,0]
v_cvt_pk_bf16_f32 v225, v10, v11
v_mfma_f32_32x32x16_bf16 v[32:47], a[212:215], v[216:219], v[32:47]
s_mov_b32 s51, 45056
ds_read_b64_tr_b16 a[236:237], v175 offset:24576
v_fma_mix_f32 v12, v228, v144, v148 op_sel_hi:[1,0,0]
v_fma_mix_f32 v13, v228, v145, v149 op_sel:[1,0,0] op_sel_hi:[1,0,0]
v_cvt_pk_bf16_f32 v228, v12, v13
v_mfma_f32_32x32x16_bf16 v[96:111], a[212:215], v[220:223], v[96:111]
ds_read_b64_tr_b16 a[238:239], v175 offset:25600
buffer_load_dwordx4 v[196:199], v14, s[20:23], s51 offen offset:0 sc1
v_fma_mix_f32 v8, v229, v146, v150 op_sel_hi:[1,0,0]
v_fma_mix_f32 v9, v229, v147, v151 op_sel:[1,0,0] op_sel_hi:[1,0,0]
v_cvt_pk_bf16_f32 v229, v8, v9
v_mfma_f32_32x32x16_bf16 v[48:63], a[216:219], v[216:219], v[48:63]
s_mov_b32 s51, 12288
ds_read_b64_tr_b16 a[240:241], v172 offset:28672
ds_read_b128 v[144:147], v15 offset:464
s_waitcnt lgkmcnt(6)
v_fma_mix_f32 v10, v226, v152, v160 op_sel_hi:[1,0,0]
v_fma_mix_f32 v11, v226, v153, v161 op_sel:[1,0,0] op_sel_hi:[1,0,0]
v_cvt_pk_bf16_f32 v226, v10, v11
v_fma_mix_f32 v12, v227, v154, v162 op_sel_hi:[1,0,0]
v_mfma_f32_32x32x16_bf16 v[112:127], a[216:219], v[220:223], v[112:127]
ds_read_b64_tr_b16 a[242:243], v172 offset:29696
ds_read_b128 v[148:151], v15 offset:2512
buffer_load_dwordx4 v[200:203], v14, s[20:23], s51 offen offset:1024 sc1
v_fma_mix_f32 v13, v227, v155, v163 op_sel:[1,0,0] op_sel_hi:[1,0,0]
v_cvt_pk_bf16_f32 v227, v12, v13
v_fma_mix_f32 v8, v230, v152, v160 op_sel_hi:[1,0,0]
v_fma_mix_f32 v9, v230, v153, v161 op_sel:[1,0,0] op_sel_hi:[1,0,0]
v_mfma_f32_32x32x16_bf16 v[64:79], a[220:223], v[216:219], v[64:79]
s_mov_b32 s51, 45056
ds_read_b64_tr_b16 a[244:245], v173 offset:28672
v_cvt_pk_bf16_f32 v230, v8, v9
v_fma_mix_f32 v10, v231, v154, v162 op_sel_hi:[1,0,0]
v_fma_mix_f32 v11, v231, v155, v163 op_sel:[1,0,0] op_sel_hi:[1,0,0]
v_cvt_pk_bf16_f32 v231, v10, v11
v_mfma_f32_32x32x16_bf16 v[128:143], a[220:223], v[220:223], v[128:143]
ds_read_b64_tr_b16 a[246:247], v173 offset:29696
buffer_load_dwordx4 v[204:207], v14, s[20:23], s51 offen offset:1024 sc1
v_mfma_f32_32x32x16_bf16 v[16:31], a[224:227], v[224:227], v[16:31]
s_mov_b32 s51, 12288
ds_read_b64_tr_b16 a[248:249], v174 offset:28672
ds_read_b128 v[152:155], v15 offset:512
buffer_load_dwordx4 v[208:211], v14, s[20:23], s51 offen offset:2048 sc1
s_waitcnt vmcnt(13)
s_waitcnt lgkmcnt(6)
v_fma_mix_f32 v12, v232, v164, v168 op_sel_hi:[1,0,0]
v_fma_mix_f32 v13, v232, v165, v169 op_sel:[1,0,0] op_sel_hi:[1,0,0]
v_cvt_pk_bf16_f32 v232, v12, v13
v_mfma_f32_32x32x16_bf16 v[80:95], a[224:227], v[228:231], v[80:95]
s_mov_b32 s51, 45056
ds_read_b64_tr_b16 a[250:251], v174 offset:29696
ds_read_b128 v[160:163], v15 offset:2560
v_fma_mix_f32 v8, v233, v166, v170 op_sel_hi:[1,0,0]
v_fma_mix_f32 v9, v233, v167, v171 op_sel:[1,0,0] op_sel_hi:[1,0,0]
v_cvt_pk_bf16_f32 v233, v8, v9
v_mfma_f32_32x32x16_bf16 v[32:47], a[228:231], v[224:227], v[32:47]
ds_read_b64_tr_b16 a[252:253], v175 offset:28672
buffer_load_dwordx4 v[212:215], v14, s[20:23], s51 offen offset:2048 sc1
v_fma_mix_f32 v10, v236, v164, v168 op_sel_hi:[1,0,0]
v_fma_mix_f32 v11, v236, v165, v169 op_sel:[1,0,0] op_sel_hi:[1,0,0]
v_cvt_pk_bf16_f32 v236, v10, v11
v_mfma_f32_32x32x16_bf16 v[96:111], a[228:231], v[228:231], v[96:111]
s_mov_b32 s51, 12288
ds_read_b64_tr_b16 a[254:255], v175 offset:29696
v_fma_mix_f32 v12, v237, v166, v170 op_sel_hi:[1,0,0]
v_fma_mix_f32 v13, v237, v167, v171 op_sel:[1,0,0] op_sel_hi:[1,0,0]
v_cvt_pk_bf16_f32 v237, v12, v13
v_add_u32 v172, 0x8000, v172
v_add_u32 v173, 0x8000, v173
v_add_u32 v174, 0x8000, v174
v_add_u32 v175, 0x8000, v175
v_mfma_f32_32x32x16_bf16 v[48:63], a[232:235], v[224:227], v[48:63]
ds_read_b64_tr_b16 a[192:193], v172 offset:0
ds_read_b128 v[164:167], v15 offset:528
buffer_load_dwordx4 v[216:219], v14, s[20:23], s51 offen offset:3072 sc1
s_waitcnt lgkmcnt(6)
v_fma_mix_f32 v8, v234, v144, v148 op_sel_hi:[1,0,0]
v_fma_mix_f32 v9, v234, v145, v149 op_sel:[1,0,0] op_sel_hi:[1,0,0]
v_cvt_pk_bf16_f32 v234, v8, v9
v_fma_mix_f32 v10, v235, v146, v150 op_sel_hi:[1,0,0]
v_mfma_f32_32x32x16_bf16 v[112:127], a[232:235], v[228:231], v[112:127]
s_mov_b32 s51, 45056
ds_read_b64_tr_b16 a[194:195], v172 offset:1024
ds_read_b128 v[168:171], v15 offset:2576
v_fma_mix_f32 v11, v235, v147, v151 op_sel:[1,0,0] op_sel_hi:[1,0,0]
v_cvt_pk_bf16_f32 v235, v10, v11
v_fma_mix_f32 v12, v238, v144, v148 op_sel_hi:[1,0,0]
v_fma_mix_f32 v13, v238, v145, v149 op_sel:[1,0,0] op_sel_hi:[1,0,0]
v_mfma_f32_32x32x16_bf16 v[64:79], a[236:239], v[224:227], v[64:79]
ds_read_b64_tr_b16 a[196:197], v173 offset:0
buffer_load_dwordx4 v[220:223], v14, s[20:23], s51 offen offset:3072 sc1
v_cvt_pk_bf16_f32 v238, v12, v13
v_fma_mix_f32 v8, v239, v146, v150 op_sel_hi:[1,0,0]
v_fma_mix_f32 v9, v239, v147, v151 op_sel:[1,0,0] op_sel_hi:[1,0,0]
v_cvt_pk_bf16_f32 v239, v8, v9
v_mfma_f32_32x32x16_bf16 v[128:143], a[236:239], v[228:231], v[128:143]
ds_read_b64_tr_b16 a[198:199], v173 offset:1024
v_mfma_f32_32x32x16_bf16 v[16:31], a[240:243], v[232:235], v[16:31]
ds_read_b64_tr_b16 a[200:201], v174 offset:0
ds_read_b128 v[144:147], v15 offset:576
s_waitcnt vmcnt(14)
s_waitcnt lgkmcnt(6)
v_fma_mix_f32 v10, v240, v152, v160 op_sel_hi:[1,0,0]
v_fma_mix_f32 v11, v240, v153, v161 op_sel:[1,0,0] op_sel_hi:[1,0,0]
v_cvt_pk_bf16_f32 v240, v10, v11
v_mfma_f32_32x32x16_bf16 v[80:95], a[240:243], v[236:239], v[80:95]
ds_read_b64_tr_b16 a[202:203], v174 offset:1024
ds_read_b128 v[148:151], v15 offset:2624
v_fma_mix_f32 v12, v241, v154, v162 op_sel_hi:[1,0,0]
v_fma_mix_f32 v13, v241, v155, v163 op_sel:[1,0,0] op_sel_hi:[1,0,0]
v_cvt_pk_bf16_f32 v241, v12, v13
v_mfma_f32_32x32x16_bf16 v[32:47], a[244:247], v[232:235], v[32:47]
ds_read_b64_tr_b16 a[204:205], v175 offset:0
v_fma_mix_f32 v8, v244, v152, v160 op_sel_hi:[1,0,0]
v_fma_mix_f32 v9, v244, v153, v161 op_sel:[1,0,0] op_sel_hi:[1,0,0]
v_cvt_pk_bf16_f32 v244, v8, v9
v_mfma_f32_32x32x16_bf16 v[96:111], a[244:247], v[236:239], v[96:111]
ds_read_b64_tr_b16 a[206:207], v175 offset:1024
v_fma_mix_f32 v10, v245, v154, v162 op_sel_hi:[1,0,0]
v_fma_mix_f32 v11, v245, v155, v163 op_sel:[1,0,0] op_sel_hi:[1,0,0]
v_cvt_pk_bf16_f32 v245, v10, v11
v_mfma_f32_32x32x16_bf16 v[48:63], a[248:251], v[232:235], v[48:63]
ds_read_b64_tr_b16 a[208:209], v172 offset:4096
ds_read_b128 v[152:155], v15 offset:592
s_waitcnt lgkmcnt(6)
v_fma_mix_f32 v12, v242, v164, v168 op_sel_hi:[1,0,0]
v_fma_mix_f32 v13, v242, v165, v169 op_sel:[1,0,0] op_sel_hi:[1,0,0]
v_cvt_pk_bf16_f32 v242, v12, v13
v_fma_mix_f32 v8, v243, v166, v170 op_sel_hi:[1,0,0]
v_mfma_f32_32x32x16_bf16 v[112:127], a[248:251], v[236:239], v[112:127]
ds_read_b64_tr_b16 a[210:211], v172 offset:5120
ds_read_b128 v[160:163], v15 offset:2640
v_fma_mix_f32 v9, v243, v167, v171 op_sel:[1,0,0] op_sel_hi:[1,0,0]
v_cvt_pk_bf16_f32 v243, v8, v9
v_fma_mix_f32 v10, v246, v164, v168 op_sel_hi:[1,0,0]
v_fma_mix_f32 v11, v246, v165, v169 op_sel:[1,0,0] op_sel_hi:[1,0,0]
v_mfma_f32_32x32x16_bf16 v[64:79], a[252:255], v[232:235], v[64:79]
ds_read_b64_tr_b16 a[212:213], v173 offset:4096
v_cvt_pk_bf16_f32 v246, v10, v11
v_fma_mix_f32 v12, v247, v166, v170 op_sel_hi:[1,0,0]
v_fma_mix_f32 v13, v247, v167, v171 op_sel:[1,0,0] op_sel_hi:[1,0,0]
v_cvt_pk_bf16_f32 v247, v12, v13
v_mfma_f32_32x32x16_bf16 v[128:143], a[252:255], v[236:239], v[128:143]
ds_read_b64_tr_b16 a[214:215], v173 offset:5120
v_mfma_f32_32x32x16_bf16 v[16:31], a[192:195], v[240:243], v[16:31]
s_mov_b32 s51, 16384
ds_read_b64_tr_b16 a[216:217], v174 offset:4096
ds_read_b128 v[164:167], v15 offset:640
buffer_load_dwordx4 v[224:227], v14, s[20:23], s51 offen offset:0 sc1
s_waitcnt vmcnt(13)
s_waitcnt lgkmcnt(6)
v_fma_mix_f32 v8, v248, v144, v148 op_sel_hi:[1,0,0]
v_fma_mix_f32 v9, v248, v145, v149 op_sel:[1,0,0] op_sel_hi:[1,0,0]
v_cvt_pk_bf16_f32 v248, v8, v9
v_mfma_f32_32x32x16_bf16 v[80:95], a[192:195], v[244:247], v[80:95]
s_mov_b32 s51, 49152
ds_read_b64_tr_b16 a[218:219], v174 offset:5120
ds_read_b128 v[168:171], v15 offset:2688
v_fma_mix_f32 v10, v249, v146, v150 op_sel_hi:[1,0,0]
v_fma_mix_f32 v11, v249, v147, v151 op_sel:[1,0,0] op_sel_hi:[1,0,0]
v_cvt_pk_bf16_f32 v249, v10, v11
v_mfma_f32_32x32x16_bf16 v[32:47], a[196:199], v[240:243], v[32:47]
ds_read_b64_tr_b16 a[220:221], v175 offset:4096
buffer_load_dwordx4 v[228:231], v14, s[20:23], s51 offen offset:0 sc1
v_fma_mix_f32 v12, v252, v144, v148 op_sel_hi:[1,0,0]
v_fma_mix_f32 v13, v252, v145, v149 op_sel:[1,0,0] op_sel_hi:[1,0,0]
v_cvt_pk_bf16_f32 v252, v12, v13
v_mfma_f32_32x32x16_bf16 v[96:111], a[196:199], v[244:247], v[96:111]
s_mov_b32 s51, 16384
ds_read_b64_tr_b16 a[222:223], v175 offset:5120
v_fma_mix_f32 v8, v253, v146, v150 op_sel_hi:[1,0,0]
v_fma_mix_f32 v9, v253, v147, v151 op_sel:[1,0,0] op_sel_hi:[1,0,0]
v_cvt_pk_bf16_f32 v253, v8, v9
v_mfma_f32_32x32x16_bf16 v[48:63], a[200:203], v[240:243], v[48:63]
ds_read_b64_tr_b16 a[224:225], v172 offset:8192
ds_read_b128 v[144:147], v15 offset:656
buffer_load_dwordx4 v[232:235], v14, s[20:23], s51 offen offset:1024 sc1
s_waitcnt lgkmcnt(6)
v_fma_mix_f32 v10, v250, v152, v160 op_sel_hi:[1,0,0]
v_fma_mix_f32 v11, v250, v153, v161 op_sel:[1,0,0] op_sel_hi:[1,0,0]
v_cvt_pk_bf16_f32 v250, v10, v11
v_fma_mix_f32 v12, v251, v154, v162 op_sel_hi:[1,0,0]
v_mfma_f32_32x32x16_bf16 v[112:127], a[200:203], v[244:247], v[112:127]
s_mov_b32 s51, 49152
ds_read_b64_tr_b16 a[226:227], v172 offset:9216
ds_read_b128 v[148:151], v15 offset:2704
v_fma_mix_f32 v13, v251, v155, v163 op_sel:[1,0,0] op_sel_hi:[1,0,0]
v_cvt_pk_bf16_f32 v251, v12, v13
v_fma_mix_f32 v8, v254, v152, v160 op_sel_hi:[1,0,0]
v_fma_mix_f32 v9, v254, v153, v161 op_sel:[1,0,0] op_sel_hi:[1,0,0]
v_mfma_f32_32x32x16_bf16 v[64:79], a[204:207], v[240:243], v[64:79]
ds_read_b64_tr_b16 a[228:229], v173 offset:8192
buffer_load_dwordx4 v[236:239], v14, s[20:23], s51 offen offset:1024 sc1
v_cvt_pk_bf16_f32 v254, v8, v9
v_fma_mix_f32 v10, v255, v154, v162 op_sel_hi:[1,0,0]
v_fma_mix_f32 v11, v255, v155, v163 op_sel:[1,0,0] op_sel_hi:[1,0,0]
v_cvt_pk_bf16_f32 v255, v10, v11
v_mfma_f32_32x32x16_bf16 v[128:143], a[204:207], v[244:247], v[128:143]
ds_read_b64_tr_b16 a[230:231], v173 offset:9216
v_mfma_f32_32x32x16_bf16 v[16:31], a[208:211], v[248:251], v[16:31]
ds_read_b64_tr_b16 a[232:233], v174 offset:8192
ds_read_b128 v[152:155], v15 offset:704
s_waitcnt vmcnt(14)
s_waitcnt lgkmcnt(6)
v_fma_mix_f32 v12, v176, v164, v168 op_sel_hi:[1,0,0]
v_fma_mix_f32 v13, v176, v165, v169 op_sel:[1,0,0] op_sel_hi:[1,0,0]
v_cvt_pk_bf16_f32 v176, v12, v13
v_mfma_f32_32x32x16_bf16 v[80:95], a[208:211], v[252:255], v[80:95]
ds_read_b64_tr_b16 a[234:235], v174 offset:9216
ds_read_b128 v[160:163], v15 offset:2752
v_fma_mix_f32 v8, v177, v166, v170 op_sel_hi:[1,0,0]
v_fma_mix_f32 v9, v177, v167, v171 op_sel:[1,0,0] op_sel_hi:[1,0,0]
v_cvt_pk_bf16_f32 v177, v8, v9
v_mfma_f32_32x32x16_bf16 v[32:47], a[212:215], v[248:251], v[32:47]
ds_read_b64_tr_b16 a[236:237], v175 offset:8192
v_fma_mix_f32 v10, v180, v164, v168 op_sel_hi:[1,0,0]
v_fma_mix_f32 v11, v180, v165, v169 op_sel:[1,0,0] op_sel_hi:[1,0,0]
v_cvt_pk_bf16_f32 v180, v10, v11
v_mfma_f32_32x32x16_bf16 v[96:111], a[212:215], v[252:255], v[96:111]
ds_read_b64_tr_b16 a[238:239], v175 offset:9216
v_fma_mix_f32 v12, v181, v166, v170 op_sel_hi:[1,0,0]
v_fma_mix_f32 v13, v181, v167, v171 op_sel:[1,0,0] op_sel_hi:[1,0,0]
v_cvt_pk_bf16_f32 v181, v12, v13
v_mfma_f32_32x32x16_bf16 v[48:63], a[216:219], v[248:251], v[48:63]
ds_read_b64_tr_b16 a[240:241], v172 offset:12288
ds_read_b128 v[164:167], v15 offset:720
s_waitcnt lgkmcnt(6)
v_fma_mix_f32 v8, v178, v144, v148 op_sel_hi:[1,0,0]
v_fma_mix_f32 v9, v178, v145, v149 op_sel:[1,0,0] op_sel_hi:[1,0,0]
v_cvt_pk_bf16_f32 v178, v8, v9
v_fma_mix_f32 v10, v179, v146, v150 op_sel_hi:[1,0,0]
v_mfma_f32_32x32x16_bf16 v[112:127], a[216:219], v[252:255], v[112:127]
ds_read_b64_tr_b16 a[242:243], v172 offset:13312
ds_read_b128 v[168:171], v15 offset:2768
v_fma_mix_f32 v11, v179, v147, v151 op_sel:[1,0,0] op_sel_hi:[1,0,0]
v_cvt_pk_bf16_f32 v179, v10, v11
v_fma_mix_f32 v12, v182, v144, v148 op_sel_hi:[1,0,0]
v_fma_mix_f32 v13, v182, v145, v149 op_sel:[1,0,0] op_sel_hi:[1,0,0]
v_mfma_f32_32x32x16_bf16 v[64:79], a[220:223], v[248:251], v[64:79]
ds_read_b64_tr_b16 a[244:245], v173 offset:12288
v_cvt_pk_bf16_f32 v182, v12, v13
v_fma_mix_f32 v8, v183, v146, v150 op_sel_hi:[1,0,0]
v_fma_mix_f32 v9, v183, v147, v151 op_sel:[1,0,0] op_sel_hi:[1,0,0]
v_cvt_pk_bf16_f32 v183, v8, v9
v_mfma_f32_32x32x16_bf16 v[128:143], a[220:223], v[252:255], v[128:143]
ds_read_b64_tr_b16 a[246:247], v173 offset:13312
v_mfma_f32_32x32x16_bf16 v[16:31], a[224:227], v[176:179], v[16:31]
s_mov_b32 s51, 16384
ds_read_b64_tr_b16 a[248:249], v174 offset:12288
ds_read_b128 v[144:147], v15 offset:768
buffer_load_dwordx4 v[240:243], v14, s[20:23], s51 offen offset:2048 sc1
s_waitcnt vmcnt(13)
s_waitcnt lgkmcnt(6)
v_fma_mix_f32 v10, v184, v152, v160 op_sel_hi:[1,0,0]
v_fma_mix_f32 v11, v184, v153, v161 op_sel:[1,0,0] op_sel_hi:[1,0,0]
v_cvt_pk_bf16_f32 v184, v10, v11
v_mfma_f32_32x32x16_bf16 v[80:95], a[224:227], v[180:183], v[80:95]
s_mov_b32 s51, 49152
ds_read_b64_tr_b16 a[250:251], v174 offset:13312
ds_read_b128 v[148:151], v15 offset:2816
v_fma_mix_f32 v12, v185, v154, v162 op_sel_hi:[1,0,0]
v_fma_mix_f32 v13, v185, v155, v163 op_sel:[1,0,0] op_sel_hi:[1,0,0]
v_cvt_pk_bf16_f32 v185, v12, v13
v_mfma_f32_32x32x16_bf16 v[32:47], a[228:231], v[176:179], v[32:47]
ds_read_b64_tr_b16 a[252:253], v175 offset:12288
buffer_load_dwordx4 v[244:247], v14, s[20:23], s51 offen offset:2048 sc1
v_fma_mix_f32 v8, v188, v152, v160 op_sel_hi:[1,0,0]
v_fma_mix_f32 v9, v188, v153, v161 op_sel:[1,0,0] op_sel_hi:[1,0,0]
v_cvt_pk_bf16_f32 v188, v8, v9
v_mfma_f32_32x32x16_bf16 v[96:111], a[228:231], v[180:183], v[96:111]
s_mov_b32 s51, 16384
ds_read_b64_tr_b16 a[254:255], v175 offset:13312
v_fma_mix_f32 v10, v189, v154, v162 op_sel_hi:[1,0,0]
v_fma_mix_f32 v11, v189, v155, v163 op_sel:[1,0,0] op_sel_hi:[1,0,0]
v_cvt_pk_bf16_f32 v189, v10, v11
v_mfma_f32_32x32x16_bf16 v[48:63], a[232:235], v[176:179], v[48:63]
ds_read_b64_tr_b16 a[192:193], v172 offset:16384
ds_read_b128 v[152:155], v15 offset:784
buffer_load_dwordx4 v[248:251], v14, s[20:23], s51 offen offset:3072 sc1
s_waitcnt lgkmcnt(6)
v_fma_mix_f32 v12, v186, v164, v168 op_sel_hi:[1,0,0]
v_fma_mix_f32 v13, v186, v165, v169 op_sel:[1,0,0] op_sel_hi:[1,0,0]
v_cvt_pk_bf16_f32 v186, v12, v13
v_fma_mix_f32 v8, v187, v166, v170 op_sel_hi:[1,0,0]
v_mfma_f32_32x32x16_bf16 v[112:127], a[232:235], v[180:183], v[112:127]
s_mov_b32 s51, 49152
ds_read_b64_tr_b16 a[194:195], v172 offset:17408
ds_read_b128 v[160:163], v15 offset:2832
v_fma_mix_f32 v9, v187, v167, v171 op_sel:[1,0,0] op_sel_hi:[1,0,0]
v_cvt_pk_bf16_f32 v187, v8, v9
v_fma_mix_f32 v10, v190, v164, v168 op_sel_hi:[1,0,0]
v_fma_mix_f32 v11, v190, v165, v169 op_sel:[1,0,0] op_sel_hi:[1,0,0]
v_mfma_f32_32x32x16_bf16 v[64:79], a[236:239], v[176:179], v[64:79]
ds_read_b64_tr_b16 a[196:197], v173 offset:16384
buffer_load_dwordx4 v[252:255], v14, s[20:23], s51 offen offset:3072 sc1
v_cvt_pk_bf16_f32 v190, v10, v11
v_fma_mix_f32 v12, v191, v166, v170 op_sel_hi:[1,0,0]
v_fma_mix_f32 v13, v191, v167, v171 op_sel:[1,0,0] op_sel_hi:[1,0,0]
v_cvt_pk_bf16_f32 v191, v12, v13
v_mfma_f32_32x32x16_bf16 v[128:143], a[236:239], v[180:183], v[128:143]
ds_read_b64_tr_b16 a[198:199], v173 offset:17408
v_mfma_f32_32x32x16_bf16 v[16:31], a[240:243], v[184:187], v[16:31]
ds_read_b64_tr_b16 a[200:201], v174 offset:16384
ds_read_b128 v[164:167], v15 offset:832
s_waitcnt vmcnt(14)
s_waitcnt lgkmcnt(6)
v_fma_mix_f32 v8, v192, v144, v148 op_sel_hi:[1,0,0]
v_fma_mix_f32 v9, v192, v145, v149 op_sel:[1,0,0] op_sel_hi:[1,0,0]
v_cvt_pk_bf16_f32 v192, v8, v9
v_mfma_f32_32x32x16_bf16 v[80:95], a[240:243], v[188:191], v[80:95]
ds_read_b64_tr_b16 a[202:203], v174 offset:17408
ds_read_b128 v[168:171], v15 offset:2880
v_fma_mix_f32 v10, v193, v146, v150 op_sel_hi:[1,0,0]
v_fma_mix_f32 v11, v193, v147, v151 op_sel:[1,0,0] op_sel_hi:[1,0,0]
v_cvt_pk_bf16_f32 v193, v10, v11
v_mfma_f32_32x32x16_bf16 v[32:47], a[244:247], v[184:187], v[32:47]
ds_read_b64_tr_b16 a[204:205], v175 offset:16384
v_fma_mix_f32 v12, v196, v144, v148 op_sel_hi:[1,0,0]
v_fma_mix_f32 v13, v196, v145, v149 op_sel:[1,0,0] op_sel_hi:[1,0,0]
v_cvt_pk_bf16_f32 v196, v12, v13
v_mfma_f32_32x32x16_bf16 v[96:111], a[244:247], v[188:191], v[96:111]
ds_read_b64_tr_b16 a[206:207], v175 offset:17408
v_fma_mix_f32 v8, v197, v146, v150 op_sel_hi:[1,0,0]
v_fma_mix_f32 v9, v197, v147, v151 op_sel:[1,0,0] op_sel_hi:[1,0,0]
v_cvt_pk_bf16_f32 v197, v8, v9
v_mfma_f32_32x32x16_bf16 v[48:63], a[248:251], v[184:187], v[48:63]
ds_read_b64_tr_b16 a[208:209], v172 offset:20480
ds_read_b128 v[144:147], v15 offset:848
s_waitcnt lgkmcnt(6)
v_fma_mix_f32 v10, v194, v152, v160 op_sel_hi:[1,0,0]
v_fma_mix_f32 v11, v194, v153, v161 op_sel:[1,0,0] op_sel_hi:[1,0,0]
v_cvt_pk_bf16_f32 v194, v10, v11
v_fma_mix_f32 v12, v195, v154, v162 op_sel_hi:[1,0,0]
v_mfma_f32_32x32x16_bf16 v[112:127], a[248:251], v[188:191], v[112:127]
ds_read_b64_tr_b16 a[210:211], v172 offset:21504
ds_read_b128 v[148:151], v15 offset:2896
v_fma_mix_f32 v13, v195, v155, v163 op_sel:[1,0,0] op_sel_hi:[1,0,0]
v_cvt_pk_bf16_f32 v195, v12, v13
v_fma_mix_f32 v8, v198, v152, v160 op_sel_hi:[1,0,0]
v_fma_mix_f32 v9, v198, v153, v161 op_sel:[1,0,0] op_sel_hi:[1,0,0]
v_mfma_f32_32x32x16_bf16 v[64:79], a[252:255], v[184:187], v[64:79]
ds_read_b64_tr_b16 a[212:213], v173 offset:20480
v_cvt_pk_bf16_f32 v198, v8, v9
v_fma_mix_f32 v10, v199, v154, v162 op_sel_hi:[1,0,0]
v_fma_mix_f32 v11, v199, v155, v163 op_sel:[1,0,0] op_sel_hi:[1,0,0]
v_cvt_pk_bf16_f32 v199, v10, v11
v_mfma_f32_32x32x16_bf16 v[128:143], a[252:255], v[188:191], v[128:143]
ds_read_b64_tr_b16 a[214:215], v173 offset:21504
v_mfma_f32_32x32x16_bf16 v[16:31], a[192:195], v[192:195], v[16:31]
s_mov_b32 s51, 20480
ds_read_b64_tr_b16 a[216:217], v174 offset:20480
ds_read_b128 v[152:155], v15 offset:896
buffer_load_dwordx4 v[176:179], v14, s[20:23], s51 offen offset:0 sc1
s_waitcnt vmcnt(13)
s_waitcnt lgkmcnt(6)
v_fma_mix_f32 v12, v200, v164, v168 op_sel_hi:[1,0,0]
v_fma_mix_f32 v13, v200, v165, v169 op_sel:[1,0,0] op_sel_hi:[1,0,0]
v_cvt_pk_bf16_f32 v200, v12, v13
v_mfma_f32_32x32x16_bf16 v[80:95], a[192:195], v[196:199], v[80:95]
s_mov_b32 s51, 53248
ds_read_b64_tr_b16 a[218:219], v174 offset:21504
ds_read_b128 v[160:163], v15 offset:2944
v_fma_mix_f32 v8, v201, v166, v170 op_sel_hi:[1,0,0]
v_fma_mix_f32 v9, v201, v167, v171 op_sel:[1,0,0] op_sel_hi:[1,0,0]
v_cvt_pk_bf16_f32 v201, v8, v9
v_mfma_f32_32x32x16_bf16 v[32:47], a[196:199], v[192:195], v[32:47]
ds_read_b64_tr_b16 a[220:221], v175 offset:20480
buffer_load_dwordx4 v[180:183], v14, s[20:23], s51 offen offset:0 sc1
v_fma_mix_f32 v10, v204, v164, v168 op_sel_hi:[1,0,0]
v_fma_mix_f32 v11, v204, v165, v169 op_sel:[1,0,0] op_sel_hi:[1,0,0]
v_cvt_pk_bf16_f32 v204, v10, v11
v_mfma_f32_32x32x16_bf16 v[96:111], a[196:199], v[196:199], v[96:111]
s_mov_b32 s51, 20480
ds_read_b64_tr_b16 a[222:223], v175 offset:21504
v_fma_mix_f32 v12, v205, v166, v170 op_sel_hi:[1,0,0]
v_fma_mix_f32 v13, v205, v167, v171 op_sel:[1,0,0] op_sel_hi:[1,0,0]
v_cvt_pk_bf16_f32 v205, v12, v13
v_mfma_f32_32x32x16_bf16 v[48:63], a[200:203], v[192:195], v[48:63]
ds_read_b64_tr_b16 a[224:225], v172 offset:24576
ds_read_b128 v[164:167], v15 offset:912
buffer_load_dwordx4 v[184:187], v14, s[20:23], s51 offen offset:1024 sc1
s_waitcnt lgkmcnt(6)
v_fma_mix_f32 v8, v202, v144, v148 op_sel_hi:[1,0,0]
v_fma_mix_f32 v9, v202, v145, v149 op_sel:[1,0,0] op_sel_hi:[1,0,0]
v_cvt_pk_bf16_f32 v202, v8, v9
v_fma_mix_f32 v10, v203, v146, v150 op_sel_hi:[1,0,0]
v_mfma_f32_32x32x16_bf16 v[112:127], a[200:203], v[196:199], v[112:127]
s_mov_b32 s51, 53248
ds_read_b64_tr_b16 a[226:227], v172 offset:25600
ds_read_b128 v[168:171], v15 offset:2960
v_fma_mix_f32 v11, v203, v147, v151 op_sel:[1,0,0] op_sel_hi:[1,0,0]
v_cvt_pk_bf16_f32 v203, v10, v11
v_fma_mix_f32 v12, v206, v144, v148 op_sel_hi:[1,0,0]
v_fma_mix_f32 v13, v206, v145, v149 op_sel:[1,0,0] op_sel_hi:[1,0,0]
v_mfma_f32_32x32x16_bf16 v[64:79], a[204:207], v[192:195], v[64:79]
ds_read_b64_tr_b16 a[228:229], v173 offset:24576
buffer_load_dwordx4 v[188:191], v14, s[20:23], s51 offen offset:1024 sc1
v_cvt_pk_bf16_f32 v206, v12, v13
v_fma_mix_f32 v8, v207, v146, v150 op_sel_hi:[1,0,0]
v_fma_mix_f32 v9, v207, v147, v151 op_sel:[1,0,0] op_sel_hi:[1,0,0]
v_cvt_pk_bf16_f32 v207, v8, v9
v_mfma_f32_32x32x16_bf16 v[128:143], a[204:207], v[196:199], v[128:143]
ds_read_b64_tr_b16 a[230:231], v173 offset:25600
v_mfma_f32_32x32x16_bf16 v[16:31], a[208:211], v[200:203], v[16:31]
ds_read_b64_tr_b16 a[232:233], v174 offset:24576
ds_read_b128 v[144:147], v15 offset:960
s_waitcnt vmcnt(14)
s_waitcnt lgkmcnt(6)
v_fma_mix_f32 v10, v208, v152, v160 op_sel_hi:[1,0,0]
v_fma_mix_f32 v11, v208, v153, v161 op_sel:[1,0,0] op_sel_hi:[1,0,0]
v_cvt_pk_bf16_f32 v208, v10, v11
v_mfma_f32_32x32x16_bf16 v[80:95], a[208:211], v[204:207], v[80:95]
ds_read_b64_tr_b16 a[234:235], v174 offset:25600
ds_read_b128 v[148:151], v15 offset:3008
v_fma_mix_f32 v12, v209, v154, v162 op_sel_hi:[1,0,0]
v_fma_mix_f32 v13, v209, v155, v163 op_sel:[1,0,0] op_sel_hi:[1,0,0]
v_cvt_pk_bf16_f32 v209, v12, v13
v_mfma_f32_32x32x16_bf16 v[32:47], a[212:215], v[200:203], v[32:47]
ds_read_b64_tr_b16 a[236:237], v175 offset:24576
v_fma_mix_f32 v8, v212, v152, v160 op_sel_hi:[1,0,0]
v_fma_mix_f32 v9, v212, v153, v161 op_sel:[1,0,0] op_sel_hi:[1,0,0]
v_cvt_pk_bf16_f32 v212, v8, v9
v_mfma_f32_32x32x16_bf16 v[96:111], a[212:215], v[204:207], v[96:111]
ds_read_b64_tr_b16 a[238:239], v175 offset:25600
v_fma_mix_f32 v10, v213, v154, v162 op_sel_hi:[1,0,0]
v_fma_mix_f32 v11, v213, v155, v163 op_sel:[1,0,0] op_sel_hi:[1,0,0]
v_cvt_pk_bf16_f32 v213, v10, v11
v_mfma_f32_32x32x16_bf16 v[48:63], a[216:219], v[200:203], v[48:63]
ds_read_b64_tr_b16 a[240:241], v172 offset:28672
ds_read_b128 v[152:155], v15 offset:976
s_waitcnt lgkmcnt(6)
v_fma_mix_f32 v12, v210, v164, v168 op_sel_hi:[1,0,0]
v_fma_mix_f32 v13, v210, v165, v169 op_sel:[1,0,0] op_sel_hi:[1,0,0]
v_cvt_pk_bf16_f32 v210, v12, v13
v_fma_mix_f32 v8, v211, v166, v170 op_sel_hi:[1,0,0]
v_mfma_f32_32x32x16_bf16 v[112:127], a[216:219], v[204:207], v[112:127]
ds_read_b64_tr_b16 a[242:243], v172 offset:29696
ds_read_b128 v[160:163], v15 offset:3024
v_fma_mix_f32 v9, v211, v167, v171 op_sel:[1,0,0] op_sel_hi:[1,0,0]
v_cvt_pk_bf16_f32 v211, v8, v9
v_fma_mix_f32 v10, v214, v164, v168 op_sel_hi:[1,0,0]
v_fma_mix_f32 v11, v214, v165, v169 op_sel:[1,0,0] op_sel_hi:[1,0,0]
v_mfma_f32_32x32x16_bf16 v[64:79], a[220:223], v[200:203], v[64:79]
ds_read_b64_tr_b16 a[244:245], v173 offset:28672
v_cvt_pk_bf16_f32 v214, v10, v11
v_fma_mix_f32 v12, v215, v166, v170 op_sel_hi:[1,0,0]
v_fma_mix_f32 v13, v215, v167, v171 op_sel:[1,0,0] op_sel_hi:[1,0,0]
v_cvt_pk_bf16_f32 v215, v12, v13
v_mfma_f32_32x32x16_bf16 v[128:143], a[220:223], v[204:207], v[128:143]
ds_read_b64_tr_b16 a[246:247], v173 offset:29696
v_mfma_f32_32x32x16_bf16 v[16:31], a[224:227], v[208:211], v[16:31]
s_mov_b32 s51, 20480
ds_read_b64_tr_b16 a[248:249], v174 offset:28672
ds_read_b128 v[164:167], v15 offset:1024
buffer_load_dwordx4 v[192:195], v14, s[20:23], s51 offen offset:2048 sc1
s_waitcnt vmcnt(13)
s_waitcnt lgkmcnt(6)
v_fma_mix_f32 v8, v216, v144, v148 op_sel_hi:[1,0,0]
v_fma_mix_f32 v9, v216, v145, v149 op_sel:[1,0,0] op_sel_hi:[1,0,0]
v_cvt_pk_bf16_f32 v216, v8, v9
v_mfma_f32_32x32x16_bf16 v[80:95], a[224:227], v[212:215], v[80:95]
s_mov_b32 s51, 53248
ds_read_b64_tr_b16 a[250:251], v174 offset:29696
ds_read_b128 v[168:171], v15 offset:3072
v_fma_mix_f32 v10, v217, v146, v150 op_sel_hi:[1,0,0]
v_fma_mix_f32 v11, v217, v147, v151 op_sel:[1,0,0] op_sel_hi:[1,0,0]
v_cvt_pk_bf16_f32 v217, v10, v11
v_mfma_f32_32x32x16_bf16 v[32:47], a[228:231], v[208:211], v[32:47]
ds_read_b64_tr_b16 a[252:253], v175 offset:28672
buffer_load_dwordx4 v[196:199], v14, s[20:23], s51 offen offset:2048 sc1
v_fma_mix_f32 v12, v220, v144, v148 op_sel_hi:[1,0,0]
v_fma_mix_f32 v13, v220, v145, v149 op_sel:[1,0,0] op_sel_hi:[1,0,0]
v_cvt_pk_bf16_f32 v220, v12, v13
v_mfma_f32_32x32x16_bf16 v[96:111], a[228:231], v[212:215], v[96:111]
s_mov_b32 s51, 20480
ds_read_b64_tr_b16 a[254:255], v175 offset:29696
v_fma_mix_f32 v8, v221, v146, v150 op_sel_hi:[1,0,0]
v_fma_mix_f32 v9, v221, v147, v151 op_sel:[1,0,0] op_sel_hi:[1,0,0]
v_cvt_pk_bf16_f32 v221, v8, v9
s_barrier
v_add_u32 v172, 0x8000, v172
v_add_u32 v173, 0x8000, v173
v_add_u32 v174, 0x8000, v174
v_add_u32 v175, 0x8000, v175
v_mfma_f32_32x32x16_bf16 v[48:63], a[232:235], v[208:211], v[48:63]
ds_read_b64_tr_b16 a[192:193], v172 offset:0
ds_read_b128 v[144:147], v15 offset:1040
buffer_load_dwordx4 v[200:203], v14, s[20:23], s51 offen offset:3072 sc1
s_waitcnt lgkmcnt(6)
v_fma_mix_f32 v10, v218, v152, v160 op_sel_hi:[1,0,0]
v_fma_mix_f32 v11, v218, v153, v161 op_sel:[1,0,0] op_sel_hi:[1,0,0]
v_cvt_pk_bf16_f32 v218, v10, v11
v_fma_mix_f32 v12, v219, v154, v162 op_sel_hi:[1,0,0]
v_mfma_f32_32x32x16_bf16 v[112:127], a[232:235], v[212:215], v[112:127]
s_mov_b32 s51, 53248
ds_read_b64_tr_b16 a[194:195], v172 offset:1024
ds_read_b128 v[148:151], v15 offset:3088
v_fma_mix_f32 v13, v219, v155, v163 op_sel:[1,0,0] op_sel_hi:[1,0,0]
v_cvt_pk_bf16_f32 v219, v12, v13
v_fma_mix_f32 v8, v222, v152, v160 op_sel_hi:[1,0,0]
v_fma_mix_f32 v9, v222, v153, v161 op_sel:[1,0,0] op_sel_hi:[1,0,0]
v_mfma_f32_32x32x16_bf16 v[64:79], a[236:239], v[208:211], v[64:79]
ds_read_b64_tr_b16 a[196:197], v173 offset:0
buffer_load_dwordx4 v[204:207], v14, s[20:23], s51 offen offset:3072 sc1
v_cvt_pk_bf16_f32 v222, v8, v9
v_fma_mix_f32 v10, v223, v154, v162 op_sel_hi:[1,0,0]
v_fma_mix_f32 v11, v223, v155, v163 op_sel:[1,0,0] op_sel_hi:[1,0,0]
v_cvt_pk_bf16_f32 v223, v10, v11
v_mfma_f32_32x32x16_bf16 v[128:143], a[236:239], v[212:215], v[128:143]
ds_read_b64_tr_b16 a[198:199], v173 offset:1024
v_mfma_f32_32x32x16_bf16 v[16:31], a[240:243], v[216:219], v[16:31]
ds_read_b64_tr_b16 a[200:201], v174 offset:0
ds_read_b128 v[152:155], v15 offset:1088
s_waitcnt vmcnt(14)
s_waitcnt lgkmcnt(6)
v_fma_mix_f32 v12, v224, v164, v168 op_sel_hi:[1,0,0]
v_fma_mix_f32 v13, v224, v165, v169 op_sel:[1,0,0] op_sel_hi:[1,0,0]
v_cvt_pk_bf16_f32 v224, v12, v13
v_mfma_f32_32x32x16_bf16 v[80:95], a[240:243], v[220:223], v[80:95]
ds_read_b64_tr_b16 a[202:203], v174 offset:1024
ds_read_b128 v[160:163], v15 offset:3136
v_fma_mix_f32 v8, v225, v166, v170 op_sel_hi:[1,0,0]
v_fma_mix_f32 v9, v225, v167, v171 op_sel:[1,0,0] op_sel_hi:[1,0,0]
v_cvt_pk_bf16_f32 v225, v8, v9
v_mfma_f32_32x32x16_bf16 v[32:47], a[244:247], v[216:219], v[32:47]
ds_read_b64_tr_b16 a[204:205], v175 offset:0
v_fma_mix_f32 v10, v228, v164, v168 op_sel_hi:[1,0,0]
v_fma_mix_f32 v11, v228, v165, v169 op_sel:[1,0,0] op_sel_hi:[1,0,0]
v_cvt_pk_bf16_f32 v228, v10, v11
v_mfma_f32_32x32x16_bf16 v[96:111], a[244:247], v[220:223], v[96:111]
ds_read_b64_tr_b16 a[206:207], v175 offset:1024
v_fma_mix_f32 v12, v229, v166, v170 op_sel_hi:[1,0,0]
v_fma_mix_f32 v13, v229, v167, v171 op_sel:[1,0,0] op_sel_hi:[1,0,0]
v_cvt_pk_bf16_f32 v229, v12, v13
v_mfma_f32_32x32x16_bf16 v[48:63], a[248:251], v[216:219], v[48:63]
ds_read_b64_tr_b16 a[208:209], v172 offset:4096
ds_read_b128 v[164:167], v15 offset:1104
s_waitcnt lgkmcnt(6)
v_fma_mix_f32 v8, v226, v144, v148 op_sel_hi:[1,0,0]
v_fma_mix_f32 v9, v226, v145, v149 op_sel:[1,0,0] op_sel_hi:[1,0,0]
v_cvt_pk_bf16_f32 v226, v8, v9
v_fma_mix_f32 v10, v227, v146, v150 op_sel_hi:[1,0,0]
v_mfma_f32_32x32x16_bf16 v[112:127], a[248:251], v[220:223], v[112:127]
ds_read_b64_tr_b16 a[210:211], v172 offset:5120
ds_read_b128 v[168:171], v15 offset:3152
v_fma_mix_f32 v11, v227, v147, v151 op_sel:[1,0,0] op_sel_hi:[1,0,0]
v_cvt_pk_bf16_f32 v227, v10, v11
v_fma_mix_f32 v12, v230, v144, v148 op_sel_hi:[1,0,0]
v_fma_mix_f32 v13, v230, v145, v149 op_sel:[1,0,0] op_sel_hi:[1,0,0]
v_mfma_f32_32x32x16_bf16 v[64:79], a[252:255], v[216:219], v[64:79]
ds_read_b64_tr_b16 a[212:213], v173 offset:4096
v_cvt_pk_bf16_f32 v230, v12, v13
v_fma_mix_f32 v8, v231, v146, v150 op_sel_hi:[1,0,0]
v_fma_mix_f32 v9, v231, v147, v151 op_sel:[1,0,0] op_sel_hi:[1,0,0]
v_cvt_pk_bf16_f32 v231, v8, v9
v_mfma_f32_32x32x16_bf16 v[128:143], a[252:255], v[220:223], v[128:143]
ds_read_b64_tr_b16 a[214:215], v173 offset:5120
v_mfma_f32_32x32x16_bf16 v[16:31], a[192:195], v[224:227], v[16:31]
s_mov_b32 s51, 24576
ds_read_b64_tr_b16 a[216:217], v174 offset:4096
ds_read_b128 v[144:147], v15 offset:1152
buffer_load_dwordx4 v[208:211], v14, s[20:23], s51 offen offset:0 sc1
s_waitcnt vmcnt(13)
s_waitcnt lgkmcnt(6)
v_fma_mix_f32 v10, v232, v152, v160 op_sel_hi:[1,0,0]
v_fma_mix_f32 v11, v232, v153, v161 op_sel:[1,0,0] op_sel_hi:[1,0,0]
v_cvt_pk_bf16_f32 v232, v10, v11
v_mfma_f32_32x32x16_bf16 v[80:95], a[192:195], v[228:231], v[80:95]
s_mov_b32 s51, 57344
ds_read_b64_tr_b16 a[218:219], v174 offset:5120
ds_read_b128 v[148:151], v15 offset:3200
v_fma_mix_f32 v12, v233, v154, v162 op_sel_hi:[1,0,0]
v_fma_mix_f32 v13, v233, v155, v163 op_sel:[1,0,0] op_sel_hi:[1,0,0]
v_cvt_pk_bf16_f32 v233, v12, v13
v_mfma_f32_32x32x16_bf16 v[32:47], a[196:199], v[224:227], v[32:47]
ds_read_b64_tr_b16 a[220:221], v175 offset:4096
buffer_load_dwordx4 v[212:215], v14, s[20:23], s51 offen offset:0 sc1
v_fma_mix_f32 v8, v236, v152, v160 op_sel_hi:[1,0,0]
v_fma_mix_f32 v9, v236, v153, v161 op_sel:[1,0,0] op_sel_hi:[1,0,0]
v_cvt_pk_bf16_f32 v236, v8, v9
v_mfma_f32_32x32x16_bf16 v[96:111], a[196:199], v[228:231], v[96:111]
s_mov_b32 s51, 24576
ds_read_b64_tr_b16 a[222:223], v175 offset:5120
v_fma_mix_f32 v10, v237, v154, v162 op_sel_hi:[1,0,0]
v_fma_mix_f32 v11, v237, v155, v163 op_sel:[1,0,0] op_sel_hi:[1,0,0]
v_cvt_pk_bf16_f32 v237, v10, v11
v_mfma_f32_32x32x16_bf16 v[48:63], a[200:203], v[224:227], v[48:63]
ds_read_b64_tr_b16 a[224:225], v172 offset:8192
ds_read_b128 v[152:155], v15 offset:1168
buffer_load_dwordx4 v[216:219], v14, s[20:23], s51 offen offset:1024 sc1
s_waitcnt lgkmcnt(6)
v_fma_mix_f32 v12, v234, v164, v168 op_sel_hi:[1,0,0]
v_fma_mix_f32 v13, v234, v165, v169 op_sel:[1,0,0] op_sel_hi:[1,0,0]
v_cvt_pk_bf16_f32 v234, v12, v13
v_fma_mix_f32 v8, v235, v166, v170 op_sel_hi:[1,0,0]
v_mfma_f32_32x32x16_bf16 v[112:127], a[200:203], v[228:231], v[112:127]
s_mov_b32 s51, 57344
ds_read_b64_tr_b16 a[226:227], v172 offset:9216
ds_read_b128 v[160:163], v15 offset:3216
v_fma_mix_f32 v9, v235, v167, v171 op_sel:[1,0,0] op_sel_hi:[1,0,0]
v_cvt_pk_bf16_f32 v235, v8, v9
v_fma_mix_f32 v10, v238, v164, v168 op_sel_hi:[1,0,0]
v_fma_mix_f32 v11, v238, v165, v169 op_sel:[1,0,0] op_sel_hi:[1,0,0]
v_mfma_f32_32x32x16_bf16 v[64:79], a[204:207], v[224:227], v[64:79]
ds_read_b64_tr_b16 a[228:229], v173 offset:8192
buffer_load_dwordx4 v[220:223], v14, s[20:23], s51 offen offset:1024 sc1
v_cvt_pk_bf16_f32 v238, v10, v11
v_fma_mix_f32 v12, v239, v166, v170 op_sel_hi:[1,0,0]
v_fma_mix_f32 v13, v239, v167, v171 op_sel:[1,0,0] op_sel_hi:[1,0,0]
v_cvt_pk_bf16_f32 v239, v12, v13
v_mfma_f32_32x32x16_bf16 v[128:143], a[204:207], v[228:231], v[128:143]
ds_read_b64_tr_b16 a[230:231], v173 offset:9216
v_mfma_f32_32x32x16_bf16 v[16:31], a[208:211], v[232:235], v[16:31]
s_add_u32 s54, s48, 16384
s_mov_b32 m0, s54
ds_read_b64_tr_b16 a[232:233], v174 offset:8192
ds_read_b128 v[164:167], v15 offset:1216
s_waitcnt vmcnt(14)
s_waitcnt lgkmcnt(6)
v_fma_mix_f32 v8, v240, v144, v148 op_sel_hi:[1,0,0]
v_fma_mix_f32 v9, v240, v145, v149 op_sel:[1,0,0] op_sel_hi:[1,0,0]
v_cvt_pk_bf16_f32 v240, v8, v9
v_mfma_f32_32x32x16_bf16 v[80:95], a[208:211], v[236:239], v[80:95]
ds_read_b64_tr_b16 a[234:235], v174 offset:9216
ds_read_b128 v[168:171], v15 offset:3264
buffer_load_dwordx4 v156, s[8:11], s54 offen offset:0 nt lds
v_fma_mix_f32 v10, v241, v146, v150 op_sel_hi:[1,0,0]
v_fma_mix_f32 v11, v241, v147, v151 op_sel:[1,0,0] op_sel_hi:[1,0,0]
v_cvt_pk_bf16_f32 v241, v10, v11
v_mfma_f32_32x32x16_bf16 v[32:47], a[212:215], v[232:235], v[32:47]
ds_read_b64_tr_b16 a[236:237], v175 offset:8192
v_fma_mix_f32 v12, v244, v144, v148 op_sel_hi:[1,0,0]
v_fma_mix_f32 v13, v244, v145, v149 op_sel:[1,0,0] op_sel_hi:[1,0,0]
v_cvt_pk_bf16_f32 v244, v12, v13
v_mfma_f32_32x32x16_bf16 v[96:111], a[212:215], v[236:239], v[96:111]
ds_read_b64_tr_b16 a[238:239], v175 offset:9216
buffer_load_dwordx4 v157, s[8:11], s54 offen offset:1024 nt lds
v_fma_mix_f32 v8, v245, v146, v150 op_sel_hi:[1,0,0]
v_fma_mix_f32 v9, v245, v147, v151 op_sel:[1,0,0] op_sel_hi:[1,0,0]
v_cvt_pk_bf16_f32 v245, v8, v9
v_mfma_f32_32x32x16_bf16 v[48:63], a[216:219], v[232:235], v[48:63]
ds_read_b64_tr_b16 a[240:241], v172 offset:12288
ds_read_b128 v[144:147], v15 offset:1232
s_waitcnt lgkmcnt(6)
v_fma_mix_f32 v10, v242, v152, v160 op_sel_hi:[1,0,0]
v_fma_mix_f32 v11, v242, v153, v161 op_sel:[1,0,0] op_sel_hi:[1,0,0]
v_cvt_pk_bf16_f32 v242, v10, v11
v_fma_mix_f32 v12, v243, v154, v162 op_sel_hi:[1,0,0]
v_mfma_f32_32x32x16_bf16 v[112:127], a[216:219], v[236:239], v[112:127]
ds_read_b64_tr_b16 a[242:243], v172 offset:13312
ds_read_b128 v[148:151], v15 offset:3280
buffer_load_dwordx4 v158, s[8:11], s54 offen offset:2048 nt lds
v_fma_mix_f32 v13, v243, v155, v163 op_sel:[1,0,0] op_sel_hi:[1,0,0]
v_cvt_pk_bf16_f32 v243, v12, v13
v_fma_mix_f32 v8, v246, v152, v160 op_sel_hi:[1,0,0]
v_fma_mix_f32 v9, v246, v153, v161 op_sel:[1,0,0] op_sel_hi:[1,0,0]
v_mfma_f32_32x32x16_bf16 v[64:79], a[220:223], v[232:235], v[64:79]
ds_read_b64_tr_b16 a[244:245], v173 offset:12288
v_cvt_pk_bf16_f32 v246, v8, v9
v_fma_mix_f32 v10, v247, v154, v162 op_sel_hi:[1,0,0]
v_fma_mix_f32 v11, v247, v155, v163 op_sel:[1,0,0] op_sel_hi:[1,0,0]
v_cvt_pk_bf16_f32 v247, v10, v11
v_mfma_f32_32x32x16_bf16 v[128:143], a[220:223], v[236:239], v[128:143]
ds_read_b64_tr_b16 a[246:247], v173 offset:13312
buffer_load_dwordx4 v159, s[8:11], s54 offen offset:3072 nt lds
v_mfma_f32_32x32x16_bf16 v[16:31], a[224:227], v[240:243], v[16:31]
s_mov_b32 s51, 24576
ds_read_b64_tr_b16 a[248:249], v174 offset:12288
ds_read_b128 v[152:155], v15 offset:1280
buffer_load_dwordx4 v[224:227], v14, s[20:23], s51 offen offset:2048 sc1
s_waitcnt vmcnt(17)
s_waitcnt lgkmcnt(6)
v_fma_mix_f32 v12, v248, v164, v168 op_sel_hi:[1,0,0]
v_fma_mix_f32 v13, v248, v165, v169 op_sel:[1,0,0] op_sel_hi:[1,0,0]
v_cvt_pk_bf16_f32 v248, v12, v13
v_mfma_f32_32x32x16_bf16 v[80:95], a[224:227], v[244:247], v[80:95]
s_mov_b32 s51, 57344
ds_read_b64_tr_b16 a[250:251], v174 offset:13312
ds_read_b128 v[160:163], v15 offset:3328
v_fma_mix_f32 v8, v249, v166, v170 op_sel_hi:[1,0,0]
v_fma_mix_f32 v9, v249, v167, v171 op_sel:[1,0,0] op_sel_hi:[1,0,0]
v_cvt_pk_bf16_f32 v249, v8, v9
v_mfma_f32_32x32x16_bf16 v[32:47], a[228:231], v[240:243], v[32:47]
ds_read_b64_tr_b16 a[252:253], v175 offset:12288
buffer_load_dwordx4 v[228:231], v14, s[20:23], s51 offen offset:2048 sc1
v_fma_mix_f32 v10, v252, v164, v168 op_sel_hi:[1,0,0]
v_fma_mix_f32 v11, v252, v165, v169 op_sel:[1,0,0] op_sel_hi:[1,0,0]
v_cvt_pk_bf16_f32 v252, v10, v11
v_mfma_f32_32x32x16_bf16 v[96:111], a[228:231], v[244:247], v[96:111]
s_mov_b32 s51, 24576
ds_read_b64_tr_b16 a[254:255], v175 offset:13312
v_fma_mix_f32 v12, v253, v166, v170 op_sel_hi:[1,0,0]
v_fma_mix_f32 v13, v253, v167, v171 op_sel:[1,0,0] op_sel_hi:[1,0,0]
v_cvt_pk_bf16_f32 v253, v12, v13
v_mfma_f32_32x32x16_bf16 v[48:63], a[232:235], v[240:243], v[48:63]
ds_read_b64_tr_b16 a[192:193], v172 offset:16384
ds_read_b128 v[164:167], v15 offset:1296
buffer_load_dwordx4 v[232:235], v14, s[20:23], s51 offen offset:3072 sc1
s_waitcnt lgkmcnt(6)
v_fma_mix_f32 v8, v250, v144, v148 op_sel_hi:[1,0,0]
v_fma_mix_f32 v9, v250, v145, v149 op_sel:[1,0,0] op_sel_hi:[1,0,0]
v_cvt_pk_bf16_f32 v250, v8, v9
v_fma_mix_f32 v10, v251, v146, v150 op_sel_hi:[1,0,0]
v_mfma_f32_32x32x16_bf16 v[112:127], a[232:235], v[244:247], v[112:127]
s_mov_b32 s51, 57344
ds_read_b64_tr_b16 a[194:195], v172 offset:17408
ds_read_b128 v[168:171], v15 offset:3344
v_fma_mix_f32 v11, v251, v147, v151 op_sel:[1,0,0] op_sel_hi:[1,0,0]
v_cvt_pk_bf16_f32 v251, v10, v11
v_fma_mix_f32 v12, v254, v144, v148 op_sel_hi:[1,0,0]
v_fma_mix_f32 v13, v254, v145, v149 op_sel:[1,0,0] op_sel_hi:[1,0,0]
v_mfma_f32_32x32x16_bf16 v[64:79], a[236:239], v[240:243], v[64:79]
ds_read_b64_tr_b16 a[196:197], v173 offset:16384
buffer_load_dwordx4 v[236:239], v14, s[20:23], s51 offen offset:3072 sc1
v_cvt_pk_bf16_f32 v254, v12, v13
v_fma_mix_f32 v8, v255, v146, v150 op_sel_hi:[1,0,0]
v_fma_mix_f32 v9, v255, v147, v151 op_sel:[1,0,0] op_sel_hi:[1,0,0]
v_cvt_pk_bf16_f32 v255, v8, v9
v_mfma_f32_32x32x16_bf16 v[128:143], a[236:239], v[244:247], v[128:143]
ds_read_b64_tr_b16 a[198:199], v173 offset:17408
v_mfma_f32_32x32x16_bf16 v[16:31], a[240:243], v[248:251], v[16:31]
s_add_u32 s55, s48, 20480
s_mov_b32 m0, s55
ds_read_b64_tr_b16 a[200:201], v174 offset:16384
ds_read_b128 v[144:147], v15 offset:1344
s_waitcnt vmcnt(18)
s_waitcnt lgkmcnt(6)
v_fma_mix_f32 v10, v176, v152, v160 op_sel_hi:[1,0,0]
v_fma_mix_f32 v11, v176, v153, v161 op_sel:[1,0,0] op_sel_hi:[1,0,0]
v_cvt_pk_bf16_f32 v176, v10, v11
v_mfma_f32_32x32x16_bf16 v[80:95], a[240:243], v[252:255], v[80:95]
ds_read_b64_tr_b16 a[202:203], v174 offset:17408
ds_read_b128 v[148:151], v15 offset:3392
buffer_load_dwordx4 v156, s[8:11], s55 offen offset:0 nt lds
v_fma_mix_f32 v12, v177, v154, v162 op_sel_hi:[1,0,0]
v_fma_mix_f32 v13, v177, v155, v163 op_sel:[1,0,0] op_sel_hi:[1,0,0]
v_cvt_pk_bf16_f32 v177, v12, v13
v_mfma_f32_32x32x16_bf16 v[32:47], a[244:247], v[248:251], v[32:47]
ds_read_b64_tr_b16 a[204:205], v175 offset:16384
v_fma_mix_f32 v8, v180, v152, v160 op_sel_hi:[1,0,0]
v_fma_mix_f32 v9, v180, v153, v161 op_sel:[1,0,0] op_sel_hi:[1,0,0]
v_cvt_pk_bf16_f32 v180, v8, v9
v_mfma_f32_32x32x16_bf16 v[96:111], a[244:247], v[252:255], v[96:111]
ds_read_b64_tr_b16 a[206:207], v175 offset:17408
buffer_load_dwordx4 v157, s[8:11], s55 offen offset:1024 nt lds
v_fma_mix_f32 v10, v181, v154, v162 op_sel_hi:[1,0,0]
v_fma_mix_f32 v11, v181, v155, v163 op_sel:[1,0,0] op_sel_hi:[1,0,0]
v_cvt_pk_bf16_f32 v181, v10, v11
v_mfma_f32_32x32x16_bf16 v[48:63], a[248:251], v[248:251], v[48:63]
ds_read_b64_tr_b16 a[208:209], v172 offset:20480
ds_read_b128 v[152:155], v15 offset:1360
s_waitcnt lgkmcnt(6)
v_fma_mix_f32 v12, v178, v164, v168 op_sel_hi:[1,0,0]
v_fma_mix_f32 v13, v178, v165, v169 op_sel:[1,0,0] op_sel_hi:[1,0,0]
v_cvt_pk_bf16_f32 v178, v12, v13
v_fma_mix_f32 v8, v179, v166, v170 op_sel_hi:[1,0,0]
v_mfma_f32_32x32x16_bf16 v[112:127], a[248:251], v[252:255], v[112:127]
ds_read_b64_tr_b16 a[210:211], v172 offset:21504
ds_read_b128 v[160:163], v15 offset:3408
buffer_load_dwordx4 v158, s[8:11], s55 offen offset:2048 nt lds
v_fma_mix_f32 v9, v179, v167, v171 op_sel:[1,0,0] op_sel_hi:[1,0,0]
v_cvt_pk_bf16_f32 v179, v8, v9
v_fma_mix_f32 v10, v182, v164, v168 op_sel_hi:[1,0,0]
v_fma_mix_f32 v11, v182, v165, v169 op_sel:[1,0,0] op_sel_hi:[1,0,0]
v_mfma_f32_32x32x16_bf16 v[64:79], a[252:255], v[248:251], v[64:79]
ds_read_b64_tr_b16 a[212:213], v173 offset:20480
v_cvt_pk_bf16_f32 v182, v10, v11
v_fma_mix_f32 v12, v183, v166, v170 op_sel_hi:[1,0,0]
v_fma_mix_f32 v13, v183, v167, v171 op_sel:[1,0,0] op_sel_hi:[1,0,0]
v_cvt_pk_bf16_f32 v183, v12, v13
v_mfma_f32_32x32x16_bf16 v[128:143], a[252:255], v[252:255], v[128:143]
ds_read_b64_tr_b16 a[214:215], v173 offset:21504
buffer_load_dwordx4 v159, s[8:11], s55 offen offset:3072 nt lds
v_mfma_f32_32x32x16_bf16 v[16:31], a[192:195], v[176:179], v[16:31]
s_mov_b32 s51, 28672
ds_read_b64_tr_b16 a[216:217], v174 offset:20480
ds_read_b128 v[164:167], v15 offset:1408
buffer_load_dwordx4 v[240:243], v14, s[20:23], s51 offen offset:0 sc1
s_waitcnt vmcnt(21)
s_waitcnt lgkmcnt(6)
v_fma_mix_f32 v8, v184, v144, v148 op_sel_hi:[1,0,0]
v_fma_mix_f32 v9, v184, v145, v149 op_sel:[1,0,0] op_sel_hi:[1,0,0]
v_cvt_pk_bf16_f32 v184, v8, v9
v_mfma_f32_32x32x16_bf16 v[80:95], a[192:195], v[180:183], v[80:95]
s_mov_b32 s51, 61440
ds_read_b64_tr_b16 a[218:219], v174 offset:21504
ds_read_b128 v[168:171], v15 offset:3456
v_fma_mix_f32 v10, v185, v146, v150 op_sel_hi:[1,0,0]
v_fma_mix_f32 v11, v185, v147, v151 op_sel:[1,0,0] op_sel_hi:[1,0,0]
v_cvt_pk_bf16_f32 v185, v10, v11
v_mfma_f32_32x32x16_bf16 v[32:47], a[196:199], v[176:179], v[32:47]
ds_read_b64_tr_b16 a[220:221], v175 offset:20480
buffer_load_dwordx4 v[244:247], v14, s[20:23], s51 offen offset:0 sc1
v_fma_mix_f32 v12, v188, v144, v148 op_sel_hi:[1,0,0]
v_fma_mix_f32 v13, v188, v145, v149 op_sel:[1,0,0] op_sel_hi:[1,0,0]
v_cvt_pk_bf16_f32 v188, v12, v13
v_mfma_f32_32x32x16_bf16 v[96:111], a[196:199], v[180:183], v[96:111]
s_mov_b32 s51, 28672
ds_read_b64_tr_b16 a[222:223], v175 offset:21504
v_fma_mix_f32 v8, v189, v146, v150 op_sel_hi:[1,0,0]
v_fma_mix_f32 v9, v189, v147, v151 op_sel:[1,0,0] op_sel_hi:[1,0,0]
v_cvt_pk_bf16_f32 v189, v8, v9
v_mfma_f32_32x32x16_bf16 v[48:63], a[200:203], v[176:179], v[48:63]
ds_read_b64_tr_b16 a[224:225], v172 offset:24576
ds_read_b128 v[144:147], v15 offset:1424
buffer_load_dwordx4 v[248:251], v14, s[20:23], s51 offen offset:1024 sc1
s_waitcnt lgkmcnt(6)
v_fma_mix_f32 v10, v186, v152, v160 op_sel_hi:[1,0,0]
v_fma_mix_f32 v11, v186, v153, v161 op_sel:[1,0,0] op_sel_hi:[1,0,0]
v_cvt_pk_bf16_f32 v186, v10, v11
v_fma_mix_f32 v12, v187, v154, v162 op_sel_hi:[1,0,0]
v_mfma_f32_32x32x16_bf16 v[112:127], a[200:203], v[180:183], v[112:127]
s_mov_b32 s51, 61440
ds_read_b64_tr_b16 a[226:227], v172 offset:25600
ds_read_b128 v[148:151], v15 offset:3472
v_fma_mix_f32 v13, v187, v155, v163 op_sel:[1,0,0] op_sel_hi:[1,0,0]
v_cvt_pk_bf16_f32 v187, v12, v13
v_fma_mix_f32 v8, v190, v152, v160 op_sel_hi:[1,0,0]
v_fma_mix_f32 v9, v190, v153, v161 op_sel:[1,0,0] op_sel_hi:[1,0,0]
v_mfma_f32_32x32x16_bf16 v[64:79], a[204:207], v[176:179], v[64:79]
ds_read_b64_tr_b16 a[228:229], v173 offset:24576
buffer_load_dwordx4 v[252:255], v14, s[20:23], s51 offen offset:1024 sc1
v_cvt_pk_bf16_f32 v190, v8, v9
v_fma_mix_f32 v10, v191, v154, v162 op_sel_hi:[1,0,0]
v_fma_mix_f32 v11, v191, v155, v163 op_sel:[1,0,0] op_sel_hi:[1,0,0]
v_cvt_pk_bf16_f32 v191, v10, v11
v_mfma_f32_32x32x16_bf16 v[128:143], a[204:207], v[180:183], v[128:143]
ds_read_b64_tr_b16 a[230:231], v173 offset:25600
v_mfma_f32_32x32x16_bf16 v[16:31], a[208:211], v[184:187], v[16:31]
ds_read_b64_tr_b16 a[232:233], v174 offset:24576
ds_read_b128 v[152:155], v15 offset:1472
s_waitcnt vmcnt(22)
s_waitcnt lgkmcnt(6)
v_fma_mix_f32 v12, v192, v164, v168 op_sel_hi:[1,0,0]
v_fma_mix_f32 v13, v192, v165, v169 op_sel:[1,0,0] op_sel_hi:[1,0,0]
v_cvt_pk_bf16_f32 v192, v12, v13
v_mfma_f32_32x32x16_bf16 v[80:95], a[208:211], v[188:191], v[80:95]
ds_read_b64_tr_b16 a[234:235], v174 offset:25600
ds_read_b128 v[160:163], v15 offset:3520
v_fma_mix_f32 v8, v193, v166, v170 op_sel_hi:[1,0,0]
v_fma_mix_f32 v9, v193, v167, v171 op_sel:[1,0,0] op_sel_hi:[1,0,0]
v_cvt_pk_bf16_f32 v193, v8, v9
v_mfma_f32_32x32x16_bf16 v[32:47], a[212:215], v[184:187], v[32:47]
ds_read_b64_tr_b16 a[236:237], v175 offset:24576
v_fma_mix_f32 v10, v196, v164, v168 op_sel_hi:[1,0,0]
v_fma_mix_f32 v11, v196, v165, v169 op_sel:[1,0,0] op_sel_hi:[1,0,0]
v_cvt_pk_bf16_f32 v196, v10, v11
v_mfma_f32_32x32x16_bf16 v[96:111], a[212:215], v[188:191], v[96:111]
ds_read_b64_tr_b16 a[238:239], v175 offset:25600
v_fma_mix_f32 v12, v197, v166, v170 op_sel_hi:[1,0,0]
v_fma_mix_f32 v13, v197, v167, v171 op_sel:[1,0,0] op_sel_hi:[1,0,0]
v_cvt_pk_bf16_f32 v197, v12, v13
v_mfma_f32_32x32x16_bf16 v[48:63], a[216:219], v[184:187], v[48:63]
ds_read_b64_tr_b16 a[240:241], v172 offset:28672
ds_read_b128 v[164:167], v15 offset:1488
s_waitcnt lgkmcnt(6)
v_fma_mix_f32 v8, v194, v144, v148 op_sel_hi:[1,0,0]
v_fma_mix_f32 v9, v194, v145, v149 op_sel:[1,0,0] op_sel_hi:[1,0,0]
v_cvt_pk_bf16_f32 v194, v8, v9
v_fma_mix_f32 v10, v195, v146, v150 op_sel_hi:[1,0,0]
v_mfma_f32_32x32x16_bf16 v[112:127], a[216:219], v[188:191], v[112:127]
ds_read_b64_tr_b16 a[242:243], v172 offset:29696
ds_read_b128 v[168:171], v15 offset:3536
v_fma_mix_f32 v11, v195, v147, v151 op_sel:[1,0,0] op_sel_hi:[1,0,0]
v_cvt_pk_bf16_f32 v195, v10, v11
v_fma_mix_f32 v12, v198, v144, v148 op_sel_hi:[1,0,0]
v_fma_mix_f32 v13, v198, v145, v149 op_sel:[1,0,0] op_sel_hi:[1,0,0]
v_mfma_f32_32x32x16_bf16 v[64:79], a[220:223], v[184:187], v[64:79]
ds_read_b64_tr_b16 a[244:245], v173 offset:28672
v_cvt_pk_bf16_f32 v198, v12, v13
v_fma_mix_f32 v8, v199, v146, v150 op_sel_hi:[1,0,0]
v_fma_mix_f32 v9, v199, v147, v151 op_sel:[1,0,0] op_sel_hi:[1,0,0]
v_cvt_pk_bf16_f32 v199, v8, v9
v_mfma_f32_32x32x16_bf16 v[128:143], a[220:223], v[188:191], v[128:143]
ds_read_b64_tr_b16 a[246:247], v173 offset:29696
v_mfma_f32_32x32x16_bf16 v[16:31], a[224:227], v[192:195], v[16:31]
s_mov_b32 s51, 28672
ds_read_b64_tr_b16 a[248:249], v174 offset:28672
ds_read_b128 v[144:147], v15 offset:1536
buffer_load_dwordx4 v[176:179], v14, s[20:23], s51 offen offset:2048 sc1
s_waitcnt vmcnt(21)
s_waitcnt lgkmcnt(6)
v_fma_mix_f32 v10, v200, v152, v160 op_sel_hi:[1,0,0]
v_fma_mix_f32 v11, v200, v153, v161 op_sel:[1,0,0] op_sel_hi:[1,0,0]
v_cvt_pk_bf16_f32 v200, v10, v11
v_mfma_f32_32x32x16_bf16 v[80:95], a[224:227], v[196:199], v[80:95]
s_mov_b32 s51, 61440
ds_read_b64_tr_b16 a[250:251], v174 offset:29696
ds_read_b128 v[148:151], v15 offset:3584
v_fma_mix_f32 v12, v201, v154, v162 op_sel_hi:[1,0,0]
v_fma_mix_f32 v13, v201, v155, v163 op_sel:[1,0,0] op_sel_hi:[1,0,0]
v_cvt_pk_bf16_f32 v201, v12, v13
v_mfma_f32_32x32x16_bf16 v[32:47], a[228:231], v[192:195], v[32:47]
ds_read_b64_tr_b16 a[252:253], v175 offset:28672
buffer_load_dwordx4 v[180:183], v14, s[20:23], s51 offen offset:2048 sc1
v_fma_mix_f32 v8, v204, v152, v160 op_sel_hi:[1,0,0]
v_fma_mix_f32 v9, v204, v153, v161 op_sel:[1,0,0] op_sel_hi:[1,0,0]
v_cvt_pk_bf16_f32 v204, v8, v9
v_mfma_f32_32x32x16_bf16 v[96:111], a[228:231], v[196:199], v[96:111]
s_mov_b32 s51, 28672
ds_read_b64_tr_b16 a[254:255], v175 offset:29696
v_fma_mix_f32 v10, v205, v154, v162 op_sel_hi:[1,0,0]
v_fma_mix_f32 v11, v205, v155, v163 op_sel:[1,0,0] op_sel_hi:[1,0,0]
v_cvt_pk_bf16_f32 v205, v10, v11
s_barrier
v_add_u32 v172, 0x8000, v172
v_add_u32 v173, 0x8000, v173
v_add_u32 v174, 0x8000, v174
v_add_u32 v175, 0x8000, v175
v_mfma_f32_32x32x16_bf16 v[48:63], a[232:235], v[192:195], v[48:63]
ds_read_b64_tr_b16 a[192:193], v172 offset:0
ds_read_b128 v[152:155], v15 offset:1552
buffer_load_dwordx4 v[184:187], v14, s[20:23], s51 offen offset:3072 sc1
s_waitcnt lgkmcnt(6)
v_fma_mix_f32 v12, v202, v164, v168 op_sel_hi:[1,0,0]
v_fma_mix_f32 v13, v202, v165, v169 op_sel:[1,0,0] op_sel_hi:[1,0,0]
v_cvt_pk_bf16_f32 v202, v12, v13
v_fma_mix_f32 v8, v203, v166, v170 op_sel_hi:[1,0,0]
v_mfma_f32_32x32x16_bf16 v[112:127], a[232:235], v[196:199], v[112:127]
s_mov_b32 s51, 61440
ds_read_b64_tr_b16 a[194:195], v172 offset:1024
ds_read_b128 v[160:163], v15 offset:3600
v_fma_mix_f32 v9, v203, v167, v171 op_sel:[1,0,0] op_sel_hi:[1,0,0]
v_cvt_pk_bf16_f32 v203, v8, v9
v_fma_mix_f32 v10, v206, v164, v168 op_sel_hi:[1,0,0]
v_fma_mix_f32 v11, v206, v165, v169 op_sel:[1,0,0] op_sel_hi:[1,0,0]
v_mfma_f32_32x32x16_bf16 v[64:79], a[236:239], v[192:195], v[64:79]
ds_read_b64_tr_b16 a[196:197], v173 offset:0
buffer_load_dwordx4 v[188:191], v14, s[20:23], s51 offen offset:3072 sc1
v_cvt_pk_bf16_f32 v206, v10, v11
v_fma_mix_f32 v12, v207, v166, v170 op_sel_hi:[1,0,0]
v_fma_mix_f32 v13, v207, v167, v171 op_sel:[1,0,0] op_sel_hi:[1,0,0]
v_cvt_pk_bf16_f32 v207, v12, v13
v_mfma_f32_32x32x16_bf16 v[128:143], a[236:239], v[196:199], v[128:143]
ds_read_b64_tr_b16 a[198:199], v173 offset:1024
v_mfma_f32_32x32x16_bf16 v[16:31], a[240:243], v[200:203], v[16:31]
ds_read_b64_tr_b16 a[200:201], v174 offset:0
ds_read_b128 v[164:167], v15 offset:1600
s_waitcnt vmcnt(22)
s_waitcnt lgkmcnt(6)
v_fma_mix_f32 v8, v208, v144, v148 op_sel_hi:[1,0,0]
v_fma_mix_f32 v9, v208, v145, v149 op_sel:[1,0,0] op_sel_hi:[1,0,0]
v_cvt_pk_bf16_f32 v208, v8, v9
v_mfma_f32_32x32x16_bf16 v[80:95], a[240:243], v[204:207], v[80:95]
ds_read_b64_tr_b16 a[202:203], v174 offset:1024
ds_read_b128 v[168:171], v15 offset:3648
v_fma_mix_f32 v10, v209, v146, v150 op_sel_hi:[1,0,0]
v_fma_mix_f32 v11, v209, v147, v151 op_sel:[1,0,0] op_sel_hi:[1,0,0]
v_cvt_pk_bf16_f32 v209, v10, v11
v_mfma_f32_32x32x16_bf16 v[32:47], a[244:247], v[200:203], v[32:47]
ds_read_b64_tr_b16 a[204:205], v175 offset:0
v_fma_mix_f32 v12, v212, v144, v148 op_sel_hi:[1,0,0]
v_fma_mix_f32 v13, v212, v145, v149 op_sel:[1,0,0] op_sel_hi:[1,0,0]
v_cvt_pk_bf16_f32 v212, v12, v13
v_mfma_f32_32x32x16_bf16 v[96:111], a[244:247], v[204:207], v[96:111]
ds_read_b64_tr_b16 a[206:207], v175 offset:1024
v_fma_mix_f32 v8, v213, v146, v150 op_sel_hi:[1,0,0]
v_fma_mix_f32 v9, v213, v147, v151 op_sel:[1,0,0] op_sel_hi:[1,0,0]
v_cvt_pk_bf16_f32 v213, v8, v9
v_mfma_f32_32x32x16_bf16 v[48:63], a[248:251], v[200:203], v[48:63]
ds_read_b64_tr_b16 a[208:209], v172 offset:4096
ds_read_b128 v[144:147], v15 offset:1616
s_waitcnt lgkmcnt(6)
v_fma_mix_f32 v10, v210, v152, v160 op_sel_hi:[1,0,0]
v_fma_mix_f32 v11, v210, v153, v161 op_sel:[1,0,0] op_sel_hi:[1,0,0]
v_cvt_pk_bf16_f32 v210, v10, v11
v_fma_mix_f32 v12, v211, v154, v162 op_sel_hi:[1,0,0]
v_mfma_f32_32x32x16_bf16 v[112:127], a[248:251], v[204:207], v[112:127]
ds_read_b64_tr_b16 a[210:211], v172 offset:5120
ds_read_b128 v[148:151], v15 offset:3664
v_fma_mix_f32 v13, v211, v155, v163 op_sel:[1,0,0] op_sel_hi:[1,0,0]
v_cvt_pk_bf16_f32 v211, v12, v13
v_fma_mix_f32 v8, v214, v152, v160 op_sel_hi:[1,0,0]
v_fma_mix_f32 v9, v214, v153, v161 op_sel:[1,0,0] op_sel_hi:[1,0,0]
v_mfma_f32_32x32x16_bf16 v[64:79], a[252:255], v[200:203], v[64:79]
ds_read_b64_tr_b16 a[212:213], v173 offset:4096
v_cvt_pk_bf16_f32 v214, v8, v9
v_fma_mix_f32 v10, v215, v154, v162 op_sel_hi:[1,0,0]
v_fma_mix_f32 v11, v215, v155, v163 op_sel:[1,0,0] op_sel_hi:[1,0,0]
v_cvt_pk_bf16_f32 v215, v10, v11
v_mfma_f32_32x32x16_bf16 v[128:143], a[252:255], v[204:207], v[128:143]
ds_read_b64_tr_b16 a[214:215], v173 offset:5120
v_mfma_f32_32x32x16_bf16 v[16:31], a[192:195], v[208:211], v[16:31]
s_mul_i32 s54, s28, 6144
s_add_u32 m0, s54, 65536
s_nop 0
ds_read_b64_tr_b16 a[216:217], v174 offset:4096
ds_read_b128 v[152:155], v15 offset:1664
buffer_load_dwordx4 v6, s[12:15], s54 offen offset:0 nt lds
s_waitcnt vmcnt(21)
s_waitcnt lgkmcnt(6)
v_fma_mix_f32 v12, v216, v164, v168 op_sel_hi:[1,0,0]
v_fma_mix_f32 v13, v216, v165, v169 op_sel:[1,0,0] op_sel_hi:[1,0,0]
v_cvt_pk_bf16_f32 v216, v12, v13
v_mfma_f32_32x32x16_bf16 v[80:95], a[192:195], v[212:215], v[80:95]
ds_read_b64_tr_b16 a[218:219], v174 offset:5120
ds_read_b128 v[160:163], v15 offset:3712
v_fma_mix_f32 v8, v217, v166, v170 op_sel_hi:[1,0,0]
v_fma_mix_f32 v9, v217, v167, v171 op_sel:[1,0,0] op_sel_hi:[1,0,0]
v_cvt_pk_bf16_f32 v217, v8, v9
v_mfma_f32_32x32x16_bf16 v[32:47], a[196:199], v[208:211], v[32:47]
ds_read_b64_tr_b16 a[220:221], v175 offset:4096
buffer_load_dwordx4 v7, s[12:15], s54 offen offset:1024 nt lds
v_fma_mix_f32 v10, v220, v164, v168 op_sel_hi:[1,0,0]
v_fma_mix_f32 v11, v220, v165, v169 op_sel:[1,0,0] op_sel_hi:[1,0,0]
v_cvt_pk_bf16_f32 v220, v10, v11
v_mfma_f32_32x32x16_bf16 v[96:111], a[196:199], v[212:215], v[96:111]
ds_read_b64_tr_b16 a[222:223], v175 offset:5120
v_fma_mix_f32 v12, v221, v166, v170 op_sel_hi:[1,0,0]
v_fma_mix_f32 v13, v221, v167, v171 op_sel:[1,0,0] op_sel_hi:[1,0,0]
v_cvt_pk_bf16_f32 v221, v12, v13
v_mfma_f32_32x32x16_bf16 v[48:63], a[200:203], v[208:211], v[48:63]
ds_read_b64_tr_b16 a[224:225], v172 offset:8192
ds_read_b128 v[164:167], v15 offset:1680
buffer_load_dwordx4 v6, s[12:15], s54 offen offset:2048 nt lds
s_waitcnt lgkmcnt(6)
v_fma_mix_f32 v8, v218, v144, v148 op_sel_hi:[1,0,0]
v_fma_mix_f32 v9, v218, v145, v149 op_sel:[1,0,0] op_sel_hi:[1,0,0]
v_cvt_pk_bf16_f32 v218, v8, v9
v_fma_mix_f32 v10, v219, v146, v150 op_sel_hi:[1,0,0]
v_mfma_f32_32x32x16_bf16 v[112:127], a[200:203], v[212:215], v[112:127]
ds_read_b64_tr_b16 a[226:227], v172 offset:9216
ds_read_b128 v[168:171], v15 offset:3728
v_fma_mix_f32 v11, v219, v147, v151 op_sel:[1,0,0] op_sel_hi:[1,0,0]
v_cvt_pk_bf16_f32 v219, v10, v11
v_fma_mix_f32 v12, v222, v144, v148 op_sel_hi:[1,0,0]
v_fma_mix_f32 v13, v222, v145, v149 op_sel:[1,0,0] op_sel_hi:[1,0,0]
v_mfma_f32_32x32x16_bf16 v[64:79], a[204:207], v[208:211], v[64:79]
ds_read_b64_tr_b16 a[228:229], v173 offset:8192
buffer_load_dwordx4 v7, s[12:15], s54 offen offset:3072 nt lds
v_cvt_pk_bf16_f32 v222, v12, v13
v_fma_mix_f32 v8, v223, v146, v150 op_sel_hi:[1,0,0]
v_fma_mix_f32 v9, v223, v147, v151 op_sel:[1,0,0] op_sel_hi:[1,0,0]
v_cvt_pk_bf16_f32 v223, v8, v9
v_mfma_f32_32x32x16_bf16 v[128:143], a[204:207], v[212:215], v[128:143]
ds_read_b64_tr_b16 a[230:231], v173 offset:9216
v_mfma_f32_32x32x16_bf16 v[16:31], a[208:211], v[216:219], v[16:31]
s_add_u32 s54, s54, 4096
s_add_u32 m0, s54, 65536
ds_read_b64_tr_b16 a[232:233], v174 offset:8192
ds_read_b128 v[144:147], v15 offset:1728
s_waitcnt vmcnt(18)
s_waitcnt lgkmcnt(6)
v_fma_mix_f32 v10, v224, v152, v160 op_sel_hi:[1,0,0]
v_fma_mix_f32 v11, v224, v153, v161 op_sel:[1,0,0] op_sel_hi:[1,0,0]
v_cvt_pk_bf16_f32 v224, v10, v11
v_mfma_f32_32x32x16_bf16 v[80:95], a[208:211], v[220:223], v[80:95]
ds_read_b64_tr_b16 a[234:235], v174 offset:9216
ds_read_b128 v[148:151], v15 offset:3776
buffer_load_dwordx4 v6, s[12:15], s54 offen offset:0 nt lds
v_fma_mix_f32 v12, v225, v154, v162 op_sel_hi:[1,0,0]
v_fma_mix_f32 v13, v225, v155, v163 op_sel:[1,0,0] op_sel_hi:[1,0,0]
v_cvt_pk_bf16_f32 v225, v12, v13
v_mfma_f32_32x32x16_bf16 v[32:47], a[212:215], v[216:219], v[32:47]
ds_read_b64_tr_b16 a[236:237], v175 offset:8192
v_fma_mix_f32 v8, v228, v152, v160 op_sel_hi:[1,0,0]
v_fma_mix_f32 v9, v228, v153, v161 op_sel:[1,0,0] op_sel_hi:[1,0,0]
v_cvt_pk_bf16_f32 v228, v8, v9
v_mfma_f32_32x32x16_bf16 v[96:111], a[212:215], v[220:223], v[96:111]
ds_read_b64_tr_b16 a[238:239], v175 offset:9216
buffer_load_dwordx4 v7, s[12:15], s54 offen offset:1024 nt lds
v_fma_mix_f32 v10, v229, v154, v162 op_sel_hi:[1,0,0]
v_fma_mix_f32 v11, v229, v155, v163 op_sel:[1,0,0] op_sel_hi:[1,0,0]
v_cvt_pk_bf16_f32 v229, v10, v11
v_mfma_f32_32x32x16_bf16 v[48:63], a[216:219], v[216:219], v[48:63]
ds_read_b64_tr_b16 a[240:241], v172 offset:12288
ds_read_b128 v[152:155], v15 offset:1744
s_waitcnt lgkmcnt(6)
v_fma_mix_f32 v12, v226, v164, v168 op_sel_hi:[1,0,0]
v_fma_mix_f32 v13, v226, v165, v169 op_sel:[1,0,0] op_sel_hi:[1,0,0]
v_cvt_pk_bf16_f32 v226, v12, v13
v_fma_mix_f32 v8, v227, v166, v170 op_sel_hi:[1,0,0]
v_mfma_f32_32x32x16_bf16 v[112:127], a[216:219], v[220:223], v[112:127]
ds_read_b64_tr_b16 a[242:243], v172 offset:13312
ds_read_b128 v[160:163], v15 offset:3792
v_fma_mix_f32 v9, v227, v167, v171 op_sel:[1,0,0] op_sel_hi:[1,0,0]
v_cvt_pk_bf16_f32 v227, v8, v9
v_fma_mix_f32 v10, v230, v164, v168 op_sel_hi:[1,0,0]
v_fma_mix_f32 v11, v230, v165, v169 op_sel:[1,0,0] op_sel_hi:[1,0,0]
v_mfma_f32_32x32x16_bf16 v[64:79], a[220:223], v[216:219], v[64:79]
ds_read_b64_tr_b16 a[244:245], v173 offset:12288
v_cvt_pk_bf16_f32 v230, v10, v11
v_fma_mix_f32 v12, v231, v166, v170 op_sel_hi:[1,0,0]
v_fma_mix_f32 v13, v231, v167, v171 op_sel:[1,0,0] op_sel_hi:[1,0,0]
v_cvt_pk_bf16_f32 v231, v12, v13
v_mfma_f32_32x32x16_bf16 v[128:143], a[220:223], v[220:223], v[128:143]
ds_read_b64_tr_b16 a[246:247], v173 offset:13312
v_mfma_f32_32x32x16_bf16 v[16:31], a[224:227], v[224:227], v[16:31]
ds_read_b64_tr_b16 a[248:249], v174 offset:12288
ds_read_b128 v[164:167], v15 offset:1792
s_waitcnt vmcnt(18)
s_waitcnt lgkmcnt(6)
v_fma_mix_f32 v8, v232, v144, v148 op_sel_hi:[1,0,0]
v_fma_mix_f32 v9, v232, v145, v149 op_sel:[1,0,0] op_sel_hi:[1,0,0]
v_cvt_pk_bf16_f32 v232, v8, v9
v_mfma_f32_32x32x16_bf16 v[80:95], a[224:227], v[228:231], v[80:95]
ds_read_b64_tr_b16 a[250:251], v174 offset:13312
ds_read_b128 v[168:171], v15 offset:3840
v_fma_mix_f32 v10, v233, v146, v150 op_sel_hi:[1,0,0]
v_fma_mix_f32 v11, v233, v147, v151 op_sel:[1,0,0] op_sel_hi:[1,0,0]
v_cvt_pk_bf16_f32 v233, v10, v11
v_mfma_f32_32x32x16_bf16 v[32:47], a[228:231], v[224:227], v[32:47]
ds_read_b64_tr_b16 a[252:253], v175 offset:12288
v_fma_mix_f32 v12, v236, v144, v148 op_sel_hi:[1,0,0]
v_fma_mix_f32 v13, v236, v145, v149 op_sel:[1,0,0] op_sel_hi:[1,0,0]
v_cvt_pk_bf16_f32 v236, v12, v13
v_mfma_f32_32x32x16_bf16 v[96:111], a[228:231], v[228:231], v[96:111]
ds_read_b64_tr_b16 a[254:255], v175 offset:13312
v_fma_mix_f32 v8, v237, v146, v150 op_sel_hi:[1,0,0]
v_fma_mix_f32 v9, v237, v147, v151 op_sel:[1,0,0] op_sel_hi:[1,0,0]
v_cvt_pk_bf16_f32 v237, v8, v9
v_mfma_f32_32x32x16_bf16 v[48:63], a[232:235], v[224:227], v[48:63]
ds_read_b64_tr_b16 a[192:193], v172 offset:16384
ds_read_b128 v[144:147], v15 offset:1808
s_waitcnt lgkmcnt(6)
v_fma_mix_f32 v10, v234, v152, v160 op_sel_hi:[1,0,0]
v_fma_mix_f32 v11, v234, v153, v161 op_sel:[1,0,0] op_sel_hi:[1,0,0]
v_cvt_pk_bf16_f32 v234, v10, v11
v_fma_mix_f32 v12, v235, v154, v162 op_sel_hi:[1,0,0]
v_mfma_f32_32x32x16_bf16 v[112:127], a[232:235], v[228:231], v[112:127]
ds_read_b64_tr_b16 a[194:195], v172 offset:17408
ds_read_b128 v[148:151], v15 offset:3856
v_fma_mix_f32 v13, v235, v155, v163 op_sel:[1,0,0] op_sel_hi:[1,0,0]
v_cvt_pk_bf16_f32 v235, v12, v13
v_fma_mix_f32 v8, v238, v152, v160 op_sel_hi:[1,0,0]
v_fma_mix_f32 v9, v238, v153, v161 op_sel:[1,0,0] op_sel_hi:[1,0,0]
v_mfma_f32_32x32x16_bf16 v[64:79], a[236:239], v[224:227], v[64:79]
ds_read_b64_tr_b16 a[196:197], v173 offset:16384
v_cvt_pk_bf16_f32 v238, v8, v9
v_fma_mix_f32 v10, v239, v154, v162 op_sel_hi:[1,0,0]
v_fma_mix_f32 v11, v239, v155, v163 op_sel:[1,0,0] op_sel_hi:[1,0,0]
v_cvt_pk_bf16_f32 v239, v10, v11
v_mfma_f32_32x32x16_bf16 v[128:143], a[236:239], v[228:231], v[128:143]
ds_read_b64_tr_b16 a[198:199], v173 offset:17408
v_mfma_f32_32x32x16_bf16 v[16:31], a[240:243], v[232:235], v[16:31]
ds_read_b64_tr_b16 a[200:201], v174 offset:16384
ds_read_b128 v[152:155], v15 offset:1856
s_waitcnt vmcnt(12)
s_waitcnt lgkmcnt(6)
v_fma_mix_f32 v12, v240, v164, v168 op_sel_hi:[1,0,0]
v_fma_mix_f32 v13, v240, v165, v169 op_sel:[1,0,0] op_sel_hi:[1,0,0]
v_cvt_pk_bf16_f32 v240, v12, v13
v_mfma_f32_32x32x16_bf16 v[80:95], a[240:243], v[236:239], v[80:95]
ds_read_b64_tr_b16 a[202:203], v174 offset:17408
ds_read_b128 v[160:163], v15 offset:3904
v_fma_mix_f32 v8, v241, v166, v170 op_sel_hi:[1,0,0]
v_fma_mix_f32 v9, v241, v167, v171 op_sel:[1,0,0] op_sel_hi:[1,0,0]
v_cvt_pk_bf16_f32 v241, v8, v9
v_mfma_f32_32x32x16_bf16 v[32:47], a[244:247], v[232:235], v[32:47]
ds_read_b64_tr_b16 a[204:205], v175 offset:16384
v_fma_mix_f32 v10, v244, v164, v168 op_sel_hi:[1,0,0]
v_fma_mix_f32 v11, v244, v165, v169 op_sel:[1,0,0] op_sel_hi:[1,0,0]
v_cvt_pk_bf16_f32 v244, v10, v11
v_mfma_f32_32x32x16_bf16 v[96:111], a[244:247], v[236:239], v[96:111]
ds_read_b64_tr_b16 a[206:207], v175 offset:17408
v_fma_mix_f32 v12, v245, v166, v170 op_sel_hi:[1,0,0]
v_fma_mix_f32 v13, v245, v167, v171 op_sel:[1,0,0] op_sel_hi:[1,0,0]
v_cvt_pk_bf16_f32 v245, v12, v13
v_mfma_f32_32x32x16_bf16 v[48:63], a[248:251], v[232:235], v[48:63]
ds_read_b64_tr_b16 a[208:209], v172 offset:20480
ds_read_b128 v[164:167], v15 offset:1872
s_waitcnt lgkmcnt(6)
v_fma_mix_f32 v8, v242, v144, v148 op_sel_hi:[1,0,0]
v_fma_mix_f32 v9, v242, v145, v149 op_sel:[1,0,0] op_sel_hi:[1,0,0]
v_cvt_pk_bf16_f32 v242, v8, v9
v_fma_mix_f32 v10, v243, v146, v150 op_sel_hi:[1,0,0]
v_mfma_f32_32x32x16_bf16 v[112:127], a[248:251], v[236:239], v[112:127]
ds_read_b64_tr_b16 a[210:211], v172 offset:21504
ds_read_b128 v[168:171], v15 offset:3920
v_fma_mix_f32 v11, v243, v147, v151 op_sel:[1,0,0] op_sel_hi:[1,0,0]
v_cvt_pk_bf16_f32 v243, v10, v11
v_fma_mix_f32 v12, v246, v144, v148 op_sel_hi:[1,0,0]
v_fma_mix_f32 v13, v246, v145, v149 op_sel:[1,0,0] op_sel_hi:[1,0,0]
v_mfma_f32_32x32x16_bf16 v[64:79], a[252:255], v[232:235], v[64:79]
ds_read_b64_tr_b16 a[212:213], v173 offset:20480
v_cvt_pk_bf16_f32 v246, v12, v13
v_fma_mix_f32 v8, v247, v146, v150 op_sel_hi:[1,0,0]
v_fma_mix_f32 v9, v247, v147, v151 op_sel:[1,0,0] op_sel_hi:[1,0,0]
v_cvt_pk_bf16_f32 v247, v8, v9
v_mfma_f32_32x32x16_bf16 v[128:143], a[252:255], v[236:239], v[128:143]
ds_read_b64_tr_b16 a[214:215], v173 offset:21504
v_mfma_f32_32x32x16_bf16 v[16:31], a[192:195], v[240:243], v[16:31]
ds_read_b64_tr_b16 a[216:217], v174 offset:20480
ds_read_b128 v[144:147], v15 offset:1920
s_waitcnt vmcnt(10)
s_waitcnt lgkmcnt(6)
v_fma_mix_f32 v10, v248, v152, v160 op_sel_hi:[1,0,0]
v_fma_mix_f32 v11, v248, v153, v161 op_sel:[1,0,0] op_sel_hi:[1,0,0]
v_cvt_pk_bf16_f32 v248, v10, v11
v_mfma_f32_32x32x16_bf16 v[80:95], a[192:195], v[244:247], v[80:95]
ds_read_b64_tr_b16 a[218:219], v174 offset:21504
ds_read_b128 v[148:151], v15 offset:3968
v_fma_mix_f32 v12, v249, v154, v162 op_sel_hi:[1,0,0]
v_fma_mix_f32 v13, v249, v155, v163 op_sel:[1,0,0] op_sel_hi:[1,0,0]
v_cvt_pk_bf16_f32 v249, v12, v13
v_mfma_f32_32x32x16_bf16 v[32:47], a[196:199], v[240:243], v[32:47]
ds_read_b64_tr_b16 a[220:221], v175 offset:20480
v_fma_mix_f32 v8, v252, v152, v160 op_sel_hi:[1,0,0]
v_fma_mix_f32 v9, v252, v153, v161 op_sel:[1,0,0] op_sel_hi:[1,0,0]
v_cvt_pk_bf16_f32 v252, v8, v9
v_mfma_f32_32x32x16_bf16 v[96:111], a[196:199], v[244:247], v[96:111]
ds_read_b64_tr_b16 a[222:223], v175 offset:21504
v_fma_mix_f32 v10, v253, v154, v162 op_sel_hi:[1,0,0]
v_fma_mix_f32 v11, v253, v155, v163 op_sel:[1,0,0] op_sel_hi:[1,0,0]
v_cvt_pk_bf16_f32 v253, v10, v11
v_mfma_f32_32x32x16_bf16 v[48:63], a[200:203], v[240:243], v[48:63]
ds_read_b64_tr_b16 a[224:225], v172 offset:24576
ds_read_b128 v[152:155], v15 offset:1936
s_waitcnt lgkmcnt(6)
v_fma_mix_f32 v12, v250, v164, v168 op_sel_hi:[1,0,0]
v_fma_mix_f32 v13, v250, v165, v169 op_sel:[1,0,0] op_sel_hi:[1,0,0]
v_cvt_pk_bf16_f32 v250, v12, v13
v_fma_mix_f32 v8, v251, v166, v170 op_sel_hi:[1,0,0]
v_mfma_f32_32x32x16_bf16 v[112:127], a[200:203], v[244:247], v[112:127]
ds_read_b64_tr_b16 a[226:227], v172 offset:25600
ds_read_b128 v[160:163], v15 offset:3984
v_fma_mix_f32 v9, v251, v167, v171 op_sel:[1,0,0] op_sel_hi:[1,0,0]
v_cvt_pk_bf16_f32 v251, v8, v9
v_fma_mix_f32 v10, v254, v164, v168 op_sel_hi:[1,0,0]
v_fma_mix_f32 v11, v254, v165, v169 op_sel:[1,0,0] op_sel_hi:[1,0,0]
v_mfma_f32_32x32x16_bf16 v[64:79], a[204:207], v[240:243], v[64:79]
ds_read_b64_tr_b16 a[228:229], v173 offset:24576
v_cvt_pk_bf16_f32 v254, v10, v11
v_fma_mix_f32 v12, v255, v166, v170 op_sel_hi:[1,0,0]
v_fma_mix_f32 v13, v255, v167, v171 op_sel:[1,0,0] op_sel_hi:[1,0,0]
v_cvt_pk_bf16_f32 v255, v12, v13
v_mfma_f32_32x32x16_bf16 v[128:143], a[204:207], v[244:247], v[128:143]
ds_read_b64_tr_b16 a[230:231], v173 offset:25600
v_mfma_f32_32x32x16_bf16 v[16:31], a[208:211], v[248:251], v[16:31]
ds_read_b64_tr_b16 a[232:233], v174 offset:24576
ds_read_b128 v[164:167], v15 offset:1984
s_waitcnt vmcnt(8)
s_waitcnt lgkmcnt(6)
v_fma_mix_f32 v8, v176, v144, v148 op_sel_hi:[1,0,0]
v_fma_mix_f32 v9, v176, v145, v149 op_sel:[1,0,0] op_sel_hi:[1,0,0]
v_cvt_pk_bf16_f32 v176, v8, v9
v_mfma_f32_32x32x16_bf16 v[80:95], a[208:211], v[252:255], v[80:95]
ds_read_b64_tr_b16 a[234:235], v174 offset:25600
ds_read_b128 v[168:171], v15 offset:4032
v_fma_mix_f32 v10, v177, v146, v150 op_sel_hi:[1,0,0]
v_fma_mix_f32 v11, v177, v147, v151 op_sel:[1,0,0] op_sel_hi:[1,0,0]
v_cvt_pk_bf16_f32 v177, v10, v11
v_mfma_f32_32x32x16_bf16 v[32:47], a[212:215], v[248:251], v[32:47]
ds_read_b64_tr_b16 a[236:237], v175 offset:24576
v_fma_mix_f32 v12, v180, v144, v148 op_sel_hi:[1,0,0]
v_fma_mix_f32 v13, v180, v145, v149 op_sel:[1,0,0] op_sel_hi:[1,0,0]
v_cvt_pk_bf16_f32 v180, v12, v13
v_mfma_f32_32x32x16_bf16 v[96:111], a[212:215], v[252:255], v[96:111]
ds_read_b64_tr_b16 a[238:239], v175 offset:25600
v_fma_mix_f32 v8, v181, v146, v150 op_sel_hi:[1,0,0]
v_fma_mix_f32 v9, v181, v147, v151 op_sel:[1,0,0] op_sel_hi:[1,0,0]
v_cvt_pk_bf16_f32 v181, v8, v9
v_mfma_f32_32x32x16_bf16 v[48:63], a[216:219], v[248:251], v[48:63]
ds_read_b64_tr_b16 a[240:241], v172 offset:28672
ds_read_b128 v[144:147], v15 offset:2000
s_waitcnt lgkmcnt(6)
v_fma_mix_f32 v10, v178, v152, v160 op_sel_hi:[1,0,0]
v_fma_mix_f32 v11, v178, v153, v161 op_sel:[1,0,0] op_sel_hi:[1,0,0]
v_cvt_pk_bf16_f32 v178, v10, v11
v_fma_mix_f32 v12, v179, v154, v162 op_sel_hi:[1,0,0]
v_mfma_f32_32x32x16_bf16 v[112:127], a[216:219], v[252:255], v[112:127]
ds_read_b64_tr_b16 a[242:243], v172 offset:29696
ds_read_b128 v[148:151], v15 offset:4048
v_fma_mix_f32 v13, v179, v155, v163 op_sel:[1,0,0] op_sel_hi:[1,0,0]
v_cvt_pk_bf16_f32 v179, v12, v13
v_fma_mix_f32 v8, v182, v152, v160 op_sel_hi:[1,0,0]
v_fma_mix_f32 v9, v182, v153, v161 op_sel:[1,0,0] op_sel_hi:[1,0,0]
v_mfma_f32_32x32x16_bf16 v[64:79], a[220:223], v[248:251], v[64:79]
ds_read_b64_tr_b16 a[244:245], v173 offset:28672
v_cvt_pk_bf16_f32 v182, v8, v9
v_fma_mix_f32 v10, v183, v154, v162 op_sel_hi:[1,0,0]
v_fma_mix_f32 v11, v183, v155, v163 op_sel:[1,0,0] op_sel_hi:[1,0,0]
v_cvt_pk_bf16_f32 v183, v10, v11
v_mfma_f32_32x32x16_bf16 v[128:143], a[220:223], v[252:255], v[128:143]
ds_read_b64_tr_b16 a[246:247], v173 offset:29696
v_mfma_f32_32x32x16_bf16 v[16:31], a[224:227], v[176:179], v[16:31]
ds_read_b64_tr_b16 a[248:249], v174 offset:28672
s_waitcnt vmcnt(6)
s_waitcnt lgkmcnt(5)
v_fma_mix_f32 v12, v184, v164, v168 op_sel_hi:[1,0,0]
v_fma_mix_f32 v13, v184, v165, v169 op_sel:[1,0,0] op_sel_hi:[1,0,0]
v_cvt_pk_bf16_f32 v184, v12, v13
v_mfma_f32_32x32x16_bf16 v[80:95], a[224:227], v[180:183], v[80:95]
ds_read_b64_tr_b16 a[250:251], v174 offset:29696
v_fma_mix_f32 v8, v185, v166, v170 op_sel_hi:[1,0,0]
v_fma_mix_f32 v9, v185, v167, v171 op_sel:[1,0,0] op_sel_hi:[1,0,0]
v_cvt_pk_bf16_f32 v185, v8, v9
v_mfma_f32_32x32x16_bf16 v[32:47], a[228:231], v[176:179], v[32:47]
ds_read_b64_tr_b16 a[252:253], v175 offset:28672
v_fma_mix_f32 v10, v188, v164, v168 op_sel_hi:[1,0,0]
v_fma_mix_f32 v11, v188, v165, v169 op_sel:[1,0,0] op_sel_hi:[1,0,0]
v_cvt_pk_bf16_f32 v188, v10, v11
v_mfma_f32_32x32x16_bf16 v[96:111], a[228:231], v[180:183], v[96:111]
ds_read_b64_tr_b16 a[254:255], v175 offset:29696
v_fma_mix_f32 v12, v189, v166, v170 op_sel_hi:[1,0,0]
v_fma_mix_f32 v13, v189, v167, v171 op_sel:[1,0,0] op_sel_hi:[1,0,0]
v_cvt_pk_bf16_f32 v189, v12, v13
v_mfma_f32_32x32x16_bf16 v[48:63], a[232:235], v[176:179], v[48:63]
s_waitcnt lgkmcnt(3)
v_fma_mix_f32 v8, v186, v144, v148 op_sel_hi:[1,0,0]
v_fma_mix_f32 v9, v186, v145, v149 op_sel:[1,0,0] op_sel_hi:[1,0,0]
v_cvt_pk_bf16_f32 v186, v8, v9
v_fma_mix_f32 v10, v187, v146, v150 op_sel_hi:[1,0,0]
v_mfma_f32_32x32x16_bf16 v[112:127], a[232:235], v[180:183], v[112:127]
v_fma_mix_f32 v11, v187, v147, v151 op_sel:[1,0,0] op_sel_hi:[1,0,0]
v_cvt_pk_bf16_f32 v187, v10, v11
v_fma_mix_f32 v12, v190, v144, v148 op_sel_hi:[1,0,0]
v_fma_mix_f32 v13, v190, v145, v149 op_sel:[1,0,0] op_sel_hi:[1,0,0]
v_mfma_f32_32x32x16_bf16 v[64:79], a[236:239], v[176:179], v[64:79]
v_cvt_pk_bf16_f32 v190, v12, v13
v_fma_mix_f32 v8, v191, v146, v150 op_sel_hi:[1,0,0]
v_fma_mix_f32 v9, v191, v147, v151 op_sel:[1,0,0] op_sel_hi:[1,0,0]
v_cvt_pk_bf16_f32 v191, v8, v9
v_mfma_f32_32x32x16_bf16 v[128:143], a[236:239], v[180:183], v[128:143]
v_mfma_f32_32x32x16_bf16 v[16:31], a[240:243], v[184:187], v[16:31]
v_mov_b32 v160, v6
v_mov_b32 v161, v7
v_xor_b32 v5, v3, v4
v_lshlrev_b32 v5, 4, v5
v_lshl_add_u32 v144, v3, 8, v5
v_mfma_f32_32x32x16_bf16 v[80:95], a[240:243], v[188:191], v[80:95]
v_xor_b32 v145, 64, v144
v_xor_b32 v146, 128, v144
v_xor_b32 v147, 192, v144
v_lshrrev_b32 v6, 2, v2
v_lshlrev_b32 v7, 8, v6
v_mfma_f32_32x32x16_bf16 v[32:47], a[244:247], v[184:187], v[32:47]
v_and_b32 v6, 7, v6
v_lshl_add_u32 v7, v1, 3, v7
v_add_u32 v7, 0x10000, v7
v_xor_b32 v5, 0, v6
v_lshl_add_u32 v148, v5, 5, v7
v_mfma_f32_32x32x16_bf16 v[96:111], a[244:247], v[188:191], v[96:111]
s_waitcnt lgkmcnt(0)
v_xor_b32 v5, 1, v6
v_lshl_add_u32 v149, v5, 5, v7
v_xor_b32 v5, 2, v6
v_lshl_add_u32 v150, v5, 5, v7
v_xor_b32 v5, 3, v6
v_mfma_f32_32x32x16_bf16 v[48:63], a[248:251], v[184:187], v[48:63]
ds_read_b128 a[196:199], v145 offset:0
ds_read_b128 a[192:195], v144 offset:0
v_lshl_add_u32 v151, v5, 5, v7
v_xor_b32 v5, 4, v6
v_lshl_add_u32 v152, v5, 5, v7
v_xor_b32 v5, 5, v6
v_lshl_add_u32 v153, v5, 5, v7
v_mfma_f32_32x32x16_bf16 v[112:127], a[248:251], v[188:191], v[112:127]
ds_read_b128 a[204:207], v147 offset:0
ds_read_b128 a[200:203], v146 offset:0
v_xor_b32 v5, 6, v6
v_lshl_add_u32 v154, v5, 5, v7
v_xor_b32 v5, 7, v6
v_lshl_add_u32 v155, v5, 5, v7
v_mfma_f32_32x32x16_bf16 v[64:79], a[252:255], v[184:187], v[64:79]
ds_read_b128 a[212:215], v145 offset:4096
ds_read_b128 a[208:211], v144 offset:4096
v_mfma_f32_32x32x16_bf16 v[128:143], a[252:255], v[188:191], v[128:143]
ds_read_b128 a[220:223], v147 offset:4096
ds_read_b128 a[216:219], v146 offset:4096
adaLN_cond__mha_block_cached__glu_gated_bilinear__prompt_kernel_mid:
s_nop 1
v_cvt_pk_bf16_f32 v192, v16, v17
v_cvt_pk_bf16_f32 v193, v18, v19
v_cvt_pk_bf16_f32 v208, v20, v21
v_cvt_pk_bf16_f32 v209, v22, v23
v_cvt_pk_bf16_f32 v194, v24, v25
v_cvt_pk_bf16_f32 v195, v26, v27
v_cvt_pk_bf16_f32 v210, v28, v29
v_cvt_pk_bf16_f32 v211, v30, v31
v_cvt_pk_bf16_f32 v196, v32, v33
v_cvt_pk_bf16_f32 v197, v34, v35
v_cvt_pk_bf16_f32 v212, v36, v37
v_cvt_pk_bf16_f32 v213, v38, v39
v_cvt_pk_bf16_f32 v198, v40, v41
v_cvt_pk_bf16_f32 v199, v42, v43
v_cvt_pk_bf16_f32 v214, v44, v45
v_cvt_pk_bf16_f32 v215, v46, v47
v_permlane16_swap_b32 v192, v208
v_permlane16_swap_b32 v193, v209
v_permlane16_swap_b32 v194, v210
v_permlane16_swap_b32 v195, v211
v_cvt_pk_bf16_f32 v200, v48, v49
v_cvt_pk_bf16_f32 v201, v50, v51
v_cvt_pk_bf16_f32 v216, v52, v53
v_cvt_pk_bf16_f32 v217, v54, v55
v_cvt_pk_bf16_f32 v202, v56, v57
v_cvt_pk_bf16_f32 v203, v58, v59
v_cvt_pk_bf16_f32 v218, v60, v61
v_cvt_pk_bf16_f32 v219, v62, v63
v_permlane16_swap_b32 v196, v212
v_permlane16_swap_b32 v197, v213
v_permlane16_swap_b32 v198, v214
v_permlane16_swap_b32 v199, v215
v_cvt_pk_bf16_f32 v204, v64, v65
v_cvt_pk_bf16_f32 v205, v66, v67
v_cvt_pk_bf16_f32 v220, v68, v69
v_cvt_pk_bf16_f32 v221, v70, v71
v_cvt_pk_bf16_f32 v206, v72, v73
v_cvt_pk_bf16_f32 v207, v74, v75
v_cvt_pk_bf16_f32 v222, v76, v77
v_cvt_pk_bf16_f32 v223, v78, v79
v_permlane16_swap_b32 v200, v216
v_permlane16_swap_b32 v201, v217
v_permlane16_swap_b32 v202, v218
v_permlane16_swap_b32 v203, v219
s_nop 0
s_nop 0
v_permlane16_swap_b32 v204, v220
v_permlane16_swap_b32 v205, v221
v_permlane16_swap_b32 v206, v222
v_permlane16_swap_b32 v207, v223
s_nop 1
s_waitcnt lgkmcnt(6)
v_mfma_f32_16x16x32_bf16 v[16:19], a[192:195], v[192:195], 0
s_lshl_b32 s46, s45, 19
v_cvt_pk_bf16_f32 v224, v80, v81
v_cvt_pk_bf16_f32 v225, v82, v83
v_cvt_pk_bf16_f32 v240, v84, v85
v_cvt_pk_bf16_f32 v241, v86, v87
v_mfma_f32_16x16x32_bf16 v[16:19], a[196:199], v[196:199], v[16:19]
s_waitcnt lgkmcnt(4)
s_lshl_b32 s47, s44, 14
v_cvt_pk_bf16_f32 v226, v88, v89
v_cvt_pk_bf16_f32 v227, v90, v91
v_cvt_pk_bf16_f32 v242, v92, v93
v_mfma_f32_16x16x32_bf16 v[16:19], a[200:203], v[200:203], v[16:19]
s_add_u32 s46, s46, s47
v_cvt_pk_bf16_f32 v243, v94, v95
v_cvt_pk_bf16_f32 v228, v96, v97
v_cvt_pk_bf16_f32 v229, v98, v99
v_mfma_f32_16x16x32_bf16 v[16:19], a[204:207], v[204:207], v[16:19]
s_waitcnt lgkmcnt(2)
s_add_u32 s46, s46, 4194304
v_cvt_pk_bf16_f32 v244, v100, v101
v_cvt_pk_bf16_f32 v245, v102, v103
v_cvt_pk_bf16_f32 v230, v104, v105
v_cvt_pk_bf16_f32 v231, v106, v107
v_mfma_f32_16x16x32_bf16 v[20:23], a[208:211], v[192:195], 0
s_lshr_b32 s53, s2, 3
v_cvt_pk_bf16_f32 v246, v108, v109
v_cvt_pk_bf16_f32 v247, v110, v111
v_permlane16_swap_b32 v224, v240
v_mfma_f32_16x16x32_bf16 v[20:23], a[212:215], v[196:199], v[20:23]
s_waitcnt lgkmcnt(0)
s_lshl_b32 s53, s53, 2
v_permlane16_swap_b32 v225, v241
v_permlane16_swap_b32 v226, v242
v_permlane16_swap_b32 v227, v243
v_mfma_f32_16x16x32_bf16 v[20:23], a[216:219], v[200:203], v[20:23]
s_add_u32 s53, s53, s28
v_cvt_pk_bf16_f32 v232, v112, v113
v_cvt_pk_bf16_f32 v233, v114, v115
v_cvt_pk_bf16_f32 v248, v116, v117
v_cvt_pk_bf16_f32 v249, v118, v119
v_mfma_f32_16x16x32_bf16 v[20:23], a[220:223], v[204:207], v[20:23]
s_bfe_u32 s56, s2, 0x20001
v_cvt_pk_bf16_f32 v234, v120, v121
v_cvt_pk_bf16_f32 v235, v122, v123
v_cvt_pk_bf16_f32 v250, v124, v125
v_mfma_f32_16x16x32_bf16 v[24:27], a[192:195], v[208:211], 0
s_lshl_b32 s54, s53, 13
v_cvt_pk_bf16_f32 v251, v126, v127
v_permlane16_swap_b32 v228, v244
v_permlane16_swap_b32 v229, v245
v_mfma_f32_16x16x32_bf16 v[24:27], a[196:199], v[212:215], v[24:27]
s_lshl_b32 s55, s56, 20
v_permlane16_swap_b32 v230, v246
v_permlane16_swap_b32 v231, v247
v_cvt_pk_bf16_f32 v236, v128, v129
v_cvt_pk_bf16_f32 v237, v130, v131
v_mfma_f32_16x16x32_bf16 v[24:27], a[200:203], v[216:219], v[24:27]
s_add_u32 s84, s54, s55
v_cvt_pk_bf16_f32 v252, v132, v133
v_cvt_pk_bf16_f32 v253, v134, v135
v_cvt_pk_bf16_f32 v238, v136, v137
v_mfma_f32_16x16x32_bf16 v[24:27], a[204:207], v[220:223], v[24:27]
s_mul_i32 s54, s53, 14336
v_cvt_pk_bf16_f32 v239, v138, v139
v_cvt_pk_bf16_f32 v254, v140, v141
v_cvt_pk_bf16_f32 v255, v142, v143
v_mfma_f32_16x16x32_bf16 v[28:31], a[208:211], v[208:211], 0
s_mul_i32 s55, s56, 896
v_permlane16_swap_b32 v232, v248
v_permlane16_swap_b32 v233, v249
v_permlane16_swap_b32 v234, v250
v_permlane16_swap_b32 v235, v251
v_mfma_f32_16x16x32_bf16 v[28:31], a[212:215], v[212:215], v[28:31]
s_add_u32 s85, s54, s55
s_nop 0
s_nop 0
v_permlane16_swap_b32 v236, v252
v_mfma_f32_16x16x32_bf16 v[28:31], a[216:219], v[216:219], v[28:31]
s_bfe_u32 s55, s2, 0x10002
v_permlane16_swap_b32 v237, v253
v_permlane16_swap_b32 v238, v254
v_permlane16_swap_b32 v239, v255
v_mfma_f32_16x16x32_bf16 v[28:31], a[220:223], v[220:223], v[28:31]
s_lshl_b32 s55, s55, 9
s_nop 0
v_mfma_f32_16x16x32_bf16 v[32:35], a[192:195], v[224:227], 0
s_add_u32 s86, s54, s55
v_mov_b32 v172, 0x3f803f80
v_mov_b32 v173, 0x3f803f80
v_mfma_f32_16x16x32_bf16 v[32:35], a[196:199], v[228:231], v[32:35]
v_mov_b32 v174, 0x3f803f80
v_mov_b32 v175, 0x3f803f80
v_mfma_f32_16x16x32_bf16 v[32:35], a[200:203], v[232:235], v[32:35]
v_mov_b32 v164, 0
v_mov_b32 v165, 0
v_mfma_f32_16x16x32_bf16 v[32:35], a[204:207], v[236:239], v[32:35]
v_mov_b32 v168, 0
v_mov_b32 v169, 0
v_mfma_f32_16x16x32_bf16 v[36:39], a[208:211], v[224:227], 0
s_add_u32 s24, s42, s46
s_addc_u32 s25, s43, 0
v_max3_f32 v8, v16, v17, v18
v_max3_f32 v9, v24, v25, v26
v_mfma_f32_16x16x32_bf16 v[36:39], a[212:215], v[228:231], v[36:39]
s_mov_b32 s26, 16384
v_max3_f32 v12, v19, v20, v21
v_max3_f32 v13, v27, v28, v29
v_mfma_f32_16x16x32_bf16 v[36:39], a[216:219], v[232:235], v[36:39]
s_mov_b32 s27, 0x20000
v_max3_f32 v8, v8, v22, v23
v_max3_f32 v9, v9, v30, v31
v_mfma_f32_16x16x32_bf16 v[36:39], a[220:223], v[236:239], v[36:39]
v_max_f32 v8, v8, v12
v_max_f32 v9, v9, v13
v_mfma_f32_16x16x32_bf16 v[40:43], a[192:195], v[240:243], 0
v_mov_b32 v12, v8
v_mov_b32 v13, v9
v_mfma_f32_16x16x32_bf16 v[40:43], a[196:199], v[244:247], v[40:43]
s_nop 0
v_mfma_f32_16x16x32_bf16 v[40:43], a[200:203], v[248:251], v[40:43]
v_permlane32_swap_b32 v8, v12
v_permlane32_swap_b32 v9, v13
v_mfma_f32_16x16x32_bf16 v[40:43], a[204:207], v[252:255], v[40:43]
v_max_f32 v8, v8, v12
v_max_f32 v9, v9, v13
v_mfma_f32_16x16x32_bf16 v[44:47], a[208:211], v[240:243], 0
v_mov_b32 v12, v8
v_mov_b32 v13, v9
v_mfma_f32_16x16x32_bf16 v[44:47], a[212:215], v[244:247], v[44:47]
s_nop 0
v_mfma_f32_16x16x32_bf16 v[44:47], a[216:219], v[248:251], v[44:47]
v_permlane16_swap_b32 v8, v12
v_permlane16_swap_b32 v9, v13
v_mfma_f32_16x16x32_bf16 v[44:47], a[220:223], v[252:255], v[44:47]
v_max_f32 v8, v8, v12
v_max_f32 v9, v9, v13
ds_read_b128 a[192:195], v144 offset:8192
ds_read_b128 a[196:199], v145 offset:8192
ds_read_b128 a[200:203], v146 offset:8192
ds_read_b128 a[204:207], v147 offset:8192
ds_read_b128 a[208:211], v144 offset:12288
ds_read_b128 a[212:215], v145 offset:12288
ds_read_b128 a[216:219], v146 offset:12288
ds_read_b128 a[220:223], v147 offset:12288
v_sub_f32 v112, 0xc2c80000, v8
v_sub_f32 v116, 0xc2c80000, v9
v_max3_f32 v10, v32, v33, v34
v_max3_f32 v11, v40, v41, v42
v_max3_f32 v14, v35, v36, v37
v_max3_f32 v15, v43, v44, v45
v_max3_f32 v10, v10, v38, v39
v_max3_f32 v11, v11, v46, v47
v_max_f32 v10, v10, v14
v_max_f32 v11, v11, v15
v_mov_b32 v14, v10
v_mov_b32 v15, v11
s_nop 1
v_permlane32_swap_b32 v10, v14
v_permlane32_swap_b32 v11, v15
v_max_f32 v10, v10, v14
v_max_f32 v11, v11, v15
v_mov_b32 v14, v10
v_mov_b32 v15, v11
s_nop 1
v_permlane16_swap_b32 v10, v14
v_permlane16_swap_b32 v11, v15
v_max_f32 v10, v10, v14
v_max_f32 v11, v11, v15
v_sub_f32 v120, 0xc2c80000, v10
v_sub_f32 v124, 0xc2c80000, v11
v_mov_b32 v113, v112
v_mov_b32 v114, v112
v_mov_b32 v115, v112
v_mov_b32 v117, v116
v_mov_b32 v118, v116
v_mov_b32 v119, v116
v_mov_b32 v121, v120
v_mov_b32 v122, v120
v_mov_b32 v123, v120
v_mov_b32 v125, v124
v_mov_b32 v126, v124
v_mov_b32 v127, v124
v_pk_add_f32 v[16:17], v[16:17], v[112:113]
v_pk_add_f32 v[18:19], v[18:19], v[112:113]
v_pk_add_f32 v[20:21], v[20:21], v[112:113]
v_pk_add_f32 v[22:23], v[22:23], v[112:113]
v_pk_add_f32 v[24:25], v[24:25], v[116:117]
v_pk_add_f32 v[26:27], v[26:27], v[116:117]
v_pk_add_f32 v[28:29], v[28:29], v[116:117]
v_pk_add_f32 v[30:31], v[30:31], v[116:117]
v_pk_add_f32 v[32:33], v[32:33], v[120:121]
v_pk_add_f32 v[34:35], v[34:35], v[120:121]
v_pk_add_f32 v[36:37], v[36:37], v[120:121]
v_pk_add_f32 v[38:39], v[38:39], v[120:121]
v_pk_add_f32 v[40:41], v[40:41], v[124:125]
v_pk_add_f32 v[42:43], v[42:43], v[124:125]
v_pk_add_f32 v[44:45], v[44:45], v[124:125]
v_pk_add_f32 v[46:47], v[46:47], v[124:125]
s_mov_b32 s20, s42
s_mov_b32 s21, s43
s_mov_b32 s22, 41943040
s_mov_b32 s23, 0x20000
s_getpc_b64 s[40:41]
adaLN_cond__mha_block_cached__glu_gated_bilinear__prompt_kernel_pc2:
s_add_u32 s40, s40, adaLN_cond__mha_block_cached__glu_gated_bilinear__prompt_kernel_late - adaLN_cond__mha_block_cached__glu_gated_bilinear__prompt_kernel_pc2
s_addc_u32 s41, s41, 0
s_lshr_b32 s53, s2, 3
s_lshl_b32 s53, s53, 2
s_add_u32 s53, s53, s28
s_lshl_b32 s87, s53, 9
s_waitcnt vmcnt(0) lgkmcnt(0)
s_barrier
v_mfma_f32_16x16x32_bf16 v[48:51], a[192:195], v[192:195], v[112:115]
v_exp_f32 v16, v16
v_mfma_f32_16x16x32_bf16 v[48:51], a[196:199], v[196:199], v[48:51]
v_exp_f32 v17, v17
v_mfma_f32_16x16x32_bf16 v[48:51], a[200:203], v[200:203], v[48:51]
v_cvt_pk_bf16_f32 v80, v16, v17
v_exp_f32 v18, v18
s_mov_b32 m0, s30
v_mfma_f32_16x16x32_bf16 v[48:51], a[204:207], v[204:207], v[48:51]
v_exp_f32 v19, v19
buffer_load_dwordx4 v156, s[8:11], s34 offen offset:0 nt lds
v_mfma_f32_16x16x32_bf16 v[56:59], a[192:195], v[208:211], v[116:119]
v_cvt_pk_bf16_f32 v81, v18, v19
v_exp_f32 v20, v20
v_mfma_f32_16x16x32_bf16 v[56:59], a[196:199], v[212:215], v[56:59]
v_exp_f32 v21, v21
buffer_load_dwordx4 v157, s[8:11], s34 offen offset:1024 nt lds
v_mfma_f32_16x16x32_bf16 v[56:59], a[200:203], v[216:219], v[56:59]
v_cvt_pk_bf16_f32 v82, v20, v21
v_exp_f32 v22, v22
v_mfma_f32_16x16x32_bf16 v[56:59], a[204:207], v[220:223], v[56:59]
v_exp_f32 v23, v23
buffer_load_dwordx4 v158, s[8:11], s34 offen offset:2048 nt lds
v_mfma_f32_16x16x32_bf16 v[64:67], a[192:195], v[224:227], v[120:123]
v_cvt_pk_bf16_f32 v83, v22, v23
v_exp_f32 v24, v24
v_mfma_f32_16x16x32_bf16 v[64:67], a[196:199], v[228:231], v[64:67]
v_add_f32 v164, v164, v24
v_exp_f32 v25, v25
buffer_load_dwordx4 v159, s[8:11], s34 offen offset:3072 nt lds
v_mfma_f32_16x16x32_bf16 v[64:67], a[200:203], v[232:235], v[64:67]
v_add_f32 v165, v165, v25
v_cvt_pk_bf16_f32 v84, v24, v25
v_exp_f32 v26, v26
s_add_u32 m0, s30, 4096
v_mfma_f32_16x16x32_bf16 v[64:67], a[204:207], v[236:239], v[64:67]
v_add_f32 v164, v164, v26
v_exp_f32 v27, v27
buffer_load_dwordx4 v156, s[8:11], s35 offen offset:0 nt lds
v_mfma_f32_16x16x32_bf16 v[72:75], a[192:195], v[240:243], v[124:127]
v_add_f32 v165, v165, v27
v_cvt_pk_bf16_f32 v85, v26, v27
v_exp_f32 v28, v28
v_mfma_f32_16x16x32_bf16 v[72:75], a[196:199], v[244:247], v[72:75]
v_add_f32 v164, v164, v28
v_exp_f32 v29, v29
buffer_load_dwordx4 v157, s[8:11], s35 offen offset:1024 nt lds
v_mfma_f32_16x16x32_bf16 v[72:75], a[200:203], v[248:251], v[72:75]
v_add_f32 v165, v165, v29
v_cvt_pk_bf16_f32 v86, v28, v29
v_exp_f32 v30, v30
v_mfma_f32_16x16x32_bf16 v[72:75], a[204:207], v[252:255], v[72:75]
v_add_f32 v164, v164, v30
v_exp_f32 v31, v31
buffer_load_dwordx4 v158, s[8:11], s35 offen offset:2048 nt lds
v_mfma_f32_16x16x32_bf16 v[52:55], a[208:211], v[192:195], v[112:115]
v_add_f32 v165, v165, v31
v_cvt_pk_bf16_f32 v87, v30, v31
v_exp_f32 v32, v32
v_mfma_f32_16x16x32_bf16 v[52:55], a[212:215], v[196:199], v[52:55]
ds_read_b128 a[192:195], v144 offset:16384
v_exp_f32 v33, v33
v_mfma_f32_16x16x32_bf16 v[52:55], a[216:219], v[200:203], v[52:55]
v_cvt_pk_bf16_f32 v88, v32, v33
v_exp_f32 v34, v34
v_mfma_f32_16x16x32_bf16 v[52:55], a[220:223], v[204:207], v[52:55]
ds_read_b128 a[196:199], v145 offset:16384
v_exp_f32 v35, v35
v_mfma_f32_16x16x32_bf16 v[60:63], a[208:211], v[208:211], v[116:119]
v_cvt_pk_bf16_f32 v89, v34, v35
v_exp_f32 v36, v36
v_mfma_f32_16x16x32_bf16 v[60:63], a[212:215], v[212:215], v[60:63]
ds_read_b128 a[200:203], v146 offset:16384
v_exp_f32 v37, v37
v_mfma_f32_16x16x32_bf16 v[60:63], a[216:219], v[216:219], v[60:63]
v_cvt_pk_bf16_f32 v90, v36, v37
v_exp_f32 v38, v38
v_mfma_f32_16x16x32_bf16 v[60:63], a[220:223], v[220:223], v[60:63]
ds_read_b128 a[204:207], v147 offset:16384
v_exp_f32 v39, v39
v_mfma_f32_16x16x32_bf16 v[68:71], a[208:211], v[224:227], v[120:123]
v_cvt_pk_bf16_f32 v91, v38, v39
v_exp_f32 v40, v40
v_mfma_f32_16x16x32_bf16 v[68:71], a[212:215], v[228:231], v[68:71]
v_add_f32 v168, v168, v40
v_exp_f32 v41, v41
v_mfma_f32_16x16x32_bf16 v[68:71], a[216:219], v[232:235], v[68:71]
v_add_f32 v169, v169, v41
v_cvt_pk_bf16_f32 v92, v40, v41
v_exp_f32 v42, v42
v_mfma_f32_16x16x32_bf16 v[68:71], a[220:223], v[236:239], v[68:71]
v_add_f32 v168, v168, v42
v_exp_f32 v43, v43
v_mfma_f32_16x16x32_bf16 v[76:79], a[208:211], v[240:243], v[124:127]
v_add_f32 v169, v169, v43
v_cvt_pk_bf16_f32 v93, v42, v43
v_exp_f32 v44, v44
v_mfma_f32_16x16x32_bf16 v[76:79], a[212:215], v[244:247], v[76:79]
v_add_f32 v168, v168, v44
v_exp_f32 v45, v45
v_mfma_f32_16x16x32_bf16 v[76:79], a[216:219], v[248:251], v[76:79]
v_add_f32 v169, v169, v45
v_cvt_pk_bf16_f32 v94, v44, v45
v_exp_f32 v46, v46
v_mfma_f32_16x16x32_bf16 v[76:79], a[220:223], v[252:255], v[76:79]
v_add_f32 v168, v168, v46
v_exp_f32 v47, v47
s_nop 0
v_add_f32 v169, v169, v47
v_cvt_pk_bf16_f32 v95, v46, v47
ds_read_b128 a[208:211], v144 offset:20480
ds_read_b128 a[212:215], v145 offset:20480
ds_read_b128 a[216:219], v146 offset:20480
ds_read_b128 a[220:223], v147 offset:20480
s_waitcnt lgkmcnt(4)
v_mfma_f32_16x16x32_bf16 v[16:19], a[192:195], v[192:195], v[112:115]
v_exp_f32 v48, v48
v_mfma_f32_16x16x32_bf16 v[16:19], a[196:199], v[196:199], v[16:19]
ds_read_b64_tr_b16 a[224:225], v148 offset:0
v_mov_b32 v8, -1
v_mfma_f32_16x16x32_bf16 v[16:19], a[200:203], v[200:203], v[16:19]
v_exp_f32 v49, v49
v_mfma_f32_16x16x32_bf16 v[16:19], a[204:207], v[204:207], v[16:19]
buffer_load_dwordx4 v159, s[8:11], s35 offen offset:3072 nt lds
v_mfma_f32_16x16x32_bf16 v[24:27], a[192:195], v[208:211], v[116:119]
v_exp_f32 v50, v50
v_mfma_f32_16x16x32_bf16 v[24:27], a[196:199], v[212:215], v[24:27]
ds_read_b64_tr_b16 a[226:227], v148 offset:4096
v_cvt_pk_bf16_f32 v96, v48, v49
v_mfma_f32_16x16x32_bf16 v[24:27], a[200:203], v[216:219], v[24:27]
v_exp_f32 v51, v51
v_mfma_f32_16x16x32_bf16 v[24:27], a[204:207], v[220:223], v[24:27]
ds_read_b64_tr_b16 a[228:229], v149 offset:0
v_mov_b32 v9, -1
v_mfma_f32_16x16x32_bf16 v[32:35], a[192:195], v[224:227], v[120:123]
v_exp_f32 v52, v52
v_mfma_f32_16x16x32_bf16 v[32:35], a[196:199], v[228:231], v[32:35]
ds_read_b64_tr_b16 a[230:231], v149 offset:4096
v_cvt_pk_bf16_f32 v97, v50, v51
v_mfma_f32_16x16x32_bf16 v[32:35], a[200:203], v[232:235], v[32:35]
v_exp_f32 v53, v53
v_mfma_f32_16x16x32_bf16 v[32:35], a[204:207], v[236:239], v[32:35]
ds_read_b64_tr_b16 a[232:233], v150 offset:0
v_mov_b32 v10, -1
v_mfma_f32_16x16x32_bf16 v[40:43], a[192:195], v[240:243], v[124:127]
s_mov_b32 m0, s32
v_exp_f32 v54, v54
v_mfma_f32_16x16x32_bf16 v[40:43], a[196:199], v[244:247], v[40:43]
buffer_load_dwordx4 v160, s[12:15], s36 offen offset:0 nt lds
v_mfma_f32_16x16x32_bf16 v[40:43], a[200:203], v[248:251], v[40:43]
v_exp_f32 v55, v55
v_mfma_f32_16x16x32_bf16 v[40:43], a[204:207], v[252:255], v[40:43]
s_waitcnt lgkmcnt(2)
ds_read_b64_tr_b16 a[234:235], v150 offset:4096
v_cvt_pk_bf16_f32 v98, v52, v53
v_mfma_f32_16x16x32_bf16 v[20:23], a[208:211], v[192:195], v[112:115]
s_bfe_u32 s50, s2, 0x20001
v_exp_f32 v56, v56
v_mfma_f32_16x16x32_bf16 v[20:23], a[212:215], v[196:199], v[20:23]
s_and_b32 s51, s2, 1
ds_read_b64_tr_b16 a[236:237], v151 offset:0
v_mov_b32 v11, -1
v_mfma_f32_16x16x32_bf16 v[20:23], a[216:219], v[200:203], v[20:23]
s_lshl_b32 s51, s51, 3
v_exp_f32 v57, v57
v_mfma_f32_16x16x32_bf16 v[20:23], a[220:223], v[204:207], v[20:23]
s_lshr_b32 s52, s2, 5
ds_read_b64_tr_b16 a[238:239], v151 offset:4096
v_cvt_pk_bf16_f32 v99, v54, v55
v_mfma_f32_16x16x32_bf16 v[28:31], a[208:211], v[208:211], v[116:119]
s_add_u32 s51, s51, s52
v_exp_f32 v58, v58
v_mfma_f32_16x16x32_bf16 v[28:31], a[212:215], v[212:215], v[28:31]
s_bfe_u32 s52, s2, 0x20003
buffer_load_dwordx4 v161, s[12:15], s36 offen offset:1024 nt lds
v_mfma_f32_16x16x32_bf16 v[28:31], a[216:219], v[216:219], v[28:31]
s_lshl_b32 s4, s51, 1
v_exp_f32 v59, v59
v_mfma_f32_16x16x32_bf16 v[28:31], a[220:223], v[220:223], v[28:31]
s_lshr_b32 s53, s28, 1
ds_read_b64_tr_b16 a[240:241], v152 offset:0
v_add_f32 v164, v164, v56
v_mfma_f32_16x16x32_bf16 v[36:39], a[208:211], v[224:227], v[120:123]
s_add_u32 s4, s4, s53
v_exp_f32 v60, v60
v_mfma_f32_16x16x32_bf16 v[36:39], a[212:215], v[228:231], v[36:39]
s_lshl_b32 s4, s4, 16
ds_read_b64_tr_b16 a[242:243], v152 offset:4096
v_lshlrev_b32 v13, 4, v2
v_mfma_f32_16x16x32_bf16 v[36:39], a[216:219], v[232:235], v[36:39]
s_lshl_b32 s53, s50, 21
v_exp_f32 v61, v61
v_mfma_f32_16x16x32_bf16 v[36:39], a[220:223], v[236:239], v[36:39]
s_add_u32 s4, s4, s53
ds_read_b64_tr_b16 a[244:245], v153 offset:0
v_add_f32 v165, v165, v57
v_mfma_f32_16x16x32_bf16 v[44:47], a[208:211], v[240:243], v[124:127]
s_lshl_b32 s53, s52, 12
v_exp_f32 v62, v62
v_mfma_f32_16x16x32_bf16 v[44:47], a[212:215], v[244:247], v[44:47]
s_add_u32 s4, s4, s53
ds_read_b64_tr_b16 a[246:247], v153 offset:4096
v_cvt_pk_bf16_f32 v100, v56, v57
v_mfma_f32_16x16x32_bf16 v[44:47], a[216:219], v[248:251], v[44:47]
s_and_b32 s53, s28, 1
v_exp_f32 v63, v63
v_mfma_f32_16x16x32_bf16 v[44:47], a[220:223], v[252:255], v[44:47]
s_lshl_b32 s53, s53, 11
buffer_load_dwordx4 v160, s[12:15], s36 offen offset:2048 nt lds
v_mfma_f32_16x16x32_bf16 a[0:3], v[80:83], a[224:227], 0
s_add_u32 s4, s4, s53
v_exp_f32 v64, v64
v_mfma_f32_16x16x32_bf16 a[4:7], v[84:87], a[224:227], 0
s_add_u32 s4, s4, 20971520
ds_read_b64_tr_b16 a[248:249], v154 offset:0
v_add_f32 v164, v164, v58
v_mfma_f32_16x16x32_bf16 a[8:11], v[88:91], a[224:227], 0
s_lshl_b32 s5, s51, 4
v_exp_f32 v65, v65
v_mfma_f32_16x16x32_bf16 a[12:15], v[92:95], a[224:227], 0
s_waitcnt lgkmcnt(2)
s_lshl_b32 s53, s50, 2
ds_read_b64_tr_b16 a[250:251], v154 offset:4096
v_lshrrev_b32 v12, 5, v2
v_mfma_f32_16x16x32_bf16 a[16:19], v[80:83], a[228:231], 0
s_add_u32 s53, s53, s52
v_exp_f32 v66, v66
v_mfma_f32_16x16x32_bf16 a[20:23], v[84:87], a[228:231], 0
s_add_u32 s5, s5, s53
ds_read_b64_tr_b16 a[252:253], v155 offset:0
v_add_f32 v165, v165, v59
v_mfma_f32_16x16x32_bf16 a[24:27], v[88:91], a[228:231], 0
s_mul_i32 s6, s53, 7168
v_exp_f32 v67, v67
v_mfma_f32_16x16x32_bf16 a[28:31], v[92:95], a[228:231], 0
s_and_b32 s53, s5, 1
buffer_load_dwordx4 v161, s[12:15], s36 offen offset:3072 nt lds
v_mfma_f32_16x16x32_bf16 a[32:35], v[80:83], a[232:235], 0
s_lshl_b32 s53, s53, 7
v_exp_f32 v68, v68
v_mfma_f32_16x16x32_bf16 a[36:39], v[84:87], a[232:235], 0
s_lshr_b32 s5, s5, 1
ds_read_b64_tr_b16 a[254:255], v155 offset:4096
v_cvt_pk_bf16_f32 v101, v58, v59
v_mfma_f32_16x16x32_bf16 a[40:43], v[88:91], a[232:235], 0
s_lshl_b32 s5, s5, 14
v_exp_f32 v69, v69
v_mfma_f32_16x16x32_bf16 a[44:47], v[92:95], a[232:235], 0
s_add_u32 s5, s5, s53
ds_read_b128 a[192:195], v144 offset:24576
v_add_f32 v164, v164, v60
v_mfma_f32_16x16x32_bf16 a[48:51], v[80:83], a[236:239], 0
s_add_u32 s5, s5, 29360128
v_exp_f32 v70, v70
v_mfma_f32_16x16x32_bf16 a[52:55], v[84:87], a[236:239], 0
s_lshl_b32 s53, s51, 2
ds_read_b128 a[196:199], v145 offset:24576
v_lshl_add_u32 v12, s28, 2, v12
v_mfma_f32_16x16x32_bf16 a[56:59], v[88:91], a[236:239], 0
s_add_u32 s53, s53, s28
v_exp_f32 v71, v71
v_mfma_f32_16x16x32_bf16 a[60:63], v[92:95], a[236:239], 0
s_mul_i32 s53, s53, 114688
ds_read_b128 a[200:203], v146 offset:24576
v_add_f32 v165, v165, v61
v_mfma_f32_16x16x32_bf16 a[64:67], v[80:83], a[240:243], 0
s_add_u32 s6, s6, s53
v_exp_f32 v72, v72
v_mfma_f32_16x16x32_bf16 a[68:71], v[84:87], a[240:243], 0
s_add_u32 s6, s6, 33554432
ds_read_b128 a[204:207], v147 offset:24576
v_cvt_pk_bf16_f32 v102, v60, v61
v_mfma_f32_16x16x32_bf16 a[72:75], v[88:91], a[240:243], 0
s_mov_b32 s7, 1024
v_exp_f32 v73, v73
v_mfma_f32_16x16x32_bf16 a[76:79], v[92:95], a[240:243], 0
s_waitcnt lgkmcnt(3)
ds_read_b128 a[208:211], v144 offset:28672
v_add_f32 v164, v164, v62
v_mfma_f32_16x16x32_bf16 a[80:83], v[80:83], a[244:247], 0
v_exp_f32 v74, v74
v_mfma_f32_16x16x32_bf16 a[84:87], v[84:87], a[244:247], 0
ds_read_b128 a[212:215], v145 offset:28672
v_lshlrev_b32 v12, 10, v12
v_mfma_f32_16x16x32_bf16 a[88:91], v[88:91], a[244:247], 0
v_exp_f32 v75, v75
v_mfma_f32_16x16x32_bf16 a[92:95], v[92:95], a[244:247], 0
ds_read_b128 a[216:219], v146 offset:28672
v_add_f32 v165, v165, v63
v_mfma_f32_16x16x32_bf16 a[96:99], v[80:83], a[248:251], 0
v_exp_f32 v76, v76
v_mfma_f32_16x16x32_bf16 a[100:103], v[84:87], a[248:251], 0
ds_read_b128 a[220:223], v147 offset:28672
v_cvt_pk_bf16_f32 v103, v62, v63
v_mfma_f32_16x16x32_bf16 a[104:107], v[88:91], a[248:251], 0
v_exp_f32 v77, v77
v_mfma_f32_16x16x32_bf16 a[108:111], v[92:95], a[248:251], 0
v_and_b32 v14, 7, v2
v_cvt_pk_bf16_f32 v104, v64, v65
v_mfma_f32_16x16x32_bf16 a[112:115], v[80:83], a[252:255], 0
v_exp_f32 v78, v78
v_mfma_f32_16x16x32_bf16 a[116:119], v[84:87], a[252:255], 0
v_lshl_add_u32 v12, v14, 4, v12
v_cvt_pk_bf16_f32 v105, v66, v67
v_mfma_f32_16x16x32_bf16 a[120:123], v[88:91], a[252:255], 0
v_exp_f32 v79, v79
v_mfma_f32_16x16x32_bf16 a[124:127], v[92:95], a[252:255], 0
v_bfe_u32 v14, v2, 3, 2
v_cvt_pk_bf16_f32 v106, v68, v69
v_mfma_f32_16x16x32_bf16 v[176:179], v[80:83], v[172:175], 0
v_lshl_add_u32 v12, v14, 8, v12
v_cvt_pk_bf16_f32 v107, v70, v71
v_mfma_f32_16x16x32_bf16 v[184:187], v[88:91], v[172:175], 0
v_add_f32 v168, v168, v72
v_add_f32 v169, v169, v73
v_cvt_pk_bf16_f32 v108, v72, v73
v_add_f32 v168, v168, v74
v_add_f32 v169, v169, v75
v_cvt_pk_bf16_f32 v109, v74, v75
v_add_f32 v168, v168, v76
v_add_f32 v169, v169, v77
v_cvt_pk_bf16_f32 v110, v76, v77
v_add_f32 v168, v168, v78
v_add_f32 v169, v169, v79
v_cvt_pk_bf16_f32 v111, v78, v79
v_mfma_f32_16x16x32_bf16 v[48:51], a[192:195], v[192:195], v[112:115]
s_waitcnt lgkmcnt(0)
v_exp_f32 v16, v16
v_mfma_f32_16x16x32_bf16 v[48:51], a[196:199], v[196:199], v[48:51]
ds_read_b64_tr_b16 a[224:225], v148 offset:8192
v_min_u32 v5, 55, v2
v_mfma_f32_16x16x32_bf16 v[48:51], a[200:203], v[200:203], v[48:51]
s_add_u32 m0, s32, 4096
v_exp_f32 v17, v17
v_mfma_f32_16x16x32_bf16 v[48:51], a[204:207], v[204:207], v[48:51]
buffer_load_dwordx4 v160, s[12:15], s37 offen offset:0 nt lds
v_mfma_f32_16x16x32_bf16 v[56:59], a[192:195], v[208:211], v[116:119]
v_exp_f32 v18, v18
v_mfma_f32_16x16x32_bf16 v[56:59], a[196:199], v[212:215], v[56:59]
ds_read_b64_tr_b16 a[226:227], v148 offset:12288
v_cvt_pk_bf16_f32 v80, v16, v17
v_mfma_f32_16x16x32_bf16 v[56:59], a[200:203], v[216:219], v[56:59]
v_exp_f32 v19, v19
v_mfma_f32_16x16x32_bf16 v[56:59], a[204:207], v[220:223], v[56:59]
ds_read_b64_tr_b16 a[228:229], v149 offset:8192
v_lshrrev_b32 v6, 2, v5
v_mfma_f32_16x16x32_bf16 v[64:67], a[192:195], v[224:227], v[120:123]
v_exp_f32 v20, v20
v_mfma_f32_16x16x32_bf16 v[64:67], a[196:199], v[228:231], v[64:67]
ds_read_b64_tr_b16 a[230:231], v149 offset:12288
v_cvt_pk_bf16_f32 v81, v18, v19
v_mfma_f32_16x16x32_bf16 v[64:67], a[200:203], v[232:235], v[64:67]
v_exp_f32 v21, v21
v_mfma_f32_16x16x32_bf16 v[64:67], a[204:207], v[236:239], v[64:67]
ds_read_b64_tr_b16 a[232:233], v150 offset:8192
v_and_b32 v5, 3, v5
v_mfma_f32_16x16x32_bf16 v[72:75], a[192:195], v[240:243], v[124:127]
v_exp_f32 v22, v22
v_mfma_f32_16x16x32_bf16 v[72:75], a[196:199], v[244:247], v[72:75]
buffer_load_dwordx4 v161, s[12:15], s37 offen offset:1024 nt lds
v_mfma_f32_16x16x32_bf16 v[72:75], a[200:203], v[248:251], v[72:75]
v_exp_f32 v23, v23
v_mfma_f32_16x16x32_bf16 v[72:75], a[204:207], v[252:255], v[72:75]
ds_read_b64_tr_b16 a[234:235], v150 offset:12288
v_cvt_pk_bf16_f32 v82, v20, v21
v_mfma_f32_16x16x32_bf16 v[52:55], a[208:211], v[192:195], v[112:115]
v_exp_f32 v24, v24
v_mfma_f32_16x16x32_bf16 v[52:55], a[212:215], v[196:199], v[52:55]
ds_read_b64_tr_b16 a[236:237], v151 offset:8192
v_lshlrev_b32 v6, 10, v6
v_mfma_f32_16x16x32_bf16 v[52:55], a[216:219], v[200:203], v[52:55]
v_exp_f32 v25, v25
v_mfma_f32_16x16x32_bf16 v[52:55], a[220:223], v[204:207], v[52:55]
ds_read_b64_tr_b16 a[238:239], v151 offset:12288
v_cvt_pk_bf16_f32 v83, v22, v23
v_mfma_f32_16x16x32_bf16 v[60:63], a[208:211], v[208:211], v[116:119]
v_exp_f32 v26, v26
v_mfma_f32_16x16x32_bf16 v[60:63], a[212:215], v[212:215], v[60:63]
buffer_load_dwordx4 v160, s[12:15], s37 offen offset:2048 nt lds
v_mfma_f32_16x16x32_bf16 v[60:63], a[216:219], v[216:219], v[60:63]
v_exp_f32 v27, v27
v_mfma_f32_16x16x32_bf16 v[60:63], a[220:223], v[220:223], v[60:63]
ds_read_b64_tr_b16 a[240:241], v152 offset:8192
v_add_f32 v164, v164, v24
v_mfma_f32_16x16x32_bf16 v[68:71], a[208:211], v[224:227], v[120:123]
v_exp_f32 v28, v28
v_mfma_f32_16x16x32_bf16 v[68:71], a[212:215], v[228:231], v[68:71]
ds_read_b64_tr_b16 a[242:243], v152 offset:12288
v_lshl_add_u32 v6, v5, 7, v6
v_mfma_f32_16x16x32_bf16 v[68:71], a[216:219], v[232:235], v[68:71]
v_exp_f32 v29, v29
v_mfma_f32_16x16x32_bf16 v[68:71], a[220:223], v[236:239], v[68:71]
ds_read_b64_tr_b16 a[244:245], v153 offset:8192
v_add_f32 v165, v165, v25
v_mfma_f32_16x16x32_bf16 v[76:79], a[208:211], v[240:243], v[124:127]
v_exp_f32 v30, v30
v_mfma_f32_16x16x32_bf16 v[76:79], a[212:215], v[244:247], v[76:79]
ds_read_b64_tr_b16 a[246:247], v153 offset:12288
v_cvt_pk_bf16_f32 v84, v24, v25
v_mfma_f32_16x16x32_bf16 v[76:79], a[216:219], v[248:251], v[76:79]
v_exp_f32 v31, v31
v_mfma_f32_16x16x32_bf16 v[76:79], a[220:223], v[252:255], v[76:79]
s_waitcnt lgkmcnt(3)
buffer_load_dwordx4 v161, s[12:15], s37 offen offset:3072 nt lds
v_mfma_f32_16x16x32_bf16 a[0:3], v[96:99], a[224:227], a[0:3]
v_exp_f32 v32, v32
v_mfma_f32_16x16x32_bf16 a[4:7], v[100:103], a[224:227], a[4:7]
ds_read_b64_tr_b16 a[248:249], v154 offset:8192
v_add_f32 v164, v164, v26
v_mfma_f32_16x16x32_bf16 a[8:11], v[104:107], a[224:227], a[8:11]
v_exp_f32 v33, v33
v_mfma_f32_16x16x32_bf16 a[12:15], v[108:111], a[224:227], a[12:15]
ds_read_b64_tr_b16 a[250:251], v154 offset:12288
v_add_u32 v138, s86, v6
v_mfma_f32_16x16x32_bf16 a[16:19], v[96:99], a[228:231], a[16:19]
v_exp_f32 v34, v34
v_mfma_f32_16x16x32_bf16 a[20:23], v[100:103], a[228:231], a[20:23]
ds_read_b64_tr_b16 a[252:253], v155 offset:8192
v_add_f32 v165, v165, v27
v_mfma_f32_16x16x32_bf16 a[24:27], v[104:107], a[228:231], a[24:27]
s_add_u32 s5, s5, 2097152
v_exp_f32 v35, v35
v_mfma_f32_16x16x32_bf16 a[28:31], v[108:111], a[228:231], a[28:31]
buffer_store_dwordx4 v[8:11], v12, s[20:23], s5 offen offset:0 sc1
v_mfma_f32_16x16x32_bf16 a[32:35], v[96:99], a[232:235], a[32:35]
v_exp_f32 v36, v36
v_mfma_f32_16x16x32_bf16 a[36:39], v[100:103], a[232:235], a[36:39]
ds_read_b64_tr_b16 a[254:255], v155 offset:12288
v_cvt_pk_bf16_f32 v85, v26, v27
v_mfma_f32_16x16x32_bf16 a[40:43], v[104:107], a[232:235], a[40:43]
v_exp_f32 v37, v37
v_mfma_f32_16x16x32_bf16 a[44:47], v[108:111], a[232:235], a[44:47]
ds_read_b128 a[192:195], v144 offset:32768
v_add_f32 v164, v164, v28
v_mfma_f32_16x16x32_bf16 a[48:51], v[96:99], a[236:239], a[48:51]
v_exp_f32 v38, v38
v_mfma_f32_16x16x32_bf16 a[52:55], v[100:103], a[236:239], a[52:55]
ds_read_b128 a[196:199], v145 offset:32768
v_add_f32 v165, v165, v29
v_mfma_f32_16x16x32_bf16 a[56:59], v[104:107], a[236:239], a[56:59]
v_exp_f32 v39, v39
v_mfma_f32_16x16x32_bf16 a[60:63], v[108:111], a[236:239], a[60:63]
s_waitcnt lgkmcnt(3)
ds_read_b128 a[200:203], v146 offset:32768
v_cvt_pk_bf16_f32 v86, v28, v29
v_mfma_f32_16x16x32_bf16 a[64:67], v[96:99], a[240:243], a[64:67]
v_exp_f32 v40, v40
v_mfma_f32_16x16x32_bf16 a[68:71], v[100:103], a[240:243], a[68:71]
ds_read_b128 a[204:207], v147 offset:32768
v_add_f32 v164, v164, v30
v_mfma_f32_16x16x32_bf16 a[72:75], v[104:107], a[240:243], a[72:75]
v_exp_f32 v41, v41
v_mfma_f32_16x16x32_bf16 a[76:79], v[108:111], a[240:243], a[76:79]
ds_read_b128 a[208:211], v144 offset:36864
v_add_f32 v165, v165, v31
v_mfma_f32_16x16x32_bf16 a[80:83], v[96:99], a[244:247], a[80:83]
v_exp_f32 v42, v42
v_mfma_f32_16x16x32_bf16 a[84:87], v[100:103], a[244:247], a[84:87]
ds_read_b128 a[212:215], v145 offset:36864
v_cvt_pk_bf16_f32 v87, v30, v31
v_mfma_f32_16x16x32_bf16 a[88:91], v[104:107], a[244:247], a[88:91]
v_exp_f32 v43, v43
v_mfma_f32_16x16x32_bf16 a[92:95], v[108:111], a[244:247], a[92:95]
ds_read_b128 a[216:219], v146 offset:36864
v_cvt_pk_bf16_f32 v88, v32, v33
v_mfma_f32_16x16x32_bf16 a[96:99], v[96:99], a[248:251], a[96:99]
v_exp_f32 v44, v44
v_mfma_f32_16x16x32_bf16 a[100:103], v[100:103], a[248:251], a[100:103]
ds_read_b128 a[220:223], v147 offset:36864
v_cvt_pk_bf16_f32 v89, v34, v35
v_mfma_f32_16x16x32_bf16 a[104:107], v[104:107], a[248:251], a[104:107]
v_exp_f32 v45, v45
v_mfma_f32_16x16x32_bf16 a[108:111], v[108:111], a[248:251], a[108:111]
s_waitcnt lgkmcnt(3)
v_cvt_pk_bf16_f32 v90, v36, v37
v_cvt_pk_bf16_f32 v91, v38, v39
v_mfma_f32_16x16x32_bf16 a[112:115], v[96:99], a[252:255], a[112:115]
v_exp_f32 v46, v46
v_mfma_f32_16x16x32_bf16 a[116:119], v[100:103], a[252:255], a[116:119]
v_add_f32 v168, v168, v40
v_add_f32 v169, v169, v41
v_mfma_f32_16x16x32_bf16 a[120:123], v[104:107], a[252:255], a[120:123]
v_exp_f32 v47, v47
v_mfma_f32_16x16x32_bf16 a[124:127], v[108:111], a[252:255], a[124:127]
v_cvt_pk_bf16_f32 v92, v40, v41
v_add_f32 v168, v168, v42
v_mfma_f32_16x16x32_bf16 v[176:179], v[96:99], v[172:175], v[176:179]
v_add_f32 v169, v169, v43
v_cvt_pk_bf16_f32 v93, v42, v43
v_mfma_f32_16x16x32_bf16 v[184:187], v[104:107], v[172:175], v[184:187]
v_add_f32 v168, v168, v44
v_add_f32 v169, v169, v45
v_cvt_pk_bf16_f32 v94, v44, v45
v_add_f32 v168, v168, v46
v_add_f32 v169, v169, v47
v_cvt_pk_bf16_f32 v95, v46, v47
v_mfma_f32_16x16x32_bf16 v[16:19], a[192:195], v[192:195], v[112:115]
v_exp_f32 v48, v48
v_mfma_f32_16x16x32_bf16 v[16:19], a[196:199], v[196:199], v[16:19]
ds_read_b64_tr_b16 a[224:225], v148 offset:16384
v_subrev_u32 v128, 0x10000, v148
v_mfma_f32_16x16x32_bf16 v[16:19], a[200:203], v[200:203], v[16:19]
v_exp_f32 v49, v49
v_mfma_f32_16x16x32_bf16 v[16:19], a[204:207], v[204:207], v[16:19]
buffer_store_dwordx4 v[8:11], v12, s[20:23], s5 offen offset:2048 sc1
v_mfma_f32_16x16x32_bf16 v[24:27], a[192:195], v[208:211], v[116:119]
v_exp_f32 v50, v50
v_mfma_f32_16x16x32_bf16 v[24:27], a[196:199], v[212:215], v[24:27]
ds_read_b64_tr_b16 a[226:227], v148 offset:20480
v_cvt_pk_bf16_f32 v96, v48, v49
v_mfma_f32_16x16x32_bf16 v[24:27], a[200:203], v[216:219], v[24:27]
v_exp_f32 v51, v51
v_mfma_f32_16x16x32_bf16 v[24:27], a[204:207], v[220:223], v[24:27]
ds_read_b64_tr_b16 a[228:229], v149 offset:16384
v_subrev_u32 v129, 0x10000, v149
v_mfma_f32_16x16x32_bf16 v[32:35], a[192:195], v[224:227], v[120:123]
v_exp_f32 v52, v52
v_mfma_f32_16x16x32_bf16 v[32:35], a[196:199], v[228:231], v[32:35]
ds_read_b64_tr_b16 a[230:231], v149 offset:20480
v_cvt_pk_bf16_f32 v97, v50, v51
v_mfma_f32_16x16x32_bf16 v[32:35], a[200:203], v[232:235], v[32:35]
v_exp_f32 v53, v53
v_mfma_f32_16x16x32_bf16 v[32:35], a[204:207], v[236:239], v[32:35]
ds_read_b64_tr_b16 a[232:233], v150 offset:16384
v_subrev_u32 v130, 0x10000, v150
v_mfma_f32_16x16x32_bf16 v[40:43], a[192:195], v[240:243], v[124:127]
v_exp_f32 v54, v54
v_mfma_f32_16x16x32_bf16 v[40:43], a[196:199], v[244:247], v[40:43]
ds_read_b64_tr_b16 a[234:235], v150 offset:20480
v_cvt_pk_bf16_f32 v98, v52, v53
v_mfma_f32_16x16x32_bf16 v[40:43], a[200:203], v[248:251], v[40:43]
v_exp_f32 v55, v55
v_mfma_f32_16x16x32_bf16 v[40:43], a[204:207], v[252:255], v[40:43]
ds_read_b64_tr_b16 a[236:237], v151 offset:16384
v_subrev_u32 v131, 0x10000, v151
v_mfma_f32_16x16x32_bf16 v[20:23], a[208:211], v[192:195], v[112:115]
s_waitcnt lgkmcnt(4)
v_exp_f32 v56, v56
v_mfma_f32_16x16x32_bf16 v[20:23], a[212:215], v[196:199], v[20:23]
ds_read_b64_tr_b16 a[238:239], v151 offset:20480
v_cvt_pk_bf16_f32 v99, v54, v55
v_mfma_f32_16x16x32_bf16 v[20:23], a[216:219], v[200:203], v[20:23]
v_exp_f32 v57, v57
v_mfma_f32_16x16x32_bf16 v[20:23], a[220:223], v[204:207], v[20:23]
ds_read_b64_tr_b16 a[240:241], v152 offset:16384
v_add_f32 v164, v164, v56
v_mfma_f32_16x16x32_bf16 v[28:31], a[208:211], v[208:211], v[116:119]
v_exp_f32 v58, v58
v_mfma_f32_16x16x32_bf16 v[28:31], a[212:215], v[212:215], v[28:31]
ds_read_b64_tr_b16 a[242:243], v152 offset:20480
v_subrev_u32 v132, 0x10000, v152
v_mfma_f32_16x16x32_bf16 v[28:31], a[216:219], v[216:219], v[28:31]
v_exp_f32 v59, v59
v_mfma_f32_16x16x32_bf16 v[28:31], a[220:223], v[220:223], v[28:31]
ds_read_b64_tr_b16 a[244:245], v153 offset:16384
v_add_f32 v165, v165, v57
v_mfma_f32_16x16x32_bf16 v[36:39], a[208:211], v[224:227], v[120:123]
v_exp_f32 v60, v60
v_mfma_f32_16x16x32_bf16 v[36:39], a[212:215], v[228:231], v[36:39]
ds_read_b64_tr_b16 a[246:247], v153 offset:20480
v_cvt_pk_bf16_f32 v100, v56, v57
v_mfma_f32_16x16x32_bf16 v[36:39], a[216:219], v[232:235], v[36:39]
v_exp_f32 v61, v61
v_mfma_f32_16x16x32_bf16 v[36:39], a[220:223], v[236:239], v[36:39]
ds_read_b64_tr_b16 a[248:249], v154 offset:16384
v_add_f32 v164, v164, v58
v_mfma_f32_16x16x32_bf16 v[44:47], a[208:211], v[240:243], v[124:127]
v_exp_f32 v62, v62
v_mfma_f32_16x16x32_bf16 v[44:47], a[212:215], v[244:247], v[44:47]
ds_read_b64_tr_b16 a[250:251], v154 offset:20480
v_subrev_u32 v133, 0x10000, v153
v_mfma_f32_16x16x32_bf16 v[44:47], a[216:219], v[248:251], v[44:47]
v_exp_f32 v63, v63
v_mfma_f32_16x16x32_bf16 v[44:47], a[220:223], v[252:255], v[44:47]
ds_read_b64_tr_b16 a[252:253], v155 offset:16384
v_add_f32 v165, v165, v59
v_mfma_f32_16x16x32_bf16 a[0:3], v[80:83], a[224:227], a[0:3]
v_exp_f32 v64, v64
v_mfma_f32_16x16x32_bf16 a[4:7], v[84:87], a[224:227], a[4:7]
ds_read_b64_tr_b16 a[254:255], v155 offset:20480
v_cvt_pk_bf16_f32 v101, v58, v59
v_mfma_f32_16x16x32_bf16 a[8:11], v[88:91], a[224:227], a[8:11]
v_exp_f32 v65, v65
v_mfma_f32_16x16x32_bf16 a[12:15], v[92:95], a[224:227], a[12:15]
s_waitcnt lgkmcnt(3)
ds_read_b128 a[192:195], v144 offset:40960
v_add_f32 v164, v164, v60
v_mfma_f32_16x16x32_bf16 a[16:19], v[80:83], a[228:231], a[16:19]
v_exp_f32 v66, v66
v_mfma_f32_16x16x32_bf16 a[20:23], v[84:87], a[228:231], a[20:23]
ds_read_b128 a[196:199], v145 offset:40960
v_subrev_u32 v134, 0x10000, v154
v_mfma_f32_16x16x32_bf16 a[24:27], v[88:91], a[228:231], a[24:27]
v_exp_f32 v67, v67
v_mfma_f32_16x16x32_bf16 a[28:31], v[92:95], a[228:231], a[28:31]
ds_read_b128 a[200:203], v146 offset:40960
v_add_f32 v165, v165, v61
v_mfma_f32_16x16x32_bf16 a[32:35], v[80:83], a[232:235], a[32:35]
s_add_u32 s34, s34, 32768
v_exp_f32 v68, v68
v_mfma_f32_16x16x32_bf16 a[36:39], v[84:87], a[232:235], a[36:39]
ds_read_b128 a[204:207], v147 offset:40960
v_cvt_pk_bf16_f32 v102, v60, v61
v_mfma_f32_16x16x32_bf16 a[40:43], v[88:91], a[232:235], a[40:43]
s_add_u32 s35, s35, 32768
v_exp_f32 v69, v69
v_mfma_f32_16x16x32_bf16 a[44:47], v[92:95], a[232:235], a[44:47]
ds_read_b128 a[208:211], v144 offset:45056
v_add_f32 v164, v164, v62
v_mfma_f32_16x16x32_bf16 a[48:51], v[80:83], a[236:239], a[48:51]
s_add_u32 s36, s36, 32768
v_exp_f32 v70, v70
v_mfma_f32_16x16x32_bf16 a[52:55], v[84:87], a[236:239], a[52:55]
ds_read_b128 a[212:215], v145 offset:45056
v_subrev_u32 v135, 0x10000, v155
v_mfma_f32_16x16x32_bf16 a[56:59], v[88:91], a[236:239], a[56:59]
s_add_u32 s37, s37, 32768
v_exp_f32 v71, v71
v_mfma_f32_16x16x32_bf16 a[60:63], v[92:95], a[236:239], a[60:63]
ds_read_b128 a[216:219], v146 offset:45056
v_add_f32 v165, v165, v63
v_mfma_f32_16x16x32_bf16 a[64:67], v[80:83], a[240:243], a[64:67]
v_exp_f32 v72, v72
v_mfma_f32_16x16x32_bf16 a[68:71], v[84:87], a[240:243], a[68:71]
ds_read_b128 a[220:223], v147 offset:45056
v_cvt_pk_bf16_f32 v103, v62, v63
v_mfma_f32_16x16x32_bf16 a[72:75], v[88:91], a[240:243], a[72:75]
v_exp_f32 v73, v73
v_mfma_f32_16x16x32_bf16 a[76:79], v[92:95], a[240:243], a[76:79]
v_lshlrev_b32 v5, 7, v2
v_cvt_pk_bf16_f32 v104, v64, v65
v_mfma_f32_16x16x32_bf16 a[80:83], v[80:83], a[244:247], a[80:83]
v_exp_f32 v74, v74
v_mfma_f32_16x16x32_bf16 a[84:87], v[84:87], a[244:247], a[84:87]
v_add_u32 v136, s84, v5
v_cvt_pk_bf16_f32 v105, v66, v67
v_mfma_f32_16x16x32_bf16 a[88:91], v[88:91], a[244:247], a[88:91]
v_exp_f32 v75, v75
v_mfma_f32_16x16x32_bf16 a[92:95], v[92:95], a[244:247], a[92:95]
s_waitcnt lgkmcnt(1)
v_lshlrev_b32 v140, 6, v2
v_cvt_pk_bf16_f32 v106, v68, v69
v_mfma_f32_16x16x32_bf16 a[96:99], v[80:83], a[248:251], a[96:99]
v_exp_f32 v76, v76
v_mfma_f32_16x16x32_bf16 a[100:103], v[84:87], a[248:251], a[100:103]
v_add_u32 v140, 135168, v140
v_cvt_pk_bf16_f32 v107, v70, v71
v_mfma_f32_16x16x32_bf16 a[104:107], v[88:91], a[248:251], a[104:107]
v_exp_f32 v77, v77
v_mfma_f32_16x16x32_bf16 a[108:111], v[92:95], a[248:251], a[108:111]
v_add_f32 v168, v168, v72
v_add_f32 v169, v169, v73
v_mfma_f32_16x16x32_bf16 a[112:115], v[80:83], a[252:255], a[112:115]
v_exp_f32 v78, v78
v_mfma_f32_16x16x32_bf16 a[116:119], v[84:87], a[252:255], a[116:119]
v_cvt_pk_bf16_f32 v108, v72, v73
v_add_f32 v168, v168, v74
v_mfma_f32_16x16x32_bf16 a[120:123], v[88:91], a[252:255], a[120:123]
v_exp_f32 v79, v79
v_mfma_f32_16x16x32_bf16 a[124:127], v[92:95], a[252:255], a[124:127]
v_add_f32 v169, v169, v75
v_cvt_pk_bf16_f32 v109, v74, v75
v_mfma_f32_16x16x32_bf16 v[176:179], v[80:83], v[172:175], v[176:179]
v_add_f32 v168, v168, v76
v_add_f32 v169, v169, v77
v_mfma_f32_16x16x32_bf16 v[184:187], v[88:91], v[172:175], v[184:187]
v_cvt_pk_bf16_f32 v110, v76, v77
v_add_f32 v168, v168, v78
v_add_f32 v169, v169, v79
v_cvt_pk_bf16_f32 v111, v78, v79
s_waitcnt vmcnt(2) lgkmcnt(0)
s_barrier
v_mfma_f32_16x16x32_bf16 v[48:51], a[192:195], v[192:195], v[112:115]
v_exp_f32 v16, v16
v_mfma_f32_16x16x32_bf16 v[48:51], a[196:199], v[196:199], v[48:51]
ds_read_b64_tr_b16 a[224:225], v148 offset:24576
ds_read_b64_tr_b16 a[226:227], v148 offset:28672
v_mfma_f32_16x16x32_bf16 v[48:51], a[200:203], v[200:203], v[48:51]
s_mov_b32 m0, s31
v_exp_f32 v17, v17
v_mfma_f32_16x16x32_bf16 v[48:51], a[204:207], v[204:207], v[48:51]
buffer_load_dwordx4 v156, s[8:11], s34 offen offset:0 nt lds
v_mfma_f32_16x16x32_bf16 v[56:59], a[192:195], v[208:211], v[116:119]
v_exp_f32 v18, v18
v_mfma_f32_16x16x32_bf16 v[56:59], a[196:199], v[212:215], v[56:59]
ds_read_b64_tr_b16 a[228:229], v149 offset:24576
v_cvt_pk_bf16_f32 v80, v16, v17
v_mfma_f32_16x16x32_bf16 v[56:59], a[200:203], v[216:219], v[56:59]
v_exp_f32 v19, v19
v_mfma_f32_16x16x32_bf16 v[56:59], a[204:207], v[220:223], v[56:59]
ds_read_b64_tr_b16 a[230:231], v149 offset:28672
v_cvt_pk_bf16_f32 v81, v18, v19
v_mfma_f32_16x16x32_bf16 v[64:67], a[192:195], v[224:227], v[120:123]
v_exp_f32 v20, v20
v_mfma_f32_16x16x32_bf16 v[64:67], a[196:199], v[228:231], v[64:67]
ds_read_b64_tr_b16 a[232:233], v150 offset:24576
ds_read_b64_tr_b16 a[234:235], v150 offset:28672
v_mfma_f32_16x16x32_bf16 v[64:67], a[200:203], v[232:235], v[64:67]
v_exp_f32 v21, v21
v_mfma_f32_16x16x32_bf16 v[64:67], a[204:207], v[236:239], v[64:67]
ds_read_b64_tr_b16 a[236:237], v151 offset:24576
v_cvt_pk_bf16_f32 v82, v20, v21
v_mfma_f32_16x16x32_bf16 v[72:75], a[192:195], v[240:243], v[124:127]
v_exp_f32 v22, v22
v_mfma_f32_16x16x32_bf16 v[72:75], a[196:199], v[244:247], v[72:75]
buffer_load_dwordx4 v157, s[8:11], s34 offen offset:1024 nt lds
v_mfma_f32_16x16x32_bf16 v[72:75], a[200:203], v[248:251], v[72:75]
v_exp_f32 v23, v23
v_mfma_f32_16x16x32_bf16 v[72:75], a[204:207], v[252:255], v[72:75]
ds_read_b64_tr_b16 a[238:239], v151 offset:28672
v_cvt_pk_bf16_f32 v83, v22, v23
v_mfma_f32_16x16x32_bf16 v[52:55], a[208:211], v[192:195], v[112:115]
v_exp_f32 v24, v24
v_mfma_f32_16x16x32_bf16 v[52:55], a[212:215], v[196:199], v[52:55]
ds_read_b64_tr_b16 a[240:241], v152 offset:24576
v_add_f32 v164, v164, v24
v_mfma_f32_16x16x32_bf16 v[52:55], a[216:219], v[200:203], v[52:55]
v_exp_f32 v25, v25
v_mfma_f32_16x16x32_bf16 v[52:55], a[220:223], v[204:207], v[52:55]
ds_read_b64_tr_b16 a[242:243], v152 offset:28672
v_add_f32 v165, v165, v25
v_mfma_f32_16x16x32_bf16 v[60:63], a[208:211], v[208:211], v[116:119]
v_exp_f32 v26, v26
v_mfma_f32_16x16x32_bf16 v[60:63], a[212:215], v[212:215], v[60:63]
buffer_load_dwordx4 v158, s[8:11], s34 offen offset:2048 nt lds
v_mfma_f32_16x16x32_bf16 v[60:63], a[216:219], v[216:219], v[60:63]
v_exp_f32 v27, v27
v_mfma_f32_16x16x32_bf16 v[60:63], a[220:223], v[220:223], v[60:63]
ds_read_b64_tr_b16 a[244:245], v153 offset:24576
v_cvt_pk_bf16_f32 v84, v24, v25
v_mfma_f32_16x16x32_bf16 v[68:71], a[208:211], v[224:227], v[120:123]
v_exp_f32 v28, v28
v_mfma_f32_16x16x32_bf16 v[68:71], a[212:215], v[228:231], v[68:71]
ds_read_b64_tr_b16 a[246:247], v153 offset:28672
v_add_f32 v164, v164, v26
v_mfma_f32_16x16x32_bf16 v[68:71], a[216:219], v[232:235], v[68:71]
v_exp_f32 v29, v29
v_mfma_f32_16x16x32_bf16 v[68:71], a[220:223], v[236:239], v[68:71]
ds_read_b64_tr_b16 a[248:249], v154 offset:24576
v_add_f32 v165, v165, v27
v_mfma_f32_16x16x32_bf16 v[76:79], a[208:211], v[240:243], v[124:127]
v_exp_f32 v30, v30
v_mfma_f32_16x16x32_bf16 v[76:79], a[212:215], v[244:247], v[76:79]
ds_read_b64_tr_b16 a[250:251], v154 offset:28672
v_cvt_pk_bf16_f32 v85, v26, v27
v_mfma_f32_16x16x32_bf16 v[76:79], a[216:219], v[248:251], v[76:79]
v_exp_f32 v31, v31
v_mfma_f32_16x16x32_bf16 v[76:79], a[220:223], v[252:255], v[76:79]
s_waitcnt lgkmcnt(3)
buffer_load_dwordx4 v159, s[8:11], s34 offen offset:3072 nt lds
v_mfma_f32_16x16x32_bf16 a[0:3], v[96:99], a[224:227], a[0:3]
v_exp_f32 v32, v32
v_mfma_f32_16x16x32_bf16 a[4:7], v[100:103], a[224:227], a[4:7]
ds_read_b64_tr_b16 a[252:253], v155 offset:24576
v_add_f32 v164, v164, v28
v_mfma_f32_16x16x32_bf16 a[8:11], v[104:107], a[224:227], a[8:11]
v_exp_f32 v33, v33
v_mfma_f32_16x16x32_bf16 a[12:15], v[108:111], a[224:227], a[12:15]
ds_read_b64_tr_b16 a[254:255], v155 offset:28672
v_add_f32 v165, v165, v29
v_mfma_f32_16x16x32_bf16 a[16:19], v[96:99], a[228:231], a[16:19]
v_exp_f32 v34, v34
v_mfma_f32_16x16x32_bf16 a[20:23], v[100:103], a[228:231], a[20:23]
ds_read_b128 a[192:195], v144 offset:49152
v_cvt_pk_bf16_f32 v86, v28, v29
v_mfma_f32_16x16x32_bf16 a[24:27], v[104:107], a[228:231], a[24:27]
s_add_u32 m0, s31, 4096
v_exp_f32 v35, v35
v_mfma_f32_16x16x32_bf16 a[28:31], v[108:111], a[228:231], a[28:31]
buffer_load_dwordx4 v156, s[8:11], s35 offen offset:0 nt lds
v_mfma_f32_16x16x32_bf16 a[32:35], v[96:99], a[232:235], a[32:35]
v_exp_f32 v36, v36
v_mfma_f32_16x16x32_bf16 a[36:39], v[100:103], a[232:235], a[36:39]
ds_read_b128 a[196:199], v145 offset:49152
v_add_f32 v164, v164, v30
v_mfma_f32_16x16x32_bf16 a[40:43], v[104:107], a[232:235], a[40:43]
v_exp_f32 v37, v37
v_mfma_f32_16x16x32_bf16 a[44:47], v[108:111], a[232:235], a[44:47]
ds_read_b128 a[200:203], v146 offset:49152
v_add_f32 v165, v165, v31
v_mfma_f32_16x16x32_bf16 a[48:51], v[96:99], a[236:239], a[48:51]
v_exp_f32 v38, v38
v_mfma_f32_16x16x32_bf16 a[52:55], v[100:103], a[236:239], a[52:55]
ds_read_b128 a[204:207], v147 offset:49152
v_cvt_pk_bf16_f32 v87, v30, v31
v_mfma_f32_16x16x32_bf16 a[56:59], v[104:107], a[236:239], a[56:59]
v_exp_f32 v39, v39
v_mfma_f32_16x16x32_bf16 a[60:63], v[108:111], a[236:239], a[60:63]
ds_read_b128 a[208:211], v144 offset:53248
v_cvt_pk_bf16_f32 v88, v32, v33
v_mfma_f32_16x16x32_bf16 a[64:67], v[96:99], a[240:243], a[64:67]
v_exp_f32 v40, v40
v_mfma_f32_16x16x32_bf16 a[68:71], v[100:103], a[240:243], a[68:71]
buffer_load_dwordx4 v157, s[8:11], s35 offen offset:1024 nt lds
v_mfma_f32_16x16x32_bf16 a[72:75], v[104:107], a[240:243], a[72:75]
v_exp_f32 v41, v41
v_mfma_f32_16x16x32_bf16 a[76:79], v[108:111], a[240:243], a[76:79]
s_waitcnt lgkmcnt(2)
ds_read_b128 a[212:215], v145 offset:53248
v_cvt_pk_bf16_f32 v89, v34, v35
v_mfma_f32_16x16x32_bf16 a[80:83], v[96:99], a[244:247], a[80:83]
v_exp_f32 v42, v42
v_mfma_f32_16x16x32_bf16 a[84:87], v[100:103], a[244:247], a[84:87]
ds_read_b128 a[216:219], v146 offset:53248
v_cvt_pk_bf16_f32 v90, v36, v37
v_mfma_f32_16x16x32_bf16 a[88:91], v[104:107], a[244:247], a[88:91]
v_exp_f32 v43, v43
v_mfma_f32_16x16x32_bf16 a[92:95], v[108:111], a[244:247], a[92:95]
ds_read_b128 a[220:223], v147 offset:53248
v_cvt_pk_bf16_f32 v91, v38, v39
v_mfma_f32_16x16x32_bf16 a[96:99], v[96:99], a[248:251], a[96:99]
v_exp_f32 v44, v44
v_mfma_f32_16x16x32_bf16 a[100:103], v[100:103], a[248:251], a[100:103]
buffer_load_dwordx4 v158, s[8:11], s35 offen offset:2048 nt lds
v_mfma_f32_16x16x32_bf16 a[104:107], v[104:107], a[248:251], a[104:107]
v_exp_f32 v45, v45
v_mfma_f32_16x16x32_bf16 a[108:111], v[108:111], a[248:251], a[108:111]
v_add_f32 v168, v168, v40
v_add_f32 v169, v169, v41
v_mfma_f32_16x16x32_bf16 a[112:115], v[96:99], a[252:255], a[112:115]
v_exp_f32 v46, v46
v_mfma_f32_16x16x32_bf16 a[116:119], v[100:103], a[252:255], a[116:119]
v_cvt_pk_bf16_f32 v92, v40, v41
v_add_f32 v168, v168, v42
v_mfma_f32_16x16x32_bf16 a[120:123], v[104:107], a[252:255], a[120:123]
v_exp_f32 v47, v47
v_mfma_f32_16x16x32_bf16 a[124:127], v[108:111], a[252:255], a[124:127]
v_add_f32 v169, v169, v43
v_cvt_pk_bf16_f32 v93, v42, v43
v_mfma_f32_16x16x32_bf16 v[176:179], v[96:99], v[172:175], v[176:179]
v_add_f32 v168, v168, v44
v_add_f32 v169, v169, v45
v_mfma_f32_16x16x32_bf16 v[184:187], v[104:107], v[172:175], v[184:187]
v_cvt_pk_bf16_f32 v94, v44, v45
v_add_f32 v168, v168, v46
v_add_f32 v169, v169, v47
v_cvt_pk_bf16_f32 v95, v46, v47
v_mfma_f32_16x16x32_bf16 v[16:19], a[192:195], v[192:195], v[112:115]
v_exp_f32 v48, v48
v_mfma_f32_16x16x32_bf16 v[16:19], a[196:199], v[196:199], v[16:19]
ds_read_b64_tr_b16 a[224:225], v148 offset:32768
ds_read_b64_tr_b16 a[226:227], v148 offset:36864
v_mfma_f32_16x16x32_bf16 v[16:19], a[200:203], v[200:203], v[16:19]
s_waitcnt lgkmcnt(2)
v_exp_f32 v49, v49
v_mfma_f32_16x16x32_bf16 v[16:19], a[204:207], v[204:207], v[16:19]
buffer_load_dwordx4 v159, s[8:11], s35 offen offset:3072 nt lds
v_mfma_f32_16x16x32_bf16 v[24:27], a[192:195], v[208:211], v[116:119]
v_exp_f32 v50, v50
v_mfma_f32_16x16x32_bf16 v[24:27], a[196:199], v[212:215], v[24:27]
ds_read_b64_tr_b16 a[228:229], v149 offset:32768
v_cvt_pk_bf16_f32 v96, v48, v49
v_mfma_f32_16x16x32_bf16 v[24:27], a[200:203], v[216:219], v[24:27]
v_exp_f32 v51, v51
v_mfma_f32_16x16x32_bf16 v[24:27], a[204:207], v[220:223], v[24:27]
ds_read_b64_tr_b16 a[230:231], v149 offset:36864
v_cvt_pk_bf16_f32 v97, v50, v51
v_mfma_f32_16x16x32_bf16 v[32:35], a[192:195], v[224:227], v[120:123]
v_exp_f32 v52, v52
v_mfma_f32_16x16x32_bf16 v[32:35], a[196:199], v[228:231], v[32:35]
ds_read_b64_tr_b16 a[232:233], v150 offset:32768
ds_read_b64_tr_b16 a[234:235], v150 offset:36864
v_mfma_f32_16x16x32_bf16 v[32:35], a[200:203], v[232:235], v[32:35]
v_exp_f32 v53, v53
v_mfma_f32_16x16x32_bf16 v[32:35], a[204:207], v[236:239], v[32:35]
ds_read_b64_tr_b16 a[236:237], v151 offset:32768
v_cvt_pk_bf16_f32 v98, v52, v53
v_mfma_f32_16x16x32_bf16 v[40:43], a[192:195], v[240:243], v[124:127]
s_mov_b32 m0, s33
v_exp_f32 v54, v54
v_mfma_f32_16x16x32_bf16 v[40:43], a[196:199], v[244:247], v[40:43]
buffer_load_dwordx4 v160, s[12:15], s36 offen offset:0 nt lds
v_mfma_f32_16x16x32_bf16 v[40:43], a[200:203], v[248:251], v[40:43]
v_exp_f32 v55, v55
v_mfma_f32_16x16x32_bf16 v[40:43], a[204:207], v[252:255], v[40:43]
ds_read_b64_tr_b16 a[238:239], v151 offset:36864
v_cvt_pk_bf16_f32 v99, v54, v55
v_mfma_f32_16x16x32_bf16 v[20:23], a[208:211], v[192:195], v[112:115]
v_exp_f32 v56, v56
v_mfma_f32_16x16x32_bf16 v[20:23], a[212:215], v[196:199], v[20:23]
ds_read_b64_tr_b16 a[240:241], v152 offset:32768
v_add_f32 v164, v164, v56
v_mfma_f32_16x16x32_bf16 v[20:23], a[216:219], v[200:203], v[20:23]
v_exp_f32 v57, v57
v_mfma_f32_16x16x32_bf16 v[20:23], a[220:223], v[204:207], v[20:23]
ds_read_b64_tr_b16 a[242:243], v152 offset:36864
v_add_f32 v165, v165, v57
v_mfma_f32_16x16x32_bf16 v[28:31], a[208:211], v[208:211], v[116:119]
v_exp_f32 v58, v58
v_mfma_f32_16x16x32_bf16 v[28:31], a[212:215], v[212:215], v[28:31]
buffer_load_dwordx4 v161, s[12:15], s36 offen offset:1024 nt lds
v_mfma_f32_16x16x32_bf16 v[28:31], a[216:219], v[216:219], v[28:31]
v_exp_f32 v59, v59
v_mfma_f32_16x16x32_bf16 v[28:31], a[220:223], v[220:223], v[28:31]
ds_read_b64_tr_b16 a[244:245], v153 offset:32768
v_cvt_pk_bf16_f32 v100, v56, v57
v_mfma_f32_16x16x32_bf16 v[36:39], a[208:211], v[224:227], v[120:123]
v_exp_f32 v60, v60
v_mfma_f32_16x16x32_bf16 v[36:39], a[212:215], v[228:231], v[36:39]
ds_read_b64_tr_b16 a[246:247], v153 offset:36864
v_add_f32 v164, v164, v58
v_mfma_f32_16x16x32_bf16 v[36:39], a[216:219], v[232:235], v[36:39]
v_exp_f32 v61, v61
v_mfma_f32_16x16x32_bf16 v[36:39], a[220:223], v[236:239], v[36:39]
ds_read_b64_tr_b16 a[248:249], v154 offset:32768
v_add_f32 v165, v165, v59
v_mfma_f32_16x16x32_bf16 v[44:47], a[208:211], v[240:243], v[124:127]
v_exp_f32 v62, v62
v_mfma_f32_16x16x32_bf16 v[44:47], a[212:215], v[244:247], v[44:47]
ds_read_b64_tr_b16 a[250:251], v154 offset:36864
v_cvt_pk_bf16_f32 v101, v58, v59
v_mfma_f32_16x16x32_bf16 v[44:47], a[216:219], v[248:251], v[44:47]
v_exp_f32 v63, v63
v_mfma_f32_16x16x32_bf16 v[44:47], a[220:223], v[252:255], v[44:47]
s_waitcnt lgkmcnt(3)
buffer_load_dwordx4 v160, s[12:15], s36 offen offset:2048 nt lds
v_mfma_f32_16x16x32_bf16 a[0:3], v[80:83], a[224:227], a[0:3]
v_exp_f32 v64, v64
v_mfma_f32_16x16x32_bf16 a[4:7], v[84:87], a[224:227], a[4:7]
ds_read_b64_tr_b16 a[252:253], v155 offset:32768
v_add_f32 v164, v164, v60
v_mfma_f32_16x16x32_bf16 a[8:11], v[88:91], a[224:227], a[8:11]
v_exp_f32 v65, v65
v_mfma_f32_16x16x32_bf16 a[12:15], v[92:95], a[224:227], a[12:15]
ds_read_b64_tr_b16 a[254:255], v155 offset:36864
v_add_f32 v165, v165, v61
v_mfma_f32_16x16x32_bf16 a[16:19], v[80:83], a[228:231], a[16:19]
v_exp_f32 v66, v66
v_mfma_f32_16x16x32_bf16 a[20:23], v[84:87], a[228:231], a[20:23]
ds_read_b128 a[192:195], v144 offset:57344
v_cvt_pk_bf16_f32 v102, v60, v61
v_mfma_f32_16x16x32_bf16 a[24:27], v[88:91], a[228:231], a[24:27]
v_exp_f32 v67, v67
v_mfma_f32_16x16x32_bf16 a[28:31], v[92:95], a[228:231], a[28:31]
buffer_load_dwordx4 v161, s[12:15], s36 offen offset:3072 nt lds
v_mfma_f32_16x16x32_bf16 a[32:35], v[80:83], a[232:235], a[32:35]
v_exp_f32 v68, v68
v_mfma_f32_16x16x32_bf16 a[36:39], v[84:87], a[232:235], a[36:39]
ds_read_b128 a[196:199], v145 offset:57344
v_add_f32 v164, v164, v62
v_mfma_f32_16x16x32_bf16 a[40:43], v[88:91], a[232:235], a[40:43]
v_exp_f32 v69, v69
v_mfma_f32_16x16x32_bf16 a[44:47], v[92:95], a[232:235], a[44:47]
ds_read_b128 a[200:203], v146 offset:57344
v_add_f32 v165, v165, v63
v_mfma_f32_16x16x32_bf16 a[48:51], v[80:83], a[236:239], a[48:51]
v_exp_f32 v70, v70
v_mfma_f32_16x16x32_bf16 a[52:55], v[84:87], a[236:239], a[52:55]
ds_read_b128 a[204:207], v147 offset:57344
v_cvt_pk_bf16_f32 v103, v62, v63
v_mfma_f32_16x16x32_bf16 a[56:59], v[88:91], a[236:239], a[56:59]
v_exp_f32 v71, v71
v_mfma_f32_16x16x32_bf16 a[60:63], v[92:95], a[236:239], a[60:63]
ds_read_b128 a[208:211], v144 offset:61440
v_cvt_pk_bf16_f32 v104, v64, v65
v_mfma_f32_16x16x32_bf16 a[64:67], v[80:83], a[240:243], a[64:67]
v_exp_f32 v72, v72
v_mfma_f32_16x16x32_bf16 a[68:71], v[84:87], a[240:243], a[68:71]
ds_read_b128 a[212:215], v145 offset:61440
v_cvt_pk_bf16_f32 v105, v66, v67
v_mfma_f32_16x16x32_bf16 a[72:75], v[88:91], a[240:243], a[72:75]
v_exp_f32 v73, v73
v_mfma_f32_16x16x32_bf16 a[76:79], v[92:95], a[240:243], a[76:79]
s_waitcnt lgkmcnt(3)
ds_read_b128 a[216:219], v146 offset:61440
v_cvt_pk_bf16_f32 v106, v68, v69
v_mfma_f32_16x16x32_bf16 a[80:83], v[80:83], a[244:247], a[80:83]
v_exp_f32 v74, v74
v_mfma_f32_16x16x32_bf16 a[84:87], v[84:87], a[244:247], a[84:87]
ds_read_b128 a[220:223], v147 offset:61440
v_cvt_pk_bf16_f32 v107, v70, v71
v_mfma_f32_16x16x32_bf16 a[88:91], v[88:91], a[244:247], a[88:91]
v_exp_f32 v75, v75
v_mfma_f32_16x16x32_bf16 a[92:95], v[92:95], a[244:247], a[92:95]
v_add_f32 v168, v168, v72
v_add_f32 v169, v169, v73
v_mfma_f32_16x16x32_bf16 a[96:99], v[80:83], a[248:251], a[96:99]
v_exp_f32 v76, v76
v_mfma_f32_16x16x32_bf16 a[100:103], v[84:87], a[248:251], a[100:103]
v_cvt_pk_bf16_f32 v108, v72, v73
v_add_f32 v168, v168, v74
v_mfma_f32_16x16x32_bf16 a[104:107], v[88:91], a[248:251], a[104:107]
v_exp_f32 v77, v77
v_mfma_f32_16x16x32_bf16 a[108:111], v[92:95], a[248:251], a[108:111]
v_add_f32 v169, v169, v75
v_cvt_pk_bf16_f32 v109, v74, v75
v_mfma_f32_16x16x32_bf16 a[112:115], v[80:83], a[252:255], a[112:115]
v_exp_f32 v78, v78
v_mfma_f32_16x16x32_bf16 a[116:119], v[84:87], a[252:255], a[116:119]
v_add_f32 v168, v168, v76
v_add_f32 v169, v169, v77
v_mfma_f32_16x16x32_bf16 a[120:123], v[88:91], a[252:255], a[120:123]
v_exp_f32 v79, v79
v_mfma_f32_16x16x32_bf16 a[124:127], v[92:95], a[252:255], a[124:127]
v_cvt_pk_bf16_f32 v110, v76, v77
v_add_f32 v168, v168, v78
v_mfma_f32_16x16x32_bf16 v[176:179], v[80:83], v[172:175], v[176:179]
v_add_f32 v169, v169, v79
v_cvt_pk_bf16_f32 v111, v78, v79
v_mfma_f32_16x16x32_bf16 v[184:187], v[88:91], v[172:175], v[184:187]
v_mfma_f32_16x16x32_bf16 v[48:51], a[192:195], v[192:195], v[112:115]
v_exp_f32 v16, v16
v_mfma_f32_16x16x32_bf16 v[48:51], a[196:199], v[196:199], v[48:51]
ds_read_b64_tr_b16 a[224:225], v148 offset:40960
ds_read_b64_tr_b16 a[226:227], v148 offset:45056
v_mfma_f32_16x16x32_bf16 v[48:51], a[200:203], v[200:203], v[48:51]
s_waitcnt lgkmcnt(2)
s_add_u32 m0, s33, 4096
v_exp_f32 v17, v17
v_mfma_f32_16x16x32_bf16 v[48:51], a[204:207], v[204:207], v[48:51]
buffer_load_dwordx4 v160, s[12:15], s37 offen offset:0 nt lds
v_mfma_f32_16x16x32_bf16 v[56:59], a[192:195], v[208:211], v[116:119]
v_exp_f32 v18, v18
v_mfma_f32_16x16x32_bf16 v[56:59], a[196:199], v[212:215], v[56:59]
ds_read_b64_tr_b16 a[228:229], v149 offset:40960
v_cvt_pk_bf16_f32 v80, v16, v17
v_mfma_f32_16x16x32_bf16 v[56:59], a[200:203], v[216:219], v[56:59]
v_exp_f32 v19, v19
v_mfma_f32_16x16x32_bf16 v[56:59], a[204:207], v[220:223], v[56:59]
ds_read_b64_tr_b16 a[230:231], v149 offset:45056
v_cvt_pk_bf16_f32 v81, v18, v19
v_mfma_f32_16x16x32_bf16 v[64:67], a[192:195], v[224:227], v[120:123]
v_exp_f32 v20, v20
v_mfma_f32_16x16x32_bf16 v[64:67], a[196:199], v[228:231], v[64:67]
ds_read_b64_tr_b16 a[232:233], v150 offset:40960
ds_read_b64_tr_b16 a[234:235], v150 offset:45056
v_mfma_f32_16x16x32_bf16 v[64:67], a[200:203], v[232:235], v[64:67]
v_exp_f32 v21, v21
v_mfma_f32_16x16x32_bf16 v[64:67], a[204:207], v[236:239], v[64:67]
ds_read_b64_tr_b16 a[236:237], v151 offset:40960
v_cvt_pk_bf16_f32 v82, v20, v21
v_mfma_f32_16x16x32_bf16 v[72:75], a[192:195], v[240:243], v[124:127]
v_exp_f32 v22, v22
v_mfma_f32_16x16x32_bf16 v[72:75], a[196:199], v[244:247], v[72:75]
buffer_load_dwordx4 v161, s[12:15], s37 offen offset:1024 nt lds
v_mfma_f32_16x16x32_bf16 v[72:75], a[200:203], v[248:251], v[72:75]
v_exp_f32 v23, v23
v_mfma_f32_16x16x32_bf16 v[72:75], a[204:207], v[252:255], v[72:75]
ds_read_b64_tr_b16 a[238:239], v151 offset:45056
v_cvt_pk_bf16_f32 v83, v22, v23
v_mfma_f32_16x16x32_bf16 v[52:55], a[208:211], v[192:195], v[112:115]
v_exp_f32 v24, v24
v_mfma_f32_16x16x32_bf16 v[52:55], a[212:215], v[196:199], v[52:55]
ds_read_b64_tr_b16 a[240:241], v152 offset:40960
v_add_f32 v164, v164, v24
v_mfma_f32_16x16x32_bf16 v[52:55], a[216:219], v[200:203], v[52:55]
v_exp_f32 v25, v25
v_mfma_f32_16x16x32_bf16 v[52:55], a[220:223], v[204:207], v[52:55]
ds_read_b64_tr_b16 a[242:243], v152 offset:45056
v_add_f32 v165, v165, v25
v_mfma_f32_16x16x32_bf16 v[60:63], a[208:211], v[208:211], v[116:119]
v_exp_f32 v26, v26
v_mfma_f32_16x16x32_bf16 v[60:63], a[212:215], v[212:215], v[60:63]
buffer_load_dwordx4 v160, s[12:15], s37 offen offset:2048 nt lds
v_mfma_f32_16x16x32_bf16 v[60:63], a[216:219], v[216:219], v[60:63]
v_exp_f32 v27, v27
v_mfma_f32_16x16x32_bf16 v[60:63], a[220:223], v[220:223], v[60:63]
ds_read_b64_tr_b16 a[244:245], v153 offset:40960
v_cvt_pk_bf16_f32 v84, v24, v25
v_mfma_f32_16x16x32_bf16 v[68:71], a[208:211], v[224:227], v[120:123]
v_exp_f32 v28, v28
v_mfma_f32_16x16x32_bf16 v[68:71], a[212:215], v[228:231], v[68:71]
ds_read_b64_tr_b16 a[246:247], v153 offset:45056
v_add_f32 v164, v164, v26
v_mfma_f32_16x16x32_bf16 v[68:71], a[216:219], v[232:235], v[68:71]
v_exp_f32 v29, v29
v_mfma_f32_16x16x32_bf16 v[68:71], a[220:223], v[236:239], v[68:71]
ds_read_b64_tr_b16 a[248:249], v154 offset:40960
v_add_f32 v165, v165, v27
v_mfma_f32_16x16x32_bf16 v[76:79], a[208:211], v[240:243], v[124:127]
v_exp_f32 v30, v30
v_mfma_f32_16x16x32_bf16 v[76:79], a[212:215], v[244:247], v[76:79]
ds_read_b64_tr_b16 a[250:251], v154 offset:45056
v_cvt_pk_bf16_f32 v85, v26, v27
v_mfma_f32_16x16x32_bf16 v[76:79], a[216:219], v[248:251], v[76:79]
v_exp_f32 v31, v31
v_mfma_f32_16x16x32_bf16 v[76:79], a[220:223], v[252:255], v[76:79]
s_waitcnt lgkmcnt(3)
buffer_load_dwordx4 v161, s[12:15], s37 offen offset:3072 nt lds
v_mfma_f32_16x16x32_bf16 a[0:3], v[96:99], a[224:227], a[0:3]
v_exp_f32 v32, v32
v_mfma_f32_16x16x32_bf16 a[4:7], v[100:103], a[224:227], a[4:7]
ds_read_b64_tr_b16 a[252:253], v155 offset:40960
v_add_f32 v164, v164, v28
v_mfma_f32_16x16x32_bf16 a[8:11], v[104:107], a[224:227], a[8:11]
v_exp_f32 v33, v33
v_mfma_f32_16x16x32_bf16 a[12:15], v[108:111], a[224:227], a[12:15]
ds_read_b64_tr_b16 a[254:255], v155 offset:45056
v_add_f32 v165, v165, v29
v_mfma_f32_16x16x32_bf16 a[16:19], v[96:99], a[228:231], a[16:19]
v_exp_f32 v34, v34
v_mfma_f32_16x16x32_bf16 a[20:23], v[100:103], a[228:231], a[20:23]
ds_read_b128 a[192:195], v144 offset:0
v_cvt_pk_bf16_f32 v86, v28, v29
v_mfma_f32_16x16x32_bf16 a[24:27], v[104:107], a[228:231], a[24:27]
v_exp_f32 v35, v35
v_mfma_f32_16x16x32_bf16 a[28:31], v[108:111], a[228:231], a[28:31]
buffer_store_dwordx4 v[8:11], v13, s[20:23], s4 offen offset:0 sc1
v_mfma_f32_16x16x32_bf16 a[32:35], v[96:99], a[232:235], a[32:35]
v_exp_f32 v36, v36
v_mfma_f32_16x16x32_bf16 a[36:39], v[100:103], a[232:235], a[36:39]
ds_read_b128 a[196:199], v145 offset:0
v_add_f32 v164, v164, v30
v_mfma_f32_16x16x32_bf16 a[40:43], v[104:107], a[232:235], a[40:43]
v_exp_f32 v37, v37
v_mfma_f32_16x16x32_bf16 a[44:47], v[108:111], a[232:235], a[44:47]
ds_read_b128 a[200:203], v146 offset:0
v_add_f32 v165, v165, v31
v_mfma_f32_16x16x32_bf16 a[48:51], v[96:99], a[236:239], a[48:51]
v_exp_f32 v38, v38
v_mfma_f32_16x16x32_bf16 a[52:55], v[100:103], a[236:239], a[52:55]
ds_read_b128 a[204:207], v147 offset:0
v_cvt_pk_bf16_f32 v87, v30, v31
v_mfma_f32_16x16x32_bf16 a[56:59], v[104:107], a[236:239], a[56:59]
v_exp_f32 v39, v39
v_mfma_f32_16x16x32_bf16 a[60:63], v[108:111], a[236:239], a[60:63]
ds_read_b128 a[208:211], v144 offset:4096
v_cvt_pk_bf16_f32 v88, v32, v33
v_mfma_f32_16x16x32_bf16 a[64:67], v[96:99], a[240:243], a[64:67]
v_exp_f32 v40, v40
v_mfma_f32_16x16x32_bf16 a[68:71], v[100:103], a[240:243], a[68:71]
ds_read_b128 a[212:215], v145 offset:4096
v_cvt_pk_bf16_f32 v89, v34, v35
v_mfma_f32_16x16x32_bf16 a[72:75], v[104:107], a[240:243], a[72:75]
v_exp_f32 v41, v41
v_mfma_f32_16x16x32_bf16 a[76:79], v[108:111], a[240:243], a[76:79]
s_waitcnt lgkmcnt(3)
ds_read_b128 a[216:219], v146 offset:4096
v_cvt_pk_bf16_f32 v90, v36, v37
v_mfma_f32_16x16x32_bf16 a[80:83], v[96:99], a[244:247], a[80:83]
v_exp_f32 v42, v42
v_mfma_f32_16x16x32_bf16 a[84:87], v[100:103], a[244:247], a[84:87]
ds_read_b128 a[220:223], v147 offset:4096
v_cvt_pk_bf16_f32 v91, v38, v39
v_mfma_f32_16x16x32_bf16 a[88:91], v[104:107], a[244:247], a[88:91]
v_exp_f32 v43, v43
v_mfma_f32_16x16x32_bf16 a[92:95], v[108:111], a[244:247], a[92:95]
v_add_f32 v168, v168, v40
v_add_f32 v169, v169, v41
v_mfma_f32_16x16x32_bf16 a[96:99], v[96:99], a[248:251], a[96:99]
v_exp_f32 v44, v44
v_mfma_f32_16x16x32_bf16 a[100:103], v[100:103], a[248:251], a[100:103]
v_cvt_pk_bf16_f32 v92, v40, v41
v_add_f32 v168, v168, v42
v_mfma_f32_16x16x32_bf16 a[104:107], v[104:107], a[248:251], a[104:107]
v_exp_f32 v45, v45
v_mfma_f32_16x16x32_bf16 a[108:111], v[108:111], a[248:251], a[108:111]
v_add_f32 v169, v169, v43
v_cvt_pk_bf16_f32 v93, v42, v43
v_mfma_f32_16x16x32_bf16 a[112:115], v[96:99], a[252:255], a[112:115]
v_exp_f32 v46, v46
v_mfma_f32_16x16x32_bf16 a[116:119], v[100:103], a[252:255], a[116:119]
v_add_f32 v168, v168, v44
v_add_f32 v169, v169, v45
v_mfma_f32_16x16x32_bf16 a[120:123], v[104:107], a[252:255], a[120:123]
v_exp_f32 v47, v47
v_mfma_f32_16x16x32_bf16 a[124:127], v[108:111], a[252:255], a[124:127]
v_cvt_pk_bf16_f32 v94, v44, v45
v_add_f32 v168, v168, v46
v_mfma_f32_16x16x32_bf16 v[176:179], v[96:99], v[172:175], v[176:179]
v_add_f32 v169, v169, v47
v_cvt_pk_bf16_f32 v95, v46, v47
v_mfma_f32_16x16x32_bf16 v[184:187], v[104:107], v[172:175], v[184:187]
v_mfma_f32_16x16x32_bf16 v[16:19], a[192:195], v[192:195], v[112:115]
v_exp_f32 v48, v48
v_mfma_f32_16x16x32_bf16 v[16:19], a[196:199], v[196:199], v[16:19]
ds_read_b64_tr_b16 a[224:225], v148 offset:49152
v_and_b32 v5, 31, v2
v_mfma_f32_16x16x32_bf16 v[16:19], a[200:203], v[200:203], v[16:19]
s_waitcnt lgkmcnt(1)
s_add_u32 s4, s4, 1024
v_exp_f32 v49, v49
v_mfma_f32_16x16x32_bf16 v[16:19], a[204:207], v[204:207], v[16:19]
buffer_store_dwordx4 v[8:11], v13, s[20:23], s4 offen offset:0 sc1
v_mfma_f32_16x16x32_bf16 v[24:27], a[192:195], v[208:211], v[116:119]
v_exp_f32 v50, v50
v_mfma_f32_16x16x32_bf16 v[24:27], a[196:199], v[212:215], v[24:27]
ds_read_b64_tr_b16 a[226:227], v148 offset:53248
v_cvt_pk_bf16_f32 v96, v48, v49
v_mfma_f32_16x16x32_bf16 v[24:27], a[200:203], v[216:219], v[24:27]
v_exp_f32 v51, v51
v_mfma_f32_16x16x32_bf16 v[24:27], a[204:207], v[220:223], v[24:27]
ds_read_b64_tr_b16 a[228:229], v149 offset:49152
v_min_u32 v5, 27, v5
v_mfma_f32_16x16x32_bf16 v[32:35], a[192:195], v[224:227], v[120:123]
v_exp_f32 v52, v52
v_mfma_f32_16x16x32_bf16 v[32:35], a[196:199], v[228:231], v[32:35]
ds_read_b64_tr_b16 a[230:231], v149 offset:53248
v_cvt_pk_bf16_f32 v97, v50, v51
v_mfma_f32_16x16x32_bf16 v[32:35], a[200:203], v[232:235], v[32:35]
v_exp_f32 v53, v53
v_mfma_f32_16x16x32_bf16 v[32:35], a[204:207], v[236:239], v[32:35]
ds_read_b64_tr_b16 a[232:233], v150 offset:49152
v_mul_u32_u24 v6, 37, v5
v_mfma_f32_16x16x32_bf16 v[40:43], a[192:195], v[240:243], v[124:127]
v_exp_f32 v54, v54
v_mfma_f32_16x16x32_bf16 v[40:43], a[196:199], v[244:247], v[40:43]
ds_read_b64_tr_b16 a[234:235], v150 offset:53248
v_cvt_pk_bf16_f32 v98, v52, v53
v_mfma_f32_16x16x32_bf16 v[40:43], a[200:203], v[248:251], v[40:43]
v_exp_f32 v55, v55
v_mfma_f32_16x16x32_bf16 v[40:43], a[204:207], v[252:255], v[40:43]
ds_read_b64_tr_b16 a[236:237], v151 offset:49152
v_lshrrev_b32 v6, 8, v6
v_mfma_f32_16x16x32_bf16 v[20:23], a[208:211], v[192:195], v[112:115]
v_exp_f32 v56, v56
v_mfma_f32_16x16x32_bf16 v[20:23], a[212:215], v[196:199], v[20:23]
ds_read_b64_tr_b16 a[238:239], v151 offset:53248
v_cvt_pk_bf16_f32 v99, v54, v55
v_mfma_f32_16x16x32_bf16 v[20:23], a[216:219], v[200:203], v[20:23]
v_exp_f32 v57, v57
v_mfma_f32_16x16x32_bf16 v[20:23], a[220:223], v[204:207], v[20:23]
ds_read_b64_tr_b16 a[240:241], v152 offset:49152
v_add_f32 v164, v164, v56
v_mfma_f32_16x16x32_bf16 v[28:31], a[208:211], v[208:211], v[116:119]
v_exp_f32 v58, v58
v_mfma_f32_16x16x32_bf16 v[28:31], a[212:215], v[212:215], v[28:31]
ds_read_b64_tr_b16 a[242:243], v152 offset:53248
v_mul_u32_u24 v7, 7, v6
v_mfma_f32_16x16x32_bf16 v[28:31], a[216:219], v[216:219], v[28:31]
v_exp_f32 v59, v59
v_mfma_f32_16x16x32_bf16 v[28:31], a[220:223], v[220:223], v[28:31]
ds_read_b64_tr_b16 a[244:245], v153 offset:49152
v_add_f32 v165, v165, v57
v_mfma_f32_16x16x32_bf16 v[36:39], a[208:211], v[224:227], v[120:123]
v_exp_f32 v60, v60
v_mfma_f32_16x16x32_bf16 v[36:39], a[212:215], v[228:231], v[36:39]
ds_read_b64_tr_b16 a[246:247], v153 offset:53248
v_cvt_pk_bf16_f32 v100, v56, v57
v_mfma_f32_16x16x32_bf16 v[36:39], a[216:219], v[232:235], v[36:39]
v_exp_f32 v61, v61
v_mfma_f32_16x16x32_bf16 v[36:39], a[220:223], v[236:239], v[36:39]
ds_read_b64_tr_b16 a[248:249], v154 offset:49152
v_add_f32 v164, v164, v58
v_mfma_f32_16x16x32_bf16 v[44:47], a[208:211], v[240:243], v[124:127]
v_exp_f32 v62, v62
v_mfma_f32_16x16x32_bf16 v[44:47], a[212:215], v[244:247], v[44:47]
ds_read_b64_tr_b16 a[250:251], v154 offset:53248
v_sub_u32 v5, v5, v7
v_mfma_f32_16x16x32_bf16 v[44:47], a[216:219], v[248:251], v[44:47]
v_exp_f32 v63, v63
v_mfma_f32_16x16x32_bf16 v[44:47], a[220:223], v[252:255], v[44:47]
s_waitcnt lgkmcnt(3)
ds_read_b64_tr_b16 a[252:253], v155 offset:49152
v_add_f32 v165, v165, v59
v_mfma_f32_16x16x32_bf16 a[0:3], v[80:83], a[224:227], a[0:3]
v_exp_f32 v64, v64
v_mfma_f32_16x16x32_bf16 a[4:7], v[84:87], a[224:227], a[4:7]
ds_read_b64_tr_b16 a[254:255], v155 offset:53248
v_cvt_pk_bf16_f32 v101, v58, v59
v_mfma_f32_16x16x32_bf16 a[8:11], v[88:91], a[224:227], a[8:11]
v_exp_f32 v65, v65
v_mfma_f32_16x16x32_bf16 a[12:15], v[92:95], a[224:227], a[12:15]
ds_read_b128 a[192:195], v144 offset:8192
v_add_f32 v164, v164, v60
v_mfma_f32_16x16x32_bf16 a[16:19], v[80:83], a[228:231], a[16:19]
v_exp_f32 v66, v66
v_mfma_f32_16x16x32_bf16 a[20:23], v[84:87], a[228:231], a[20:23]
ds_read_b128 a[196:199], v145 offset:8192
v_mul_u32_u24 v6, 3584, v6
v_mfma_f32_16x16x32_bf16 a[24:27], v[88:91], a[228:231], a[24:27]
v_exp_f32 v67, v67
v_mfma_f32_16x16x32_bf16 a[28:31], v[92:95], a[228:231], a[28:31]
ds_read_b128 a[200:203], v146 offset:8192
v_add_f32 v165, v165, v61
v_mfma_f32_16x16x32_bf16 a[32:35], v[80:83], a[232:235], a[32:35]
s_add_u32 s34, s34, 32768
v_exp_f32 v68, v68
v_mfma_f32_16x16x32_bf16 a[36:39], v[84:87], a[232:235], a[36:39]
ds_read_b128 a[204:207], v147 offset:8192
v_cvt_pk_bf16_f32 v102, v60, v61
v_mfma_f32_16x16x32_bf16 a[40:43], v[88:91], a[232:235], a[40:43]
s_add_u32 s35, s35, 32768
v_exp_f32 v69, v69
v_mfma_f32_16x16x32_bf16 a[44:47], v[92:95], a[232:235], a[44:47]
ds_read_b128 a[208:211], v144 offset:12288
v_add_f32 v164, v164, v62
v_mfma_f32_16x16x32_bf16 a[48:51], v[80:83], a[236:239], a[48:51]
s_add_u32 s36, s36, 32768
v_exp_f32 v70, v70
v_mfma_f32_16x16x32_bf16 a[52:55], v[84:87], a[236:239], a[52:55]
ds_read_b128 a[212:215], v145 offset:12288
v_lshl_add_u32 v6, v5, 7, v6
v_mfma_f32_16x16x32_bf16 a[56:59], v[88:91], a[236:239], a[56:59]
s_add_u32 s37, s37, 32768
v_exp_f32 v71, v71
v_mfma_f32_16x16x32_bf16 a[60:63], v[92:95], a[236:239], a[60:63]
ds_read_b128 a[216:219], v146 offset:12288
v_add_f32 v165, v165, v63
v_mfma_f32_16x16x32_bf16 a[64:67], v[80:83], a[240:243], a[64:67]
v_exp_f32 v72, v72
v_mfma_f32_16x16x32_bf16 a[68:71], v[84:87], a[240:243], a[68:71]
ds_read_b128 a[220:223], v147 offset:12288
v_cvt_pk_bf16_f32 v103, v62, v63
v_mfma_f32_16x16x32_bf16 a[72:75], v[88:91], a[240:243], a[72:75]
v_exp_f32 v73, v73
v_mfma_f32_16x16x32_bf16 a[76:79], v[92:95], a[240:243], a[76:79]
s_waitcnt lgkmcnt(3)
v_lshrrev_b32 v5, 5, v2
v_cvt_pk_bf16_f32 v104, v64, v65
v_mfma_f32_16x16x32_bf16 a[80:83], v[80:83], a[244:247], a[80:83]
v_exp_f32 v74, v74
v_mfma_f32_16x16x32_bf16 a[84:87], v[84:87], a[244:247], a[84:87]
v_lshl_add_u32 v6, v5, 6, v6
v_cvt_pk_bf16_f32 v105, v66, v67
v_mfma_f32_16x16x32_bf16 a[88:91], v[88:91], a[244:247], a[88:91]
v_exp_f32 v75, v75
v_mfma_f32_16x16x32_bf16 a[92:95], v[92:95], a[244:247], a[92:95]
v_add_u32 v137, s85, v6
v_cvt_pk_bf16_f32 v106, v68, v69
v_mfma_f32_16x16x32_bf16 a[96:99], v[80:83], a[248:251], a[96:99]
v_exp_f32 v76, v76
v_mfma_f32_16x16x32_bf16 a[100:103], v[84:87], a[248:251], a[100:103]
v_and_b32 v15, 7, v2
v_cvt_pk_bf16_f32 v107, v70, v71
v_mfma_f32_16x16x32_bf16 a[104:107], v[88:91], a[248:251], a[104:107]
v_exp_f32 v77, v77
v_mfma_f32_16x16x32_bf16 a[108:111], v[92:95], a[248:251], a[108:111]
v_add_f32 v168, v168, v72
v_lshlrev_b32 v15, 6, v15
v_mfma_f32_16x16x32_bf16 a[112:115], v[80:83], a[252:255], a[112:115]
v_exp_f32 v78, v78
v_mfma_f32_16x16x32_bf16 a[116:119], v[84:87], a[252:255], a[116:119]
v_add_f32 v169, v169, v73
v_cvt_pk_bf16_f32 v108, v72, v73
v_mfma_f32_16x16x32_bf16 a[120:123], v[88:91], a[252:255], a[120:123]
v_exp_f32 v79, v79
v_mfma_f32_16x16x32_bf16 a[124:127], v[92:95], a[252:255], a[124:127]
v_add_f32 v168, v168, v74
v_add_u32 v15, s87, v15
v_mfma_f32_16x16x32_bf16 v[176:179], v[80:83], v[172:175], v[176:179]
v_add_f32 v169, v169, v75
v_cvt_pk_bf16_f32 v109, v74, v75
v_mfma_f32_16x16x32_bf16 v[184:187], v[88:91], v[172:175], v[184:187]
v_add_f32 v168, v168, v76
v_min_u32 v15, adaLN_cond__mha_block_cached__glu_gated_bilinear__prompt_kernel_end - adaLN_cond__mha_block_cached__glu_gated_bilinear__prompt_kernel_late, v15
v_add_f32 v169, v169, v77
v_cvt_pk_bf16_f32 v110, v76, v77
v_add_f32 v168, v168, v78
v_add_f32 v169, v169, v79
v_cvt_pk_bf16_f32 v111, v78, v79
s_waitcnt vmcnt(2) lgkmcnt(0)
s_barrier
s_mov_b32 s38, 0
.p2align 6
adaLN_cond__mha_block_cached__glu_gated_bilinear__prompt_kernel_loop:
v_mfma_f32_16x16x32_bf16 v[48:51], a[192:195], v[192:195], v[112:115]
v_exp_f32 v16, v16
v_mfma_f32_16x16x32_bf16 v[48:51], a[196:199], v[196:199], v[48:51]
ds_read_b64_tr_b16 a[224:225], v148 offset:57344
ds_read_b64_tr_b16 a[226:227], v148 offset:61440
v_mfma_f32_16x16x32_bf16 v[48:51], a[200:203], v[200:203], v[48:51]
s_mov_b32 m0, s30
v_exp_f32 v17, v17
v_mfma_f32_16x16x32_bf16 v[48:51], a[204:207], v[204:207], v[48:51]
buffer_load_dwordx4 v156, s[8:11], s34 offen offset:0 nt lds
v_mfma_f32_16x16x32_bf16 v[56:59], a[192:195], v[208:211], v[116:119]
v_exp_f32 v18, v18
v_mfma_f32_16x16x32_bf16 v[56:59], a[196:199], v[212:215], v[56:59]
ds_read_b64_tr_b16 a[228:229], v149 offset:57344
v_cvt_pk_bf16_f32 v80, v16, v17
v_mfma_f32_16x16x32_bf16 v[56:59], a[200:203], v[216:219], v[56:59]
v_exp_f32 v19, v19
v_mfma_f32_16x16x32_bf16 v[56:59], a[204:207], v[220:223], v[56:59]
ds_read_b64_tr_b16 a[230:231], v149 offset:61440
v_cvt_pk_bf16_f32 v81, v18, v19
v_mfma_f32_16x16x32_bf16 v[64:67], a[192:195], v[224:227], v[120:123]
v_exp_f32 v20, v20
v_mfma_f32_16x16x32_bf16 v[64:67], a[196:199], v[228:231], v[64:67]
ds_read_b64_tr_b16 a[232:233], v150 offset:57344
ds_read_b64_tr_b16 a[234:235], v150 offset:61440
v_mfma_f32_16x16x32_bf16 v[64:67], a[200:203], v[232:235], v[64:67]
v_exp_f32 v21, v21
v_mfma_f32_16x16x32_bf16 v[64:67], a[204:207], v[236:239], v[64:67]
ds_read_b64_tr_b16 a[236:237], v151 offset:57344
v_cvt_pk_bf16_f32 v82, v20, v21
v_mfma_f32_16x16x32_bf16 v[72:75], a[192:195], v[240:243], v[124:127]
v_exp_f32 v22, v22
v_mfma_f32_16x16x32_bf16 v[72:75], a[196:199], v[244:247], v[72:75]
buffer_load_dwordx4 v157, s[8:11], s34 offen offset:1024 nt lds
v_mfma_f32_16x16x32_bf16 v[72:75], a[200:203], v[248:251], v[72:75]
v_exp_f32 v23, v23
v_mfma_f32_16x16x32_bf16 v[72:75], a[204:207], v[252:255], v[72:75]
ds_read_b64_tr_b16 a[238:239], v151 offset:61440
v_cvt_pk_bf16_f32 v83, v22, v23
v_mfma_f32_16x16x32_bf16 v[52:55], a[208:211], v[192:195], v[112:115]
v_exp_f32 v24, v24
v_mfma_f32_16x16x32_bf16 v[52:55], a[212:215], v[196:199], v[52:55]
ds_read_b64_tr_b16 a[240:241], v152 offset:57344
v_add_f32 v164, v164, v24
v_mfma_f32_16x16x32_bf16 v[52:55], a[216:219], v[200:203], v[52:55]
v_exp_f32 v25, v25
v_mfma_f32_16x16x32_bf16 v[52:55], a[220:223], v[204:207], v[52:55]
ds_read_b64_tr_b16 a[242:243], v152 offset:61440
v_add_f32 v165, v165, v25
v_mfma_f32_16x16x32_bf16 v[60:63], a[208:211], v[208:211], v[116:119]
v_exp_f32 v26, v26
v_mfma_f32_16x16x32_bf16 v[60:63], a[212:215], v[212:215], v[60:63]
buffer_load_dwordx4 v158, s[8:11], s34 offen offset:2048 nt lds
v_mfma_f32_16x16x32_bf16 v[60:63], a[216:219], v[216:219], v[60:63]
v_exp_f32 v27, v27
v_mfma_f32_16x16x32_bf16 v[60:63], a[220:223], v[220:223], v[60:63]
ds_read_b64_tr_b16 a[244:245], v153 offset:57344
v_cvt_pk_bf16_f32 v84, v24, v25
v_mfma_f32_16x16x32_bf16 v[68:71], a[208:211], v[224:227], v[120:123]
v_exp_f32 v28, v28
v_mfma_f32_16x16x32_bf16 v[68:71], a[212:215], v[228:231], v[68:71]
ds_read_b64_tr_b16 a[246:247], v153 offset:61440
v_add_f32 v164, v164, v26
v_mfma_f32_16x16x32_bf16 v[68:71], a[216:219], v[232:235], v[68:71]
v_exp_f32 v29, v29
v_mfma_f32_16x16x32_bf16 v[68:71], a[220:223], v[236:239], v[68:71]
ds_read_b64_tr_b16 a[248:249], v154 offset:57344
v_add_f32 v165, v165, v27
v_mfma_f32_16x16x32_bf16 v[76:79], a[208:211], v[240:243], v[124:127]
v_exp_f32 v30, v30
v_mfma_f32_16x16x32_bf16 v[76:79], a[212:215], v[244:247], v[76:79]
ds_read_b64_tr_b16 a[250:251], v154 offset:61440
v_cvt_pk_bf16_f32 v85, v26, v27
v_mfma_f32_16x16x32_bf16 v[76:79], a[216:219], v[248:251], v[76:79]
v_exp_f32 v31, v31
v_mfma_f32_16x16x32_bf16 v[76:79], a[220:223], v[252:255], v[76:79]
s_waitcnt lgkmcnt(3)
buffer_load_dwordx4 v159, s[8:11], s34 offen offset:3072 nt lds
v_mfma_f32_16x16x32_bf16 a[0:3], v[96:99], a[224:227], a[0:3]
v_exp_f32 v32, v32
v_mfma_f32_16x16x32_bf16 a[4:7], v[100:103], a[224:227], a[4:7]
ds_read_b64_tr_b16 a[252:253], v155 offset:57344
v_add_f32 v164, v164, v28
v_mfma_f32_16x16x32_bf16 a[8:11], v[104:107], a[224:227], a[8:11]
v_exp_f32 v33, v33
v_mfma_f32_16x16x32_bf16 a[12:15], v[108:111], a[224:227], a[12:15]
ds_read_b64_tr_b16 a[254:255], v155 offset:61440
v_add_f32 v165, v165, v29
v_mfma_f32_16x16x32_bf16 a[16:19], v[96:99], a[228:231], a[16:19]
v_exp_f32 v34, v34
v_mfma_f32_16x16x32_bf16 a[20:23], v[100:103], a[228:231], a[20:23]
ds_read_b128 a[192:195], v144 offset:16384
v_cvt_pk_bf16_f32 v86, v28, v29
v_mfma_f32_16x16x32_bf16 a[24:27], v[104:107], a[228:231], a[24:27]
s_add_u32 m0, s30, 4096
v_exp_f32 v35, v35
v_mfma_f32_16x16x32_bf16 a[28:31], v[108:111], a[228:231], a[28:31]
buffer_load_dwordx4 v156, s[8:11], s35 offen offset:0 nt lds
v_mfma_f32_16x16x32_bf16 a[32:35], v[96:99], a[232:235], a[32:35]
v_exp_f32 v36, v36
v_mfma_f32_16x16x32_bf16 a[36:39], v[100:103], a[232:235], a[36:39]
ds_read_b128 a[196:199], v145 offset:16384
v_add_f32 v164, v164, v30
v_mfma_f32_16x16x32_bf16 a[40:43], v[104:107], a[232:235], a[40:43]
v_exp_f32 v37, v37
v_mfma_f32_16x16x32_bf16 a[44:47], v[108:111], a[232:235], a[44:47]
ds_read_b128 a[200:203], v146 offset:16384
v_add_f32 v165, v165, v31
v_mfma_f32_16x16x32_bf16 a[48:51], v[96:99], a[236:239], a[48:51]
v_exp_f32 v38, v38
v_mfma_f32_16x16x32_bf16 a[52:55], v[100:103], a[236:239], a[52:55]
ds_read_b128 a[204:207], v147 offset:16384
v_cvt_pk_bf16_f32 v87, v30, v31
v_mfma_f32_16x16x32_bf16 a[56:59], v[104:107], a[236:239], a[56:59]
v_exp_f32 v39, v39
v_mfma_f32_16x16x32_bf16 a[60:63], v[108:111], a[236:239], a[60:63]
ds_read_b128 a[208:211], v144 offset:20480
v_cvt_pk_bf16_f32 v88, v32, v33
v_mfma_f32_16x16x32_bf16 a[64:67], v[96:99], a[240:243], a[64:67]
v_exp_f32 v40, v40
v_mfma_f32_16x16x32_bf16 a[68:71], v[100:103], a[240:243], a[68:71]
buffer_load_dwordx4 v157, s[8:11], s35 offen offset:1024 nt lds
v_mfma_f32_16x16x32_bf16 a[72:75], v[104:107], a[240:243], a[72:75]
v_exp_f32 v41, v41
v_mfma_f32_16x16x32_bf16 a[76:79], v[108:111], a[240:243], a[76:79]
s_waitcnt lgkmcnt(2)
ds_read_b128 a[212:215], v145 offset:20480
v_cvt_pk_bf16_f32 v89, v34, v35
v_mfma_f32_16x16x32_bf16 a[80:83], v[96:99], a[244:247], a[80:83]
v_exp_f32 v42, v42
v_mfma_f32_16x16x32_bf16 a[84:87], v[100:103], a[244:247], a[84:87]
ds_read_b128 a[216:219], v146 offset:20480
v_cvt_pk_bf16_f32 v90, v36, v37
v_mfma_f32_16x16x32_bf16 a[88:91], v[104:107], a[244:247], a[88:91]
v_exp_f32 v43, v43
v_mfma_f32_16x16x32_bf16 a[92:95], v[108:111], a[244:247], a[92:95]
ds_read_b128 a[220:223], v147 offset:20480
v_cvt_pk_bf16_f32 v91, v38, v39
v_mfma_f32_16x16x32_bf16 a[96:99], v[96:99], a[248:251], a[96:99]
v_exp_f32 v44, v44
v_mfma_f32_16x16x32_bf16 a[100:103], v[100:103], a[248:251], a[100:103]
buffer_load_dwordx4 v158, s[8:11], s35 offen offset:2048 nt lds
v_mfma_f32_16x16x32_bf16 a[104:107], v[104:107], a[248:251], a[104:107]
v_exp_f32 v45, v45
v_mfma_f32_16x16x32_bf16 a[108:111], v[108:111], a[248:251], a[108:111]
v_add_f32 v168, v168, v40
v_add_f32 v169, v169, v41
v_mfma_f32_16x16x32_bf16 a[112:115], v[96:99], a[252:255], a[112:115]
v_exp_f32 v46, v46
v_mfma_f32_16x16x32_bf16 a[116:119], v[100:103], a[252:255], a[116:119]
v_cvt_pk_bf16_f32 v92, v40, v41
v_add_f32 v168, v168, v42
v_mfma_f32_16x16x32_bf16 a[120:123], v[104:107], a[252:255], a[120:123]
v_exp_f32 v47, v47
v_mfma_f32_16x16x32_bf16 a[124:127], v[108:111], a[252:255], a[124:127]
v_add_f32 v169, v169, v43
v_cvt_pk_bf16_f32 v93, v42, v43
v_mfma_f32_16x16x32_bf16 v[176:179], v[96:99], v[172:175], v[176:179]
v_add_f32 v168, v168, v44
v_add_f32 v169, v169, v45
v_mfma_f32_16x16x32_bf16 v[184:187], v[104:107], v[172:175], v[184:187]
v_cvt_pk_bf16_f32 v94, v44, v45
v_add_f32 v168, v168, v46
v_add_f32 v169, v169, v47
v_cvt_pk_bf16_f32 v95, v46, v47
v_mfma_f32_16x16x32_bf16 v[16:19], a[192:195], v[192:195], v[112:115]
v_exp_f32 v48, v48
v_mfma_f32_16x16x32_bf16 v[16:19], a[196:199], v[196:199], v[16:19]
ds_read_b64_tr_b16 a[224:225], v148 offset:0
ds_read_b64_tr_b16 a[226:227], v148 offset:4096
v_mfma_f32_16x16x32_bf16 v[16:19], a[200:203], v[200:203], v[16:19]
s_waitcnt lgkmcnt(2)
v_exp_f32 v49, v49
v_mfma_f32_16x16x32_bf16 v[16:19], a[204:207], v[204:207], v[16:19]
buffer_load_dwordx4 v159, s[8:11], s35 offen offset:3072 nt lds
v_mfma_f32_16x16x32_bf16 v[24:27], a[192:195], v[208:211], v[116:119]
v_exp_f32 v50, v50
v_mfma_f32_16x16x32_bf16 v[24:27], a[196:199], v[212:215], v[24:27]
ds_read_b64_tr_b16 a[228:229], v149 offset:0
v_cvt_pk_bf16_f32 v96, v48, v49
v_mfma_f32_16x16x32_bf16 v[24:27], a[200:203], v[216:219], v[24:27]
v_exp_f32 v51, v51
v_mfma_f32_16x16x32_bf16 v[24:27], a[204:207], v[220:223], v[24:27]
ds_read_b64_tr_b16 a[230:231], v149 offset:4096
v_cvt_pk_bf16_f32 v97, v50, v51
v_mfma_f32_16x16x32_bf16 v[32:35], a[192:195], v[224:227], v[120:123]
v_exp_f32 v52, v52
v_mfma_f32_16x16x32_bf16 v[32:35], a[196:199], v[228:231], v[32:35]
ds_read_b64_tr_b16 a[232:233], v150 offset:0
ds_read_b64_tr_b16 a[234:235], v150 offset:4096
v_mfma_f32_16x16x32_bf16 v[32:35], a[200:203], v[232:235], v[32:35]
v_exp_f32 v53, v53
v_mfma_f32_16x16x32_bf16 v[32:35], a[204:207], v[236:239], v[32:35]
ds_read_b64_tr_b16 a[236:237], v151 offset:0
v_cvt_pk_bf16_f32 v98, v52, v53
v_mfma_f32_16x16x32_bf16 v[40:43], a[192:195], v[240:243], v[124:127]
s_mov_b32 m0, s32
v_exp_f32 v54, v54
v_mfma_f32_16x16x32_bf16 v[40:43], a[196:199], v[244:247], v[40:43]
buffer_load_dwordx4 v160, s[12:15], s36 offen offset:0 nt lds
v_mfma_f32_16x16x32_bf16 v[40:43], a[200:203], v[248:251], v[40:43]
v_exp_f32 v55, v55
v_mfma_f32_16x16x32_bf16 v[40:43], a[204:207], v[252:255], v[40:43]
ds_read_b64_tr_b16 a[238:239], v151 offset:4096
v_cvt_pk_bf16_f32 v99, v54, v55
v_mfma_f32_16x16x32_bf16 v[20:23], a[208:211], v[192:195], v[112:115]
v_exp_f32 v56, v56
v_mfma_f32_16x16x32_bf16 v[20:23], a[212:215], v[196:199], v[20:23]
ds_read_b64_tr_b16 a[240:241], v152 offset:0
v_add_f32 v164, v164, v56
v_mfma_f32_16x16x32_bf16 v[20:23], a[216:219], v[200:203], v[20:23]
v_exp_f32 v57, v57
v_mfma_f32_16x16x32_bf16 v[20:23], a[220:223], v[204:207], v[20:23]
ds_read_b64_tr_b16 a[242:243], v152 offset:4096
v_add_f32 v165, v165, v57
v_mfma_f32_16x16x32_bf16 v[28:31], a[208:211], v[208:211], v[116:119]
v_exp_f32 v58, v58
v_mfma_f32_16x16x32_bf16 v[28:31], a[212:215], v[212:215], v[28:31]
buffer_load_dwordx4 v161, s[12:15], s36 offen offset:1024 nt lds
v_mfma_f32_16x16x32_bf16 v[28:31], a[216:219], v[216:219], v[28:31]
v_exp_f32 v59, v59
v_mfma_f32_16x16x32_bf16 v[28:31], a[220:223], v[220:223], v[28:31]
ds_read_b64_tr_b16 a[244:245], v153 offset:0
v_cvt_pk_bf16_f32 v100, v56, v57
v_mfma_f32_16x16x32_bf16 v[36:39], a[208:211], v[224:227], v[120:123]
v_exp_f32 v60, v60
v_mfma_f32_16x16x32_bf16 v[36:39], a[212:215], v[228:231], v[36:39]
ds_read_b64_tr_b16 a[246:247], v153 offset:4096
v_add_f32 v164, v164, v58
v_mfma_f32_16x16x32_bf16 v[36:39], a[216:219], v[232:235], v[36:39]
v_exp_f32 v61, v61
v_mfma_f32_16x16x32_bf16 v[36:39], a[220:223], v[236:239], v[36:39]
ds_read_b64_tr_b16 a[248:249], v154 offset:0
v_add_f32 v165, v165, v59
v_mfma_f32_16x16x32_bf16 v[44:47], a[208:211], v[240:243], v[124:127]
v_exp_f32 v62, v62
v_mfma_f32_16x16x32_bf16 v[44:47], a[212:215], v[244:247], v[44:47]
ds_read_b64_tr_b16 a[250:251], v154 offset:4096
v_cvt_pk_bf16_f32 v101, v58, v59
v_mfma_f32_16x16x32_bf16 v[44:47], a[216:219], v[248:251], v[44:47]
v_exp_f32 v63, v63
v_mfma_f32_16x16x32_bf16 v[44:47], a[220:223], v[252:255], v[44:47]
s_waitcnt lgkmcnt(3)
buffer_load_dwordx4 v160, s[12:15], s36 offen offset:2048 nt lds
v_mfma_f32_16x16x32_bf16 a[0:3], v[80:83], a[224:227], a[0:3]
v_exp_f32 v64, v64
v_mfma_f32_16x16x32_bf16 a[4:7], v[84:87], a[224:227], a[4:7]
ds_read_b64_tr_b16 a[252:253], v155 offset:0
v_add_f32 v164, v164, v60
v_mfma_f32_16x16x32_bf16 a[8:11], v[88:91], a[224:227], a[8:11]
v_exp_f32 v65, v65
v_mfma_f32_16x16x32_bf16 a[12:15], v[92:95], a[224:227], a[12:15]
ds_read_b64_tr_b16 a[254:255], v155 offset:4096
v_add_f32 v165, v165, v61
v_mfma_f32_16x16x32_bf16 a[16:19], v[80:83], a[228:231], a[16:19]
v_exp_f32 v66, v66
v_mfma_f32_16x16x32_bf16 a[20:23], v[84:87], a[228:231], a[20:23]
ds_read_b128 a[192:195], v144 offset:24576
v_cvt_pk_bf16_f32 v102, v60, v61
v_mfma_f32_16x16x32_bf16 a[24:27], v[88:91], a[228:231], a[24:27]
v_exp_f32 v67, v67
v_mfma_f32_16x16x32_bf16 a[28:31], v[92:95], a[228:231], a[28:31]
buffer_load_dwordx4 v161, s[12:15], s36 offen offset:3072 nt lds
v_mfma_f32_16x16x32_bf16 a[32:35], v[80:83], a[232:235], a[32:35]
v_exp_f32 v68, v68
v_mfma_f32_16x16x32_bf16 a[36:39], v[84:87], a[232:235], a[36:39]
ds_read_b128 a[196:199], v145 offset:24576
v_add_f32 v164, v164, v62
v_mfma_f32_16x16x32_bf16 a[40:43], v[88:91], a[232:235], a[40:43]
v_exp_f32 v69, v69
v_mfma_f32_16x16x32_bf16 a[44:47], v[92:95], a[232:235], a[44:47]
ds_read_b128 a[200:203], v146 offset:24576
v_add_f32 v165, v165, v63
v_mfma_f32_16x16x32_bf16 a[48:51], v[80:83], a[236:239], a[48:51]
v_exp_f32 v70, v70
v_mfma_f32_16x16x32_bf16 a[52:55], v[84:87], a[236:239], a[52:55]
ds_read_b128 a[204:207], v147 offset:24576
v_cvt_pk_bf16_f32 v103, v62, v63
v_mfma_f32_16x16x32_bf16 a[56:59], v[88:91], a[236:239], a[56:59]
v_exp_f32 v71, v71
v_mfma_f32_16x16x32_bf16 a[60:63], v[92:95], a[236:239], a[60:63]
ds_read_b128 a[208:211], v144 offset:28672
v_cvt_pk_bf16_f32 v104, v64, v65
v_mfma_f32_16x16x32_bf16 a[64:67], v[80:83], a[240:243], a[64:67]
v_exp_f32 v72, v72
v_mfma_f32_16x16x32_bf16 a[68:71], v[84:87], a[240:243], a[68:71]
ds_read_b128 a[212:215], v145 offset:28672
v_cvt_pk_bf16_f32 v105, v66, v67
v_mfma_f32_16x16x32_bf16 a[72:75], v[88:91], a[240:243], a[72:75]
v_exp_f32 v73, v73
v_mfma_f32_16x16x32_bf16 a[76:79], v[92:95], a[240:243], a[76:79]
s_waitcnt lgkmcnt(3)
ds_read_b128 a[216:219], v146 offset:28672
v_cvt_pk_bf16_f32 v106, v68, v69
v_mfma_f32_16x16x32_bf16 a[80:83], v[80:83], a[244:247], a[80:83]
v_exp_f32 v74, v74
v_mfma_f32_16x16x32_bf16 a[84:87], v[84:87], a[244:247], a[84:87]
ds_read_b128 a[220:223], v147 offset:28672
v_cvt_pk_bf16_f32 v107, v70, v71
v_mfma_f32_16x16x32_bf16 a[88:91], v[88:91], a[244:247], a[88:91]
v_exp_f32 v75, v75
v_mfma_f32_16x16x32_bf16 a[92:95], v[92:95], a[244:247], a[92:95]
v_add_f32 v168, v168, v72
v_add_f32 v169, v169, v73
v_mfma_f32_16x16x32_bf16 a[96:99], v[80:83], a[248:251], a[96:99]
v_exp_f32 v76, v76
v_mfma_f32_16x16x32_bf16 a[100:103], v[84:87], a[248:251], a[100:103]
v_cvt_pk_bf16_f32 v108, v72, v73
v_add_f32 v168, v168, v74
v_mfma_f32_16x16x32_bf16 a[104:107], v[88:91], a[248:251], a[104:107]
v_exp_f32 v77, v77
v_mfma_f32_16x16x32_bf16 a[108:111], v[92:95], a[248:251], a[108:111]
v_add_f32 v169, v169, v75
v_cvt_pk_bf16_f32 v109, v74, v75
v_mfma_f32_16x16x32_bf16 a[112:115], v[80:83], a[252:255], a[112:115]
v_exp_f32 v78, v78
v_mfma_f32_16x16x32_bf16 a[116:119], v[84:87], a[252:255], a[116:119]
v_add_f32 v168, v168, v76
v_add_f32 v169, v169, v77
v_mfma_f32_16x16x32_bf16 a[120:123], v[88:91], a[252:255], a[120:123]
v_exp_f32 v79, v79
v_mfma_f32_16x16x32_bf16 a[124:127], v[92:95], a[252:255], a[124:127]
v_cvt_pk_bf16_f32 v110, v76, v77
v_add_f32 v168, v168, v78
v_mfma_f32_16x16x32_bf16 v[176:179], v[80:83], v[172:175], v[176:179]
v_add_f32 v169, v169, v79
v_cvt_pk_bf16_f32 v111, v78, v79
v_mfma_f32_16x16x32_bf16 v[184:187], v[88:91], v[172:175], v[184:187]
v_mfma_f32_16x16x32_bf16 v[48:51], a[192:195], v[192:195], v[112:115]
v_exp_f32 v16, v16
v_mfma_f32_16x16x32_bf16 v[48:51], a[196:199], v[196:199], v[48:51]
ds_read_b64_tr_b16 a[224:225], v148 offset:8192
ds_read_b64_tr_b16 a[226:227], v148 offset:12288
v_mfma_f32_16x16x32_bf16 v[48:51], a[200:203], v[200:203], v[48:51]
s_waitcnt lgkmcnt(2)
s_add_u32 m0, s32, 4096
v_exp_f32 v17, v17
v_mfma_f32_16x16x32_bf16 v[48:51], a[204:207], v[204:207], v[48:51]
buffer_load_dwordx4 v160, s[12:15], s37 offen offset:0 nt lds
v_mfma_f32_16x16x32_bf16 v[56:59], a[192:195], v[208:211], v[116:119]
v_exp_f32 v18, v18
v_mfma_f32_16x16x32_bf16 v[56:59], a[196:199], v[212:215], v[56:59]
ds_read_b64_tr_b16 a[228:229], v149 offset:8192
v_cvt_pk_bf16_f32 v80, v16, v17
v_mfma_f32_16x16x32_bf16 v[56:59], a[200:203], v[216:219], v[56:59]
v_exp_f32 v19, v19
v_mfma_f32_16x16x32_bf16 v[56:59], a[204:207], v[220:223], v[56:59]
ds_read_b64_tr_b16 a[230:231], v149 offset:12288
v_cvt_pk_bf16_f32 v81, v18, v19
v_mfma_f32_16x16x32_bf16 v[64:67], a[192:195], v[224:227], v[120:123]
v_exp_f32 v20, v20
v_mfma_f32_16x16x32_bf16 v[64:67], a[196:199], v[228:231], v[64:67]
ds_read_b64_tr_b16 a[232:233], v150 offset:8192
ds_read_b64_tr_b16 a[234:235], v150 offset:12288
v_mfma_f32_16x16x32_bf16 v[64:67], a[200:203], v[232:235], v[64:67]
v_exp_f32 v21, v21
v_mfma_f32_16x16x32_bf16 v[64:67], a[204:207], v[236:239], v[64:67]
ds_read_b64_tr_b16 a[236:237], v151 offset:8192
v_cvt_pk_bf16_f32 v82, v20, v21
v_mfma_f32_16x16x32_bf16 v[72:75], a[192:195], v[240:243], v[124:127]
v_exp_f32 v22, v22
v_mfma_f32_16x16x32_bf16 v[72:75], a[196:199], v[244:247], v[72:75]
buffer_load_dwordx4 v161, s[12:15], s37 offen offset:1024 nt lds
v_mfma_f32_16x16x32_bf16 v[72:75], a[200:203], v[248:251], v[72:75]
v_exp_f32 v23, v23
v_mfma_f32_16x16x32_bf16 v[72:75], a[204:207], v[252:255], v[72:75]
ds_read_b64_tr_b16 a[238:239], v151 offset:12288
v_cvt_pk_bf16_f32 v83, v22, v23
v_mfma_f32_16x16x32_bf16 v[52:55], a[208:211], v[192:195], v[112:115]
v_exp_f32 v24, v24
v_mfma_f32_16x16x32_bf16 v[52:55], a[212:215], v[196:199], v[52:55]
ds_read_b64_tr_b16 a[240:241], v152 offset:8192
v_add_f32 v164, v164, v24
v_mfma_f32_16x16x32_bf16 v[52:55], a[216:219], v[200:203], v[52:55]
v_exp_f32 v25, v25
v_mfma_f32_16x16x32_bf16 v[52:55], a[220:223], v[204:207], v[52:55]
ds_read_b64_tr_b16 a[242:243], v152 offset:12288
v_add_f32 v165, v165, v25
v_mfma_f32_16x16x32_bf16 v[60:63], a[208:211], v[208:211], v[116:119]
v_exp_f32 v26, v26
v_mfma_f32_16x16x32_bf16 v[60:63], a[212:215], v[212:215], v[60:63]
buffer_load_dwordx4 v160, s[12:15], s37 offen offset:2048 nt lds
v_mfma_f32_16x16x32_bf16 v[60:63], a[216:219], v[216:219], v[60:63]
v_exp_f32 v27, v27
v_mfma_f32_16x16x32_bf16 v[60:63], a[220:223], v[220:223], v[60:63]
ds_read_b64_tr_b16 a[244:245], v153 offset:8192
v_cvt_pk_bf16_f32 v84, v24, v25
v_mfma_f32_16x16x32_bf16 v[68:71], a[208:211], v[224:227], v[120:123]
v_exp_f32 v28, v28
v_mfma_f32_16x16x32_bf16 v[68:71], a[212:215], v[228:231], v[68:71]
ds_read_b64_tr_b16 a[246:247], v153 offset:12288
v_add_f32 v164, v164, v26
v_mfma_f32_16x16x32_bf16 v[68:71], a[216:219], v[232:235], v[68:71]
v_exp_f32 v29, v29
v_mfma_f32_16x16x32_bf16 v[68:71], a[220:223], v[236:239], v[68:71]
ds_read_b64_tr_b16 a[248:249], v154 offset:8192
v_add_f32 v165, v165, v27
v_mfma_f32_16x16x32_bf16 v[76:79], a[208:211], v[240:243], v[124:127]
v_exp_f32 v30, v30
v_mfma_f32_16x16x32_bf16 v[76:79], a[212:215], v[244:247], v[76:79]
ds_read_b64_tr_b16 a[250:251], v154 offset:12288
v_cvt_pk_bf16_f32 v85, v26, v27
v_mfma_f32_16x16x32_bf16 v[76:79], a[216:219], v[248:251], v[76:79]
v_exp_f32 v31, v31
v_mfma_f32_16x16x32_bf16 v[76:79], a[220:223], v[252:255], v[76:79]
s_waitcnt lgkmcnt(3)
buffer_load_dwordx4 v161, s[12:15], s37 offen offset:3072 nt lds
v_mfma_f32_16x16x32_bf16 a[0:3], v[96:99], a[224:227], a[0:3]
v_exp_f32 v32, v32
v_mfma_f32_16x16x32_bf16 a[4:7], v[100:103], a[224:227], a[4:7]
ds_read_b64_tr_b16 a[252:253], v155 offset:8192
v_add_f32 v164, v164, v28
v_mfma_f32_16x16x32_bf16 a[8:11], v[104:107], a[224:227], a[8:11]
v_exp_f32 v33, v33
v_mfma_f32_16x16x32_bf16 a[12:15], v[108:111], a[224:227], a[12:15]
ds_read_b64_tr_b16 a[254:255], v155 offset:12288
v_add_f32 v165, v165, v29
v_mfma_f32_16x16x32_bf16 a[16:19], v[96:99], a[228:231], a[16:19]
v_exp_f32 v34, v34
v_mfma_f32_16x16x32_bf16 a[20:23], v[100:103], a[228:231], a[20:23]
ds_read_b128 a[192:195], v144 offset:32768
v_cvt_pk_bf16_f32 v86, v28, v29
v_mfma_f32_16x16x32_bf16 a[24:27], v[104:107], a[228:231], a[24:27]
v_exp_f32 v35, v35
v_mfma_f32_16x16x32_bf16 a[28:31], v[108:111], a[228:231], a[28:31]
ds_read_b128 a[196:199], v145 offset:32768
v_add_f32 v164, v164, v30
v_mfma_f32_16x16x32_bf16 a[32:35], v[96:99], a[232:235], a[32:35]
v_exp_f32 v36, v36
v_mfma_f32_16x16x32_bf16 a[36:39], v[100:103], a[232:235], a[36:39]
ds_read_b128 a[200:203], v146 offset:32768
v_add_f32 v165, v165, v31
v_mfma_f32_16x16x32_bf16 a[40:43], v[104:107], a[232:235], a[40:43]
v_exp_f32 v37, v37
v_mfma_f32_16x16x32_bf16 a[44:47], v[108:111], a[232:235], a[44:47]
ds_read_b128 a[204:207], v147 offset:32768
v_cvt_pk_bf16_f32 v87, v30, v31
v_mfma_f32_16x16x32_bf16 a[48:51], v[96:99], a[236:239], a[48:51]
v_exp_f32 v38, v38
v_mfma_f32_16x16x32_bf16 a[52:55], v[100:103], a[236:239], a[52:55]
ds_read_b128 a[208:211], v144 offset:36864
v_cvt_pk_bf16_f32 v88, v32, v33
v_mfma_f32_16x16x32_bf16 a[56:59], v[104:107], a[236:239], a[56:59]
v_exp_f32 v39, v39
v_mfma_f32_16x16x32_bf16 a[60:63], v[108:111], a[236:239], a[60:63]
ds_read_b128 a[212:215], v145 offset:36864
v_cvt_pk_bf16_f32 v89, v34, v35
v_mfma_f32_16x16x32_bf16 a[64:67], v[96:99], a[240:243], a[64:67]
v_exp_f32 v40, v40
v_mfma_f32_16x16x32_bf16 a[68:71], v[100:103], a[240:243], a[68:71]
ds_read_b128 a[216:219], v146 offset:36864
v_cvt_pk_bf16_f32 v90, v36, v37
v_mfma_f32_16x16x32_bf16 a[72:75], v[104:107], a[240:243], a[72:75]
v_exp_f32 v41, v41
v_mfma_f32_16x16x32_bf16 a[76:79], v[108:111], a[240:243], a[76:79]
s_waitcnt lgkmcnt(3)
ds_read_b128 a[220:223], v147 offset:36864
v_cvt_pk_bf16_f32 v91, v38, v39
v_mfma_f32_16x16x32_bf16 a[80:83], v[96:99], a[244:247], a[80:83]
v_exp_f32 v42, v42
v_mfma_f32_16x16x32_bf16 a[84:87], v[100:103], a[244:247], a[84:87]
v_add_f32 v168, v168, v40
v_add_f32 v169, v169, v41
v_mfma_f32_16x16x32_bf16 a[88:91], v[104:107], a[244:247], a[88:91]
v_exp_f32 v43, v43
v_mfma_f32_16x16x32_bf16 a[92:95], v[108:111], a[244:247], a[92:95]
v_cvt_pk_bf16_f32 v92, v40, v41
v_add_f32 v168, v168, v42
v_mfma_f32_16x16x32_bf16 a[96:99], v[96:99], a[248:251], a[96:99]
v_exp_f32 v44, v44
v_mfma_f32_16x16x32_bf16 a[100:103], v[100:103], a[248:251], a[100:103]
v_add_f32 v169, v169, v43
v_cvt_pk_bf16_f32 v93, v42, v43
v_mfma_f32_16x16x32_bf16 a[104:107], v[104:107], a[248:251], a[104:107]
v_exp_f32 v45, v45
v_mfma_f32_16x16x32_bf16 a[108:111], v[108:111], a[248:251], a[108:111]
v_add_f32 v168, v168, v44
v_add_f32 v169, v169, v45
v_mfma_f32_16x16x32_bf16 a[112:115], v[96:99], a[252:255], a[112:115]
v_exp_f32 v46, v46
v_mfma_f32_16x16x32_bf16 a[116:119], v[100:103], a[252:255], a[116:119]
v_cvt_pk_bf16_f32 v94, v44, v45
v_add_f32 v168, v168, v46
v_mfma_f32_16x16x32_bf16 a[120:123], v[104:107], a[252:255], a[120:123]
v_exp_f32 v47, v47
v_mfma_f32_16x16x32_bf16 a[124:127], v[108:111], a[252:255], a[124:127]
v_add_f32 v169, v169, v47
v_cvt_pk_bf16_f32 v95, v46, v47
v_mfma_f32_16x16x32_bf16 v[176:179], v[96:99], v[172:175], v[176:179]
v_mfma_f32_16x16x32_bf16 v[184:187], v[104:107], v[172:175], v[184:187]
v_mfma_f32_16x16x32_bf16 v[16:19], a[192:195], v[192:195], v[112:115]
v_exp_f32 v48, v48
v_mfma_f32_16x16x32_bf16 v[16:19], a[196:199], v[196:199], v[16:19]
ds_read_b64_tr_b16 a[224:225], v148 offset:16384
ds_read_b64_tr_b16 a[226:227], v148 offset:20480
v_mfma_f32_16x16x32_bf16 v[16:19], a[200:203], v[200:203], v[16:19]
v_exp_f32 v49, v49
v_mfma_f32_16x16x32_bf16 v[16:19], a[204:207], v[204:207], v[16:19]
ds_read_b64_tr_b16 a[228:229], v149 offset:16384
v_cvt_pk_bf16_f32 v96, v48, v49
v_mfma_f32_16x16x32_bf16 v[24:27], a[192:195], v[208:211], v[116:119]
v_exp_f32 v50, v50
v_mfma_f32_16x16x32_bf16 v[24:27], a[196:199], v[212:215], v[24:27]
ds_read_b64_tr_b16 a[230:231], v149 offset:20480
ds_read_b64_tr_b16 a[232:233], v150 offset:16384
v_mfma_f32_16x16x32_bf16 v[24:27], a[200:203], v[216:219], v[24:27]
v_exp_f32 v51, v51
v_mfma_f32_16x16x32_bf16 v[24:27], a[204:207], v[220:223], v[24:27]
ds_read_b64_tr_b16 a[234:235], v150 offset:20480
v_cvt_pk_bf16_f32 v97, v50, v51
v_mfma_f32_16x16x32_bf16 v[32:35], a[192:195], v[224:227], v[120:123]
v_exp_f32 v52, v52
v_mfma_f32_16x16x32_bf16 v[32:35], a[196:199], v[228:231], v[32:35]
ds_read_b64_tr_b16 a[236:237], v151 offset:16384
ds_read_b64_tr_b16 a[238:239], v151 offset:20480
v_mfma_f32_16x16x32_bf16 v[32:35], a[200:203], v[232:235], v[32:35]
v_exp_f32 v53, v53
v_mfma_f32_16x16x32_bf16 v[32:35], a[204:207], v[236:239], v[32:35]
ds_read_b64_tr_b16 a[240:241], v152 offset:16384
v_cvt_pk_bf16_f32 v98, v52, v53
v_mfma_f32_16x16x32_bf16 v[40:43], a[192:195], v[240:243], v[124:127]
v_exp_f32 v54, v54
v_mfma_f32_16x16x32_bf16 v[40:43], a[196:199], v[244:247], v[40:43]
ds_read_b64_tr_b16 a[242:243], v152 offset:20480
ds_read_b64_tr_b16 a[244:245], v153 offset:16384
v_mfma_f32_16x16x32_bf16 v[40:43], a[200:203], v[248:251], v[40:43]
v_exp_f32 v55, v55
v_mfma_f32_16x16x32_bf16 v[40:43], a[204:207], v[252:255], v[40:43]
s_waitcnt lgkmcnt(5)
ds_read_b64_tr_b16 a[246:247], v153 offset:20480
v_cvt_pk_bf16_f32 v99, v54, v55
v_mfma_f32_16x16x32_bf16 v[20:23], a[208:211], v[192:195], v[112:115]
v_exp_f32 v56, v56
v_mfma_f32_16x16x32_bf16 v[20:23], a[212:215], v[196:199], v[20:23]
ds_read_b64_tr_b16 a[248:249], v154 offset:16384
v_add_f32 v164, v164, v56
v_mfma_f32_16x16x32_bf16 v[20:23], a[216:219], v[200:203], v[20:23]
v_exp_f32 v57, v57
v_mfma_f32_16x16x32_bf16 v[20:23], a[220:223], v[204:207], v[20:23]
ds_read_b64_tr_b16 a[250:251], v154 offset:20480
v_add_f32 v165, v165, v57
v_mfma_f32_16x16x32_bf16 v[28:31], a[208:211], v[208:211], v[116:119]
v_exp_f32 v58, v58
v_mfma_f32_16x16x32_bf16 v[28:31], a[212:215], v[212:215], v[28:31]
ds_read_b64_tr_b16 a[252:253], v155 offset:16384
v_cvt_pk_bf16_f32 v100, v56, v57
v_mfma_f32_16x16x32_bf16 v[28:31], a[216:219], v[216:219], v[28:31]
v_exp_f32 v59, v59
v_mfma_f32_16x16x32_bf16 v[28:31], a[220:223], v[220:223], v[28:31]
ds_read_b64_tr_b16 a[254:255], v155 offset:20480
v_add_f32 v164, v164, v58
v_mfma_f32_16x16x32_bf16 v[36:39], a[208:211], v[224:227], v[120:123]
v_exp_f32 v60, v60
v_mfma_f32_16x16x32_bf16 v[36:39], a[212:215], v[228:231], v[36:39]
ds_read_b128 a[192:195], v144 offset:40960
v_add_f32 v165, v165, v59
v_mfma_f32_16x16x32_bf16 v[36:39], a[216:219], v[232:235], v[36:39]
v_exp_f32 v61, v61
v_mfma_f32_16x16x32_bf16 v[36:39], a[220:223], v[236:239], v[36:39]
ds_read_b128 a[196:199], v145 offset:40960
v_cvt_pk_bf16_f32 v101, v58, v59
v_mfma_f32_16x16x32_bf16 v[44:47], a[208:211], v[240:243], v[124:127]
v_exp_f32 v62, v62
v_mfma_f32_16x16x32_bf16 v[44:47], a[212:215], v[244:247], v[44:47]
ds_read_b128 a[200:203], v146 offset:40960
v_add_f32 v164, v164, v60
v_mfma_f32_16x16x32_bf16 v[44:47], a[216:219], v[248:251], v[44:47]
v_exp_f32 v63, v63
v_mfma_f32_16x16x32_bf16 v[44:47], a[220:223], v[252:255], v[44:47]
ds_read_b128 a[204:207], v147 offset:40960
v_add_f32 v165, v165, v61
v_mfma_f32_16x16x32_bf16 a[0:3], v[80:83], a[224:227], a[0:3]
v_exp_f32 v64, v64
v_mfma_f32_16x16x32_bf16 a[4:7], v[84:87], a[224:227], a[4:7]
ds_read_b128 a[208:211], v144 offset:45056
v_cvt_pk_bf16_f32 v102, v60, v61
v_mfma_f32_16x16x32_bf16 a[8:11], v[88:91], a[224:227], a[8:11]
v_exp_f32 v65, v65
v_mfma_f32_16x16x32_bf16 a[12:15], v[92:95], a[224:227], a[12:15]
ds_read_b128 a[212:215], v145 offset:45056
v_add_f32 v164, v164, v62
v_mfma_f32_16x16x32_bf16 a[16:19], v[80:83], a[228:231], a[16:19]
v_exp_f32 v66, v66
v_mfma_f32_16x16x32_bf16 a[20:23], v[84:87], a[228:231], a[20:23]
ds_read_b128 a[216:219], v146 offset:45056
v_add_f32 v165, v165, v63
v_mfma_f32_16x16x32_bf16 a[24:27], v[88:91], a[228:231], a[24:27]
v_exp_f32 v67, v67
v_mfma_f32_16x16x32_bf16 a[28:31], v[92:95], a[228:231], a[28:31]
ds_read_b128 a[220:223], v147 offset:45056
v_cvt_pk_bf16_f32 v103, v62, v63
v_mfma_f32_16x16x32_bf16 a[32:35], v[80:83], a[232:235], a[32:35]
s_add_u32 s34, s34, 32768
v_exp_f32 v68, v68
v_mfma_f32_16x16x32_bf16 a[36:39], v[84:87], a[232:235], a[36:39]
v_cvt_pk_bf16_f32 v104, v64, v65
v_cvt_pk_bf16_f32 v105, v66, v67
v_mfma_f32_16x16x32_bf16 a[40:43], v[88:91], a[232:235], a[40:43]
s_add_u32 s35, s35, 32768
v_exp_f32 v69, v69
v_mfma_f32_16x16x32_bf16 a[44:47], v[92:95], a[232:235], a[44:47]
s_waitcnt lgkmcnt(2)
v_cvt_pk_bf16_f32 v106, v68, v69
v_mfma_f32_16x16x32_bf16 a[48:51], v[80:83], a[236:239], a[48:51]
s_add_u32 s36, s36, 32768
v_exp_f32 v70, v70
v_mfma_f32_16x16x32_bf16 a[52:55], v[84:87], a[236:239], a[52:55]
v_mfma_f32_16x16x32_bf16 a[56:59], v[88:91], a[236:239], a[56:59]
s_add_u32 s37, s37, 32768
v_exp_f32 v71, v71
v_mfma_f32_16x16x32_bf16 a[60:63], v[92:95], a[236:239], a[60:63]
v_cvt_pk_bf16_f32 v107, v70, v71
v_mfma_f32_16x16x32_bf16 a[64:67], v[80:83], a[240:243], a[64:67]
v_exp_f32 v72, v72
v_mfma_f32_16x16x32_bf16 a[68:71], v[84:87], a[240:243], a[68:71]
v_add_f32 v168, v168, v72
v_mfma_f32_16x16x32_bf16 a[72:75], v[88:91], a[240:243], a[72:75]
v_exp_f32 v73, v73
v_mfma_f32_16x16x32_bf16 a[76:79], v[92:95], a[240:243], a[76:79]
v_add_f32 v169, v169, v73
v_cvt_pk_bf16_f32 v108, v72, v73
v_mfma_f32_16x16x32_bf16 a[80:83], v[80:83], a[244:247], a[80:83]
v_exp_f32 v74, v74
v_mfma_f32_16x16x32_bf16 a[84:87], v[84:87], a[244:247], a[84:87]
v_add_f32 v168, v168, v74
v_mfma_f32_16x16x32_bf16 a[88:91], v[88:91], a[244:247], a[88:91]
v_exp_f32 v75, v75
v_mfma_f32_16x16x32_bf16 a[92:95], v[92:95], a[244:247], a[92:95]
v_add_f32 v169, v169, v75
v_cvt_pk_bf16_f32 v109, v74, v75
v_mfma_f32_16x16x32_bf16 a[96:99], v[80:83], a[248:251], a[96:99]
v_exp_f32 v76, v76
v_mfma_f32_16x16x32_bf16 a[100:103], v[84:87], a[248:251], a[100:103]
v_add_f32 v168, v168, v76
v_mfma_f32_16x16x32_bf16 a[104:107], v[88:91], a[248:251], a[104:107]
v_exp_f32 v77, v77
v_mfma_f32_16x16x32_bf16 a[108:111], v[92:95], a[248:251], a[108:111]
v_add_f32 v169, v169, v77
v_cvt_pk_bf16_f32 v110, v76, v77
v_mfma_f32_16x16x32_bf16 a[112:115], v[80:83], a[252:255], a[112:115]
v_exp_f32 v78, v78
v_mfma_f32_16x16x32_bf16 a[116:119], v[84:87], a[252:255], a[116:119]
v_add_f32 v168, v168, v78
v_mfma_f32_16x16x32_bf16 a[120:123], v[88:91], a[252:255], a[120:123]
v_exp_f32 v79, v79
v_mfma_f32_16x16x32_bf16 a[124:127], v[92:95], a[252:255], a[124:127]
v_add_f32 v169, v169, v79
v_cvt_pk_bf16_f32 v111, v78, v79
v_mfma_f32_16x16x32_bf16 v[176:179], v[80:83], v[172:175], v[176:179]
v_mfma_f32_16x16x32_bf16 v[184:187], v[88:91], v[172:175], v[184:187]
s_waitcnt vmcnt(0) lgkmcnt(0)
s_barrier
v_mfma_f32_16x16x32_bf16 v[48:51], a[192:195], v[192:195], v[112:115]
v_exp_f32 v16, v16
v_mfma_f32_16x16x32_bf16 v[48:51], a[196:199], v[196:199], v[48:51]
ds_read_b64_tr_b16 a[224:225], v148 offset:24576
ds_read_b64_tr_b16 a[226:227], v148 offset:28672
v_mfma_f32_16x16x32_bf16 v[48:51], a[200:203], v[200:203], v[48:51]
s_mov_b32 m0, s31
v_exp_f32 v17, v17
v_mfma_f32_16x16x32_bf16 v[48:51], a[204:207], v[204:207], v[48:51]
buffer_load_dwordx4 v156, s[8:11], s34 offen offset:0 nt lds
v_mfma_f32_16x16x32_bf16 v[56:59], a[192:195], v[208:211], v[116:119]
v_exp_f32 v18, v18
v_mfma_f32_16x16x32_bf16 v[56:59], a[196:199], v[212:215], v[56:59]
ds_read_b64_tr_b16 a[228:229], v149 offset:24576
v_cvt_pk_bf16_f32 v80, v16, v17
v_mfma_f32_16x16x32_bf16 v[56:59], a[200:203], v[216:219], v[56:59]
v_exp_f32 v19, v19
v_mfma_f32_16x16x32_bf16 v[56:59], a[204:207], v[220:223], v[56:59]
ds_read_b64_tr_b16 a[230:231], v149 offset:28672
v_cvt_pk_bf16_f32 v81, v18, v19
v_mfma_f32_16x16x32_bf16 v[64:67], a[192:195], v[224:227], v[120:123]
v_exp_f32 v20, v20
v_mfma_f32_16x16x32_bf16 v[64:67], a[196:199], v[228:231], v[64:67]
ds_read_b64_tr_b16 a[232:233], v150 offset:24576
ds_read_b64_tr_b16 a[234:235], v150 offset:28672
v_mfma_f32_16x16x32_bf16 v[64:67], a[200:203], v[232:235], v[64:67]
v_exp_f32 v21, v21
v_mfma_f32_16x16x32_bf16 v[64:67], a[204:207], v[236:239], v[64:67]
ds_read_b64_tr_b16 a[236:237], v151 offset:24576
v_cvt_pk_bf16_f32 v82, v20, v21
v_mfma_f32_16x16x32_bf16 v[72:75], a[192:195], v[240:243], v[124:127]
v_exp_f32 v22, v22
v_mfma_f32_16x16x32_bf16 v[72:75], a[196:199], v[244:247], v[72:75]
buffer_load_dwordx4 v157, s[8:11], s34 offen offset:1024 nt lds
v_mfma_f32_16x16x32_bf16 v[72:75], a[200:203], v[248:251], v[72:75]
v_exp_f32 v23, v23
v_mfma_f32_16x16x32_bf16 v[72:75], a[204:207], v[252:255], v[72:75]
ds_read_b64_tr_b16 a[238:239], v151 offset:28672
v_cvt_pk_bf16_f32 v83, v22, v23
v_mfma_f32_16x16x32_bf16 v[52:55], a[208:211], v[192:195], v[112:115]
v_exp_f32 v24, v24
v_mfma_f32_16x16x32_bf16 v[52:55], a[212:215], v[196:199], v[52:55]
ds_read_b64_tr_b16 a[240:241], v152 offset:24576
v_add_f32 v164, v164, v24
v_mfma_f32_16x16x32_bf16 v[52:55], a[216:219], v[200:203], v[52:55]
v_exp_f32 v25, v25
v_mfma_f32_16x16x32_bf16 v[52:55], a[220:223], v[204:207], v[52:55]
ds_read_b64_tr_b16 a[242:243], v152 offset:28672
v_add_f32 v165, v165, v25
v_mfma_f32_16x16x32_bf16 v[60:63], a[208:211], v[208:211], v[116:119]
v_exp_f32 v26, v26
v_mfma_f32_16x16x32_bf16 v[60:63], a[212:215], v[212:215], v[60:63]
buffer_load_dwordx4 v158, s[8:11], s34 offen offset:2048 nt lds
v_mfma_f32_16x16x32_bf16 v[60:63], a[216:219], v[216:219], v[60:63]
v_exp_f32 v27, v27
v_mfma_f32_16x16x32_bf16 v[60:63], a[220:223], v[220:223], v[60:63]
ds_read_b64_tr_b16 a[244:245], v153 offset:24576
v_cvt_pk_bf16_f32 v84, v24, v25
v_mfma_f32_16x16x32_bf16 v[68:71], a[208:211], v[224:227], v[120:123]
v_exp_f32 v28, v28
v_mfma_f32_16x16x32_bf16 v[68:71], a[212:215], v[228:231], v[68:71]
ds_read_b64_tr_b16 a[246:247], v153 offset:28672
v_add_f32 v164, v164, v26
v_mfma_f32_16x16x32_bf16 v[68:71], a[216:219], v[232:235], v[68:71]
v_exp_f32 v29, v29
v_mfma_f32_16x16x32_bf16 v[68:71], a[220:223], v[236:239], v[68:71]
ds_read_b64_tr_b16 a[248:249], v154 offset:24576
v_add_f32 v165, v165, v27
v_mfma_f32_16x16x32_bf16 v[76:79], a[208:211], v[240:243], v[124:127]
v_exp_f32 v30, v30
v_mfma_f32_16x16x32_bf16 v[76:79], a[212:215], v[244:247], v[76:79]
ds_read_b64_tr_b16 a[250:251], v154 offset:28672
v_cvt_pk_bf16_f32 v85, v26, v27
v_mfma_f32_16x16x32_bf16 v[76:79], a[216:219], v[248:251], v[76:79]
v_exp_f32 v31, v31
v_mfma_f32_16x16x32_bf16 v[76:79], a[220:223], v[252:255], v[76:79]
s_waitcnt lgkmcnt(3)
buffer_load_dwordx4 v159, s[8:11], s34 offen offset:3072 nt lds
v_mfma_f32_16x16x32_bf16 a[0:3], v[96:99], a[224:227], a[0:3]
v_exp_f32 v32, v32
v_mfma_f32_16x16x32_bf16 a[4:7], v[100:103], a[224:227], a[4:7]
ds_read_b64_tr_b16 a[252:253], v155 offset:24576
v_add_f32 v164, v164, v28
v_mfma_f32_16x16x32_bf16 a[8:11], v[104:107], a[224:227], a[8:11]
v_exp_f32 v33, v33
v_mfma_f32_16x16x32_bf16 a[12:15], v[108:111], a[224:227], a[12:15]
ds_read_b64_tr_b16 a[254:255], v155 offset:28672
v_add_f32 v165, v165, v29
v_mfma_f32_16x16x32_bf16 a[16:19], v[96:99], a[228:231], a[16:19]
v_exp_f32 v34, v34
v_mfma_f32_16x16x32_bf16 a[20:23], v[100:103], a[228:231], a[20:23]
ds_read_b128 a[192:195], v144 offset:49152
v_cvt_pk_bf16_f32 v86, v28, v29
v_mfma_f32_16x16x32_bf16 a[24:27], v[104:107], a[228:231], a[24:27]
s_add_u32 m0, s31, 4096
v_exp_f32 v35, v35
v_mfma_f32_16x16x32_bf16 a[28:31], v[108:111], a[228:231], a[28:31]
buffer_load_dwordx4 v156, s[8:11], s35 offen offset:0 nt lds
v_mfma_f32_16x16x32_bf16 a[32:35], v[96:99], a[232:235], a[32:35]
v_exp_f32 v36, v36
v_mfma_f32_16x16x32_bf16 a[36:39], v[100:103], a[232:235], a[36:39]
ds_read_b128 a[196:199], v145 offset:49152
v_add_f32 v164, v164, v30
v_mfma_f32_16x16x32_bf16 a[40:43], v[104:107], a[232:235], a[40:43]
v_exp_f32 v37, v37
v_mfma_f32_16x16x32_bf16 a[44:47], v[108:111], a[232:235], a[44:47]
ds_read_b128 a[200:203], v146 offset:49152
v_add_f32 v165, v165, v31
v_mfma_f32_16x16x32_bf16 a[48:51], v[96:99], a[236:239], a[48:51]
v_exp_f32 v38, v38
v_mfma_f32_16x16x32_bf16 a[52:55], v[100:103], a[236:239], a[52:55]
ds_read_b128 a[204:207], v147 offset:49152
v_cvt_pk_bf16_f32 v87, v30, v31
v_mfma_f32_16x16x32_bf16 a[56:59], v[104:107], a[236:239], a[56:59]
v_exp_f32 v39, v39
v_mfma_f32_16x16x32_bf16 a[60:63], v[108:111], a[236:239], a[60:63]
ds_read_b128 a[208:211], v144 offset:53248
v_cvt_pk_bf16_f32 v88, v32, v33
v_mfma_f32_16x16x32_bf16 a[64:67], v[96:99], a[240:243], a[64:67]
v_exp_f32 v40, v40
v_mfma_f32_16x16x32_bf16 a[68:71], v[100:103], a[240:243], a[68:71]
buffer_load_dwordx4 v157, s[8:11], s35 offen offset:1024 nt lds
v_mfma_f32_16x16x32_bf16 a[72:75], v[104:107], a[240:243], a[72:75]
v_exp_f32 v41, v41
v_mfma_f32_16x16x32_bf16 a[76:79], v[108:111], a[240:243], a[76:79]
s_waitcnt lgkmcnt(2)
ds_read_b128 a[212:215], v145 offset:53248
v_cvt_pk_bf16_f32 v89, v34, v35
v_mfma_f32_16x16x32_bf16 a[80:83], v[96:99], a[244:247], a[80:83]
v_exp_f32 v42, v42
v_mfma_f32_16x16x32_bf16 a[84:87], v[100:103], a[244:247], a[84:87]
ds_read_b128 a[216:219], v146 offset:53248
v_cvt_pk_bf16_f32 v90, v36, v37
v_mfma_f32_16x16x32_bf16 a[88:91], v[104:107], a[244:247], a[88:91]
v_exp_f32 v43, v43
v_mfma_f32_16x16x32_bf16 a[92:95], v[108:111], a[244:247], a[92:95]
ds_read_b128 a[220:223], v147 offset:53248
v_cvt_pk_bf16_f32 v91, v38, v39
v_mfma_f32_16x16x32_bf16 a[96:99], v[96:99], a[248:251], a[96:99]
v_exp_f32 v44, v44
v_mfma_f32_16x16x32_bf16 a[100:103], v[100:103], a[248:251], a[100:103]
buffer_load_dwordx4 v158, s[8:11], s35 offen offset:2048 nt lds
v_mfma_f32_16x16x32_bf16 a[104:107], v[104:107], a[248:251], a[104:107]
v_exp_f32 v45, v45
v_mfma_f32_16x16x32_bf16 a[108:111], v[108:111], a[248:251], a[108:111]
v_add_f32 v168, v168, v40
v_add_f32 v169, v169, v41
v_mfma_f32_16x16x32_bf16 a[112:115], v[96:99], a[252:255], a[112:115]
v_exp_f32 v46, v46
v_mfma_f32_16x16x32_bf16 a[116:119], v[100:103], a[252:255], a[116:119]
v_cvt_pk_bf16_f32 v92, v40, v41
v_add_f32 v168, v168, v42
v_mfma_f32_16x16x32_bf16 a[120:123], v[104:107], a[252:255], a[120:123]
v_exp_f32 v47, v47
v_mfma_f32_16x16x32_bf16 a[124:127], v[108:111], a[252:255], a[124:127]
v_add_f32 v169, v169, v43
v_cvt_pk_bf16_f32 v93, v42, v43
v_mfma_f32_16x16x32_bf16 v[176:179], v[96:99], v[172:175], v[176:179]
v_add_f32 v168, v168, v44
v_add_f32 v169, v169, v45
v_mfma_f32_16x16x32_bf16 v[184:187], v[104:107], v[172:175], v[184:187]
v_cvt_pk_bf16_f32 v94, v44, v45
v_add_f32 v168, v168, v46
v_add_f32 v169, v169, v47
v_cvt_pk_bf16_f32 v95, v46, v47
v_mfma_f32_16x16x32_bf16 v[16:19], a[192:195], v[192:195], v[112:115]
v_exp_f32 v48, v48
v_mfma_f32_16x16x32_bf16 v[16:19], a[196:199], v[196:199], v[16:19]
ds_read_b64_tr_b16 a[224:225], v148 offset:32768
ds_read_b64_tr_b16 a[226:227], v148 offset:36864
v_mfma_f32_16x16x32_bf16 v[16:19], a[200:203], v[200:203], v[16:19]
s_waitcnt lgkmcnt(2)
v_exp_f32 v49, v49
v_mfma_f32_16x16x32_bf16 v[16:19], a[204:207], v[204:207], v[16:19]
buffer_load_dwordx4 v159, s[8:11], s35 offen offset:3072 nt lds
v_mfma_f32_16x16x32_bf16 v[24:27], a[192:195], v[208:211], v[116:119]
v_exp_f32 v50, v50
v_mfma_f32_16x16x32_bf16 v[24:27], a[196:199], v[212:215], v[24:27]
ds_read_b64_tr_b16 a[228:229], v149 offset:32768
v_cvt_pk_bf16_f32 v96, v48, v49
v_mfma_f32_16x16x32_bf16 v[24:27], a[200:203], v[216:219], v[24:27]
v_exp_f32 v51, v51
v_mfma_f32_16x16x32_bf16 v[24:27], a[204:207], v[220:223], v[24:27]
ds_read_b64_tr_b16 a[230:231], v149 offset:36864
v_cvt_pk_bf16_f32 v97, v50, v51
v_mfma_f32_16x16x32_bf16 v[32:35], a[192:195], v[224:227], v[120:123]
v_exp_f32 v52, v52
v_mfma_f32_16x16x32_bf16 v[32:35], a[196:199], v[228:231], v[32:35]
ds_read_b64_tr_b16 a[232:233], v150 offset:32768
ds_read_b64_tr_b16 a[234:235], v150 offset:36864
v_mfma_f32_16x16x32_bf16 v[32:35], a[200:203], v[232:235], v[32:35]
v_exp_f32 v53, v53
v_mfma_f32_16x16x32_bf16 v[32:35], a[204:207], v[236:239], v[32:35]
ds_read_b64_tr_b16 a[236:237], v151 offset:32768
v_cvt_pk_bf16_f32 v98, v52, v53
v_mfma_f32_16x16x32_bf16 v[40:43], a[192:195], v[240:243], v[124:127]
s_mov_b32 m0, s33
v_exp_f32 v54, v54
v_mfma_f32_16x16x32_bf16 v[40:43], a[196:199], v[244:247], v[40:43]
buffer_load_dwordx4 v160, s[12:15], s36 offen offset:0 nt lds
v_mfma_f32_16x16x32_bf16 v[40:43], a[200:203], v[248:251], v[40:43]
v_exp_f32 v55, v55
v_mfma_f32_16x16x32_bf16 v[40:43], a[204:207], v[252:255], v[40:43]
ds_read_b64_tr_b16 a[238:239], v151 offset:36864
v_cvt_pk_bf16_f32 v99, v54, v55
v_mfma_f32_16x16x32_bf16 v[20:23], a[208:211], v[192:195], v[112:115]
v_exp_f32 v56, v56
v_mfma_f32_16x16x32_bf16 v[20:23], a[212:215], v[196:199], v[20:23]
ds_read_b64_tr_b16 a[240:241], v152 offset:32768
v_add_f32 v164, v164, v56
v_mfma_f32_16x16x32_bf16 v[20:23], a[216:219], v[200:203], v[20:23]
v_exp_f32 v57, v57
v_mfma_f32_16x16x32_bf16 v[20:23], a[220:223], v[204:207], v[20:23]
ds_read_b64_tr_b16 a[242:243], v152 offset:36864
v_add_f32 v165, v165, v57
v_mfma_f32_16x16x32_bf16 v[28:31], a[208:211], v[208:211], v[116:119]
v_exp_f32 v58, v58
v_mfma_f32_16x16x32_bf16 v[28:31], a[212:215], v[212:215], v[28:31]
buffer_load_dwordx4 v161, s[12:15], s36 offen offset:1024 nt lds
v_mfma_f32_16x16x32_bf16 v[28:31], a[216:219], v[216:219], v[28:31]
v_exp_f32 v59, v59
v_mfma_f32_16x16x32_bf16 v[28:31], a[220:223], v[220:223], v[28:31]
ds_read_b64_tr_b16 a[244:245], v153 offset:32768
v_cvt_pk_bf16_f32 v100, v56, v57
v_mfma_f32_16x16x32_bf16 v[36:39], a[208:211], v[224:227], v[120:123]
v_exp_f32 v60, v60
v_mfma_f32_16x16x32_bf16 v[36:39], a[212:215], v[228:231], v[36:39]
ds_read_b64_tr_b16 a[246:247], v153 offset:36864
v_add_f32 v164, v164, v58
v_mfma_f32_16x16x32_bf16 v[36:39], a[216:219], v[232:235], v[36:39]
v_exp_f32 v61, v61
v_mfma_f32_16x16x32_bf16 v[36:39], a[220:223], v[236:239], v[36:39]
ds_read_b64_tr_b16 a[248:249], v154 offset:32768
v_add_f32 v165, v165, v59
v_mfma_f32_16x16x32_bf16 v[44:47], a[208:211], v[240:243], v[124:127]
v_exp_f32 v62, v62
v_mfma_f32_16x16x32_bf16 v[44:47], a[212:215], v[244:247], v[44:47]
ds_read_b64_tr_b16 a[250:251], v154 offset:36864
v_cvt_pk_bf16_f32 v101, v58, v59
v_mfma_f32_16x16x32_bf16 v[44:47], a[216:219], v[248:251], v[44:47]
v_exp_f32 v63, v63
v_mfma_f32_16x16x32_bf16 v[44:47], a[220:223], v[252:255], v[44:47]
s_waitcnt lgkmcnt(3)
buffer_load_dwordx4 v160, s[12:15], s36 offen offset:2048 nt lds
v_mfma_f32_16x16x32_bf16 a[0:3], v[80:83], a[224:227], a[0:3]
v_exp_f32 v64, v64
v_mfma_f32_16x16x32_bf16 a[4:7], v[84:87], a[224:227], a[4:7]
ds_read_b64_tr_b16 a[252:253], v155 offset:32768
v_add_f32 v164, v164, v60
v_mfma_f32_16x16x32_bf16 a[8:11], v[88:91], a[224:227], a[8:11]
v_exp_f32 v65, v65
v_mfma_f32_16x16x32_bf16 a[12:15], v[92:95], a[224:227], a[12:15]
ds_read_b64_tr_b16 a[254:255], v155 offset:36864
v_add_f32 v165, v165, v61
v_mfma_f32_16x16x32_bf16 a[16:19], v[80:83], a[228:231], a[16:19]
v_exp_f32 v66, v66
v_mfma_f32_16x16x32_bf16 a[20:23], v[84:87], a[228:231], a[20:23]
ds_read_b128 a[192:195], v144 offset:57344
v_cvt_pk_bf16_f32 v102, v60, v61
v_mfma_f32_16x16x32_bf16 a[24:27], v[88:91], a[228:231], a[24:27]
v_exp_f32 v67, v67
v_mfma_f32_16x16x32_bf16 a[28:31], v[92:95], a[228:231], a[28:31]
buffer_load_dwordx4 v161, s[12:15], s36 offen offset:3072 nt lds
v_mfma_f32_16x16x32_bf16 a[32:35], v[80:83], a[232:235], a[32:35]
v_exp_f32 v68, v68
v_mfma_f32_16x16x32_bf16 a[36:39], v[84:87], a[232:235], a[36:39]
ds_read_b128 a[196:199], v145 offset:57344
v_add_f32 v164, v164, v62
v_mfma_f32_16x16x32_bf16 a[40:43], v[88:91], a[232:235], a[40:43]
v_exp_f32 v69, v69
v_mfma_f32_16x16x32_bf16 a[44:47], v[92:95], a[232:235], a[44:47]
ds_read_b128 a[200:203], v146 offset:57344
v_add_f32 v165, v165, v63
v_mfma_f32_16x16x32_bf16 a[48:51], v[80:83], a[236:239], a[48:51]
v_exp_f32 v70, v70
v_mfma_f32_16x16x32_bf16 a[52:55], v[84:87], a[236:239], a[52:55]
ds_read_b128 a[204:207], v147 offset:57344
v_cvt_pk_bf16_f32 v103, v62, v63
v_mfma_f32_16x16x32_bf16 a[56:59], v[88:91], a[236:239], a[56:59]
v_exp_f32 v71, v71
v_mfma_f32_16x16x32_bf16 a[60:63], v[92:95], a[236:239], a[60:63]
ds_read_b128 a[208:211], v144 offset:61440
v_cvt_pk_bf16_f32 v104, v64, v65
v_mfma_f32_16x16x32_bf16 a[64:67], v[80:83], a[240:243], a[64:67]
v_exp_f32 v72, v72
v_mfma_f32_16x16x32_bf16 a[68:71], v[84:87], a[240:243], a[68:71]
ds_read_b128 a[212:215], v145 offset:61440
v_cvt_pk_bf16_f32 v105, v66, v67
v_mfma_f32_16x16x32_bf16 a[72:75], v[88:91], a[240:243], a[72:75]
v_exp_f32 v73, v73
v_mfma_f32_16x16x32_bf16 a[76:79], v[92:95], a[240:243], a[76:79]
s_waitcnt lgkmcnt(3)
ds_read_b128 a[216:219], v146 offset:61440
v_cvt_pk_bf16_f32 v106, v68, v69
v_mfma_f32_16x16x32_bf16 a[80:83], v[80:83], a[244:247], a[80:83]
v_exp_f32 v74, v74
v_mfma_f32_16x16x32_bf16 a[84:87], v[84:87], a[244:247], a[84:87]
ds_read_b128 a[220:223], v147 offset:61440
v_cvt_pk_bf16_f32 v107, v70, v71
v_mfma_f32_16x16x32_bf16 a[88:91], v[88:91], a[244:247], a[88:91]
v_exp_f32 v75, v75
v_mfma_f32_16x16x32_bf16 a[92:95], v[92:95], a[244:247], a[92:95]
v_add_f32 v168, v168, v72
v_add_f32 v169, v169, v73
v_mfma_f32_16x16x32_bf16 a[96:99], v[80:83], a[248:251], a[96:99]
v_exp_f32 v76, v76
v_mfma_f32_16x16x32_bf16 a[100:103], v[84:87], a[248:251], a[100:103]
v_cvt_pk_bf16_f32 v108, v72, v73
v_add_f32 v168, v168, v74
v_mfma_f32_16x16x32_bf16 a[104:107], v[88:91], a[248:251], a[104:107]
v_exp_f32 v77, v77
v_mfma_f32_16x16x32_bf16 a[108:111], v[92:95], a[248:251], a[108:111]
v_add_f32 v169, v169, v75
v_cvt_pk_bf16_f32 v109, v74, v75
v_mfma_f32_16x16x32_bf16 a[112:115], v[80:83], a[252:255], a[112:115]
v_exp_f32 v78, v78
v_mfma_f32_16x16x32_bf16 a[116:119], v[84:87], a[252:255], a[116:119]
v_add_f32 v168, v168, v76
v_add_f32 v169, v169, v77
v_mfma_f32_16x16x32_bf16 a[120:123], v[88:91], a[252:255], a[120:123]
v_exp_f32 v79, v79
v_mfma_f32_16x16x32_bf16 a[124:127], v[92:95], a[252:255], a[124:127]
v_cvt_pk_bf16_f32 v110, v76, v77
v_add_f32 v168, v168, v78
v_mfma_f32_16x16x32_bf16 v[176:179], v[80:83], v[172:175], v[176:179]
v_add_f32 v169, v169, v79
v_cvt_pk_bf16_f32 v111, v78, v79
v_mfma_f32_16x16x32_bf16 v[184:187], v[88:91], v[172:175], v[184:187]
v_mfma_f32_16x16x32_bf16 v[48:51], a[192:195], v[192:195], v[112:115]
v_exp_f32 v16, v16
v_mfma_f32_16x16x32_bf16 v[48:51], a[196:199], v[196:199], v[48:51]
ds_read_b64_tr_b16 a[224:225], v148 offset:40960
ds_read_b64_tr_b16 a[226:227], v148 offset:45056
v_mfma_f32_16x16x32_bf16 v[48:51], a[200:203], v[200:203], v[48:51]
s_waitcnt lgkmcnt(2)
s_add_u32 m0, s33, 4096
v_exp_f32 v17, v17
v_mfma_f32_16x16x32_bf16 v[48:51], a[204:207], v[204:207], v[48:51]
buffer_load_dwordx4 v160, s[12:15], s37 offen offset:0 nt lds
v_mfma_f32_16x16x32_bf16 v[56:59], a[192:195], v[208:211], v[116:119]
v_exp_f32 v18, v18
v_mfma_f32_16x16x32_bf16 v[56:59], a[196:199], v[212:215], v[56:59]
ds_read_b64_tr_b16 a[228:229], v149 offset:40960
v_cvt_pk_bf16_f32 v80, v16, v17
v_mfma_f32_16x16x32_bf16 v[56:59], a[200:203], v[216:219], v[56:59]
v_exp_f32 v19, v19
v_mfma_f32_16x16x32_bf16 v[56:59], a[204:207], v[220:223], v[56:59]
ds_read_b64_tr_b16 a[230:231], v149 offset:45056
v_cvt_pk_bf16_f32 v81, v18, v19
v_mfma_f32_16x16x32_bf16 v[64:67], a[192:195], v[224:227], v[120:123]
v_exp_f32 v20, v20
v_mfma_f32_16x16x32_bf16 v[64:67], a[196:199], v[228:231], v[64:67]
ds_read_b64_tr_b16 a[232:233], v150 offset:40960
ds_read_b64_tr_b16 a[234:235], v150 offset:45056
v_mfma_f32_16x16x32_bf16 v[64:67], a[200:203], v[232:235], v[64:67]
v_exp_f32 v21, v21
v_mfma_f32_16x16x32_bf16 v[64:67], a[204:207], v[236:239], v[64:67]
ds_read_b64_tr_b16 a[236:237], v151 offset:40960
v_cvt_pk_bf16_f32 v82, v20, v21
v_mfma_f32_16x16x32_bf16 v[72:75], a[192:195], v[240:243], v[124:127]
v_exp_f32 v22, v22
v_mfma_f32_16x16x32_bf16 v[72:75], a[196:199], v[244:247], v[72:75]
buffer_load_dwordx4 v161, s[12:15], s37 offen offset:1024 nt lds
v_mfma_f32_16x16x32_bf16 v[72:75], a[200:203], v[248:251], v[72:75]
v_exp_f32 v23, v23
v_mfma_f32_16x16x32_bf16 v[72:75], a[204:207], v[252:255], v[72:75]
ds_read_b64_tr_b16 a[238:239], v151 offset:45056
v_cvt_pk_bf16_f32 v83, v22, v23
v_mfma_f32_16x16x32_bf16 v[52:55], a[208:211], v[192:195], v[112:115]
v_exp_f32 v24, v24
v_mfma_f32_16x16x32_bf16 v[52:55], a[212:215], v[196:199], v[52:55]
ds_read_b64_tr_b16 a[240:241], v152 offset:40960
v_add_f32 v164, v164, v24
v_mfma_f32_16x16x32_bf16 v[52:55], a[216:219], v[200:203], v[52:55]
v_exp_f32 v25, v25
v_mfma_f32_16x16x32_bf16 v[52:55], a[220:223], v[204:207], v[52:55]
ds_read_b64_tr_b16 a[242:243], v152 offset:45056
v_add_f32 v165, v165, v25
v_mfma_f32_16x16x32_bf16 v[60:63], a[208:211], v[208:211], v[116:119]
v_exp_f32 v26, v26
v_mfma_f32_16x16x32_bf16 v[60:63], a[212:215], v[212:215], v[60:63]
buffer_load_dwordx4 v160, s[12:15], s37 offen offset:2048 nt lds
v_mfma_f32_16x16x32_bf16 v[60:63], a[216:219], v[216:219], v[60:63]
v_exp_f32 v27, v27
v_mfma_f32_16x16x32_bf16 v[60:63], a[220:223], v[220:223], v[60:63]
ds_read_b64_tr_b16 a[244:245], v153 offset:40960
v_cvt_pk_bf16_f32 v84, v24, v25
v_mfma_f32_16x16x32_bf16 v[68:71], a[208:211], v[224:227], v[120:123]
v_exp_f32 v28, v28
v_mfma_f32_16x16x32_bf16 v[68:71], a[212:215], v[228:231], v[68:71]
ds_read_b64_tr_b16 a[246:247], v153 offset:45056
v_add_f32 v164, v164, v26
v_mfma_f32_16x16x32_bf16 v[68:71], a[216:219], v[232:235], v[68:71]
v_exp_f32 v29, v29
v_mfma_f32_16x16x32_bf16 v[68:71], a[220:223], v[236:239], v[68:71]
ds_read_b64_tr_b16 a[248:249], v154 offset:40960
v_add_f32 v165, v165, v27
v_mfma_f32_16x16x32_bf16 v[76:79], a[208:211], v[240:243], v[124:127]
v_exp_f32 v30, v30
v_mfma_f32_16x16x32_bf16 v[76:79], a[212:215], v[244:247], v[76:79]
ds_read_b64_tr_b16 a[250:251], v154 offset:45056
v_cvt_pk_bf16_f32 v85, v26, v27
v_mfma_f32_16x16x32_bf16 v[76:79], a[216:219], v[248:251], v[76:79]
v_exp_f32 v31, v31
v_mfma_f32_16x16x32_bf16 v[76:79], a[220:223], v[252:255], v[76:79]
s_waitcnt lgkmcnt(3)
buffer_load_dwordx4 v161, s[12:15], s37 offen offset:3072 nt lds
v_mfma_f32_16x16x32_bf16 a[0:3], v[96:99], a[224:227], a[0:3]
v_exp_f32 v32, v32
v_mfma_f32_16x16x32_bf16 a[4:7], v[100:103], a[224:227], a[4:7]
ds_read_b64_tr_b16 a[252:253], v155 offset:40960
v_add_f32 v164, v164, v28
v_mfma_f32_16x16x32_bf16 a[8:11], v[104:107], a[224:227], a[8:11]
v_exp_f32 v33, v33
v_mfma_f32_16x16x32_bf16 a[12:15], v[108:111], a[224:227], a[12:15]
ds_read_b64_tr_b16 a[254:255], v155 offset:45056
v_add_f32 v165, v165, v29
v_mfma_f32_16x16x32_bf16 a[16:19], v[96:99], a[228:231], a[16:19]
v_exp_f32 v34, v34
v_mfma_f32_16x16x32_bf16 a[20:23], v[100:103], a[228:231], a[20:23]
s_xor_b32 s7, s7, 14336
ds_read_b128 a[192:195], v144 offset:0
v_cvt_pk_bf16_f32 v86, v28, v29
v_mfma_f32_16x16x32_bf16 a[24:27], v[104:107], a[228:231], a[24:27]
s_add_u32 s4, s4, s7
v_exp_f32 v35, v35
v_mfma_f32_16x16x32_bf16 a[28:31], v[108:111], a[228:231], a[28:31]
buffer_store_dwordx4 v[8:11], v13, s[20:23], s4 offen offset:0 sc1
v_mfma_f32_16x16x32_bf16 a[32:35], v[96:99], a[232:235], a[32:35]
v_exp_f32 v36, v36
v_mfma_f32_16x16x32_bf16 a[36:39], v[100:103], a[232:235], a[36:39]
ds_read_b128 a[196:199], v145 offset:0
v_add_f32 v164, v164, v30
v_mfma_f32_16x16x32_bf16 a[40:43], v[104:107], a[232:235], a[40:43]
v_exp_f32 v37, v37
v_mfma_f32_16x16x32_bf16 a[44:47], v[108:111], a[232:235], a[44:47]
ds_read_b128 a[200:203], v146 offset:0
v_add_f32 v165, v165, v31
v_mfma_f32_16x16x32_bf16 a[48:51], v[96:99], a[236:239], a[48:51]
v_exp_f32 v38, v38
v_mfma_f32_16x16x32_bf16 a[52:55], v[100:103], a[236:239], a[52:55]
ds_read_b128 a[204:207], v147 offset:0
v_cvt_pk_bf16_f32 v87, v30, v31
v_mfma_f32_16x16x32_bf16 a[56:59], v[104:107], a[236:239], a[56:59]
v_exp_f32 v39, v39
v_mfma_f32_16x16x32_bf16 a[60:63], v[108:111], a[236:239], a[60:63]
ds_read_b128 a[208:211], v144 offset:4096
v_cvt_pk_bf16_f32 v88, v32, v33
v_mfma_f32_16x16x32_bf16 a[64:67], v[96:99], a[240:243], a[64:67]
v_exp_f32 v40, v40
v_mfma_f32_16x16x32_bf16 a[68:71], v[100:103], a[240:243], a[68:71]
ds_read_b128 a[212:215], v145 offset:4096
v_cvt_pk_bf16_f32 v89, v34, v35
v_mfma_f32_16x16x32_bf16 a[72:75], v[104:107], a[240:243], a[72:75]
v_exp_f32 v41, v41
v_mfma_f32_16x16x32_bf16 a[76:79], v[108:111], a[240:243], a[76:79]
s_waitcnt lgkmcnt(3)
ds_read_b128 a[216:219], v146 offset:4096
v_cvt_pk_bf16_f32 v90, v36, v37
v_mfma_f32_16x16x32_bf16 a[80:83], v[96:99], a[244:247], a[80:83]
v_exp_f32 v42, v42
v_mfma_f32_16x16x32_bf16 a[84:87], v[100:103], a[244:247], a[84:87]
ds_read_b128 a[220:223], v147 offset:4096
v_cvt_pk_bf16_f32 v91, v38, v39
v_mfma_f32_16x16x32_bf16 a[88:91], v[104:107], a[244:247], a[88:91]
v_exp_f32 v43, v43
v_mfma_f32_16x16x32_bf16 a[92:95], v[108:111], a[244:247], a[92:95]
v_add_f32 v168, v168, v40
v_add_f32 v169, v169, v41
v_mfma_f32_16x16x32_bf16 a[96:99], v[96:99], a[248:251], a[96:99]
v_exp_f32 v44, v44
v_mfma_f32_16x16x32_bf16 a[100:103], v[100:103], a[248:251], a[100:103]
v_cvt_pk_bf16_f32 v92, v40, v41
v_add_f32 v168, v168, v42
v_mfma_f32_16x16x32_bf16 a[104:107], v[104:107], a[248:251], a[104:107]
v_exp_f32 v45, v45
v_mfma_f32_16x16x32_bf16 a[108:111], v[108:111], a[248:251], a[108:111]
v_add_f32 v169, v169, v43
v_cvt_pk_bf16_f32 v93, v42, v43
v_mfma_f32_16x16x32_bf16 a[112:115], v[96:99], a[252:255], a[112:115]
v_exp_f32 v46, v46
v_mfma_f32_16x16x32_bf16 a[116:119], v[100:103], a[252:255], a[116:119]
v_add_f32 v168, v168, v44
v_add_f32 v169, v169, v45
v_mfma_f32_16x16x32_bf16 a[120:123], v[104:107], a[252:255], a[120:123]
v_exp_f32 v47, v47
v_mfma_f32_16x16x32_bf16 a[124:127], v[108:111], a[252:255], a[124:127]
v_cvt_pk_bf16_f32 v94, v44, v45
v_add_f32 v168, v168, v46
v_mfma_f32_16x16x32_bf16 v[176:179], v[96:99], v[172:175], v[176:179]
v_add_f32 v169, v169, v47
v_cvt_pk_bf16_f32 v95, v46, v47
v_mfma_f32_16x16x32_bf16 v[184:187], v[104:107], v[172:175], v[184:187]
v_mfma_f32_16x16x32_bf16 v[16:19], a[192:195], v[192:195], v[112:115]
v_exp_f32 v48, v48
v_mfma_f32_16x16x32_bf16 v[16:19], a[196:199], v[196:199], v[16:19]
ds_read_b64_tr_b16 a[224:225], v148 offset:49152
ds_read_b64_tr_b16 a[226:227], v148 offset:53248
v_mfma_f32_16x16x32_bf16 v[16:19], a[200:203], v[200:203], v[16:19]
s_waitcnt lgkmcnt(2)
v_exp_f32 v49, v49
v_mfma_f32_16x16x32_bf16 v[16:19], a[204:207], v[204:207], v[16:19]
ds_read_b64_tr_b16 a[228:229], v149 offset:49152
v_cvt_pk_bf16_f32 v96, v48, v49
v_mfma_f32_16x16x32_bf16 v[24:27], a[192:195], v[208:211], v[116:119]
v_exp_f32 v50, v50
v_mfma_f32_16x16x32_bf16 v[24:27], a[196:199], v[212:215], v[24:27]
ds_read_b64_tr_b16 a[230:231], v149 offset:53248
ds_read_b64_tr_b16 a[232:233], v150 offset:49152
v_mfma_f32_16x16x32_bf16 v[24:27], a[200:203], v[216:219], v[24:27]
v_exp_f32 v51, v51
v_mfma_f32_16x16x32_bf16 v[24:27], a[204:207], v[220:223], v[24:27]
ds_read_b64_tr_b16 a[234:235], v150 offset:53248
v_cvt_pk_bf16_f32 v97, v50, v51
v_mfma_f32_16x16x32_bf16 v[32:35], a[192:195], v[224:227], v[120:123]
v_exp_f32 v52, v52
v_mfma_f32_16x16x32_bf16 v[32:35], a[196:199], v[228:231], v[32:35]
ds_read_b64_tr_b16 a[236:237], v151 offset:49152
ds_read_b64_tr_b16 a[238:239], v151 offset:53248
v_mfma_f32_16x16x32_bf16 v[32:35], a[200:203], v[232:235], v[32:35]
v_exp_f32 v53, v53
v_mfma_f32_16x16x32_bf16 v[32:35], a[204:207], v[236:239], v[32:35]
ds_read_b64_tr_b16 a[240:241], v152 offset:49152
v_cvt_pk_bf16_f32 v98, v52, v53
v_mfma_f32_16x16x32_bf16 v[40:43], a[192:195], v[240:243], v[124:127]
v_exp_f32 v54, v54
v_mfma_f32_16x16x32_bf16 v[40:43], a[196:199], v[244:247], v[40:43]
ds_read_b64_tr_b16 a[242:243], v152 offset:53248
ds_read_b64_tr_b16 a[244:245], v153 offset:49152
v_mfma_f32_16x16x32_bf16 v[40:43], a[200:203], v[248:251], v[40:43]
v_exp_f32 v55, v55
v_mfma_f32_16x16x32_bf16 v[40:43], a[204:207], v[252:255], v[40:43]
ds_read_b64_tr_b16 a[246:247], v153 offset:53248
v_cvt_pk_bf16_f32 v99, v54, v55
v_mfma_f32_16x16x32_bf16 v[20:23], a[208:211], v[192:195], v[112:115]
v_exp_f32 v56, v56
v_mfma_f32_16x16x32_bf16 v[20:23], a[212:215], v[196:199], v[20:23]
ds_read_b64_tr_b16 a[248:249], v154 offset:49152
v_add_f32 v164, v164, v56
v_mfma_f32_16x16x32_bf16 v[20:23], a[216:219], v[200:203], v[20:23]
v_exp_f32 v57, v57
v_mfma_f32_16x16x32_bf16 v[20:23], a[220:223], v[204:207], v[20:23]
ds_read_b64_tr_b16 a[250:251], v154 offset:53248
v_add_f32 v165, v165, v57
v_mfma_f32_16x16x32_bf16 v[28:31], a[208:211], v[208:211], v[116:119]
v_exp_f32 v58, v58
v_mfma_f32_16x16x32_bf16 v[28:31], a[212:215], v[212:215], v[28:31]
ds_read_b64_tr_b16 a[252:253], v155 offset:49152
v_cvt_pk_bf16_f32 v100, v56, v57
v_mfma_f32_16x16x32_bf16 v[28:31], a[216:219], v[216:219], v[28:31]
v_exp_f32 v59, v59
v_mfma_f32_16x16x32_bf16 v[28:31], a[220:223], v[220:223], v[28:31]
ds_read_b64_tr_b16 a[254:255], v155 offset:53248
v_add_f32 v164, v164, v58
v_mfma_f32_16x16x32_bf16 v[36:39], a[208:211], v[224:227], v[120:123]
v_exp_f32 v60, v60
v_mfma_f32_16x16x32_bf16 v[36:39], a[212:215], v[228:231], v[36:39]
ds_read_b128 a[192:195], v144 offset:8192
v_add_f32 v165, v165, v59
v_mfma_f32_16x16x32_bf16 v[36:39], a[216:219], v[232:235], v[36:39]
v_exp_f32 v61, v61
v_mfma_f32_16x16x32_bf16 v[36:39], a[220:223], v[236:239], v[36:39]
ds_read_b128 a[196:199], v145 offset:8192
v_cvt_pk_bf16_f32 v101, v58, v59
v_mfma_f32_16x16x32_bf16 v[44:47], a[208:211], v[240:243], v[124:127]
v_exp_f32 v62, v62
v_mfma_f32_16x16x32_bf16 v[44:47], a[212:215], v[244:247], v[44:47]
ds_read_b128 a[200:203], v146 offset:8192
v_add_f32 v164, v164, v60
v_mfma_f32_16x16x32_bf16 v[44:47], a[216:219], v[248:251], v[44:47]
v_exp_f32 v63, v63
v_mfma_f32_16x16x32_bf16 v[44:47], a[220:223], v[252:255], v[44:47]
s_waitcnt lgkmcnt(3)
ds_read_b128 a[204:207], v147 offset:8192
v_add_f32 v165, v165, v61
v_mfma_f32_16x16x32_bf16 a[0:3], v[80:83], a[224:227], a[0:3]
v_exp_f32 v64, v64
v_mfma_f32_16x16x32_bf16 a[4:7], v[84:87], a[224:227], a[4:7]
ds_read_b128 a[208:211], v144 offset:12288
v_cvt_pk_bf16_f32 v102, v60, v61
v_mfma_f32_16x16x32_bf16 a[8:11], v[88:91], a[224:227], a[8:11]
v_exp_f32 v65, v65
v_mfma_f32_16x16x32_bf16 a[12:15], v[92:95], a[224:227], a[12:15]
ds_read_b128 a[212:215], v145 offset:12288
v_add_f32 v164, v164, v62
v_mfma_f32_16x16x32_bf16 a[16:19], v[80:83], a[228:231], a[16:19]
v_exp_f32 v66, v66
v_mfma_f32_16x16x32_bf16 a[20:23], v[84:87], a[228:231], a[20:23]
ds_read_b128 a[216:219], v146 offset:12288
v_add_f32 v165, v165, v63
v_mfma_f32_16x16x32_bf16 a[24:27], v[88:91], a[228:231], a[24:27]
v_exp_f32 v67, v67
v_mfma_f32_16x16x32_bf16 a[28:31], v[92:95], a[228:231], a[28:31]
ds_read_b128 a[220:223], v147 offset:12288
v_cvt_pk_bf16_f32 v103, v62, v63
v_mfma_f32_16x16x32_bf16 a[32:35], v[80:83], a[232:235], a[32:35]
s_add_u32 s34, s34, 32768
v_exp_f32 v68, v68
v_mfma_f32_16x16x32_bf16 a[36:39], v[84:87], a[232:235], a[36:39]
v_cvt_pk_bf16_f32 v104, v64, v65
v_cvt_pk_bf16_f32 v105, v66, v67
v_mfma_f32_16x16x32_bf16 a[40:43], v[88:91], a[232:235], a[40:43]
s_add_u32 s35, s35, 32768
v_exp_f32 v69, v69
v_mfma_f32_16x16x32_bf16 a[44:47], v[92:95], a[232:235], a[44:47]
v_cvt_pk_bf16_f32 v106, v68, v69
v_mfma_f32_16x16x32_bf16 a[48:51], v[80:83], a[236:239], a[48:51]
s_add_u32 s36, s36, 32768
v_exp_f32 v70, v70
v_mfma_f32_16x16x32_bf16 a[52:55], v[84:87], a[236:239], a[52:55]
v_mfma_f32_16x16x32_bf16 a[56:59], v[88:91], a[236:239], a[56:59]
s_add_u32 s37, s37, 32768
v_exp_f32 v71, v71
v_mfma_f32_16x16x32_bf16 a[60:63], v[92:95], a[236:239], a[60:63]
v_cvt_pk_bf16_f32 v107, v70, v71
v_mfma_f32_16x16x32_bf16 a[64:67], v[80:83], a[240:243], a[64:67]
s_add_u32 s38, s38, 1
v_exp_f32 v72, v72
v_mfma_f32_16x16x32_bf16 a[68:71], v[84:87], a[240:243], a[68:71]
v_add_f32 v168, v168, v72
v_mfma_f32_16x16x32_bf16 a[72:75], v[88:91], a[240:243], a[72:75]
s_cmp_lt_u32 s38, 6
v_exp_f32 v73, v73
v_mfma_f32_16x16x32_bf16 a[76:79], v[92:95], a[240:243], a[76:79]
v_add_f32 v169, v169, v73
v_cvt_pk_bf16_f32 v108, v72, v73
v_mfma_f32_16x16x32_bf16 a[80:83], v[80:83], a[244:247], a[80:83]
v_exp_f32 v74, v74
v_mfma_f32_16x16x32_bf16 a[84:87], v[84:87], a[244:247], a[84:87]
v_add_f32 v168, v168, v74
v_mfma_f32_16x16x32_bf16 a[88:91], v[88:91], a[244:247], a[88:91]
v_exp_f32 v75, v75
v_mfma_f32_16x16x32_bf16 a[92:95], v[92:95], a[244:247], a[92:95]
v_add_f32 v169, v169, v75
v_cvt_pk_bf16_f32 v109, v74, v75
v_mfma_f32_16x16x32_bf16 a[96:99], v[80:83], a[248:251], a[96:99]
v_exp_f32 v76, v76
v_mfma_f32_16x16x32_bf16 a[100:103], v[84:87], a[248:251], a[100:103]
v_add_f32 v168, v168, v76
v_mfma_f32_16x16x32_bf16 a[104:107], v[88:91], a[248:251], a[104:107]
v_exp_f32 v77, v77
v_mfma_f32_16x16x32_bf16 a[108:111], v[92:95], a[248:251], a[108:111]
v_add_f32 v169, v169, v77
v_cvt_pk_bf16_f32 v110, v76, v77
v_mfma_f32_16x16x32_bf16 a[112:115], v[80:83], a[252:255], a[112:115]
v_exp_f32 v78, v78
v_mfma_f32_16x16x32_bf16 a[116:119], v[84:87], a[252:255], a[116:119]
v_add_f32 v168, v168, v78
v_mfma_f32_16x16x32_bf16 a[120:123], v[88:91], a[252:255], a[120:123]
v_exp_f32 v79, v79
v_mfma_f32_16x16x32_bf16 a[124:127], v[92:95], a[252:255], a[124:127]
v_add_f32 v169, v169, v79
v_cvt_pk_bf16_f32 v111, v78, v79
v_mfma_f32_16x16x32_bf16 v[176:179], v[80:83], v[172:175], v[176:179]
v_mfma_f32_16x16x32_bf16 v[184:187], v[88:91], v[172:175], v[184:187]
s_waitcnt lgkmcnt(0)
s_waitcnt vmcnt(1) lgkmcnt(0)
s_barrier
s_cbranch_scc1 adaLN_cond__mha_block_cached__glu_gated_bilinear__prompt_kernel_loop
s_cmp_eq_u32 s28, 2
s_cselect_b32 s16, s12, s8
s_cselect_b32 s17, s13, s9
s_cselect_b32 s34, 516096, s34
s_cselect_b32 s35, 520192, s35
s_cselect_b64 vcc, -1, 0
s_mov_b32 s19, 0x20000
s_cmp_eq_u32 s28, 3
s_cselect_b32 s18, 0, s10
v_cndmask_b32 v156, v156, v160, vcc
v_cndmask_b32 v157, v157, v161, vcc
v_cndmask_b32 v158, v158, v160, vcc
v_cndmask_b32 v159, v159, v161, vcc
v_mfma_f32_16x16x32_bf16 v[48:51], a[192:195], v[192:195], v[112:115]
v_exp_f32 v16, v16
v_mfma_f32_16x16x32_bf16 v[48:51], a[196:199], v[196:199], v[48:51]
ds_read_b64_tr_b16 a[224:225], v148 offset:57344
ds_read_b64_tr_b16 a[226:227], v148 offset:61440
v_mfma_f32_16x16x32_bf16 v[48:51], a[200:203], v[200:203], v[48:51]
v_exp_f32 v17, v17
v_mfma_f32_16x16x32_bf16 v[48:51], a[204:207], v[204:207], v[48:51]
global_load_dword v15, v15, s[40:41]
v_mfma_f32_16x16x32_bf16 v[56:59], a[192:195], v[208:211], v[116:119]
v_exp_f32 v18, v18
v_mfma_f32_16x16x32_bf16 v[56:59], a[196:199], v[212:215], v[56:59]
ds_read_b64_tr_b16 a[228:229], v149 offset:57344
v_cvt_pk_bf16_f32 v80, v16, v17
v_mfma_f32_16x16x32_bf16 v[56:59], a[200:203], v[216:219], v[56:59]
v_exp_f32 v19, v19
v_mfma_f32_16x16x32_bf16 v[56:59], a[204:207], v[220:223], v[56:59]
ds_read_b64_tr_b16 a[230:231], v149 offset:61440
v_cvt_pk_bf16_f32 v81, v18, v19
v_mfma_f32_16x16x32_bf16 v[64:67], a[192:195], v[224:227], v[120:123]
v_exp_f32 v20, v20
v_mfma_f32_16x16x32_bf16 v[64:67], a[196:199], v[228:231], v[64:67]
ds_read_b64_tr_b16 a[232:233], v150 offset:57344
ds_read_b64_tr_b16 a[234:235], v150 offset:61440
v_mfma_f32_16x16x32_bf16 v[64:67], a[200:203], v[232:235], v[64:67]
v_exp_f32 v21, v21
v_mfma_f32_16x16x32_bf16 v[64:67], a[204:207], v[236:239], v[64:67]
ds_read_b64_tr_b16 a[236:237], v151 offset:57344
v_cvt_pk_bf16_f32 v82, v20, v21
v_mfma_f32_16x16x32_bf16 v[72:75], a[192:195], v[240:243], v[124:127]
v_exp_f32 v22, v22
v_mfma_f32_16x16x32_bf16 v[72:75], a[196:199], v[244:247], v[72:75]
buffer_load_dword v140, v140, s[20:23], 0 offen sc1
v_mfma_f32_16x16x32_bf16 v[72:75], a[200:203], v[248:251], v[72:75]
v_exp_f32 v23, v23
v_mfma_f32_16x16x32_bf16 v[72:75], a[204:207], v[252:255], v[72:75]
ds_read_b64_tr_b16 a[238:239], v151 offset:61440
v_cvt_pk_bf16_f32 v83, v22, v23
v_mfma_f32_16x16x32_bf16 v[52:55], a[208:211], v[192:195], v[112:115]
v_exp_f32 v24, v24
v_mfma_f32_16x16x32_bf16 v[52:55], a[212:215], v[196:199], v[52:55]
ds_read_b64_tr_b16 a[240:241], v152 offset:57344
v_add_f32 v164, v164, v24
v_mfma_f32_16x16x32_bf16 v[52:55], a[216:219], v[200:203], v[52:55]
v_exp_f32 v25, v25
v_mfma_f32_16x16x32_bf16 v[52:55], a[220:223], v[204:207], v[52:55]
ds_read_b64_tr_b16 a[242:243], v152 offset:61440
v_add_f32 v165, v165, v25
v_mfma_f32_16x16x32_bf16 v[60:63], a[208:211], v[208:211], v[116:119]
s_mov_b32 m0, s30
v_exp_f32 v26, v26
v_mfma_f32_16x16x32_bf16 v[60:63], a[212:215], v[212:215], v[60:63]
buffer_load_dwordx4 v156, s[16:19], s34 offen offset:0 nt lds
v_mfma_f32_16x16x32_bf16 v[60:63], a[216:219], v[216:219], v[60:63]
v_exp_f32 v27, v27
v_mfma_f32_16x16x32_bf16 v[60:63], a[220:223], v[220:223], v[60:63]
ds_read_b64_tr_b16 a[244:245], v153 offset:57344
v_cvt_pk_bf16_f32 v84, v24, v25
v_mfma_f32_16x16x32_bf16 v[68:71], a[208:211], v[224:227], v[120:123]
v_exp_f32 v28, v28
v_mfma_f32_16x16x32_bf16 v[68:71], a[212:215], v[228:231], v[68:71]
ds_read_b64_tr_b16 a[246:247], v153 offset:61440
v_add_f32 v164, v164, v26
v_mfma_f32_16x16x32_bf16 v[68:71], a[216:219], v[232:235], v[68:71]
v_exp_f32 v29, v29
v_mfma_f32_16x16x32_bf16 v[68:71], a[220:223], v[236:239], v[68:71]
ds_read_b64_tr_b16 a[248:249], v154 offset:57344
v_add_f32 v165, v165, v27
v_mfma_f32_16x16x32_bf16 v[76:79], a[208:211], v[240:243], v[124:127]
v_exp_f32 v30, v30
v_mfma_f32_16x16x32_bf16 v[76:79], a[212:215], v[244:247], v[76:79]
ds_read_b64_tr_b16 a[250:251], v154 offset:61440
v_cvt_pk_bf16_f32 v85, v26, v27
v_mfma_f32_16x16x32_bf16 v[76:79], a[216:219], v[248:251], v[76:79]
v_exp_f32 v31, v31
v_mfma_f32_16x16x32_bf16 v[76:79], a[220:223], v[252:255], v[76:79]
s_waitcnt lgkmcnt(3)
buffer_load_dwordx4 v157, s[16:19], s34 offen offset:1024 nt lds
v_mfma_f32_16x16x32_bf16 a[0:3], v[96:99], a[224:227], a[0:3]
v_exp_f32 v32, v32
v_mfma_f32_16x16x32_bf16 a[4:7], v[100:103], a[224:227], a[4:7]
ds_read_b64_tr_b16 a[252:253], v155 offset:57344
v_add_f32 v164, v164, v28
v_mfma_f32_16x16x32_bf16 a[8:11], v[104:107], a[224:227], a[8:11]
v_exp_f32 v33, v33
v_mfma_f32_16x16x32_bf16 a[12:15], v[108:111], a[224:227], a[12:15]
ds_read_b64_tr_b16 a[254:255], v155 offset:61440
v_add_f32 v165, v165, v29
v_mfma_f32_16x16x32_bf16 a[16:19], v[96:99], a[228:231], a[16:19]
v_exp_f32 v34, v34
v_mfma_f32_16x16x32_bf16 a[20:23], v[100:103], a[228:231], a[20:23]
ds_read_b128 a[192:195], v144 offset:16384
v_cvt_pk_bf16_f32 v86, v28, v29
v_mfma_f32_16x16x32_bf16 a[24:27], v[104:107], a[228:231], a[24:27]
v_exp_f32 v35, v35
v_mfma_f32_16x16x32_bf16 a[28:31], v[108:111], a[228:231], a[28:31]
buffer_load_dwordx4 v158, s[16:19], s34 offen offset:2048 nt lds
v_mfma_f32_16x16x32_bf16 a[32:35], v[96:99], a[232:235], a[32:35]
v_exp_f32 v36, v36
v_mfma_f32_16x16x32_bf16 a[36:39], v[100:103], a[232:235], a[36:39]
ds_read_b128 a[196:199], v145 offset:16384
v_add_f32 v164, v164, v30
v_mfma_f32_16x16x32_bf16 a[40:43], v[104:107], a[232:235], a[40:43]
v_exp_f32 v37, v37
v_mfma_f32_16x16x32_bf16 a[44:47], v[108:111], a[232:235], a[44:47]
ds_read_b128 a[200:203], v146 offset:16384
v_add_f32 v165, v165, v31
v_mfma_f32_16x16x32_bf16 a[48:51], v[96:99], a[236:239], a[48:51]
v_exp_f32 v38, v38
v_mfma_f32_16x16x32_bf16 a[52:55], v[100:103], a[236:239], a[52:55]
ds_read_b128 a[204:207], v147 offset:16384
v_cvt_pk_bf16_f32 v87, v30, v31
v_mfma_f32_16x16x32_bf16 a[56:59], v[104:107], a[236:239], a[56:59]
v_exp_f32 v39, v39
v_mfma_f32_16x16x32_bf16 a[60:63], v[108:111], a[236:239], a[60:63]
ds_read_b128 a[208:211], v144 offset:20480
v_cvt_pk_bf16_f32 v88, v32, v33
v_mfma_f32_16x16x32_bf16 a[64:67], v[96:99], a[240:243], a[64:67]
v_exp_f32 v40, v40
v_mfma_f32_16x16x32_bf16 a[68:71], v[100:103], a[240:243], a[68:71]
buffer_load_dwordx4 v159, s[16:19], s34 offen offset:3072 nt lds
v_mfma_f32_16x16x32_bf16 a[72:75], v[104:107], a[240:243], a[72:75]
v_exp_f32 v41, v41
v_mfma_f32_16x16x32_bf16 a[76:79], v[108:111], a[240:243], a[76:79]
s_waitcnt lgkmcnt(2)
ds_read_b128 a[212:215], v145 offset:20480
v_cvt_pk_bf16_f32 v89, v34, v35
v_mfma_f32_16x16x32_bf16 a[80:83], v[96:99], a[244:247], a[80:83]
v_exp_f32 v42, v42
v_mfma_f32_16x16x32_bf16 a[84:87], v[100:103], a[244:247], a[84:87]
ds_read_b128 a[216:219], v146 offset:20480
v_cvt_pk_bf16_f32 v90, v36, v37
v_mfma_f32_16x16x32_bf16 a[88:91], v[104:107], a[244:247], a[88:91]
v_exp_f32 v43, v43
v_mfma_f32_16x16x32_bf16 a[92:95], v[108:111], a[244:247], a[92:95]
ds_read_b128 a[220:223], v147 offset:20480
v_cvt_pk_bf16_f32 v91, v38, v39
v_mfma_f32_16x16x32_bf16 a[96:99], v[96:99], a[248:251], a[96:99]
v_exp_f32 v44, v44
v_mfma_f32_16x16x32_bf16 a[100:103], v[100:103], a[248:251], a[100:103]
v_add_f32 v168, v168, v40
v_add_f32 v169, v169, v41
v_mfma_f32_16x16x32_bf16 a[104:107], v[104:107], a[248:251], a[104:107]
v_exp_f32 v45, v45
v_mfma_f32_16x16x32_bf16 a[108:111], v[108:111], a[248:251], a[108:111]
v_cvt_pk_bf16_f32 v92, v40, v41
v_add_f32 v168, v168, v42
v_mfma_f32_16x16x32_bf16 a[112:115], v[96:99], a[252:255], a[112:115]
v_exp_f32 v46, v46
v_mfma_f32_16x16x32_bf16 a[116:119], v[100:103], a[252:255], a[116:119]
v_add_f32 v169, v169, v43
v_cvt_pk_bf16_f32 v93, v42, v43
v_mfma_f32_16x16x32_bf16 a[120:123], v[104:107], a[252:255], a[120:123]
v_exp_f32 v47, v47
v_mfma_f32_16x16x32_bf16 a[124:127], v[108:111], a[252:255], a[124:127]
v_add_f32 v168, v168, v44
v_add_f32 v169, v169, v45
v_mfma_f32_16x16x32_bf16 v[176:179], v[96:99], v[172:175], v[176:179]
v_cvt_pk_bf16_f32 v94, v44, v45
v_add_f32 v168, v168, v46
v_mfma_f32_16x16x32_bf16 v[184:187], v[104:107], v[172:175], v[184:187]
v_add_f32 v169, v169, v47
v_cvt_pk_bf16_f32 v95, v46, v47
v_mfma_f32_16x16x32_bf16 v[16:19], a[192:195], v[192:195], v[112:115]
v_exp_f32 v48, v48
v_mfma_f32_16x16x32_bf16 v[16:19], a[196:199], v[196:199], v[16:19]
ds_read_b64_tr_b16 a[224:225], v148 offset:0
ds_read_b64_tr_b16 a[226:227], v148 offset:4096
v_mfma_f32_16x16x32_bf16 v[16:19], a[200:203], v[200:203], v[16:19]
s_waitcnt lgkmcnt(2)
s_add_u32 m0, s30, 4096
v_exp_f32 v49, v49
v_mfma_f32_16x16x32_bf16 v[16:19], a[204:207], v[204:207], v[16:19]
buffer_load_dwordx4 v156, s[16:19], s35 offen offset:0 nt lds
v_mfma_f32_16x16x32_bf16 v[24:27], a[192:195], v[208:211], v[116:119]
v_exp_f32 v50, v50
v_mfma_f32_16x16x32_bf16 v[24:27], a[196:199], v[212:215], v[24:27]
ds_read_b64_tr_b16 a[228:229], v149 offset:0
v_cvt_pk_bf16_f32 v96, v48, v49
v_mfma_f32_16x16x32_bf16 v[24:27], a[200:203], v[216:219], v[24:27]
v_exp_f32 v51, v51
v_mfma_f32_16x16x32_bf16 v[24:27], a[204:207], v[220:223], v[24:27]
ds_read_b64_tr_b16 a[230:231], v149 offset:4096
v_cvt_pk_bf16_f32 v97, v50, v51
v_mfma_f32_16x16x32_bf16 v[32:35], a[192:195], v[224:227], v[120:123]
v_exp_f32 v52, v52
v_mfma_f32_16x16x32_bf16 v[32:35], a[196:199], v[228:231], v[32:35]
ds_read_b64_tr_b16 a[232:233], v150 offset:0
ds_read_b64_tr_b16 a[234:235], v150 offset:4096
v_mfma_f32_16x16x32_bf16 v[32:35], a[200:203], v[232:235], v[32:35]
v_exp_f32 v53, v53
v_mfma_f32_16x16x32_bf16 v[32:35], a[204:207], v[236:239], v[32:35]
ds_read_b64_tr_b16 a[236:237], v151 offset:0
v_cvt_pk_bf16_f32 v98, v52, v53
v_mfma_f32_16x16x32_bf16 v[40:43], a[192:195], v[240:243], v[124:127]
v_exp_f32 v54, v54
v_mfma_f32_16x16x32_bf16 v[40:43], a[196:199], v[244:247], v[40:43]
buffer_load_dwordx4 v157, s[16:19], s35 offen offset:1024 nt lds
v_mfma_f32_16x16x32_bf16 v[40:43], a[200:203], v[248:251], v[40:43]
v_exp_f32 v55, v55
v_mfma_f32_16x16x32_bf16 v[40:43], a[204:207], v[252:255], v[40:43]
ds_read_b64_tr_b16 a[238:239], v151 offset:4096
v_cvt_pk_bf16_f32 v99, v54, v55
v_mfma_f32_16x16x32_bf16 v[20:23], a[208:211], v[192:195], v[112:115]
v_exp_f32 v56, v56
v_mfma_f32_16x16x32_bf16 v[20:23], a[212:215], v[196:199], v[20:23]
ds_read_b64_tr_b16 a[240:241], v152 offset:0
v_add_f32 v164, v164, v56
v_mfma_f32_16x16x32_bf16 v[20:23], a[216:219], v[200:203], v[20:23]
v_exp_f32 v57, v57
v_mfma_f32_16x16x32_bf16 v[20:23], a[220:223], v[204:207], v[20:23]
ds_read_b64_tr_b16 a[242:243], v152 offset:4096
v_add_f32 v165, v165, v57
v_mfma_f32_16x16x32_bf16 v[28:31], a[208:211], v[208:211], v[116:119]
v_exp_f32 v58, v58
v_mfma_f32_16x16x32_bf16 v[28:31], a[212:215], v[212:215], v[28:31]
buffer_load_dwordx4 v158, s[16:19], s35 offen offset:2048 nt lds
v_mfma_f32_16x16x32_bf16 v[28:31], a[216:219], v[216:219], v[28:31]
v_exp_f32 v59, v59
v_mfma_f32_16x16x32_bf16 v[28:31], a[220:223], v[220:223], v[28:31]
ds_read_b64_tr_b16 a[244:245], v153 offset:0
v_cvt_pk_bf16_f32 v100, v56, v57
v_mfma_f32_16x16x32_bf16 v[36:39], a[208:211], v[224:227], v[120:123]
v_exp_f32 v60, v60
v_mfma_f32_16x16x32_bf16 v[36:39], a[212:215], v[228:231], v[36:39]
ds_read_b64_tr_b16 a[246:247], v153 offset:4096
v_add_f32 v164, v164, v58
v_mfma_f32_16x16x32_bf16 v[36:39], a[216:219], v[232:235], v[36:39]
v_exp_f32 v61, v61
v_mfma_f32_16x16x32_bf16 v[36:39], a[220:223], v[236:239], v[36:39]
ds_read_b64_tr_b16 a[248:249], v154 offset:0
v_add_f32 v165, v165, v59
v_mfma_f32_16x16x32_bf16 v[44:47], a[208:211], v[240:243], v[124:127]
v_exp_f32 v62, v62
v_mfma_f32_16x16x32_bf16 v[44:47], a[212:215], v[244:247], v[44:47]
ds_read_b64_tr_b16 a[250:251], v154 offset:4096
v_cvt_pk_bf16_f32 v101, v58, v59
v_mfma_f32_16x16x32_bf16 v[44:47], a[216:219], v[248:251], v[44:47]
v_exp_f32 v63, v63
v_mfma_f32_16x16x32_bf16 v[44:47], a[220:223], v[252:255], v[44:47]
s_waitcnt lgkmcnt(3)
buffer_load_dwordx4 v159, s[16:19], s35 offen offset:3072 nt lds
v_mfma_f32_16x16x32_bf16 a[0:3], v[80:83], a[224:227], a[0:3]
v_exp_f32 v64, v64
v_mfma_f32_16x16x32_bf16 a[4:7], v[84:87], a[224:227], a[4:7]
ds_read_b64_tr_b16 a[252:253], v155 offset:0
v_add_f32 v164, v164, v60
v_mfma_f32_16x16x32_bf16 a[8:11], v[88:91], a[224:227], a[8:11]
v_exp_f32 v65, v65
v_mfma_f32_16x16x32_bf16 a[12:15], v[92:95], a[224:227], a[12:15]
ds_read_b64_tr_b16 a[254:255], v155 offset:4096
v_add_f32 v165, v165, v61
v_mfma_f32_16x16x32_bf16 a[16:19], v[80:83], a[228:231], a[16:19]
v_exp_f32 v66, v66
v_mfma_f32_16x16x32_bf16 a[20:23], v[84:87], a[228:231], a[20:23]
ds_read_b128 a[192:195], v144 offset:24576
v_cvt_pk_bf16_f32 v102, v60, v61
v_mfma_f32_16x16x32_bf16 a[24:27], v[88:91], a[228:231], a[24:27]
s_mov_b32 m0, s32
v_exp_f32 v67, v67
v_mfma_f32_16x16x32_bf16 a[28:31], v[92:95], a[228:231], a[28:31]
buffer_load_dwordx4 v160, s[12:15], s36 offen offset:0 nt lds
v_mfma_f32_16x16x32_bf16 a[32:35], v[80:83], a[232:235], a[32:35]
v_exp_f32 v68, v68
v_mfma_f32_16x16x32_bf16 a[36:39], v[84:87], a[232:235], a[36:39]
ds_read_b128 a[196:199], v145 offset:24576
v_add_f32 v164, v164, v62
v_mfma_f32_16x16x32_bf16 a[40:43], v[88:91], a[232:235], a[40:43]
v_exp_f32 v69, v69
v_mfma_f32_16x16x32_bf16 a[44:47], v[92:95], a[232:235], a[44:47]
ds_read_b128 a[200:203], v146 offset:24576
v_add_f32 v165, v165, v63
v_mfma_f32_16x16x32_bf16 a[48:51], v[80:83], a[236:239], a[48:51]
v_exp_f32 v70, v70
v_mfma_f32_16x16x32_bf16 a[52:55], v[84:87], a[236:239], a[52:55]
ds_read_b128 a[204:207], v147 offset:24576
v_cvt_pk_bf16_f32 v103, v62, v63
v_mfma_f32_16x16x32_bf16 a[56:59], v[88:91], a[236:239], a[56:59]
v_exp_f32 v71, v71
v_mfma_f32_16x16x32_bf16 a[60:63], v[92:95], a[236:239], a[60:63]
ds_read_b128 a[208:211], v144 offset:28672
v_cvt_pk_bf16_f32 v104, v64, v65
v_mfma_f32_16x16x32_bf16 a[64:67], v[80:83], a[240:243], a[64:67]
v_exp_f32 v72, v72
v_mfma_f32_16x16x32_bf16 a[68:71], v[84:87], a[240:243], a[68:71]
buffer_load_dwordx4 v161, s[12:15], s36 offen offset:1024 nt lds
v_mfma_f32_16x16x32_bf16 a[72:75], v[88:91], a[240:243], a[72:75]
v_exp_f32 v73, v73
v_mfma_f32_16x16x32_bf16 a[76:79], v[92:95], a[240:243], a[76:79]
s_waitcnt lgkmcnt(2)
ds_read_b128 a[212:215], v145 offset:28672
v_cvt_pk_bf16_f32 v105, v66, v67
v_mfma_f32_16x16x32_bf16 a[80:83], v[80:83], a[244:247], a[80:83]
v_exp_f32 v74, v74
v_mfma_f32_16x16x32_bf16 a[84:87], v[84:87], a[244:247], a[84:87]
ds_read_b128 a[216:219], v146 offset:28672
v_cvt_pk_bf16_f32 v106, v68, v69
v_mfma_f32_16x16x32_bf16 a[88:91], v[88:91], a[244:247], a[88:91]
v_exp_f32 v75, v75
v_mfma_f32_16x16x32_bf16 a[92:95], v[92:95], a[244:247], a[92:95]
ds_read_b128 a[220:223], v147 offset:28672
v_cvt_pk_bf16_f32 v107, v70, v71
v_mfma_f32_16x16x32_bf16 a[96:99], v[80:83], a[248:251], a[96:99]
v_exp_f32 v76, v76
v_mfma_f32_16x16x32_bf16 a[100:103], v[84:87], a[248:251], a[100:103]
v_add_f32 v168, v168, v72
v_add_f32 v169, v169, v73
v_mfma_f32_16x16x32_bf16 a[104:107], v[88:91], a[248:251], a[104:107]
v_exp_f32 v77, v77
v_mfma_f32_16x16x32_bf16 a[108:111], v[92:95], a[248:251], a[108:111]
v_cvt_pk_bf16_f32 v108, v72, v73
v_add_f32 v168, v168, v74
v_mfma_f32_16x16x32_bf16 a[112:115], v[80:83], a[252:255], a[112:115]
v_exp_f32 v78, v78
v_mfma_f32_16x16x32_bf16 a[116:119], v[84:87], a[252:255], a[116:119]
v_add_f32 v169, v169, v75
v_cvt_pk_bf16_f32 v109, v74, v75
v_mfma_f32_16x16x32_bf16 a[120:123], v[88:91], a[252:255], a[120:123]
v_exp_f32 v79, v79
v_mfma_f32_16x16x32_bf16 a[124:127], v[92:95], a[252:255], a[124:127]
v_add_f32 v168, v168, v76
v_add_f32 v169, v169, v77
v_mfma_f32_16x16x32_bf16 v[176:179], v[80:83], v[172:175], v[176:179]
v_cvt_pk_bf16_f32 v110, v76, v77
v_add_f32 v168, v168, v78
v_mfma_f32_16x16x32_bf16 v[184:187], v[88:91], v[172:175], v[184:187]
v_add_f32 v169, v169, v79
v_cvt_pk_bf16_f32 v111, v78, v79
v_mfma_f32_16x16x32_bf16 v[48:51], a[192:195], v[192:195], v[112:115]
v_exp_f32 v16, v16
v_mfma_f32_16x16x32_bf16 v[48:51], a[196:199], v[196:199], v[48:51]
ds_read_b64_tr_b16 a[224:225], v148 offset:8192
ds_read_b64_tr_b16 a[226:227], v148 offset:12288
v_mfma_f32_16x16x32_bf16 v[48:51], a[200:203], v[200:203], v[48:51]
s_waitcnt lgkmcnt(2)
v_exp_f32 v17, v17
v_mfma_f32_16x16x32_bf16 v[48:51], a[204:207], v[204:207], v[48:51]
buffer_load_dwordx4 v160, s[12:15], s36 offen offset:2048 nt lds
v_mfma_f32_16x16x32_bf16 v[56:59], a[192:195], v[208:211], v[116:119]
v_exp_f32 v18, v18
v_mfma_f32_16x16x32_bf16 v[56:59], a[196:199], v[212:215], v[56:59]
ds_read_b64_tr_b16 a[228:229], v149 offset:8192
v_cvt_pk_bf16_f32 v80, v16, v17
v_mfma_f32_16x16x32_bf16 v[56:59], a[200:203], v[216:219], v[56:59]
v_exp_f32 v19, v19
v_mfma_f32_16x16x32_bf16 v[56:59], a[204:207], v[220:223], v[56:59]
ds_read_b64_tr_b16 a[230:231], v149 offset:12288
v_cvt_pk_bf16_f32 v81, v18, v19
v_mfma_f32_16x16x32_bf16 v[64:67], a[192:195], v[224:227], v[120:123]
v_exp_f32 v20, v20
v_mfma_f32_16x16x32_bf16 v[64:67], a[196:199], v[228:231], v[64:67]
ds_read_b64_tr_b16 a[232:233], v150 offset:8192
ds_read_b64_tr_b16 a[234:235], v150 offset:12288
v_mfma_f32_16x16x32_bf16 v[64:67], a[200:203], v[232:235], v[64:67]
v_exp_f32 v21, v21
v_mfma_f32_16x16x32_bf16 v[64:67], a[204:207], v[236:239], v[64:67]
ds_read_b64_tr_b16 a[236:237], v151 offset:8192
v_cvt_pk_bf16_f32 v82, v20, v21
v_mfma_f32_16x16x32_bf16 v[72:75], a[192:195], v[240:243], v[124:127]
v_exp_f32 v22, v22
v_mfma_f32_16x16x32_bf16 v[72:75], a[196:199], v[244:247], v[72:75]
buffer_load_dwordx4 v161, s[12:15], s36 offen offset:3072 nt lds
v_mfma_f32_16x16x32_bf16 v[72:75], a[200:203], v[248:251], v[72:75]
v_exp_f32 v23, v23
v_mfma_f32_16x16x32_bf16 v[72:75], a[204:207], v[252:255], v[72:75]
ds_read_b64_tr_b16 a[238:239], v151 offset:12288
v_cvt_pk_bf16_f32 v83, v22, v23
v_mfma_f32_16x16x32_bf16 v[52:55], a[208:211], v[192:195], v[112:115]
v_exp_f32 v24, v24
v_mfma_f32_16x16x32_bf16 v[52:55], a[212:215], v[196:199], v[52:55]
ds_read_b64_tr_b16 a[240:241], v152 offset:8192
v_add_f32 v164, v164, v24
v_mfma_f32_16x16x32_bf16 v[52:55], a[216:219], v[200:203], v[52:55]
v_exp_f32 v25, v25
v_mfma_f32_16x16x32_bf16 v[52:55], a[220:223], v[204:207], v[52:55]
ds_read_b64_tr_b16 a[242:243], v152 offset:12288
v_add_f32 v165, v165, v25
v_mfma_f32_16x16x32_bf16 v[60:63], a[208:211], v[208:211], v[116:119]
s_add_u32 m0, s32, 4096
v_exp_f32 v26, v26
v_mfma_f32_16x16x32_bf16 v[60:63], a[212:215], v[212:215], v[60:63]
buffer_load_dwordx4 v160, s[12:15], s37 offen offset:0 nt lds
v_mfma_f32_16x16x32_bf16 v[60:63], a[216:219], v[216:219], v[60:63]
v_exp_f32 v27, v27
v_mfma_f32_16x16x32_bf16 v[60:63], a[220:223], v[220:223], v[60:63]
ds_read_b64_tr_b16 a[244:245], v153 offset:8192
v_cvt_pk_bf16_f32 v84, v24, v25
v_mfma_f32_16x16x32_bf16 v[68:71], a[208:211], v[224:227], v[120:123]
v_exp_f32 v28, v28
v_mfma_f32_16x16x32_bf16 v[68:71], a[212:215], v[228:231], v[68:71]
ds_read_b64_tr_b16 a[246:247], v153 offset:12288
v_add_f32 v164, v164, v26
v_mfma_f32_16x16x32_bf16 v[68:71], a[216:219], v[232:235], v[68:71]
v_exp_f32 v29, v29
v_mfma_f32_16x16x32_bf16 v[68:71], a[220:223], v[236:239], v[68:71]
ds_read_b64_tr_b16 a[248:249], v154 offset:8192
v_add_f32 v165, v165, v27
v_mfma_f32_16x16x32_bf16 v[76:79], a[208:211], v[240:243], v[124:127]
v_exp_f32 v30, v30
v_mfma_f32_16x16x32_bf16 v[76:79], a[212:215], v[244:247], v[76:79]
ds_read_b64_tr_b16 a[250:251], v154 offset:12288
v_cvt_pk_bf16_f32 v85, v26, v27
v_mfma_f32_16x16x32_bf16 v[76:79], a[216:219], v[248:251], v[76:79]
v_exp_f32 v31, v31
v_mfma_f32_16x16x32_bf16 v[76:79], a[220:223], v[252:255], v[76:79]
s_waitcnt lgkmcnt(3)
buffer_load_dwordx4 v161, s[12:15], s37 offen offset:1024 nt lds
v_mfma_f32_16x16x32_bf16 a[0:3], v[96:99], a[224:227], a[0:3]
v_exp_f32 v32, v32
v_mfma_f32_16x16x32_bf16 a[4:7], v[100:103], a[224:227], a[4:7]
ds_read_b64_tr_b16 a[252:253], v155 offset:8192
v_add_f32 v164, v164, v28
v_mfma_f32_16x16x32_bf16 a[8:11], v[104:107], a[224:227], a[8:11]
v_exp_f32 v33, v33
v_mfma_f32_16x16x32_bf16 a[12:15], v[108:111], a[224:227], a[12:15]
ds_read_b64_tr_b16 a[254:255], v155 offset:12288
v_add_f32 v165, v165, v29
v_mfma_f32_16x16x32_bf16 a[16:19], v[96:99], a[228:231], a[16:19]
v_exp_f32 v34, v34
v_mfma_f32_16x16x32_bf16 a[20:23], v[100:103], a[228:231], a[20:23]
ds_read_b128 a[192:195], v144 offset:32768
v_cvt_pk_bf16_f32 v86, v28, v29
v_mfma_f32_16x16x32_bf16 a[24:27], v[104:107], a[228:231], a[24:27]
v_exp_f32 v35, v35
v_mfma_f32_16x16x32_bf16 a[28:31], v[108:111], a[228:231], a[28:31]
buffer_load_dwordx4 v160, s[12:15], s37 offen offset:2048 nt lds
v_mfma_f32_16x16x32_bf16 a[32:35], v[96:99], a[232:235], a[32:35]
v_exp_f32 v36, v36
v_mfma_f32_16x16x32_bf16 a[36:39], v[100:103], a[232:235], a[36:39]
ds_read_b128 a[196:199], v145 offset:32768
v_add_f32 v164, v164, v30
v_mfma_f32_16x16x32_bf16 a[40:43], v[104:107], a[232:235], a[40:43]
v_exp_f32 v37, v37
v_mfma_f32_16x16x32_bf16 a[44:47], v[108:111], a[232:235], a[44:47]
ds_read_b128 a[200:203], v146 offset:32768
v_add_f32 v165, v165, v31
v_mfma_f32_16x16x32_bf16 a[48:51], v[96:99], a[236:239], a[48:51]
v_exp_f32 v38, v38
v_mfma_f32_16x16x32_bf16 a[52:55], v[100:103], a[236:239], a[52:55]
ds_read_b128 a[204:207], v147 offset:32768
v_cvt_pk_bf16_f32 v87, v30, v31
v_mfma_f32_16x16x32_bf16 a[56:59], v[104:107], a[236:239], a[56:59]
v_exp_f32 v39, v39
v_mfma_f32_16x16x32_bf16 a[60:63], v[108:111], a[236:239], a[60:63]
ds_read_b128 a[208:211], v144 offset:36864
v_cvt_pk_bf16_f32 v88, v32, v33
v_mfma_f32_16x16x32_bf16 a[64:67], v[96:99], a[240:243], a[64:67]
v_exp_f32 v40, v40
v_mfma_f32_16x16x32_bf16 a[68:71], v[100:103], a[240:243], a[68:71]
buffer_load_dwordx4 v161, s[12:15], s37 offen offset:3072 nt lds
v_mfma_f32_16x16x32_bf16 a[72:75], v[104:107], a[240:243], a[72:75]
v_exp_f32 v41, v41
v_mfma_f32_16x16x32_bf16 a[76:79], v[108:111], a[240:243], a[76:79]
s_waitcnt lgkmcnt(2)
ds_read_b128 a[212:215], v145 offset:36864
v_cvt_pk_bf16_f32 v89, v34, v35
v_mfma_f32_16x16x32_bf16 a[80:83], v[96:99], a[244:247], a[80:83]
v_exp_f32 v42, v42
v_mfma_f32_16x16x32_bf16 a[84:87], v[100:103], a[244:247], a[84:87]
ds_read_b128 a[216:219], v146 offset:36864
v_cvt_pk_bf16_f32 v90, v36, v37
v_mfma_f32_16x16x32_bf16 a[88:91], v[104:107], a[244:247], a[88:91]
v_exp_f32 v43, v43
v_mfma_f32_16x16x32_bf16 a[92:95], v[108:111], a[244:247], a[92:95]
ds_read_b128 a[220:223], v147 offset:36864
v_cvt_pk_bf16_f32 v91, v38, v39
v_mfma_f32_16x16x32_bf16 a[96:99], v[96:99], a[248:251], a[96:99]
v_exp_f32 v44, v44
v_mfma_f32_16x16x32_bf16 a[100:103], v[100:103], a[248:251], a[100:103]
v_add_f32 v168, v168, v40
v_add_f32 v169, v169, v41
v_mfma_f32_16x16x32_bf16 a[104:107], v[104:107], a[248:251], a[104:107]
v_exp_f32 v45, v45
v_mfma_f32_16x16x32_bf16 a[108:111], v[108:111], a[248:251], a[108:111]
v_cvt_pk_bf16_f32 v92, v40, v41
v_add_f32 v168, v168, v42
v_mfma_f32_16x16x32_bf16 a[112:115], v[96:99], a[252:255], a[112:115]
v_exp_f32 v46, v46
v_mfma_f32_16x16x32_bf16 a[116:119], v[100:103], a[252:255], a[116:119]
v_add_f32 v169, v169, v43
v_cvt_pk_bf16_f32 v93, v42, v43
v_mfma_f32_16x16x32_bf16 a[120:123], v[104:107], a[252:255], a[120:123]
v_exp_f32 v47, v47
v_mfma_f32_16x16x32_bf16 a[124:127], v[108:111], a[252:255], a[124:127]
v_add_f32 v168, v168, v44
v_add_f32 v169, v169, v45
v_mfma_f32_16x16x32_bf16 v[176:179], v[96:99], v[172:175], v[176:179]
v_cvt_pk_bf16_f32 v94, v44, v45
v_add_f32 v168, v168, v46
v_mfma_f32_16x16x32_bf16 v[184:187], v[104:107], v[172:175], v[184:187]
v_add_f32 v169, v169, v47
v_cvt_pk_bf16_f32 v95, v46, v47
v_mfma_f32_16x16x32_bf16 v[16:19], a[192:195], v[192:195], v[112:115]
v_exp_f32 v48, v48
v_mfma_f32_16x16x32_bf16 v[16:19], a[196:199], v[196:199], v[16:19]
ds_read_b64_tr_b16 a[224:225], v148 offset:16384
ds_read_b64_tr_b16 a[226:227], v148 offset:20480
v_mfma_f32_16x16x32_bf16 v[16:19], a[200:203], v[200:203], v[16:19]
s_waitcnt lgkmcnt(2)
v_exp_f32 v49, v49
v_mfma_f32_16x16x32_bf16 v[16:19], a[204:207], v[204:207], v[16:19]
buffer_load_dword v139, v136, s[64:67], 0 offen offset:0
v_mfma_f32_16x16x32_bf16 v[24:27], a[192:195], v[208:211], v[116:119]
v_exp_f32 v50, v50
v_mfma_f32_16x16x32_bf16 v[24:27], a[196:199], v[212:215], v[24:27]
ds_read_b64_tr_b16 a[228:229], v149 offset:16384
v_cvt_pk_bf16_f32 v96, v48, v49
v_mfma_f32_16x16x32_bf16 v[24:27], a[200:203], v[216:219], v[24:27]
v_exp_f32 v51, v51
v_mfma_f32_16x16x32_bf16 v[24:27], a[204:207], v[220:223], v[24:27]
ds_read_b64_tr_b16 a[230:231], v149 offset:20480
v_cvt_pk_bf16_f32 v97, v50, v51
v_mfma_f32_16x16x32_bf16 v[32:35], a[192:195], v[224:227], v[120:123]
v_exp_f32 v52, v52
v_mfma_f32_16x16x32_bf16 v[32:35], a[196:199], v[228:231], v[32:35]
ds_read_b64_tr_b16 a[232:233], v150 offset:16384
ds_read_b64_tr_b16 a[234:235], v150 offset:20480
v_mfma_f32_16x16x32_bf16 v[32:35], a[200:203], v[232:235], v[32:35]
v_exp_f32 v53, v53
v_mfma_f32_16x16x32_bf16 v[32:35], a[204:207], v[236:239], v[32:35]
ds_read_b64_tr_b16 a[236:237], v151 offset:16384
v_cvt_pk_bf16_f32 v98, v52, v53
v_mfma_f32_16x16x32_bf16 v[40:43], a[192:195], v[240:243], v[124:127]
v_exp_f32 v54, v54
v_mfma_f32_16x16x32_bf16 v[40:43], a[196:199], v[244:247], v[40:43]
buffer_load_dword v139, v136, s[64:67], 0 offen offset:64
v_mfma_f32_16x16x32_bf16 v[40:43], a[200:203], v[248:251], v[40:43]
v_exp_f32 v55, v55
v_mfma_f32_16x16x32_bf16 v[40:43], a[204:207], v[252:255], v[40:43]
ds_read_b64_tr_b16 a[238:239], v151 offset:20480
v_cvt_pk_bf16_f32 v99, v54, v55
v_mfma_f32_16x16x32_bf16 v[20:23], a[208:211], v[192:195], v[112:115]
v_exp_f32 v56, v56
v_mfma_f32_16x16x32_bf16 v[20:23], a[212:215], v[196:199], v[20:23]
ds_read_b64_tr_b16 a[240:241], v152 offset:16384
v_add_f32 v164, v164, v56
v_mfma_f32_16x16x32_bf16 v[20:23], a[216:219], v[200:203], v[20:23]
v_exp_f32 v57, v57
v_mfma_f32_16x16x32_bf16 v[20:23], a[220:223], v[204:207], v[20:23]
ds_read_b64_tr_b16 a[242:243], v152 offset:20480
v_add_f32 v165, v165, v57
v_mfma_f32_16x16x32_bf16 v[28:31], a[208:211], v[208:211], v[116:119]
v_exp_f32 v58, v58
v_mfma_f32_16x16x32_bf16 v[28:31], a[212:215], v[212:215], v[28:31]
buffer_load_dword v139, v137, s[68:71], 0 offen offset:0
v_mfma_f32_16x16x32_bf16 v[28:31], a[216:219], v[216:219], v[28:31]
v_exp_f32 v59, v59
v_mfma_f32_16x16x32_bf16 v[28:31], a[220:223], v[220:223], v[28:31]
ds_read_b64_tr_b16 a[244:245], v153 offset:16384
v_cvt_pk_bf16_f32 v100, v56, v57
v_mfma_f32_16x16x32_bf16 v[36:39], a[208:211], v[224:227], v[120:123]
v_exp_f32 v60, v60
v_mfma_f32_16x16x32_bf16 v[36:39], a[212:215], v[228:231], v[36:39]
ds_read_b64_tr_b16 a[246:247], v153 offset:20480
v_add_f32 v164, v164, v58
v_mfma_f32_16x16x32_bf16 v[36:39], a[216:219], v[232:235], v[36:39]
v_exp_f32 v61, v61
v_mfma_f32_16x16x32_bf16 v[36:39], a[220:223], v[236:239], v[36:39]
ds_read_b64_tr_b16 a[248:249], v154 offset:16384
v_add_f32 v165, v165, v59
v_mfma_f32_16x16x32_bf16 v[44:47], a[208:211], v[240:243], v[124:127]
v_exp_f32 v62, v62
v_mfma_f32_16x16x32_bf16 v[44:47], a[212:215], v[244:247], v[44:47]
ds_read_b64_tr_b16 a[250:251], v154 offset:20480
v_cvt_pk_bf16_f32 v101, v58, v59
v_mfma_f32_16x16x32_bf16 v[44:47], a[216:219], v[248:251], v[44:47]
v_exp_f32 v63, v63
v_mfma_f32_16x16x32_bf16 v[44:47], a[220:223], v[252:255], v[44:47]
s_waitcnt lgkmcnt(3)
buffer_load_dword v139, v137, s[72:75], 0 offen offset:0
v_mfma_f32_16x16x32_bf16 a[0:3], v[80:83], a[224:227], a[0:3]
v_exp_f32 v64, v64
v_mfma_f32_16x16x32_bf16 a[4:7], v[84:87], a[224:227], a[4:7]
ds_read_b64_tr_b16 a[252:253], v155 offset:16384
v_add_f32 v164, v164, v60
v_mfma_f32_16x16x32_bf16 a[8:11], v[88:91], a[224:227], a[8:11]
v_exp_f32 v65, v65
v_mfma_f32_16x16x32_bf16 a[12:15], v[92:95], a[224:227], a[12:15]
ds_read_b64_tr_b16 a[254:255], v155 offset:20480
v_add_f32 v165, v165, v61
v_mfma_f32_16x16x32_bf16 a[16:19], v[80:83], a[228:231], a[16:19]
v_exp_f32 v66, v66
v_mfma_f32_16x16x32_bf16 a[20:23], v[84:87], a[228:231], a[20:23]
ds_read_b128 a[192:195], v144 offset:40960
v_cvt_pk_bf16_f32 v102, v60, v61
v_mfma_f32_16x16x32_bf16 a[24:27], v[88:91], a[228:231], a[24:27]
v_exp_f32 v67, v67
v_mfma_f32_16x16x32_bf16 a[28:31], v[92:95], a[228:231], a[28:31]
buffer_load_dword v139, v138, s[76:79], 0 offen offset:0
v_mfma_f32_16x16x32_bf16 a[32:35], v[80:83], a[232:235], a[32:35]
v_exp_f32 v68, v68
v_mfma_f32_16x16x32_bf16 a[36:39], v[84:87], a[232:235], a[36:39]
ds_read_b128 a[196:199], v145 offset:40960
v_add_f32 v164, v164, v62
v_mfma_f32_16x16x32_bf16 a[40:43], v[88:91], a[232:235], a[40:43]
v_exp_f32 v69, v69
v_mfma_f32_16x16x32_bf16 a[44:47], v[92:95], a[232:235], a[44:47]
ds_read_b128 a[200:203], v146 offset:40960
v_add_f32 v165, v165, v63
v_mfma_f32_16x16x32_bf16 a[48:51], v[80:83], a[236:239], a[48:51]
v_exp_f32 v70, v70
v_mfma_f32_16x16x32_bf16 a[52:55], v[84:87], a[236:239], a[52:55]
ds_read_b128 a[204:207], v147 offset:40960
v_cvt_pk_bf16_f32 v103, v62, v63
v_mfma_f32_16x16x32_bf16 a[56:59], v[88:91], a[236:239], a[56:59]
v_exp_f32 v71, v71
v_mfma_f32_16x16x32_bf16 a[60:63], v[92:95], a[236:239], a[60:63]
ds_read_b128 a[208:211], v144 offset:45056
v_cvt_pk_bf16_f32 v104, v64, v65
v_mfma_f32_16x16x32_bf16 a[64:67], v[80:83], a[240:243], a[64:67]
v_exp_f32 v72, v72
v_mfma_f32_16x16x32_bf16 a[68:71], v[84:87], a[240:243], a[68:71]
buffer_load_dword v139, v138, s[76:79], 0 offen offset:64
v_mfma_f32_16x16x32_bf16 a[72:75], v[88:91], a[240:243], a[72:75]
v_exp_f32 v73, v73
v_mfma_f32_16x16x32_bf16 a[76:79], v[92:95], a[240:243], a[76:79]
s_waitcnt lgkmcnt(2)
ds_read_b128 a[212:215], v145 offset:45056
v_cvt_pk_bf16_f32 v105, v66, v67
v_mfma_f32_16x16x32_bf16 a[80:83], v[80:83], a[244:247], a[80:83]
v_exp_f32 v74, v74
v_mfma_f32_16x16x32_bf16 a[84:87], v[84:87], a[244:247], a[84:87]
ds_read_b128 a[216:219], v146 offset:45056
v_cvt_pk_bf16_f32 v106, v68, v69
v_mfma_f32_16x16x32_bf16 a[88:91], v[88:91], a[244:247], a[88:91]
v_exp_f32 v75, v75
v_mfma_f32_16x16x32_bf16 a[92:95], v[92:95], a[244:247], a[92:95]
ds_read_b128 a[220:223], v147 offset:45056
v_cvt_pk_bf16_f32 v107, v70, v71
v_mfma_f32_16x16x32_bf16 a[96:99], v[80:83], a[248:251], a[96:99]
v_exp_f32 v76, v76
v_mfma_f32_16x16x32_bf16 a[100:103], v[84:87], a[248:251], a[100:103]
v_add_f32 v168, v168, v72
v_add_f32 v169, v169, v73
v_mfma_f32_16x16x32_bf16 a[104:107], v[88:91], a[248:251], a[104:107]
v_exp_f32 v77, v77
v_mfma_f32_16x16x32_bf16 a[108:111], v[92:95], a[248:251], a[108:111]
v_cvt_pk_bf16_f32 v108, v72, v73
v_add_f32 v168, v168, v74
v_mfma_f32_16x16x32_bf16 a[112:115], v[80:83], a[252:255], a[112:115]
v_exp_f32 v78, v78
v_mfma_f32_16x16x32_bf16 a[116:119], v[84:87], a[252:255], a[116:119]
v_add_f32 v169, v169, v75
v_cvt_pk_bf16_f32 v109, v74, v75
v_mfma_f32_16x16x32_bf16 a[120:123], v[88:91], a[252:255], a[120:123]
v_exp_f32 v79, v79
v_mfma_f32_16x16x32_bf16 a[124:127], v[92:95], a[252:255], a[124:127]
v_add_f32 v168, v168, v76
v_add_f32 v169, v169, v77
v_mfma_f32_16x16x32_bf16 v[176:179], v[80:83], v[172:175], v[176:179]
v_cvt_pk_bf16_f32 v110, v76, v77
v_add_f32 v168, v168, v78
v_mfma_f32_16x16x32_bf16 v[184:187], v[88:91], v[172:175], v[184:187]
v_add_f32 v169, v169, v79
v_cvt_pk_bf16_f32 v111, v78, v79
s_waitcnt vmcnt(6) lgkmcnt(0)
s_barrier
adaLN_cond__mha_block_cached__glu_gated_bilinear__prompt_kernel_late:
s_lshr_b32 s47, s28, 1
s_and_b32 s49, s28, 1
s_lshl_b32 s50, s47, 15
s_lshl_b32 s51, s49, 12
s_add_u32 s50, s50, s51
s_bfe_u32 s51, s2, 0x20001
s_lshl_b32 s51, s51, 20
s_add_u32 s50, s50, s51
s_bfe_u32 s51, s2, 0x20003
s_lshl_b32 s51, s51, 8
s_add_u32 s50, s50, s51
s_add_u32 s16, s64, s50
s_addc_u32 s17, s65, 0
s_sub_u32 s18, 4194304, s50
s_mov_b32 s19, 0x20000
s_lshl_b32 s30, s28, 12
s_lshl_b32 s53, s2, 6
s_add_u32 s53, s53, 147456
v_mov_b32 v8, s39
v_mov_b32 v9, 0
buffer_store_dword v8, v9, s[20:23], s53 offen sc1
v_mfma_f32_16x16x32_bf16 v[48:51], a[192:195], v[192:195], v[112:115]
v_exp_f32 v16, v16
v_mfma_f32_16x16x32_bf16 v[48:51], a[196:199], v[196:199], v[48:51]
ds_read_b64_tr_b16 a[224:225], v148 offset:24576
v_add_u32 v5, 0, v4
v_mfma_f32_16x16x32_bf16 v[48:51], a[200:203], v[200:203], v[48:51]
v_exp_f32 v17, v17
v_mfma_f32_16x16x32_bf16 v[48:51], a[204:207], v[204:207], v[48:51]
ds_read_b64_tr_b16 a[226:227], v148 offset:28672
v_cvt_pk_bf16_f32 v80, v16, v17
v_mfma_f32_16x16x32_bf16 v[56:59], a[192:195], v[208:211], v[116:119]
v_exp_f32 v18, v18
v_mfma_f32_16x16x32_bf16 v[56:59], a[196:199], v[212:215], v[56:59]
ds_read_b64_tr_b16 a[228:229], v149 offset:24576
v_lshlrev_b32 v5, 1, v5
v_mfma_f32_16x16x32_bf16 v[56:59], a[200:203], v[216:219], v[56:59]
v_exp_f32 v19, v19
v_mfma_f32_16x16x32_bf16 v[56:59], a[204:207], v[220:223], v[56:59]
ds_read_b64_tr_b16 a[230:231], v149 offset:28672
v_cvt_pk_bf16_f32 v81, v18, v19
v_mfma_f32_16x16x32_bf16 v[64:67], a[192:195], v[224:227], v[120:123]
v_exp_f32 v20, v20
v_mfma_f32_16x16x32_bf16 v[64:67], a[196:199], v[228:231], v[64:67]
ds_read_b64_tr_b16 a[232:233], v150 offset:24576
v_xor_b32 v5, v5, v3
v_mfma_f32_16x16x32_bf16 v[64:67], a[200:203], v[232:235], v[64:67]
v_exp_f32 v21, v21
v_mfma_f32_16x16x32_bf16 v[64:67], a[204:207], v[236:239], v[64:67]
ds_read_b64_tr_b16 a[234:235], v150 offset:28672
v_cvt_pk_bf16_f32 v82, v20, v21
v_mfma_f32_16x16x32_bf16 v[72:75], a[192:195], v[240:243], v[124:127]
v_exp_f32 v22, v22
v_mfma_f32_16x16x32_bf16 v[72:75], a[196:199], v[244:247], v[72:75]
ds_read_b64_tr_b16 a[236:237], v151 offset:24576
v_lshlrev_b32 v5, 4, v5
v_mfma_f32_16x16x32_bf16 v[72:75], a[200:203], v[248:251], v[72:75]
v_exp_f32 v23, v23
v_mfma_f32_16x16x32_bf16 v[72:75], a[204:207], v[252:255], v[72:75]
ds_read_b64_tr_b16 a[238:239], v151 offset:28672
v_cvt_pk_bf16_f32 v83, v22, v23
v_mfma_f32_16x16x32_bf16 v[52:55], a[208:211], v[192:195], v[112:115]
v_exp_f32 v24, v24
v_mfma_f32_16x16x32_bf16 v[52:55], a[212:215], v[196:199], v[52:55]
ds_read_b64_tr_b16 a[240:241], v152 offset:24576
v_add_f32 v164, v164, v24
v_mfma_f32_16x16x32_bf16 v[52:55], a[216:219], v[200:203], v[52:55]
v_exp_f32 v25, v25
v_mfma_f32_16x16x32_bf16 v[52:55], a[220:223], v[204:207], v[52:55]
ds_read_b64_tr_b16 a[242:243], v152 offset:28672
v_lshl_add_u32 v5, v4, 10, v5
v_mfma_f32_16x16x32_bf16 v[60:63], a[208:211], v[208:211], v[116:119]
v_exp_f32 v26, v26
v_mfma_f32_16x16x32_bf16 v[60:63], a[212:215], v[212:215], v[60:63]
ds_read_b64_tr_b16 a[244:245], v153 offset:24576
v_add_f32 v165, v165, v25
v_mfma_f32_16x16x32_bf16 v[60:63], a[216:219], v[216:219], v[60:63]
v_exp_f32 v27, v27
v_mfma_f32_16x16x32_bf16 v[60:63], a[220:223], v[220:223], v[60:63]
ds_read_b64_tr_b16 a[246:247], v153 offset:28672
v_cvt_pk_bf16_f32 v84, v24, v25
v_mfma_f32_16x16x32_bf16 v[68:71], a[208:211], v[224:227], v[120:123]
v_exp_f32 v28, v28
v_mfma_f32_16x16x32_bf16 v[68:71], a[212:215], v[228:231], v[68:71]
ds_read_b64_tr_b16 a[248:249], v154 offset:24576
v_add_f32 v164, v164, v26
v_mfma_f32_16x16x32_bf16 v[68:71], a[216:219], v[232:235], v[68:71]
v_exp_f32 v29, v29
v_mfma_f32_16x16x32_bf16 v[68:71], a[220:223], v[236:239], v[68:71]
ds_read_b64_tr_b16 a[250:251], v154 offset:28672
v_add_u32 v156, 0, v5
v_mfma_f32_16x16x32_bf16 v[76:79], a[208:211], v[240:243], v[124:127]
v_exp_f32 v30, v30
v_mfma_f32_16x16x32_bf16 v[76:79], a[212:215], v[244:247], v[76:79]
ds_read_b64_tr_b16 a[252:253], v155 offset:24576
v_add_f32 v165, v165, v27
v_mfma_f32_16x16x32_bf16 v[76:79], a[216:219], v[248:251], v[76:79]
v_exp_f32 v31, v31
v_mfma_f32_16x16x32_bf16 v[76:79], a[220:223], v[252:255], v[76:79]
s_waitcnt lgkmcnt(3)
ds_read_b64_tr_b16 a[254:255], v155 offset:28672
v_cvt_pk_bf16_f32 v85, v26, v27
v_mfma_f32_16x16x32_bf16 a[0:3], v[96:99], a[224:227], a[0:3]
v_exp_f32 v32, v32
v_mfma_f32_16x16x32_bf16 a[4:7], v[100:103], a[224:227], a[4:7]
ds_read_b128 a[192:195], v144 offset:49152
v_add_f32 v164, v164, v28
v_mfma_f32_16x16x32_bf16 a[8:11], v[104:107], a[224:227], a[8:11]
v_exp_f32 v33, v33
v_mfma_f32_16x16x32_bf16 a[12:15], v[108:111], a[224:227], a[12:15]
ds_read_b128 a[196:199], v145 offset:49152
v_add_u32 v5, 4, v4
v_mfma_f32_16x16x32_bf16 a[16:19], v[96:99], a[228:231], a[16:19]
v_exp_f32 v34, v34
v_mfma_f32_16x16x32_bf16 a[20:23], v[100:103], a[228:231], a[20:23]
ds_read_b128 a[200:203], v146 offset:49152
v_add_f32 v165, v165, v29
v_mfma_f32_16x16x32_bf16 a[24:27], v[104:107], a[228:231], a[24:27]
v_exp_f32 v35, v35
v_mfma_f32_16x16x32_bf16 a[28:31], v[108:111], a[228:231], a[28:31]
ds_read_b128 a[204:207], v147 offset:49152
v_cvt_pk_bf16_f32 v86, v28, v29
v_mfma_f32_16x16x32_bf16 a[32:35], v[96:99], a[232:235], a[32:35]
v_exp_f32 v36, v36
v_mfma_f32_16x16x32_bf16 a[36:39], v[100:103], a[232:235], a[36:39]
ds_read_b128 a[208:211], v144 offset:53248
v_add_f32 v164, v164, v30
v_mfma_f32_16x16x32_bf16 a[40:43], v[104:107], a[232:235], a[40:43]
v_exp_f32 v37, v37
v_mfma_f32_16x16x32_bf16 a[44:47], v[108:111], a[232:235], a[44:47]
ds_read_b128 a[212:215], v145 offset:53248
v_lshlrev_b32 v5, 1, v5
v_mfma_f32_16x16x32_bf16 a[48:51], v[96:99], a[236:239], a[48:51]
v_exp_f32 v38, v38
v_mfma_f32_16x16x32_bf16 a[52:55], v[100:103], a[236:239], a[52:55]
ds_read_b128 a[216:219], v146 offset:53248
v_add_f32 v165, v165, v31
v_mfma_f32_16x16x32_bf16 a[56:59], v[104:107], a[236:239], a[56:59]
v_exp_f32 v39, v39
v_mfma_f32_16x16x32_bf16 a[60:63], v[108:111], a[236:239], a[60:63]
ds_read_b128 a[220:223], v147 offset:53248
v_cvt_pk_bf16_f32 v87, v30, v31
v_mfma_f32_16x16x32_bf16 a[64:67], v[96:99], a[240:243], a[64:67]
v_exp_f32 v40, v40
v_mfma_f32_16x16x32_bf16 a[68:71], v[100:103], a[240:243], a[68:71]
v_xor_b32 v5, v5, v3
v_cvt_pk_bf16_f32 v88, v32, v33
v_mfma_f32_16x16x32_bf16 a[72:75], v[104:107], a[240:243], a[72:75]
v_exp_f32 v41, v41
v_mfma_f32_16x16x32_bf16 a[76:79], v[108:111], a[240:243], a[76:79]
v_lshlrev_b32 v5, 4, v5
v_cvt_pk_bf16_f32 v89, v34, v35
v_mfma_f32_16x16x32_bf16 a[80:83], v[96:99], a[244:247], a[80:83]
v_exp_f32 v42, v42
v_mfma_f32_16x16x32_bf16 a[84:87], v[100:103], a[244:247], a[84:87]
v_lshl_add_u32 v5, v4, 10, v5
v_cvt_pk_bf16_f32 v90, v36, v37
v_mfma_f32_16x16x32_bf16 a[88:91], v[104:107], a[244:247], a[88:91]
v_exp_f32 v43, v43
v_mfma_f32_16x16x32_bf16 a[92:95], v[108:111], a[244:247], a[92:95]
s_waitcnt lgkmcnt(0)
v_add_u32 v157, 15360, v5
v_cvt_pk_bf16_f32 v91, v38, v39
v_mfma_f32_16x16x32_bf16 a[96:99], v[96:99], a[248:251], a[96:99]
v_exp_f32 v44, v44
v_mfma_f32_16x16x32_bf16 a[100:103], v[100:103], a[248:251], a[100:103]
v_add_f32 v168, v168, v40
v_add_u32 v5, 0, v4
v_mfma_f32_16x16x32_bf16 a[104:107], v[104:107], a[248:251], a[104:107]
v_exp_f32 v45, v45
v_mfma_f32_16x16x32_bf16 a[108:111], v[108:111], a[248:251], a[108:111]
v_add_f32 v169, v169, v41
v_cvt_pk_bf16_f32 v92, v40, v41
v_mfma_f32_16x16x32_bf16 a[112:115], v[96:99], a[252:255], a[112:115]
v_exp_f32 v46, v46
v_mfma_f32_16x16x32_bf16 a[116:119], v[100:103], a[252:255], a[116:119]
v_add_f32 v168, v168, v42
v_lshlrev_b32 v5, 1, v5
v_mfma_f32_16x16x32_bf16 a[120:123], v[104:107], a[252:255], a[120:123]
v_exp_f32 v47, v47
v_mfma_f32_16x16x32_bf16 a[124:127], v[108:111], a[252:255], a[124:127]
v_add_f32 v169, v169, v43
v_cvt_pk_bf16_f32 v93, v42, v43
v_mfma_f32_16x16x32_bf16 v[176:179], v[96:99], v[172:175], v[176:179]
v_add_f32 v168, v168, v44
v_xor_b32 v5, v5, v3
v_mfma_f32_16x16x32_bf16 v[184:187], v[104:107], v[172:175], v[184:187]
v_add_f32 v169, v169, v45
v_cvt_pk_bf16_f32 v94, v44, v45
v_add_f32 v168, v168, v46
v_lshlrev_b32 v5, 4, v5
v_add_f32 v169, v169, v47
v_cvt_pk_bf16_f32 v95, v46, v47
v_lshl_add_u32 v5, v4, 10, v5
v_add_u32 v158, 6144, v5
v_add_u32 v5, 4, v4
v_lshlrev_b32 v5, 1, v5
v_xor_b32 v5, v5, v3
v_lshlrev_b32 v5, 4, v5
v_lshl_add_u32 v5, v4, 10, v5
v_add_u32 v159, 21504, v5
v_mfma_f32_16x16x32_bf16 v[16:19], a[192:195], v[192:195], v[112:115]
v_exp_f32 v48, v48
v_mfma_f32_16x16x32_bf16 v[16:19], a[196:199], v[196:199], v[16:19]
s_mov_b32 s34, 0
ds_read_b64_tr_b16 a[224:225], v148 offset:32768
ds_read_b64_tr_b16 a[226:227], v148 offset:36864
v_mfma_f32_16x16x32_bf16 v[16:19], a[200:203], v[200:203], v[16:19]
s_add_u32 m0, s30, 8192
v_exp_f32 v49, v49
v_mfma_f32_16x16x32_bf16 v[16:19], a[204:207], v[204:207], v[16:19]
buffer_load_dwordx4 v156, s[16:19], s34 offen offset:0 lds
v_mfma_f32_16x16x32_bf16 v[24:27], a[192:195], v[208:211], v[116:119]
v_exp_f32 v50, v50
v_mfma_f32_16x16x32_bf16 v[24:27], a[196:199], v[212:215], v[24:27]
ds_read_b64_tr_b16 a[228:229], v149 offset:32768
v_cvt_pk_bf16_f32 v96, v48, v49
v_mfma_f32_16x16x32_bf16 v[24:27], a[200:203], v[216:219], v[24:27]
v_exp_f32 v51, v51
v_mfma_f32_16x16x32_bf16 v[24:27], a[204:207], v[220:223], v[24:27]
ds_read_b64_tr_b16 a[230:231], v149 offset:36864
v_cvt_pk_bf16_f32 v97, v50, v51
v_mfma_f32_16x16x32_bf16 v[32:35], a[192:195], v[224:227], v[120:123]
v_exp_f32 v52, v52
v_mfma_f32_16x16x32_bf16 v[32:35], a[196:199], v[228:231], v[32:35]
ds_read_b64_tr_b16 a[232:233], v150 offset:32768
ds_read_b64_tr_b16 a[234:235], v150 offset:36864
v_mfma_f32_16x16x32_bf16 v[32:35], a[200:203], v[232:235], v[32:35]
v_exp_f32 v53, v53
v_mfma_f32_16x16x32_bf16 v[32:35], a[204:207], v[236:239], v[32:35]
ds_read_b64_tr_b16 a[236:237], v151 offset:32768
v_cvt_pk_bf16_f32 v98, v52, v53
v_mfma_f32_16x16x32_bf16 v[40:43], a[192:195], v[240:243], v[124:127]
v_exp_f32 v54, v54
v_mfma_f32_16x16x32_bf16 v[40:43], a[196:199], v[244:247], v[40:43]
buffer_load_dwordx4 v157, s[16:19], s34 offen offset:1024 lds
v_mfma_f32_16x16x32_bf16 v[40:43], a[200:203], v[248:251], v[40:43]
v_exp_f32 v55, v55
v_mfma_f32_16x16x32_bf16 v[40:43], a[204:207], v[252:255], v[40:43]
ds_read_b64_tr_b16 a[238:239], v151 offset:36864
v_cvt_pk_bf16_f32 v99, v54, v55
v_mfma_f32_16x16x32_bf16 v[20:23], a[208:211], v[192:195], v[112:115]
v_exp_f32 v56, v56
v_mfma_f32_16x16x32_bf16 v[20:23], a[212:215], v[196:199], v[20:23]
ds_read_b64_tr_b16 a[240:241], v152 offset:32768
v_add_f32 v164, v164, v56
v_mfma_f32_16x16x32_bf16 v[20:23], a[216:219], v[200:203], v[20:23]
v_exp_f32 v57, v57
v_mfma_f32_16x16x32_bf16 v[20:23], a[220:223], v[204:207], v[20:23]
ds_read_b64_tr_b16 a[242:243], v152 offset:36864
v_add_f32 v165, v165, v57
v_mfma_f32_16x16x32_bf16 v[28:31], a[208:211], v[208:211], v[116:119]
v_exp_f32 v58, v58
v_mfma_f32_16x16x32_bf16 v[28:31], a[212:215], v[212:215], v[28:31]
buffer_load_dwordx4 v158, s[16:19], s34 offen offset:2048 lds
v_mfma_f32_16x16x32_bf16 v[28:31], a[216:219], v[216:219], v[28:31]
v_exp_f32 v59, v59
v_mfma_f32_16x16x32_bf16 v[28:31], a[220:223], v[220:223], v[28:31]
ds_read_b64_tr_b16 a[244:245], v153 offset:32768
v_cvt_pk_bf16_f32 v100, v56, v57
v_mfma_f32_16x16x32_bf16 v[36:39], a[208:211], v[224:227], v[120:123]
v_exp_f32 v60, v60
v_mfma_f32_16x16x32_bf16 v[36:39], a[212:215], v[228:231], v[36:39]
ds_read_b64_tr_b16 a[246:247], v153 offset:36864
v_add_f32 v164, v164, v58
v_mfma_f32_16x16x32_bf16 v[36:39], a[216:219], v[232:235], v[36:39]
v_exp_f32 v61, v61
v_mfma_f32_16x16x32_bf16 v[36:39], a[220:223], v[236:239], v[36:39]
ds_read_b64_tr_b16 a[248:249], v154 offset:32768
v_add_f32 v165, v165, v59
v_mfma_f32_16x16x32_bf16 v[44:47], a[208:211], v[240:243], v[124:127]
v_exp_f32 v62, v62
v_mfma_f32_16x16x32_bf16 v[44:47], a[212:215], v[244:247], v[44:47]
ds_read_b64_tr_b16 a[250:251], v154 offset:36864
v_cvt_pk_bf16_f32 v101, v58, v59
v_mfma_f32_16x16x32_bf16 v[44:47], a[216:219], v[248:251], v[44:47]
v_exp_f32 v63, v63
v_mfma_f32_16x16x32_bf16 v[44:47], a[220:223], v[252:255], v[44:47]
s_waitcnt lgkmcnt(3)
buffer_load_dwordx4 v159, s[16:19], s34 offen offset:3072 lds
v_mfma_f32_16x16x32_bf16 a[0:3], v[80:83], a[224:227], a[0:3]
v_exp_f32 v64, v64
v_mfma_f32_16x16x32_bf16 a[4:7], v[84:87], a[224:227], a[4:7]
ds_read_b64_tr_b16 a[252:253], v155 offset:32768
v_add_f32 v164, v164, v60
v_mfma_f32_16x16x32_bf16 a[8:11], v[88:91], a[224:227], a[8:11]
v_exp_f32 v65, v65
v_mfma_f32_16x16x32_bf16 a[12:15], v[92:95], a[224:227], a[12:15]
ds_read_b64_tr_b16 a[254:255], v155 offset:36864
v_add_f32 v165, v165, v61
v_mfma_f32_16x16x32_bf16 a[16:19], v[80:83], a[228:231], a[16:19]
v_exp_f32 v66, v66
v_mfma_f32_16x16x32_bf16 a[20:23], v[84:87], a[228:231], a[20:23]
s_mov_b32 s34, 131072
ds_read_b128 a[192:195], v144 offset:57344
v_cvt_pk_bf16_f32 v102, v60, v61
v_mfma_f32_16x16x32_bf16 a[24:27], v[88:91], a[228:231], a[24:27]
s_add_u32 m0, s30, 24576
v_exp_f32 v67, v67
v_mfma_f32_16x16x32_bf16 a[28:31], v[92:95], a[228:231], a[28:31]
buffer_load_dwordx4 v156, s[16:19], s34 offen offset:0 lds
v_mfma_f32_16x16x32_bf16 a[32:35], v[80:83], a[232:235], a[32:35]
v_exp_f32 v68, v68
v_mfma_f32_16x16x32_bf16 a[36:39], v[84:87], a[232:235], a[36:39]
ds_read_b128 a[196:199], v145 offset:57344
v_add_f32 v164, v164, v62
v_mfma_f32_16x16x32_bf16 a[40:43], v[88:91], a[232:235], a[40:43]
v_exp_f32 v69, v69
v_mfma_f32_16x16x32_bf16 a[44:47], v[92:95], a[232:235], a[44:47]
ds_read_b128 a[200:203], v146 offset:57344
v_add_f32 v165, v165, v63
v_mfma_f32_16x16x32_bf16 a[48:51], v[80:83], a[236:239], a[48:51]
v_exp_f32 v70, v70
v_mfma_f32_16x16x32_bf16 a[52:55], v[84:87], a[236:239], a[52:55]
ds_read_b128 a[204:207], v147 offset:57344
v_cvt_pk_bf16_f32 v103, v62, v63
v_mfma_f32_16x16x32_bf16 a[56:59], v[88:91], a[236:239], a[56:59]
v_exp_f32 v71, v71
v_mfma_f32_16x16x32_bf16 a[60:63], v[92:95], a[236:239], a[60:63]
ds_read_b128 a[208:211], v144 offset:61440
v_cvt_pk_bf16_f32 v104, v64, v65
v_mfma_f32_16x16x32_bf16 a[64:67], v[80:83], a[240:243], a[64:67]
v_exp_f32 v72, v72
v_mfma_f32_16x16x32_bf16 a[68:71], v[84:87], a[240:243], a[68:71]
buffer_load_dwordx4 v157, s[16:19], s34 offen offset:1024 lds
v_mfma_f32_16x16x32_bf16 a[72:75], v[88:91], a[240:243], a[72:75]
v_exp_f32 v73, v73
v_mfma_f32_16x16x32_bf16 a[76:79], v[92:95], a[240:243], a[76:79]
s_waitcnt lgkmcnt(2)
ds_read_b128 a[212:215], v145 offset:61440
v_cvt_pk_bf16_f32 v105, v66, v67
v_mfma_f32_16x16x32_bf16 a[80:83], v[80:83], a[244:247], a[80:83]
v_exp_f32 v74, v74
v_mfma_f32_16x16x32_bf16 a[84:87], v[84:87], a[244:247], a[84:87]
ds_read_b128 a[216:219], v146 offset:61440
v_cvt_pk_bf16_f32 v106, v68, v69
v_mfma_f32_16x16x32_bf16 a[88:91], v[88:91], a[244:247], a[88:91]
v_exp_f32 v75, v75
v_mfma_f32_16x16x32_bf16 a[92:95], v[92:95], a[244:247], a[92:95]
ds_read_b128 a[220:223], v147 offset:61440
v_cvt_pk_bf16_f32 v107, v70, v71
v_mfma_f32_16x16x32_bf16 a[96:99], v[80:83], a[248:251], a[96:99]
v_exp_f32 v76, v76
v_mfma_f32_16x16x32_bf16 a[100:103], v[84:87], a[248:251], a[100:103]
v_add_f32 v168, v168, v72
v_add_f32 v169, v169, v73
v_mfma_f32_16x16x32_bf16 a[104:107], v[88:91], a[248:251], a[104:107]
v_exp_f32 v77, v77
v_mfma_f32_16x16x32_bf16 a[108:111], v[92:95], a[248:251], a[108:111]
v_cvt_pk_bf16_f32 v108, v72, v73
v_add_f32 v168, v168, v74
v_mfma_f32_16x16x32_bf16 a[112:115], v[80:83], a[252:255], a[112:115]
v_exp_f32 v78, v78
v_mfma_f32_16x16x32_bf16 a[116:119], v[84:87], a[252:255], a[116:119]
v_add_f32 v169, v169, v75
v_cvt_pk_bf16_f32 v109, v74, v75
v_mfma_f32_16x16x32_bf16 a[120:123], v[88:91], a[252:255], a[120:123]
v_exp_f32 v79, v79
v_mfma_f32_16x16x32_bf16 a[124:127], v[92:95], a[252:255], a[124:127]
v_add_f32 v168, v168, v76
v_add_f32 v169, v169, v77
v_mfma_f32_16x16x32_bf16 v[176:179], v[80:83], v[172:175], v[176:179]
v_cvt_pk_bf16_f32 v110, v76, v77
v_add_f32 v168, v168, v78
v_mfma_f32_16x16x32_bf16 v[184:187], v[88:91], v[172:175], v[184:187]
v_add_f32 v169, v169, v79
v_cvt_pk_bf16_f32 v111, v78, v79
v_mfma_f32_16x16x32_bf16 v[48:51], a[192:195], v[192:195], v[112:115]
v_exp_f32 v16, v16
v_mfma_f32_16x16x32_bf16 v[48:51], a[196:199], v[196:199], v[48:51]
ds_read_b64_tr_b16 a[224:225], v148 offset:40960
ds_read_b64_tr_b16 a[226:227], v148 offset:45056
v_mfma_f32_16x16x32_bf16 v[48:51], a[200:203], v[200:203], v[48:51]
s_waitcnt lgkmcnt(2)
v_exp_f32 v17, v17
v_mfma_f32_16x16x32_bf16 v[48:51], a[204:207], v[204:207], v[48:51]
buffer_load_dwordx4 v158, s[16:19], s34 offen offset:2048 lds
v_mfma_f32_16x16x32_bf16 v[56:59], a[192:195], v[208:211], v[116:119]
v_exp_f32 v18, v18
v_mfma_f32_16x16x32_bf16 v[56:59], a[196:199], v[212:215], v[56:59]
ds_read_b64_tr_b16 a[228:229], v149 offset:40960
v_cvt_pk_bf16_f32 v80, v16, v17
v_mfma_f32_16x16x32_bf16 v[56:59], a[200:203], v[216:219], v[56:59]
v_exp_f32 v19, v19
v_mfma_f32_16x16x32_bf16 v[56:59], a[204:207], v[220:223], v[56:59]
ds_read_b64_tr_b16 a[230:231], v149 offset:45056
v_cvt_pk_bf16_f32 v81, v18, v19
v_mfma_f32_16x16x32_bf16 v[64:67], a[192:195], v[224:227], v[120:123]
v_exp_f32 v20, v20
v_mfma_f32_16x16x32_bf16 v[64:67], a[196:199], v[228:231], v[64:67]
ds_read_b64_tr_b16 a[232:233], v150 offset:40960
ds_read_b64_tr_b16 a[234:235], v150 offset:45056
v_mfma_f32_16x16x32_bf16 v[64:67], a[200:203], v[232:235], v[64:67]
v_exp_f32 v21, v21
v_mfma_f32_16x16x32_bf16 v[64:67], a[204:207], v[236:239], v[64:67]
ds_read_b64_tr_b16 a[236:237], v151 offset:40960
v_cvt_pk_bf16_f32 v82, v20, v21
v_mfma_f32_16x16x32_bf16 v[72:75], a[192:195], v[240:243], v[124:127]
v_exp_f32 v22, v22
v_mfma_f32_16x16x32_bf16 v[72:75], a[196:199], v[244:247], v[72:75]
buffer_load_dwordx4 v159, s[16:19], s34 offen offset:3072 lds
v_mfma_f32_16x16x32_bf16 v[72:75], a[200:203], v[248:251], v[72:75]
v_exp_f32 v23, v23
v_mfma_f32_16x16x32_bf16 v[72:75], a[204:207], v[252:255], v[72:75]
ds_read_b64_tr_b16 a[238:239], v151 offset:45056
v_cvt_pk_bf16_f32 v83, v22, v23
v_mfma_f32_16x16x32_bf16 v[52:55], a[208:211], v[192:195], v[112:115]
v_exp_f32 v24, v24
v_mfma_f32_16x16x32_bf16 v[52:55], a[212:215], v[196:199], v[52:55]
ds_read_b64_tr_b16 a[240:241], v152 offset:40960
v_add_f32 v164, v164, v24
v_mfma_f32_16x16x32_bf16 v[52:55], a[216:219], v[200:203], v[52:55]
v_exp_f32 v25, v25
v_mfma_f32_16x16x32_bf16 v[52:55], a[220:223], v[204:207], v[52:55]
s_mov_b32 s34, 262144
ds_read_b64_tr_b16 a[242:243], v152 offset:45056
v_add_f32 v165, v165, v25
v_mfma_f32_16x16x32_bf16 v[60:63], a[208:211], v[208:211], v[116:119]
s_add_u32 m0, s30, 73728
v_exp_f32 v26, v26
v_mfma_f32_16x16x32_bf16 v[60:63], a[212:215], v[212:215], v[60:63]
buffer_load_dwordx4 v156, s[16:19], s34 offen offset:0 lds
v_mfma_f32_16x16x32_bf16 v[60:63], a[216:219], v[216:219], v[60:63]
v_exp_f32 v27, v27
v_mfma_f32_16x16x32_bf16 v[60:63], a[220:223], v[220:223], v[60:63]
ds_read_b64_tr_b16 a[244:245], v153 offset:40960
v_cvt_pk_bf16_f32 v84, v24, v25
v_mfma_f32_16x16x32_bf16 v[68:71], a[208:211], v[224:227], v[120:123]
v_exp_f32 v28, v28
v_mfma_f32_16x16x32_bf16 v[68:71], a[212:215], v[228:231], v[68:71]
ds_read_b64_tr_b16 a[246:247], v153 offset:45056
v_add_f32 v164, v164, v26
v_mfma_f32_16x16x32_bf16 v[68:71], a[216:219], v[232:235], v[68:71]
v_exp_f32 v29, v29
v_mfma_f32_16x16x32_bf16 v[68:71], a[220:223], v[236:239], v[68:71]
ds_read_b64_tr_b16 a[248:249], v154 offset:40960
v_add_f32 v165, v165, v27
v_mfma_f32_16x16x32_bf16 v[76:79], a[208:211], v[240:243], v[124:127]
v_exp_f32 v30, v30
v_mfma_f32_16x16x32_bf16 v[76:79], a[212:215], v[244:247], v[76:79]
ds_read_b64_tr_b16 a[250:251], v154 offset:45056
v_cvt_pk_bf16_f32 v85, v26, v27
v_mfma_f32_16x16x32_bf16 v[76:79], a[216:219], v[248:251], v[76:79]
v_exp_f32 v31, v31
v_mfma_f32_16x16x32_bf16 v[76:79], a[220:223], v[252:255], v[76:79]
s_waitcnt lgkmcnt(3)
buffer_load_dwordx4 v157, s[16:19], s34 offen offset:1024 lds
v_mfma_f32_16x16x32_bf16 a[0:3], v[96:99], a[224:227], a[0:3]
v_exp_f32 v32, v32
v_mfma_f32_16x16x32_bf16 a[4:7], v[100:103], a[224:227], a[4:7]
ds_read_b64_tr_b16 a[252:253], v155 offset:40960
v_add_f32 v164, v164, v28
v_mfma_f32_16x16x32_bf16 a[8:11], v[104:107], a[224:227], a[8:11]
v_exp_f32 v33, v33
v_mfma_f32_16x16x32_bf16 a[12:15], v[108:111], a[224:227], a[12:15]
ds_read_b64_tr_b16 a[254:255], v155 offset:45056
v_add_f32 v165, v165, v29
v_mfma_f32_16x16x32_bf16 a[16:19], v[96:99], a[228:231], a[16:19]
v_exp_f32 v34, v34
v_mfma_f32_16x16x32_bf16 a[20:23], v[100:103], a[228:231], a[20:23]
ds_read_b64_tr_b16 a[224:225], v148 offset:49152
v_cvt_pk_bf16_f32 v86, v28, v29
v_mfma_f32_16x16x32_bf16 a[24:27], v[104:107], a[228:231], a[24:27]
v_exp_f32 v35, v35
v_mfma_f32_16x16x32_bf16 a[28:31], v[108:111], a[228:231], a[28:31]
ds_read_b64_tr_b16 a[226:227], v148 offset:53248
v_add_f32 v164, v164, v30
v_mfma_f32_16x16x32_bf16 a[32:35], v[96:99], a[232:235], a[32:35]
v_exp_f32 v36, v36
v_mfma_f32_16x16x32_bf16 a[36:39], v[100:103], a[232:235], a[36:39]
ds_read_b64_tr_b16 a[228:229], v149 offset:49152
v_add_f32 v165, v165, v31
v_mfma_f32_16x16x32_bf16 a[40:43], v[104:107], a[232:235], a[40:43]
v_exp_f32 v37, v37
v_mfma_f32_16x16x32_bf16 a[44:47], v[108:111], a[232:235], a[44:47]
ds_read_b64_tr_b16 a[230:231], v149 offset:53248
v_cvt_pk_bf16_f32 v87, v30, v31
v_mfma_f32_16x16x32_bf16 a[48:51], v[96:99], a[236:239], a[48:51]
v_exp_f32 v38, v38
v_mfma_f32_16x16x32_bf16 a[52:55], v[100:103], a[236:239], a[52:55]
ds_read_b64_tr_b16 a[232:233], v150 offset:49152
v_cvt_pk_bf16_f32 v88, v32, v33
v_mfma_f32_16x16x32_bf16 a[56:59], v[104:107], a[236:239], a[56:59]
v_exp_f32 v39, v39
v_mfma_f32_16x16x32_bf16 a[60:63], v[108:111], a[236:239], a[60:63]
ds_read_b64_tr_b16 a[234:235], v150 offset:53248
v_cvt_pk_bf16_f32 v89, v34, v35
v_mfma_f32_16x16x32_bf16 a[64:67], v[96:99], a[240:243], a[64:67]
v_exp_f32 v40, v40
v_mfma_f32_16x16x32_bf16 a[68:71], v[100:103], a[240:243], a[68:71]
ds_read_b64_tr_b16 a[236:237], v151 offset:49152
v_cvt_pk_bf16_f32 v90, v36, v37
v_mfma_f32_16x16x32_bf16 a[72:75], v[104:107], a[240:243], a[72:75]
v_exp_f32 v41, v41
v_mfma_f32_16x16x32_bf16 a[76:79], v[108:111], a[240:243], a[76:79]
s_waitcnt lgkmcnt(3)
ds_read_b64_tr_b16 a[238:239], v151 offset:53248
v_cvt_pk_bf16_f32 v91, v38, v39
v_mfma_f32_16x16x32_bf16 a[80:83], v[96:99], a[244:247], a[80:83]
v_exp_f32 v42, v42
v_mfma_f32_16x16x32_bf16 a[84:87], v[100:103], a[244:247], a[84:87]
ds_read_b64_tr_b16 a[240:241], v152 offset:49152
v_add_f32 v168, v168, v40
v_mfma_f32_16x16x32_bf16 a[88:91], v[104:107], a[244:247], a[88:91]
v_exp_f32 v43, v43
v_mfma_f32_16x16x32_bf16 a[92:95], v[108:111], a[244:247], a[92:95]
ds_read_b64_tr_b16 a[242:243], v152 offset:53248
v_add_f32 v169, v169, v41
v_mfma_f32_16x16x32_bf16 a[96:99], v[96:99], a[248:251], a[96:99]
v_exp_f32 v44, v44
v_mfma_f32_16x16x32_bf16 a[100:103], v[100:103], a[248:251], a[100:103]
ds_read_b64_tr_b16 a[244:245], v153 offset:49152
v_cvt_pk_bf16_f32 v92, v40, v41
v_mfma_f32_16x16x32_bf16 a[104:107], v[104:107], a[248:251], a[104:107]
v_exp_f32 v45, v45
v_mfma_f32_16x16x32_bf16 a[108:111], v[108:111], a[248:251], a[108:111]
ds_read_b64_tr_b16 a[246:247], v153 offset:53248
v_add_f32 v168, v168, v42
v_mfma_f32_16x16x32_bf16 a[112:115], v[96:99], a[252:255], a[112:115]
v_exp_f32 v46, v46
v_mfma_f32_16x16x32_bf16 a[116:119], v[100:103], a[252:255], a[116:119]
ds_read_b64_tr_b16 a[248:249], v154 offset:49152
v_add_f32 v169, v169, v43
v_mfma_f32_16x16x32_bf16 a[120:123], v[104:107], a[252:255], a[120:123]
v_exp_f32 v47, v47
v_mfma_f32_16x16x32_bf16 a[124:127], v[108:111], a[252:255], a[124:127]
ds_read_b64_tr_b16 a[250:251], v154 offset:53248
v_cvt_pk_bf16_f32 v93, v42, v43
v_mfma_f32_16x16x32_bf16 v[176:179], v[96:99], v[172:175], v[176:179]
ds_read_b64_tr_b16 a[252:253], v155 offset:49152
ds_read_b64_tr_b16 a[254:255], v155 offset:53248
v_mfma_f32_16x16x32_bf16 v[184:187], v[104:107], v[172:175], v[184:187]
v_add_f32 v168, v168, v44
v_add_f32 v169, v169, v45
v_cvt_pk_bf16_f32 v94, v44, v45
v_add_f32 v168, v168, v46
v_add_f32 v169, v169, v47
v_cvt_pk_bf16_f32 v95, v46, v47
v_mfma_f32_16x16x32_bf16 a[0:3], v[80:83], a[224:227], a[0:3]
v_exp_f32 v48, v48
v_mfma_f32_16x16x32_bf16 a[4:7], v[84:87], a[224:227], a[4:7]
v_exp_f32 v49, v49
v_mfma_f32_16x16x32_bf16 a[8:11], v[88:91], a[224:227], a[8:11]
v_cvt_pk_bf16_f32 v96, v48, v49
v_exp_f32 v50, v50
v_mfma_f32_16x16x32_bf16 a[12:15], v[92:95], a[224:227], a[12:15]
v_exp_f32 v51, v51
buffer_load_dwordx4 v158, s[16:19], s34 offen offset:2048 lds
v_mfma_f32_16x16x32_bf16 a[16:19], v[80:83], a[228:231], a[16:19]
ds_read_b64_tr_b16 a[224:225], v128 offset:0
v_cvt_pk_bf16_f32 v97, v50, v51
v_exp_f32 v52, v52
v_mfma_f32_16x16x32_bf16 a[20:23], v[84:87], a[228:231], a[20:23]
ds_read_b64_tr_b16 a[226:227], v128 offset:4096
v_exp_f32 v53, v53
v_mfma_f32_16x16x32_bf16 a[24:27], v[88:91], a[228:231], a[24:27]
v_cvt_pk_bf16_f32 v98, v52, v53
v_exp_f32 v54, v54
v_mfma_f32_16x16x32_bf16 a[28:31], v[92:95], a[228:231], a[28:31]
s_waitcnt lgkmcnt(2)
v_exp_f32 v55, v55
v_mfma_f32_16x16x32_bf16 a[32:35], v[80:83], a[232:235], a[32:35]
ds_read_b64_tr_b16 a[228:229], v129 offset:0
v_cvt_pk_bf16_f32 v99, v54, v55
v_exp_f32 v56, v56
buffer_load_dwordx4 v159, s[16:19], s34 offen offset:3072 lds
v_mfma_f32_16x16x32_bf16 a[36:39], v[84:87], a[232:235], a[36:39]
ds_read_b64_tr_b16 a[230:231], v129 offset:4096
v_add_f32 v164, v164, v56
v_exp_f32 v57, v57
v_mfma_f32_16x16x32_bf16 a[40:43], v[88:91], a[232:235], a[40:43]
v_add_f32 v165, v165, v57
v_cvt_pk_bf16_f32 v100, v56, v57
v_exp_f32 v58, v58
v_mfma_f32_16x16x32_bf16 a[44:47], v[92:95], a[232:235], a[44:47]
v_add_f32 v164, v164, v58
v_exp_f32 v59, v59
v_mfma_f32_16x16x32_bf16 a[48:51], v[80:83], a[236:239], a[48:51]
ds_read_b64_tr_b16 a[232:233], v130 offset:0
v_add_f32 v165, v165, v59
v_cvt_pk_bf16_f32 v101, v58, v59
v_exp_f32 v60, v60
s_add_u32 m0, s30, 122880
s_mov_b32 s34, 393216
v_mfma_f32_16x16x32_bf16 a[52:55], v[84:87], a[236:239], a[52:55]
ds_read_b64_tr_b16 a[234:235], v130 offset:4096
v_add_f32 v164, v164, v60
v_exp_f32 v61, v61
buffer_load_dwordx4 v156, s[16:19], s34 offen offset:0 lds
v_mfma_f32_16x16x32_bf16 a[56:59], v[88:91], a[236:239], a[56:59]
v_add_f32 v165, v165, v61
v_cvt_pk_bf16_f32 v102, v60, v61
v_exp_f32 v62, v62
v_mfma_f32_16x16x32_bf16 a[60:63], v[92:95], a[236:239], a[60:63]
v_add_f32 v164, v164, v62
v_exp_f32 v63, v63
v_mfma_f32_16x16x32_bf16 a[64:67], v[80:83], a[240:243], a[64:67]
ds_read_b64_tr_b16 a[236:237], v131 offset:0
v_add_f32 v165, v165, v63
v_cvt_pk_bf16_f32 v103, v62, v63
v_exp_f32 v64, v64
v_mfma_f32_16x16x32_bf16 a[68:71], v[84:87], a[240:243], a[68:71]
ds_read_b64_tr_b16 a[238:239], v131 offset:4096
v_exp_f32 v65, v65
v_mfma_f32_16x16x32_bf16 a[72:75], v[88:91], a[240:243], a[72:75]
v_cvt_pk_bf16_f32 v104, v64, v65
v_exp_f32 v66, v66
buffer_load_dwordx4 v157, s[16:19], s34 offen offset:1024 lds
v_mfma_f32_16x16x32_bf16 a[76:79], v[92:95], a[240:243], a[76:79]
v_exp_f32 v67, v67
v_mfma_f32_16x16x32_bf16 a[80:83], v[80:83], a[244:247], a[80:83]
ds_read_b64_tr_b16 a[240:241], v132 offset:0
v_cvt_pk_bf16_f32 v105, v66, v67
v_exp_f32 v68, v68
v_mfma_f32_16x16x32_bf16 a[84:87], v[84:87], a[244:247], a[84:87]
ds_read_b64_tr_b16 a[242:243], v132 offset:4096
v_exp_f32 v69, v69
v_mfma_f32_16x16x32_bf16 a[88:91], v[88:91], a[244:247], a[88:91]
v_cvt_pk_bf16_f32 v106, v68, v69
v_exp_f32 v70, v70
v_mfma_f32_16x16x32_bf16 a[92:95], v[92:95], a[244:247], a[92:95]
v_exp_f32 v71, v71
buffer_load_dwordx4 v158, s[16:19], s34 offen offset:2048 lds
v_mfma_f32_16x16x32_bf16 a[96:99], v[80:83], a[248:251], a[96:99]
ds_read_b64_tr_b16 a[244:245], v133 offset:0
v_cvt_pk_bf16_f32 v107, v70, v71
v_exp_f32 v72, v72
v_mfma_f32_16x16x32_bf16 a[100:103], v[84:87], a[248:251], a[100:103]
ds_read_b64_tr_b16 a[246:247], v133 offset:4096
v_add_f32 v168, v168, v72
v_exp_f32 v73, v73
v_mfma_f32_16x16x32_bf16 a[104:107], v[88:91], a[248:251], a[104:107]
v_add_f32 v169, v169, v73
v_cvt_pk_bf16_f32 v108, v72, v73
v_exp_f32 v74, v74
v_mfma_f32_16x16x32_bf16 a[108:111], v[92:95], a[248:251], a[108:111]
v_add_f32 v168, v168, v74
v_exp_f32 v75, v75
v_mfma_f32_16x16x32_bf16 a[112:115], v[80:83], a[252:255], a[112:115]
ds_read_b64_tr_b16 a[248:249], v134 offset:0
v_add_f32 v169, v169, v75
v_cvt_pk_bf16_f32 v109, v74, v75
v_exp_f32 v76, v76
buffer_load_dwordx4 v159, s[16:19], s34 offen offset:3072 lds
v_mfma_f32_16x16x32_bf16 a[116:119], v[84:87], a[252:255], a[116:119]
ds_read_b64_tr_b16 a[250:251], v134 offset:4096
v_add_f32 v168, v168, v76
v_exp_f32 v77, v77
v_mfma_f32_16x16x32_bf16 a[120:123], v[88:91], a[252:255], a[120:123]
v_add_f32 v169, v169, v77
v_cvt_pk_bf16_f32 v110, v76, v77
v_exp_f32 v78, v78
v_mfma_f32_16x16x32_bf16 a[124:127], v[92:95], a[252:255], a[124:127]
v_add_f32 v168, v168, v78
v_exp_f32 v79, v79
v_mfma_f32_16x16x32_bf16 v[176:179], v[80:83], v[172:175], v[176:179]
ds_read_b64_tr_b16 a[252:253], v135 offset:0
v_add_f32 v169, v169, v79
v_cvt_pk_bf16_f32 v111, v78, v79
v_mfma_f32_16x16x32_bf16 v[184:187], v[88:91], v[172:175], v[184:187]
ds_read_b64_tr_b16 a[254:255], v135 offset:4096
s_nop 1
v_mfma_f32_16x16x32_bf16 v[176:179], v[96:99], v[172:175], v[176:179]
v_lshlrev_b32 v5, 4, v4
v_mfma_f32_16x16x32_bf16 v[184:187], v[104:107], v[172:175], v[184:187]
s_waitcnt lgkmcnt(4)
v_add_f32 v164, v164, v165
v_add_f32 v168, v168, v169
v_mfma_f32_16x16x32_bf16 a[0:3], v[96:99], a[224:227], a[0:3]
v_mov_b32 v6, v164
v_mov_b32 v7, v168
v_mfma_f32_16x16x32_bf16 a[16:19], v[96:99], a[228:231], a[16:19]
v_lshlrev_b32 v9, 2, v4
v_xor_b32 v9, v9, v2
v_mfma_f32_16x16x32_bf16 a[32:35], v[96:99], a[232:235], a[32:35]
v_permlane32_swap_b32 v164, v6
v_permlane32_swap_b32 v168, v7
v_mfma_f32_16x16x32_bf16 a[48:51], v[96:99], a[236:239], a[48:51]
v_add_f32 v164, v164, v6
v_add_f32 v168, v168, v7
v_mfma_f32_16x16x32_bf16 a[64:67], v[96:99], a[240:243], a[64:67]
v_mov_b32 v6, v164
v_mov_b32 v7, v168
v_mfma_f32_16x16x32_bf16 a[80:83], v[96:99], a[244:247], a[80:83]
s_waitcnt lgkmcnt(0)
v_lshlrev_b32 v9, 4, v9
v_mov_b32 v8, 0
v_mfma_f32_16x16x32_bf16 a[96:99], v[96:99], a[248:251], a[96:99]
v_permlane16_swap_b32 v164, v6
v_permlane16_swap_b32 v168, v7
v_mfma_f32_16x16x32_bf16 a[112:115], v[96:99], a[252:255], a[112:115]
v_add_f32 v164, v164, v6
v_add_f32 v168, v168, v7
v_mfma_f32_16x16x32_bf16 a[8:11], v[104:107], a[224:227], a[8:11]
v_add_f32 v8, v8, v176
v_rcp_f32 v176, v176
v_add_f32 v8, v8, v177
v_rcp_f32 v177, v177
v_add_f32 v8, v8, v178
v_rcp_f32 v178, v178
v_add_f32 v8, v8, v179
v_rcp_f32 v179, v179
v_mfma_f32_16x16x32_bf16 a[24:27], v[104:107], a[228:231], a[24:27]
ds_bpermute_b32 v183, v5, v164 offset:12
ds_bpermute_b32 v182, v5, v164 offset:8
ds_bpermute_b32 v181, v5, v164 offset:4
ds_bpermute_b32 v180, v5, v164 offset:0
v_mfma_f32_16x16x32_bf16 a[40:43], v[104:107], a[232:235], a[40:43]
ds_bpermute_b32 v191, v5, v168 offset:12
ds_bpermute_b32 v190, v5, v168 offset:8
ds_bpermute_b32 v189, v5, v168 offset:4
ds_bpermute_b32 v188, v5, v168 offset:0
v_mfma_f32_16x16x32_bf16 a[56:59], v[104:107], a[236:239], a[56:59]
v_mfma_f32_16x16x32_bf16 a[72:75], v[104:107], a[240:243], a[72:75]
v_accvgpr_read_b32 v16, a0
v_accvgpr_read_b32 v17, a1
v_accvgpr_read_b32 v18, a2
v_accvgpr_read_b32 v19, a3
v_mfma_f32_16x16x32_bf16 a[88:91], v[104:107], a[244:247], a[88:91]
v_accvgpr_read_b32 v20, a16
v_accvgpr_read_b32 v21, a17
v_accvgpr_read_b32 v22, a18
v_accvgpr_read_b32 v23, a19
v_mfma_f32_16x16x32_bf16 a[104:107], v[104:107], a[248:251], a[104:107]
v_maximum3_f32 v112, abs(v16), abs(v20), 0
v_maximum3_f32 v113, abs(v17), abs(v21), 0
v_maximum3_f32 v114, abs(v18), abs(v22), 0
v_maximum3_f32 v115, abs(v19), abs(v23), 0
v_mfma_f32_16x16x32_bf16 a[120:123], v[104:107], a[252:255], a[120:123]
v_mul_f32 v16, v16, v176
v_mul_f32 v17, v17, v177
v_mul_f32 v18, v18, v178
v_mul_f32 v19, v19, v179
v_mfma_f32_16x16x32_bf16 a[4:7], v[100:103], a[224:227], a[4:7]
v_mul_f32 v20, v20, v176
v_mul_f32 v21, v21, v177
v_mul_f32 v22, v22, v178
v_mul_f32 v23, v23, v179
v_mfma_f32_16x16x32_bf16 a[20:23], v[100:103], a[228:231], a[20:23]
v_cvt_pk_bf16_f32 v80, v16, v17
v_cvt_pk_bf16_f32 v81, v18, v19
v_cvt_pk_bf16_f32 v82, v20, v21
v_cvt_pk_bf16_f32 v83, v22, v23
v_mfma_f32_16x16x32_bf16 a[36:39], v[100:103], a[232:235], a[36:39]
s_mov_b32 s54, 0
buffer_store_dwordx4 v[80:83], v9, s[24:27], s54 offen offset:0 sc1
v_accvgpr_read_b32 v24, a32
v_accvgpr_read_b32 v25, a33
v_mfma_f32_16x16x32_bf16 a[52:55], v[100:103], a[236:239], a[52:55]
v_accvgpr_read_b32 v26, a34
v_accvgpr_read_b32 v27, a35
v_accvgpr_read_b32 v28, a48
v_accvgpr_read_b32 v29, a49
v_mfma_f32_16x16x32_bf16 a[68:71], v[100:103], a[240:243], a[68:71]
v_accvgpr_read_b32 v30, a50
v_accvgpr_read_b32 v31, a51
v_maximum3_f32 v112, abs(v24), abs(v28), v112
v_maximum3_f32 v113, abs(v25), abs(v29), v113
v_mfma_f32_16x16x32_bf16 a[84:87], v[100:103], a[244:247], a[84:87]
v_maximum3_f32 v114, abs(v26), abs(v30), v114
v_maximum3_f32 v115, abs(v27), abs(v31), v115
v_mul_f32 v24, v24, v176
v_mul_f32 v25, v25, v177
v_mfma_f32_16x16x32_bf16 a[100:103], v[100:103], a[248:251], a[100:103]
v_mul_f32 v26, v26, v178
v_mul_f32 v27, v27, v179
v_mul_f32 v28, v28, v176
v_mul_f32 v29, v29, v177
v_mfma_f32_16x16x32_bf16 a[116:119], v[100:103], a[252:255], a[116:119]
v_mul_f32 v30, v30, v178
v_mul_f32 v31, v31, v179
v_cvt_pk_bf16_f32 v84, v24, v25
v_cvt_pk_bf16_f32 v85, v26, v27
v_mfma_f32_16x16x32_bf16 a[12:15], v[108:111], a[224:227], a[12:15]
v_cvt_pk_bf16_f32 v86, v28, v29
v_cvt_pk_bf16_f32 v87, v30, v31
s_mov_b32 s54, 4096
buffer_store_dwordx4 v[84:87], v9, s[24:27], s54 offen offset:0 sc1
v_mfma_f32_16x16x32_bf16 a[28:31], v[108:111], a[228:231], a[28:31]
s_waitcnt lgkmcnt(0)
v_add_f32 v8, v8, v184
v_rcp_f32 v184, v184
v_add_f32 v8, v8, v185
v_mfma_f32_16x16x32_bf16 a[44:47], v[108:111], a[232:235], a[44:47]
v_rcp_f32 v185, v185
v_add_f32 v8, v8, v186
v_rcp_f32 v186, v186
v_add_f32 v8, v8, v187
v_mfma_f32_16x16x32_bf16 a[60:63], v[108:111], a[236:239], a[60:63]
v_rcp_f32 v187, v187
v_add_f32 v8, v8, v180
v_rcp_f32 v180, v180
v_add_f32 v8, v8, v181
v_mfma_f32_16x16x32_bf16 a[76:79], v[108:111], a[240:243], a[76:79]
v_rcp_f32 v181, v181
v_add_f32 v8, v8, v182
v_rcp_f32 v182, v182
v_add_f32 v8, v8, v183
v_mfma_f32_16x16x32_bf16 a[92:95], v[108:111], a[244:247], a[92:95]
v_rcp_f32 v183, v183
v_add_f32 v8, v8, v188
v_rcp_f32 v188, v188
v_add_f32 v8, v8, v189
v_mfma_f32_16x16x32_bf16 a[108:111], v[108:111], a[248:251], a[108:111]
v_rcp_f32 v189, v189
v_add_f32 v8, v8, v190
v_rcp_f32 v190, v190
v_add_f32 v8, v8, v191
v_mfma_f32_16x16x32_bf16 a[124:127], v[108:111], a[252:255], a[124:127]
v_rcp_f32 v191, v191
v_accvgpr_read_b32 v32, a8
v_accvgpr_read_b32 v33, a9
v_accvgpr_read_b32 v34, a10
v_accvgpr_read_b32 v35, a11
v_accvgpr_read_b32 v36, a24
v_accvgpr_read_b32 v37, a25
v_accvgpr_read_b32 v38, a26
v_accvgpr_read_b32 v39, a27
v_maximum3_f32 v120, abs(v32), abs(v36), 0
v_maximum3_f32 v121, abs(v33), abs(v37), 0
v_maximum3_f32 v122, abs(v34), abs(v38), 0
v_maximum3_f32 v123, abs(v35), abs(v39), 0
v_pk_mul_f32 v[32:33], v[32:33], v[184:185]
v_pk_mul_f32 v[34:35], v[34:35], v[186:187]
v_pk_mul_f32 v[36:37], v[36:37], v[184:185]
v_pk_mul_f32 v[38:39], v[38:39], v[186:187]
v_cvt_pk_bf16_f32 v88, v32, v33
v_cvt_pk_bf16_f32 v89, v34, v35
v_cvt_pk_bf16_f32 v90, v36, v37
v_cvt_pk_bf16_f32 v91, v38, v39
s_mov_b32 s54, 0
buffer_store_dwordx4 v[88:91], v9, s[24:27], s54 offen offset:2048 sc1
v_accvgpr_read_b32 v40, a40
v_accvgpr_read_b32 v41, a41
v_accvgpr_read_b32 v42, a42
v_accvgpr_read_b32 v43, a43
v_accvgpr_read_b32 v44, a56
v_accvgpr_read_b32 v45, a57
v_accvgpr_read_b32 v46, a58
v_accvgpr_read_b32 v47, a59
v_maximum3_f32 v120, abs(v40), abs(v44), v120
v_maximum3_f32 v121, abs(v41), abs(v45), v121
v_maximum3_f32 v122, abs(v42), abs(v46), v122
v_maximum3_f32 v123, abs(v43), abs(v47), v123
v_pk_mul_f32 v[40:41], v[40:41], v[184:185]
v_pk_mul_f32 v[42:43], v[42:43], v[186:187]
v_pk_mul_f32 v[44:45], v[44:45], v[184:185]
v_pk_mul_f32 v[46:47], v[46:47], v[186:187]
v_cvt_pk_bf16_f32 v92, v40, v41
v_cvt_pk_bf16_f32 v93, v42, v43
v_cvt_pk_bf16_f32 v94, v44, v45
v_cvt_pk_bf16_f32 v95, v46, v47
s_mov_b32 s54, 4096
buffer_store_dwordx4 v[92:95], v9, s[24:27], s54 offen offset:2048 sc1
v_accvgpr_read_b32 v48, a4
v_accvgpr_read_b32 v49, a5
v_accvgpr_read_b32 v50, a6
v_accvgpr_read_b32 v51, a7
v_accvgpr_read_b32 v52, a20
v_accvgpr_read_b32 v53, a21
v_accvgpr_read_b32 v54, a22
v_accvgpr_read_b32 v55, a23
v_maximum3_f32 v116, abs(v48), abs(v52), 0
v_maximum3_f32 v117, abs(v49), abs(v53), 0
v_maximum3_f32 v118, abs(v50), abs(v54), 0
v_maximum3_f32 v119, abs(v51), abs(v55), 0
v_pk_mul_f32 v[48:49], v[48:49], v[180:181]
v_pk_mul_f32 v[50:51], v[50:51], v[182:183]
v_pk_mul_f32 v[52:53], v[52:53], v[180:181]
v_pk_mul_f32 v[54:55], v[54:55], v[182:183]
v_cvt_pk_bf16_f32 v80, v48, v49
v_cvt_pk_bf16_f32 v81, v50, v51
v_cvt_pk_bf16_f32 v82, v52, v53
v_cvt_pk_bf16_f32 v83, v54, v55
s_mov_b32 s54, 0
buffer_store_dwordx4 v[80:83], v9, s[24:27], s54 offen offset:1024 sc1
v_accvgpr_read_b32 v56, a36
v_accvgpr_read_b32 v57, a37
v_accvgpr_read_b32 v58, a38
v_accvgpr_read_b32 v59, a39
v_accvgpr_read_b32 v60, a52
v_accvgpr_read_b32 v61, a53
v_accvgpr_read_b32 v62, a54
v_accvgpr_read_b32 v63, a55
v_maximum3_f32 v116, abs(v56), abs(v60), v116
v_maximum3_f32 v117, abs(v57), abs(v61), v117
v_maximum3_f32 v118, abs(v58), abs(v62), v118
v_maximum3_f32 v119, abs(v59), abs(v63), v119
v_pk_mul_f32 v[56:57], v[56:57], v[180:181]
v_pk_mul_f32 v[58:59], v[58:59], v[182:183]
v_pk_mul_f32 v[60:61], v[60:61], v[180:181]
v_pk_mul_f32 v[62:63], v[62:63], v[182:183]
v_cvt_pk_bf16_f32 v84, v56, v57
v_cvt_pk_bf16_f32 v85, v58, v59
v_cvt_pk_bf16_f32 v86, v60, v61
v_cvt_pk_bf16_f32 v87, v62, v63
s_mov_b32 s54, 4096
buffer_store_dwordx4 v[84:87], v9, s[24:27], s54 offen offset:1024 sc1
v_accvgpr_read_b32 v64, a12
v_accvgpr_read_b32 v65, a13
v_accvgpr_read_b32 v66, a14
v_accvgpr_read_b32 v67, a15
v_accvgpr_read_b32 v68, a28
v_accvgpr_read_b32 v69, a29
v_accvgpr_read_b32 v70, a30
v_accvgpr_read_b32 v71, a31
v_maximum3_f32 v124, abs(v64), abs(v68), 0
v_maximum3_f32 v125, abs(v65), abs(v69), 0
v_maximum3_f32 v126, abs(v66), abs(v70), 0
v_maximum3_f32 v127, abs(v67), abs(v71), 0
v_pk_mul_f32 v[64:65], v[64:65], v[188:189]
v_pk_mul_f32 v[66:67], v[66:67], v[190:191]
v_pk_mul_f32 v[68:69], v[68:69], v[188:189]
v_pk_mul_f32 v[70:71], v[70:71], v[190:191]
v_cvt_pk_bf16_f32 v88, v64, v65
v_cvt_pk_bf16_f32 v89, v66, v67
v_cvt_pk_bf16_f32 v90, v68, v69
v_cvt_pk_bf16_f32 v91, v70, v71
s_mov_b32 s54, 0
buffer_store_dwordx4 v[88:91], v9, s[24:27], s54 offen offset:3072 sc1
v_accvgpr_read_b32 v72, a44
v_accvgpr_read_b32 v73, a45
v_accvgpr_read_b32 v74, a46
v_accvgpr_read_b32 v75, a47
v_accvgpr_read_b32 v76, a60
v_accvgpr_read_b32 v77, a61
v_accvgpr_read_b32 v78, a62
v_accvgpr_read_b32 v79, a63
v_maximum3_f32 v124, abs(v72), abs(v76), v124
v_maximum3_f32 v125, abs(v73), abs(v77), v125
v_maximum3_f32 v126, abs(v74), abs(v78), v126
v_maximum3_f32 v127, abs(v75), abs(v79), v127
v_pk_mul_f32 v[72:73], v[72:73], v[188:189]
v_pk_mul_f32 v[74:75], v[74:75], v[190:191]
v_pk_mul_f32 v[76:77], v[76:77], v[188:189]
v_pk_mul_f32 v[78:79], v[78:79], v[190:191]
v_cvt_pk_bf16_f32 v92, v72, v73
v_cvt_pk_bf16_f32 v93, v74, v75
v_cvt_pk_bf16_f32 v94, v76, v77
v_cvt_pk_bf16_f32 v95, v78, v79
s_mov_b32 s54, 4096
buffer_store_dwordx4 v[92:95], v9, s[24:27], s54 offen offset:3072 sc1
v_accvgpr_read_b32 v16, a64
v_accvgpr_read_b32 v17, a65
v_accvgpr_read_b32 v18, a66
v_accvgpr_read_b32 v19, a67
v_accvgpr_read_b32 v20, a80
v_accvgpr_read_b32 v21, a81
v_accvgpr_read_b32 v22, a82
v_accvgpr_read_b32 v23, a83
v_maximum3_f32 v112, abs(v16), abs(v20), v112
v_maximum3_f32 v113, abs(v17), abs(v21), v113
v_maximum3_f32 v114, abs(v18), abs(v22), v114
v_maximum3_f32 v115, abs(v19), abs(v23), v115
v_pk_mul_f32 v[16:17], v[16:17], v[176:177]
v_pk_mul_f32 v[18:19], v[18:19], v[178:179]
v_pk_mul_f32 v[20:21], v[20:21], v[176:177]
v_pk_mul_f32 v[22:23], v[22:23], v[178:179]
v_cvt_pk_bf16_f32 v108, v16, v17
v_cvt_pk_bf16_f32 v109, v18, v19
v_cvt_pk_bf16_f32 v110, v20, v21
v_cvt_pk_bf16_f32 v111, v22, v23
v_accvgpr_read_b32 v24, a96
v_accvgpr_read_b32 v25, a97
v_accvgpr_read_b32 v26, a98
v_accvgpr_read_b32 v27, a99
v_accvgpr_read_b32 v28, a112
v_accvgpr_read_b32 v29, a113
v_accvgpr_read_b32 v30, a114
v_accvgpr_read_b32 v31, a115
v_maximum3_f32 v112, abs(v24), abs(v28), v112
v_maximum3_f32 v113, abs(v25), abs(v29), v113
v_maximum3_f32 v114, abs(v26), abs(v30), v114
v_maximum3_f32 v115, abs(v27), abs(v31), v115
v_pk_mul_f32 v[24:25], v[24:25], v[176:177]
v_pk_mul_f32 v[26:27], v[26:27], v[178:179]
v_pk_mul_f32 v[28:29], v[28:29], v[176:177]
v_pk_mul_f32 v[30:31], v[30:31], v[178:179]
v_cvt_pk_bf16_f32 v104, v24, v25
v_cvt_pk_bf16_f32 v105, v26, v27
v_cvt_pk_bf16_f32 v106, v28, v29
v_cvt_pk_bf16_f32 v107, v30, v31
v_accvgpr_read_b32 v32, a72
v_accvgpr_read_b32 v33, a73
v_accvgpr_read_b32 v34, a74
v_accvgpr_read_b32 v35, a75
v_accvgpr_read_b32 v36, a88
v_accvgpr_read_b32 v37, a89
v_accvgpr_read_b32 v38, a90
v_accvgpr_read_b32 v39, a91
v_maximum3_f32 v120, abs(v32), abs(v36), v120
v_maximum3_f32 v121, abs(v33), abs(v37), v121
v_maximum3_f32 v122, abs(v34), abs(v38), v122
v_maximum3_f32 v123, abs(v35), abs(v39), v123
v_pk_mul_f32 v[32:33], v[32:33], v[184:185]
v_pk_mul_f32 v[34:35], v[34:35], v[186:187]
v_pk_mul_f32 v[36:37], v[36:37], v[184:185]
v_pk_mul_f32 v[38:39], v[38:39], v[186:187]
v_cvt_pk_bf16_f32 v100, v32, v33
v_cvt_pk_bf16_f32 v101, v34, v35
v_cvt_pk_bf16_f32 v102, v36, v37
v_cvt_pk_bf16_f32 v103, v38, v39
v_accvgpr_read_b32 v40, a104
v_accvgpr_read_b32 v41, a105
v_accvgpr_read_b32 v42, a106
v_accvgpr_read_b32 v43, a107
v_accvgpr_read_b32 v44, a120
v_accvgpr_read_b32 v45, a121
v_accvgpr_read_b32 v46, a122
v_accvgpr_read_b32 v47, a123
v_maximum3_f32 v120, abs(v40), abs(v44), v120
v_maximum3_f32 v121, abs(v41), abs(v45), v121
v_maximum3_f32 v122, abs(v42), abs(v46), v122
v_maximum3_f32 v123, abs(v43), abs(v47), v123
v_pk_mul_f32 v[40:41], v[40:41], v[184:185]
v_pk_mul_f32 v[42:43], v[42:43], v[186:187]
v_pk_mul_f32 v[44:45], v[44:45], v[184:185]
v_pk_mul_f32 v[46:47], v[46:47], v[186:187]
v_cvt_pk_bf16_f32 v96, v40, v41
v_cvt_pk_bf16_f32 v97, v42, v43
v_cvt_pk_bf16_f32 v98, v44, v45
v_cvt_pk_bf16_f32 v99, v46, v47
v_accvgpr_read_b32 v48, a68
v_accvgpr_read_b32 v49, a69
v_accvgpr_read_b32 v50, a70
v_accvgpr_read_b32 v51, a71
v_accvgpr_read_b32 v52, a84
v_accvgpr_read_b32 v53, a85
v_accvgpr_read_b32 v54, a86
v_accvgpr_read_b32 v55, a87
v_maximum3_f32 v116, abs(v48), abs(v52), v116
v_maximum3_f32 v117, abs(v49), abs(v53), v117
v_maximum3_f32 v118, abs(v50), abs(v54), v118
v_maximum3_f32 v119, abs(v51), abs(v55), v119
v_pk_mul_f32 v[48:49], v[48:49], v[180:181]
v_pk_mul_f32 v[50:51], v[50:51], v[182:183]
v_pk_mul_f32 v[52:53], v[52:53], v[180:181]
v_pk_mul_f32 v[54:55], v[54:55], v[182:183]
v_cvt_pk_bf16_f32 v92, v48, v49
v_cvt_pk_bf16_f32 v93, v50, v51
v_cvt_pk_bf16_f32 v94, v52, v53
v_cvt_pk_bf16_f32 v95, v54, v55
v_accvgpr_read_b32 v56, a100
v_accvgpr_read_b32 v57, a101
v_accvgpr_read_b32 v58, a102
v_accvgpr_read_b32 v59, a103
v_accvgpr_read_b32 v60, a116
v_accvgpr_read_b32 v61, a117
v_accvgpr_read_b32 v62, a118
v_accvgpr_read_b32 v63, a119
v_maximum3_f32 v116, abs(v56), abs(v60), v116
v_maximum3_f32 v117, abs(v57), abs(v61), v117
v_maximum3_f32 v118, abs(v58), abs(v62), v118
v_maximum3_f32 v119, abs(v59), abs(v63), v119
v_pk_mul_f32 v[56:57], v[56:57], v[180:181]
v_pk_mul_f32 v[58:59], v[58:59], v[182:183]
v_pk_mul_f32 v[60:61], v[60:61], v[180:181]
v_pk_mul_f32 v[62:63], v[62:63], v[182:183]
v_cvt_pk_bf16_f32 v88, v56, v57
v_cvt_pk_bf16_f32 v89, v58, v59
v_cvt_pk_bf16_f32 v90, v60, v61
v_cvt_pk_bf16_f32 v91, v62, v63
v_accvgpr_read_b32 v64, a76
v_accvgpr_read_b32 v65, a77
v_accvgpr_read_b32 v66, a78
v_accvgpr_read_b32 v67, a79
v_accvgpr_read_b32 v68, a92
v_accvgpr_read_b32 v69, a93
v_accvgpr_read_b32 v70, a94
v_accvgpr_read_b32 v71, a95
v_maximum3_f32 v124, abs(v64), abs(v68), v124
v_maximum3_f32 v125, abs(v65), abs(v69), v125
v_maximum3_f32 v126, abs(v66), abs(v70), v126
v_maximum3_f32 v127, abs(v67), abs(v71), v127
v_pk_mul_f32 v[64:65], v[64:65], v[188:189]
v_pk_mul_f32 v[66:67], v[66:67], v[190:191]
v_pk_mul_f32 v[68:69], v[68:69], v[188:189]
v_pk_mul_f32 v[70:71], v[70:71], v[190:191]
v_cvt_pk_bf16_f32 v84, v64, v65
v_cvt_pk_bf16_f32 v85, v66, v67
v_cvt_pk_bf16_f32 v86, v68, v69
v_cvt_pk_bf16_f32 v87, v70, v71
v_accvgpr_read_b32 v72, a108
v_accvgpr_read_b32 v73, a109
v_accvgpr_read_b32 v74, a110
v_accvgpr_read_b32 v75, a111
v_accvgpr_read_b32 v76, a124
v_accvgpr_read_b32 v77, a125
v_accvgpr_read_b32 v78, a126
v_accvgpr_read_b32 v79, a127
v_maximum3_f32 v124, abs(v72), abs(v76), v124
v_maximum3_f32 v125, abs(v73), abs(v77), v125
v_maximum3_f32 v126, abs(v74), abs(v78), v126
v_maximum3_f32 v127, abs(v75), abs(v79), v127
v_pk_mul_f32 v[72:73], v[72:73], v[188:189]
v_pk_mul_f32 v[74:75], v[74:75], v[190:191]
v_pk_mul_f32 v[76:77], v[76:77], v[188:189]
v_pk_mul_f32 v[78:79], v[78:79], v[190:191]
v_cvt_pk_bf16_f32 v80, v72, v73
v_cvt_pk_bf16_f32 v81, v74, v75
v_cvt_pk_bf16_f32 v82, v76, v77
v_cvt_pk_bf16_f32 v83, v78, v79
v_maximum3_f32 v10, v112, v113, v127
v_minimum3_f32 v11, v112, v113, v127
v_maximum3_f32 v10, v10, v114, v115
v_minimum3_f32 v11, v11, v114, v115
v_maximum3_f32 v10, v10, v116, v117
v_minimum3_f32 v11, v11, v116, v117
v_maximum3_f32 v10, v10, v118, v119
v_minimum3_f32 v11, v11, v118, v119
v_maximum3_f32 v10, v10, v120, v121
v_minimum3_f32 v11, v11, v120, v121
v_maximum3_f32 v10, v10, v122, v123
v_minimum3_f32 v11, v11, v122, v123
v_maximum3_f32 v10, v10, v124, v125
v_minimum3_f32 v11, v11, v124, v125
v_maximum3_f32 v10, v10, v126, v127
v_minimum3_f32 v11, v11, v126, v127
s_mov_b32 s60, 0x7f000000
v_cmp_nle_f32 s[56:57], v10, s60
s_mov_b32 s54, 0x7c800000
s_mov_b32 s55, 0x3800000
v_cmp_nle_f32 s[62:63], v8, s54
v_cmp_nge_f32 s[58:59], v11, s55
s_nop 1
s_or_b64 s[56:57], s[56:57], s[58:59]
s_or_b64 s[56:57], s[56:57], s[62:63]
s_cmp_eq_u64 s[56:57], 0
s_mov_b32 s29, 0
s_cbranch_scc0 adaLN_cond__mha_block_cached__glu_gated_bilinear__prompt_kernel_slow
adaLN_cond__mha_block_cached__glu_gated_bilinear__prompt_kernel_fin:
s_waitcnt vmcnt(0)
s_barrier
s_and_b32 s3, s2, 1
s_lshl_b32 s3, s3, 2
s_lshr_b32 s53, s2, 6
s_add_u32 s3, s3, s53
s_lshl_b32 s3, s3, 5
s_and_b32 s53, s2, 6
s_add_u32 s3, s3, s53
s_lshl_b32 s3, s3, 6
s_add_u32 s3, s3, 65536
s_add_u32 s60, s42, 65536
s_addc_u32 s61, s43, 0
s_mov_b32 s62, 16384
s_mov_b32 s63, 0x20000
s_cmp_lg_u32 s28, 0
s_cbranch_scc1 adaLN_cond__mha_block_cached__glu_gated_bilinear__prompt_kernel_sg0
s_lshl_b32 s53, s2, 6
s_mov_b64 exec, 1
v_mov_b32 v5, s53
v_mov_b32 v6, s39
buffer_store_dword v6, v5, s[60:63], 0 offen sc1
s_mov_b64 exec, -1
adaLN_cond__mha_block_cached__glu_gated_bilinear__prompt_kernel_sg0:
s_cmp_eq_u32 s29, 1
s_cbranch_scc1 adaLN_cond__mha_block_cached__glu_gated_bilinear__prompt_kernel_nohold
s_mov_b32 s54, 8192
buffer_store_dwordx4 v[108:111], v9, s[24:27], s54 offen offset:0 sc1
s_mov_b32 s54, 12288
buffer_store_dwordx4 v[104:107], v9, s[24:27], s54 offen offset:0 sc1
s_mov_b32 s54, 8192
buffer_store_dwordx4 v[100:103], v9, s[24:27], s54 offen offset:2048 sc1
s_mov_b32 s54, 12288
buffer_store_dwordx4 v[96:99], v9, s[24:27], s54 offen offset:2048 sc1
s_mov_b32 s54, 8192
buffer_store_dwordx4 v[92:95], v9, s[24:27], s54 offen offset:1024 sc1
s_mov_b32 s54, 12288
buffer_store_dwordx4 v[88:91], v9, s[24:27], s54 offen offset:1024 sc1
s_mov_b32 s54, 8192
buffer_store_dwordx4 v[84:87], v9, s[24:27], s54 offen offset:3072 sc1
s_mov_b32 s54, 12288
buffer_store_dwordx4 v[80:83], v9, s[24:27], s54 offen offset:3072 sc1
adaLN_cond__mha_block_cached__glu_gated_bilinear__prompt_kernel_nohold:
s_lshr_b32 s47, s28, 1
s_and_b32 s48, s28, 1
s_bfe_u32 s44, s2, 0x20001
s_and_b32 s45, s2, 1
s_lshl_b32 s45, s45, 3
s_lshr_b32 s46, s2, 5
s_add_u32 s45, s45, s46
s_bfe_u32 s46, s2, 0x20003
v_lshlrev_b32 v12, 4, v2
v_lshrrev_b32 v5, 2, v2
v_and_b32 v6, 3, v2
v_lshlrev_b32 v7, 8, v5
v_lshl_add_u32 v7, v6, 3, v7
v_add_u32 v7, 8192, v7
v_and_b32 v5, 7, v5
s_lshl_b32 s49, s48, 2
s_add_u32 s50, s49, 0
v_xor_b32 v8, s50, v5
v_lshl_add_u32 v16, v8, 5, v7
v_add_u32 v20, 65536, v16
s_add_u32 s50, s49, 1
v_xor_b32 v8, s50, v5
v_lshl_add_u32 v17, v8, 5, v7
v_add_u32 v21, 65536, v17
s_add_u32 s50, s49, 2
v_xor_b32 v8, s50, v5
v_lshl_add_u32 v18, v8, 5, v7
v_add_u32 v22, 65536, v18
s_add_u32 s50, s49, 3
v_xor_b32 v8, s50, v5
v_lshl_add_u32 v19, v8, 5, v7
v_add_u32 v23, 65536, v19
v_bfe_u32 v5, v2, 2, 2
v_lshrrev_b32 v7, 5, v2
v_lshl_add_u32 v5, v7, 3, v5
v_lshlrev_b32 v7, 2, v6
v_xor_b32 v5, v5, v7
v_lshl_add_u32 v5, v6, 4, v5
v_and_b32 v7, 1, v4
v_lshlrev_b32 v7, 3, v7
v_lshl_add_u32 v5, v5, 4, v7
s_lshl_b32 s49, s47, 13
s_add_u32 s49, s49, 40960
v_add_u32 v24, s49, v5
v_xor_b32 v5, 64, v5
v_add_u32 v25, s49, v5
v_add_u32 v26, 49152, v24
v_add_u32 v27, 49152, v25
s_lshl_b32 s49, s45, 1
s_add_u32 s49, s49, s47
s_lshl_b32 s50, s49, 19
s_lshl_b32 s51, s44, 17
s_add_u32 s50, s50, s51
s_lshl_b32 s51, s48, 12
s_add_u32 s50, s50, s51
s_add_u32 s50, s50, 4194304
s_add_u32 s12, s42, s50
s_addc_u32 s13, s43, 0
s_mov_b32 s14, 131072
s_mov_b32 s15, 0x20000
s_lshl_b32 s49, s49, 16
s_lshl_b32 s50, s44, 21
s_add_u32 s49, s49, s50
s_lshl_b32 s50, s46, 12
s_add_u32 s49, s49, s50
s_lshl_b32 s50, s48, 11
s_add_u32 s49, s49, s50
s_add_u32 s49, s49, 20971520
s_add_u32 s8, s42, s49
s_addc_u32 s9, s43, 0
s_mov_b32 s10, 65536
s_mov_b32 s11, 0x20000
s_mov_b32 s4, s42
s_mov_b32 s5, s43
s_mov_b32 s6, 1048576
s_mov_b32 s7, 0x20000
s_lshl_b32 s29, s45, 4
s_lshl_b32 s50, s44, 2
s_add_u32 s29, s29, s50
s_add_u32 s29, s29, s46
v_and_b32 v5, 7, v2
v_bfe_u32 v6, v2, 3, 2
v_lshrrev_b32 v7, 5, v2
s_lshl_b32 s50, s28, 2
v_add_u32 v7, s50, v7
v_lshlrev_b32 v152, 10, v7
v_lshl_add_u32 v152, v5, 4, v152
v_lshl_add_u32 v152, v6, 8, v152
v_lshlrev_b32 v153, 10, v5
v_lshl_add_u32 v153, v7, 6, v153
v_lshl_add_u32 v153, v6, 3, v153
v_lshlrev_b32 v154, 7, v7
v_lshl_add_u32 v154, v6, 4, v154
v_lshlrev_b32 v155, 3, v5
v_add_u32 v155, 159744, v155
s_mov_b32 s20, s80
s_mov_b32 s21, s81
s_mov_b32 s22, 2097152
s_mov_b32 s23, 0x20000
s_mov_b32 s24, s42
s_mov_b32 s25, s43
s_mov_b32 s26, 12288
s_mov_b32 s27, 0x20000
s_lshl_b32 s31, s29, 13
s_lshr_b32 s50, s29, 1
s_lshl_b32 s50, s50, 14
s_and_b32 s51, s29, 1
s_lshl_b32 s51, s51, 7
s_add_u32 s29, s50, s51
s_and_b32 s53, s2, 0xc7
v_and_b32 v5, 7, v2
v_lshlrev_b32 v5, 3, v5
v_add_u32 v5, s53, v5
v_lshlrev_b32 v141, 6, v5
s_and_b32 s53, s2, 0xe1
v_and_b32 v5, 3, v2
v_lshlrev_b32 v5, 3, v5
v_bfe_u32 v6, v2, 2, 2
v_lshl_add_u32 v5, v6, 1, v5
v_add_u32 v5, s53, v5
v_lshlrev_b32 v142, 6, v5
v_cmp_eq_u32 vcc, s39, v140
s_mov_b32 s53, 0
s_nop 0
s_cmp_eq_u64 vcc, -1
s_cbranch_scc1 adaLN_cond__mha_block_cached__glu_gated_bilinear__prompt_kernel_pmd
s_add_u32 s60, s42, 131072
s_addc_u32 s61, s43, 0
s_mov_b32 s62, 16384
s_mov_b32 s63, 0x20000
v_lshlrev_b32 v6, 6, v2
v_add_u32 v6, 4096, v6
adaLN_cond__mha_block_cached__glu_gated_bilinear__prompt_kernel_pm:
buffer_load_dword v5, v6, s[60:63], 0 offen sc1
s_add_u32 s53, s53, 1
s_waitcnt vmcnt(0)
v_cmp_eq_u32 vcc, s39, v5
s_cmp_gt_u32 s53, 200000
s_cbranch_scc1 adaLN_cond__mha_block_cached__glu_gated_bilinear__prompt_kernel_pmd
s_cmp_eq_u64 vcc, -1
s_cbranch_scc0 adaLN_cond__mha_block_cached__glu_gated_bilinear__prompt_kernel_pm
adaLN_cond__mha_block_cached__glu_gated_bilinear__prompt_kernel_pmd:
s_cmp_lg_u32 s28, 3
s_cbranch_scc1 adaLN_cond__mha_block_cached__glu_gated_bilinear__prompt_kernel_pd0
s_mov_b32 s53, 0
adaLN_cond__mha_block_cached__glu_gated_bilinear__prompt_kernel_pl0:
s_load_dword s60, s[42:43], s3 offset:0 glc
s_load_dword s61, s[42:43], s3 offset:512 glc
s_load_dword s62, s[42:43], s3 offset:1024 glc
s_load_dword s63, s[42:43], s3 offset:1536 glc
s_load_dword s84, s[42:43], s3 offset:64 glc
s_load_dword s85, s[42:43], s3 offset:576 glc
s_load_dword s86, s[42:43], s3 offset:1088 glc
s_load_dword s87, s[42:43], s3 offset:1600 glc
s_add_u32 s53, s53, 1
s_cmp_gt_u32 s53, 200000
s_cbranch_scc1 adaLN_cond__mha_block_cached__glu_gated_bilinear__prompt_kernel_pd0
adaLN_cond__mha_block_cached__glu_gated_bilinear__prompt_kernel_pw0:
s_waitcnt lgkmcnt(0)
s_cmp_eq_u32 s60, s39
s_cbranch_scc0 adaLN_cond__mha_block_cached__glu_gated_bilinear__prompt_kernel_pl0
s_cmp_eq_u32 s61, s39
s_cbranch_scc0 adaLN_cond__mha_block_cached__glu_gated_bilinear__prompt_kernel_pl0
s_cmp_eq_u32 s62, s39
s_cbranch_scc0 adaLN_cond__mha_block_cached__glu_gated_bilinear__prompt_kernel_pl0
s_cmp_eq_u32 s63, s39
s_cbranch_scc0 adaLN_cond__mha_block_cached__glu_gated_bilinear__prompt_kernel_pl0
s_cmp_eq_u32 s84, s39
s_cbranch_scc0 adaLN_cond__mha_block_cached__glu_gated_bilinear__prompt_kernel_pl0
s_cmp_eq_u32 s85, s39
s_cbranch_scc0 adaLN_cond__mha_block_cached__glu_gated_bilinear__prompt_kernel_pl0
s_cmp_eq_u32 s86, s39
s_cbranch_scc0 adaLN_cond__mha_block_cached__glu_gated_bilinear__prompt_kernel_pl0
s_cmp_eq_u32 s87, s39
s_cbranch_scc0 adaLN_cond__mha_block_cached__glu_gated_bilinear__prompt_kernel_pl0
adaLN_cond__mha_block_cached__glu_gated_bilinear__prompt_kernel_pd0:
s_barrier
s_add_u32 m0, s30, 40960
s_mov_b32 s35, 0
buffer_load_dwordx4 v12, s[12:15], s35 offen offset:0 sc1 lds
buffer_load_dwordx4 v12, s[12:15], s35 offen offset:1024 sc1 lds
buffer_load_dwordx4 v12, s[12:15], s35 offen offset:2048 sc1 lds
buffer_load_dwordx4 v12, s[12:15], s35 offen offset:3072 sc1 lds
s_add_u32 m0, s30, 57344
s_mov_b32 s35, 16384
buffer_load_dwordx4 v12, s[12:15], s35 offen offset:0 sc1 lds
buffer_load_dwordx4 v12, s[12:15], s35 offen offset:1024 sc1 lds
buffer_load_dwordx4 v12, s[12:15], s35 offen offset:2048 sc1 lds
buffer_load_dwordx4 v12, s[12:15], s35 offen offset:3072 sc1 lds
s_add_u32 m0, s30, 90112
s_mov_b32 s35, 32768
buffer_load_dwordx4 v12, s[12:15], s35 offen offset:0 sc1 lds
buffer_load_dwordx4 v12, s[12:15], s35 offen offset:1024 sc1 lds
buffer_load_dwordx4 v12, s[12:15], s35 offen offset:2048 sc1 lds
buffer_load_dwordx4 v12, s[12:15], s35 offen offset:3072 sc1 lds
s_add_u32 m0, s30, 106496
s_mov_b32 s35, 49152
buffer_load_dwordx4 v12, s[12:15], s35 offen offset:0 sc1 lds
buffer_load_dwordx4 v12, s[12:15], s35 offen offset:1024 sc1 lds
buffer_load_dwordx4 v12, s[12:15], s35 offen offset:2048 sc1 lds
buffer_load_dwordx4 v12, s[12:15], s35 offen offset:3072 sc1 lds
s_waitcnt vmcnt(12)
s_barrier
ds_read_b64_tr_b16 a[0:1], v16 offset:0
ds_read_b64_tr_b16 a[2:3], v16 offset:4096
ds_read_b64_tr_b16 a[4:5], v16 offset:8192
ds_read_b64_tr_b16 a[6:7], v16 offset:12288
ds_read_b64_tr_b16 a[64:65], v24 offset:0
ds_read_b64_tr_b16 a[66:67], v25 offset:0
ds_read_b64_tr_b16 a[68:69], v24 offset:4096
ds_read_b64_tr_b16 a[70:71], v25 offset:4096
ds_read_b64_tr_b16 a[72:73], v24 offset:1024
ds_read_b64_tr_b16 a[74:75], v25 offset:1024
ds_read_b64_tr_b16 a[76:77], v24 offset:5120
ds_read_b64_tr_b16 a[78:79], v25 offset:5120
ds_read_b64_tr_b16 a[80:81], v24 offset:2048
ds_read_b64_tr_b16 a[82:83], v25 offset:2048
ds_read_b64_tr_b16 a[84:85], v24 offset:6144
ds_read_b64_tr_b16 a[86:87], v25 offset:6144
ds_read_b64_tr_b16 a[88:89], v24 offset:3072
ds_read_b64_tr_b16 a[90:91], v25 offset:3072
ds_read_b64_tr_b16 a[92:93], v24 offset:7168
ds_read_b64_tr_b16 a[94:95], v25 offset:7168
ds_read_b64_tr_b16 a[8:9], v17 offset:0
ds_read_b64_tr_b16 a[10:11], v17 offset:4096
ds_read_b64_tr_b16 a[12:13], v17 offset:8192
ds_read_b64_tr_b16 a[14:15], v17 offset:12288
ds_read_b64_tr_b16 a[16:17], v18 offset:0
ds_read_b64_tr_b16 a[18:19], v18 offset:4096
ds_read_b64_tr_b16 a[20:21], v18 offset:8192
ds_read_b64_tr_b16 a[22:23], v18 offset:12288
ds_read_b64_tr_b16 a[24:25], v19 offset:0
ds_read_b64_tr_b16 a[26:27], v19 offset:4096
ds_read_b64_tr_b16 a[28:29], v19 offset:8192
ds_read_b64_tr_b16 a[30:31], v19 offset:12288
s_cmp_lg_u32 s28, 0
s_cbranch_scc1 adaLN_cond__mha_block_cached__glu_gated_bilinear__prompt_kernel_sg6
s_lshl_b32 s53, s2, 6
s_add_u32 s53, s53, 163840
s_mov_b64 exec, 1
v_mov_b32 v5, 0
v_mov_b32 v6, s39
buffer_store_dword v6, v5, s[4:7], s53 offen sc1
s_mov_b64 exec, -1
adaLN_cond__mha_block_cached__glu_gated_bilinear__prompt_kernel_sg6:
s_add_u32 s3, s3, 98304
s_waitcnt vmcnt(8) lgkmcnt(0)
s_barrier
v_mfma_f32_16x16x32_bf16 v[64:67], a[0:3], a[64:67], 0
ds_read_b64_tr_b16 a[32:33], v16 offset:16384
ds_read_b64_tr_b16 a[34:35], v16 offset:20480
v_mfma_f32_16x16x32_bf16 v[64:67], a[4:7], a[68:71], v[64:67]
s_add_u32 m0, s30, 40960
s_mov_b32 s35, 65536
ds_read_b64_tr_b16 a[36:37], v16 offset:24576
ds_read_b64_tr_b16 a[38:39], v16 offset:28672
v_mfma_f32_16x16x32_bf16 v[68:71], a[0:3], a[72:75], 0
buffer_load_dwordx4 v12, s[12:15], s35 offen offset:0 sc1 lds
v_mfma_f32_16x16x32_bf16 v[68:71], a[4:7], a[76:79], v[68:71]
ds_read_b64_tr_b16 a[96:97], v24 offset:16384
ds_read_b64_tr_b16 a[98:99], v25 offset:16384
v_mfma_f32_16x16x32_bf16 v[72:75], a[0:3], a[80:83], 0
ds_read_b64_tr_b16 a[100:101], v24 offset:20480
ds_read_b64_tr_b16 a[102:103], v25 offset:20480
v_mfma_f32_16x16x32_bf16 v[72:75], a[4:7], a[84:87], v[72:75]
ds_read_b64_tr_b16 a[104:105], v24 offset:17408
ds_read_b64_tr_b16 a[106:107], v25 offset:17408
v_mfma_f32_16x16x32_bf16 v[76:79], a[0:3], a[88:91], 0
buffer_load_dwordx4 v12, s[12:15], s35 offen offset:1024 sc1 lds
v_mfma_f32_16x16x32_bf16 v[76:79], a[4:7], a[92:95], v[76:79]
ds_read_b64_tr_b16 a[108:109], v24 offset:21504
ds_read_b64_tr_b16 a[110:111], v25 offset:21504
v_mfma_f32_16x16x32_bf16 v[80:83], a[8:11], a[64:67], 0
ds_read_b64_tr_b16 a[112:113], v24 offset:18432
ds_read_b64_tr_b16 a[114:115], v25 offset:18432
v_mfma_f32_16x16x32_bf16 v[80:83], a[12:15], a[68:71], v[80:83]
ds_read_b64_tr_b16 a[116:117], v24 offset:22528
ds_read_b64_tr_b16 a[118:119], v25 offset:22528
v_mfma_f32_16x16x32_bf16 v[84:87], a[8:11], a[72:75], 0
buffer_load_dwordx4 v12, s[12:15], s35 offen offset:2048 sc1 lds
v_mfma_f32_16x16x32_bf16 v[84:87], a[12:15], a[76:79], v[84:87]
ds_read_b64_tr_b16 a[120:121], v24 offset:19456
ds_read_b64_tr_b16 a[122:123], v25 offset:19456
v_mfma_f32_16x16x32_bf16 v[88:91], a[8:11], a[80:83], 0
ds_read_b64_tr_b16 a[124:125], v24 offset:23552
ds_read_b64_tr_b16 a[126:127], v25 offset:23552
v_mfma_f32_16x16x32_bf16 v[88:91], a[12:15], a[84:87], v[88:91]
ds_read_b64_tr_b16 a[40:41], v17 offset:16384
ds_read_b64_tr_b16 a[42:43], v17 offset:20480
v_mfma_f32_16x16x32_bf16 v[92:95], a[8:11], a[88:91], 0
buffer_load_dwordx4 v12, s[12:15], s35 offen offset:3072 sc1 lds
v_mfma_f32_16x16x32_bf16 v[92:95], a[12:15], a[92:95], v[92:95]
ds_read_b64_tr_b16 a[44:45], v17 offset:24576
ds_read_b64_tr_b16 a[46:47], v17 offset:28672
v_mfma_f32_16x16x32_bf16 v[96:99], a[16:19], a[64:67], 0
ds_read_b64_tr_b16 a[48:49], v18 offset:16384
ds_read_b64_tr_b16 a[50:51], v18 offset:20480
v_mfma_f32_16x16x32_bf16 v[96:99], a[20:23], a[68:71], v[96:99]
s_add_u32 m0, s30, 8192
s_mov_b32 s34, 524288
ds_read_b64_tr_b16 a[52:53], v18 offset:24576
ds_read_b64_tr_b16 a[54:55], v18 offset:28672
v_mfma_f32_16x16x32_bf16 v[100:103], a[16:19], a[72:75], 0
buffer_load_dwordx4 v156, s[16:19], s34 offen offset:0 lds
v_mfma_f32_16x16x32_bf16 v[100:103], a[20:23], a[76:79], v[100:103]
ds_read_b64_tr_b16 a[56:57], v19 offset:16384
ds_read_b64_tr_b16 a[58:59], v19 offset:20480
v_mfma_f32_16x16x32_bf16 v[104:107], a[16:19], a[80:83], 0
ds_read_b64_tr_b16 a[60:61], v19 offset:24576
ds_read_b64_tr_b16 a[62:63], v19 offset:28672
v_mfma_f32_16x16x32_bf16 v[104:107], a[20:23], a[84:87], v[104:107]
v_mfma_f32_16x16x32_bf16 v[108:111], a[16:19], a[88:91], 0
buffer_load_dwordx4 v157, s[16:19], s34 offen offset:1024 lds
v_mfma_f32_16x16x32_bf16 v[108:111], a[20:23], a[92:95], v[108:111]
v_mfma_f32_16x16x32_bf16 v[112:115], a[24:27], a[64:67], 0
v_mfma_f32_16x16x32_bf16 v[112:115], a[28:31], a[68:71], v[112:115]
v_mfma_f32_16x16x32_bf16 v[116:119], a[24:27], a[72:75], 0
buffer_load_dwordx4 v158, s[16:19], s34 offen offset:2048 lds
v_mfma_f32_16x16x32_bf16 v[116:119], a[28:31], a[76:79], v[116:119]
v_mfma_f32_16x16x32_bf16 v[120:123], a[24:27], a[80:83], 0
v_mfma_f32_16x16x32_bf16 v[120:123], a[28:31], a[84:87], v[120:123]
v_mfma_f32_16x16x32_bf16 v[124:127], a[24:27], a[88:91], 0
buffer_load_dwordx4 v159, s[16:19], s34 offen offset:3072 lds
v_mfma_f32_16x16x32_bf16 v[124:127], a[28:31], a[92:95], v[124:127]
s_waitcnt vmcnt(12) lgkmcnt(0)
s_barrier
v_mfma_f32_16x16x32_bf16 v[64:67], a[32:35], a[96:99], v[64:67]
ds_read_b64_tr_b16 a[0:1], v20 offset:0
ds_read_b64_tr_b16 a[2:3], v20 offset:4096
v_mfma_f32_16x16x32_bf16 v[64:67], a[36:39], a[100:103], v[64:67]
s_add_u32 m0, s30, 57344
s_mov_b32 s35, 81920
ds_read_b64_tr_b16 a[4:5], v20 offset:8192
ds_read_b64_tr_b16 a[6:7], v20 offset:12288
v_mfma_f32_16x16x32_bf16 v[68:71], a[32:35], a[104:107], v[68:71]
buffer_load_dwordx4 v12, s[12:15], s35 offen offset:0 sc1 lds
v_mfma_f32_16x16x32_bf16 v[68:71], a[36:39], a[108:111], v[68:71]
ds_read_b64_tr_b16 a[64:65], v26 offset:0
ds_read_b64_tr_b16 a[66:67], v27 offset:0
v_mfma_f32_16x16x32_bf16 v[72:75], a[32:35], a[112:115], v[72:75]
ds_read_b64_tr_b16 a[68:69], v26 offset:4096
ds_read_b64_tr_b16 a[70:71], v27 offset:4096
v_mfma_f32_16x16x32_bf16 v[72:75], a[36:39], a[116:119], v[72:75]
ds_read_b64_tr_b16 a[72:73], v26 offset:1024
ds_read_b64_tr_b16 a[74:75], v27 offset:1024
v_mfma_f32_16x16x32_bf16 v[76:79], a[32:35], a[120:123], v[76:79]
buffer_load_dwordx4 v12, s[12:15], s35 offen offset:1024 sc1 lds
v_mfma_f32_16x16x32_bf16 v[76:79], a[36:39], a[124:127], v[76:79]
ds_read_b64_tr_b16 a[76:77], v26 offset:5120
ds_read_b64_tr_b16 a[78:79], v27 offset:5120
v_mfma_f32_16x16x32_bf16 v[80:83], a[40:43], a[96:99], v[80:83]
ds_read_b64_tr_b16 a[80:81], v26 offset:2048
ds_read_b64_tr_b16 a[82:83], v27 offset:2048
v_mfma_f32_16x16x32_bf16 v[80:83], a[44:47], a[100:103], v[80:83]
ds_read_b64_tr_b16 a[84:85], v26 offset:6144
ds_read_b64_tr_b16 a[86:87], v27 offset:6144
v_mfma_f32_16x16x32_bf16 v[84:87], a[40:43], a[104:107], v[84:87]
buffer_load_dwordx4 v12, s[12:15], s35 offen offset:2048 sc1 lds
v_mfma_f32_16x16x32_bf16 v[84:87], a[44:47], a[108:111], v[84:87]
ds_read_b64_tr_b16 a[88:89], v26 offset:3072
ds_read_b64_tr_b16 a[90:91], v27 offset:3072
v_mfma_f32_16x16x32_bf16 v[88:91], a[40:43], a[112:115], v[88:91]
ds_read_b64_tr_b16 a[92:93], v26 offset:7168
ds_read_b64_tr_b16 a[94:95], v27 offset:7168
v_mfma_f32_16x16x32_bf16 v[88:91], a[44:47], a[116:119], v[88:91]
ds_read_b64_tr_b16 a[8:9], v21 offset:0
ds_read_b64_tr_b16 a[10:11], v21 offset:4096
v_mfma_f32_16x16x32_bf16 v[92:95], a[40:43], a[120:123], v[92:95]
buffer_load_dwordx4 v12, s[12:15], s35 offen offset:3072 sc1 lds
v_mfma_f32_16x16x32_bf16 v[92:95], a[44:47], a[124:127], v[92:95]
ds_read_b64_tr_b16 a[12:13], v21 offset:8192
ds_read_b64_tr_b16 a[14:15], v21 offset:12288
v_mfma_f32_16x16x32_bf16 v[96:99], a[48:51], a[96:99], v[96:99]
ds_read_b64_tr_b16 a[16:17], v22 offset:0
ds_read_b64_tr_b16 a[18:19], v22 offset:4096
v_mfma_f32_16x16x32_bf16 v[96:99], a[52:55], a[100:103], v[96:99]
s_add_u32 m0, s30, 24576
s_mov_b32 s34, 655360
ds_read_b64_tr_b16 a[20:21], v22 offset:8192
ds_read_b64_tr_b16 a[22:23], v22 offset:12288
v_mfma_f32_16x16x32_bf16 v[100:103], a[48:51], a[104:107], v[100:103]
buffer_load_dwordx4 v156, s[16:19], s34 offen offset:0 lds
v_mfma_f32_16x16x32_bf16 v[100:103], a[52:55], a[108:111], v[100:103]
ds_read_b64_tr_b16 a[24:25], v23 offset:0
ds_read_b64_tr_b16 a[26:27], v23 offset:4096
v_mfma_f32_16x16x32_bf16 v[104:107], a[48:51], a[112:115], v[104:107]
ds_read_b64_tr_b16 a[28:29], v23 offset:8192
ds_read_b64_tr_b16 a[30:31], v23 offset:12288
v_mfma_f32_16x16x32_bf16 v[104:107], a[52:55], a[116:119], v[104:107]
v_mfma_f32_16x16x32_bf16 v[108:111], a[48:51], a[120:123], v[108:111]
buffer_load_dwordx4 v157, s[16:19], s34 offen offset:1024 lds
v_mfma_f32_16x16x32_bf16 v[108:111], a[52:55], a[124:127], v[108:111]
v_mfma_f32_16x16x32_bf16 v[112:115], a[56:59], a[96:99], v[112:115]
v_mfma_f32_16x16x32_bf16 v[112:115], a[60:63], a[100:103], v[112:115]
v_mfma_f32_16x16x32_bf16 v[116:119], a[56:59], a[104:107], v[116:119]
buffer_load_dwordx4 v158, s[16:19], s34 offen offset:2048 lds
v_mfma_f32_16x16x32_bf16 v[116:119], a[60:63], a[108:111], v[116:119]
v_mfma_f32_16x16x32_bf16 v[120:123], a[56:59], a[112:115], v[120:123]
v_mfma_f32_16x16x32_bf16 v[120:123], a[60:63], a[116:119], v[120:123]
v_mfma_f32_16x16x32_bf16 v[124:127], a[56:59], a[120:123], v[124:127]
buffer_load_dwordx4 v159, s[16:19], s34 offen offset:3072 lds
v_mfma_f32_16x16x32_bf16 v[124:127], a[60:63], a[124:127], v[124:127]
s_waitcnt vmcnt(16) lgkmcnt(0)
s_barrier
v_mfma_f32_16x16x32_bf16 v[64:67], a[0:3], a[64:67], v[64:67]
ds_read_b64_tr_b16 a[32:33], v20 offset:49152
ds_read_b64_tr_b16 a[34:35], v20 offset:53248
v_mfma_f32_16x16x32_bf16 v[64:67], a[4:7], a[68:71], v[64:67]
s_add_u32 m0, s30, 90112
s_mov_b32 s35, 98304
ds_read_b64_tr_b16 a[36:37], v20 offset:57344
ds_read_b64_tr_b16 a[38:39], v20 offset:61440
v_mfma_f32_16x16x32_bf16 v[68:71], a[0:3], a[72:75], v[68:71]
buffer_load_dwordx4 v12, s[12:15], s35 offen offset:0 sc1 lds
v_mfma_f32_16x16x32_bf16 v[68:71], a[4:7], a[76:79], v[68:71]
ds_read_b64_tr_b16 a[96:97], v26 offset:16384
ds_read_b64_tr_b16 a[98:99], v27 offset:16384
v_mfma_f32_16x16x32_bf16 v[72:75], a[0:3], a[80:83], v[72:75]
ds_read_b64_tr_b16 a[100:101], v26 offset:20480
ds_read_b64_tr_b16 a[102:103], v27 offset:20480
v_mfma_f32_16x16x32_bf16 v[72:75], a[4:7], a[84:87], v[72:75]
ds_read_b64_tr_b16 a[104:105], v26 offset:17408
ds_read_b64_tr_b16 a[106:107], v27 offset:17408
v_mfma_f32_16x16x32_bf16 v[76:79], a[0:3], a[88:91], v[76:79]
buffer_load_dwordx4 v12, s[12:15], s35 offen offset:1024 sc1 lds
v_mfma_f32_16x16x32_bf16 v[76:79], a[4:7], a[92:95], v[76:79]
ds_read_b64_tr_b16 a[108:109], v26 offset:21504
ds_read_b64_tr_b16 a[110:111], v27 offset:21504
v_mfma_f32_16x16x32_bf16 v[80:83], a[8:11], a[64:67], v[80:83]
ds_read_b64_tr_b16 a[112:113], v26 offset:18432
ds_read_b64_tr_b16 a[114:115], v27 offset:18432
v_mfma_f32_16x16x32_bf16 v[80:83], a[12:15], a[68:71], v[80:83]
ds_read_b64_tr_b16 a[116:117], v26 offset:22528
ds_read_b64_tr_b16 a[118:119], v27 offset:22528
v_mfma_f32_16x16x32_bf16 v[84:87], a[8:11], a[72:75], v[84:87]
buffer_load_dwordx4 v12, s[12:15], s35 offen offset:2048 sc1 lds
v_mfma_f32_16x16x32_bf16 v[84:87], a[12:15], a[76:79], v[84:87]
ds_read_b64_tr_b16 a[120:121], v26 offset:19456
ds_read_b64_tr_b16 a[122:123], v27 offset:19456
v_mfma_f32_16x16x32_bf16 v[88:91], a[8:11], a[80:83], v[88:91]
ds_read_b64_tr_b16 a[124:125], v26 offset:23552
ds_read_b64_tr_b16 a[126:127], v27 offset:23552
v_mfma_f32_16x16x32_bf16 v[88:91], a[12:15], a[84:87], v[88:91]
ds_read_b64_tr_b16 a[40:41], v21 offset:49152
ds_read_b64_tr_b16 a[42:43], v21 offset:53248
v_mfma_f32_16x16x32_bf16 v[92:95], a[8:11], a[88:91], v[92:95]
buffer_load_dwordx4 v12, s[12:15], s35 offen offset:3072 sc1 lds
v_mfma_f32_16x16x32_bf16 v[92:95], a[12:15], a[92:95], v[92:95]
ds_read_b64_tr_b16 a[44:45], v21 offset:57344
ds_read_b64_tr_b16 a[46:47], v21 offset:61440
v_mfma_f32_16x16x32_bf16 v[96:99], a[16:19], a[64:67], v[96:99]
ds_read_b64_tr_b16 a[48:49], v22 offset:49152
ds_read_b64_tr_b16 a[50:51], v22 offset:53248
v_mfma_f32_16x16x32_bf16 v[96:99], a[20:23], a[68:71], v[96:99]
s_add_u32 m0, s30, 73728
s_mov_b32 s34, 786432
ds_read_b64_tr_b16 a[52:53], v22 offset:57344
ds_read_b64_tr_b16 a[54:55], v22 offset:61440
v_mfma_f32_16x16x32_bf16 v[100:103], a[16:19], a[72:75], v[100:103]
buffer_load_dwordx4 v156, s[16:19], s34 offen offset:0 lds
v_mfma_f32_16x16x32_bf16 v[100:103], a[20:23], a[76:79], v[100:103]
ds_read_b64_tr_b16 a[56:57], v23 offset:49152
ds_read_b64_tr_b16 a[58:59], v23 offset:53248
v_mfma_f32_16x16x32_bf16 v[104:107], a[16:19], a[80:83], v[104:107]
ds_read_b64_tr_b16 a[60:61], v23 offset:57344
ds_read_b64_tr_b16 a[62:63], v23 offset:61440
v_mfma_f32_16x16x32_bf16 v[104:107], a[20:23], a[84:87], v[104:107]
v_mfma_f32_16x16x32_bf16 v[108:111], a[16:19], a[88:91], v[108:111]
buffer_load_dwordx4 v157, s[16:19], s34 offen offset:1024 lds
v_mfma_f32_16x16x32_bf16 v[108:111], a[20:23], a[92:95], v[108:111]
v_mfma_f32_16x16x32_bf16 v[112:115], a[24:27], a[64:67], v[112:115]
v_mfma_f32_16x16x32_bf16 v[112:115], a[28:31], a[68:71], v[112:115]
v_mfma_f32_16x16x32_bf16 v[116:119], a[24:27], a[72:75], v[116:119]
buffer_load_dwordx4 v158, s[16:19], s34 offen offset:2048 lds
v_mfma_f32_16x16x32_bf16 v[116:119], a[28:31], a[76:79], v[116:119]
v_mfma_f32_16x16x32_bf16 v[120:123], a[24:27], a[80:83], v[120:123]
v_mfma_f32_16x16x32_bf16 v[120:123], a[28:31], a[84:87], v[120:123]
v_mfma_f32_16x16x32_bf16 v[124:127], a[24:27], a[88:91], v[124:127]
buffer_load_dwordx4 v159, s[16:19], s34 offen offset:3072 lds
v_mfma_f32_16x16x32_bf16 v[124:127], a[28:31], a[92:95], v[124:127]
s_waitcnt vmcnt(16) lgkmcnt(0)
s_barrier
v_mfma_f32_16x16x32_bf16 v[64:67], a[32:35], a[96:99], v[64:67]
ds_read_b64_tr_b16 a[0:1], v16 offset:0
ds_read_b64_tr_b16 a[2:3], v16 offset:4096
v_mfma_f32_16x16x32_bf16 v[64:67], a[36:39], a[100:103], v[64:67]
s_add_u32 m0, s30, 106496
s_mov_b32 s35, 114688
ds_read_b64_tr_b16 a[4:5], v16 offset:8192
ds_read_b64_tr_b16 a[6:7], v16 offset:12288
v_mfma_f32_16x16x32_bf16 v[68:71], a[32:35], a[104:107], v[68:71]
buffer_load_dwordx4 v12, s[12:15], s35 offen offset:0 sc1 lds
v_mfma_f32_16x16x32_bf16 v[68:71], a[36:39], a[108:111], v[68:71]
ds_read_b64_tr_b16 a[64:65], v24 offset:0
ds_read_b64_tr_b16 a[66:67], v25 offset:0
v_mfma_f32_16x16x32_bf16 v[72:75], a[32:35], a[112:115], v[72:75]
ds_read_b64_tr_b16 a[68:69], v24 offset:4096
ds_read_b64_tr_b16 a[70:71], v25 offset:4096
v_mfma_f32_16x16x32_bf16 v[72:75], a[36:39], a[116:119], v[72:75]
ds_read_b64_tr_b16 a[72:73], v24 offset:1024
ds_read_b64_tr_b16 a[74:75], v25 offset:1024
v_mfma_f32_16x16x32_bf16 v[76:79], a[32:35], a[120:123], v[76:79]
buffer_load_dwordx4 v12, s[12:15], s35 offen offset:1024 sc1 lds
v_mfma_f32_16x16x32_bf16 v[76:79], a[36:39], a[124:127], v[76:79]
ds_read_b64_tr_b16 a[76:77], v24 offset:5120
ds_read_b64_tr_b16 a[78:79], v25 offset:5120
v_mfma_f32_16x16x32_bf16 v[80:83], a[40:43], a[96:99], v[80:83]
ds_read_b64_tr_b16 a[80:81], v24 offset:2048
ds_read_b64_tr_b16 a[82:83], v25 offset:2048
v_mfma_f32_16x16x32_bf16 v[80:83], a[44:47], a[100:103], v[80:83]
ds_read_b64_tr_b16 a[84:85], v24 offset:6144
ds_read_b64_tr_b16 a[86:87], v25 offset:6144
v_mfma_f32_16x16x32_bf16 v[84:87], a[40:43], a[104:107], v[84:87]
buffer_load_dwordx4 v12, s[12:15], s35 offen offset:2048 sc1 lds
v_mfma_f32_16x16x32_bf16 v[84:87], a[44:47], a[108:111], v[84:87]
ds_read_b64_tr_b16 a[88:89], v24 offset:3072
ds_read_b64_tr_b16 a[90:91], v25 offset:3072
v_mfma_f32_16x16x32_bf16 v[88:91], a[40:43], a[112:115], v[88:91]
ds_read_b64_tr_b16 a[92:93], v24 offset:7168
ds_read_b64_tr_b16 a[94:95], v25 offset:7168
v_mfma_f32_16x16x32_bf16 v[88:91], a[44:47], a[116:119], v[88:91]
ds_read_b64_tr_b16 a[8:9], v17 offset:0
ds_read_b64_tr_b16 a[10:11], v17 offset:4096
v_mfma_f32_16x16x32_bf16 v[92:95], a[40:43], a[120:123], v[92:95]
buffer_load_dwordx4 v12, s[12:15], s35 offen offset:3072 sc1 lds
v_mfma_f32_16x16x32_bf16 v[92:95], a[44:47], a[124:127], v[92:95]
ds_read_b64_tr_b16 a[12:13], v17 offset:8192
ds_read_b64_tr_b16 a[14:15], v17 offset:12288
v_mfma_f32_16x16x32_bf16 v[96:99], a[48:51], a[96:99], v[96:99]
ds_read_b64_tr_b16 a[16:17], v18 offset:0
ds_read_b64_tr_b16 a[18:19], v18 offset:4096
v_mfma_f32_16x16x32_bf16 v[96:99], a[52:55], a[100:103], v[96:99]
s_add_u32 m0, s30, 122880
s_mov_b32 s34, 917504
ds_read_b64_tr_b16 a[20:21], v18 offset:8192
ds_read_b64_tr_b16 a[22:23], v18 offset:12288
v_mfma_f32_16x16x32_bf16 v[100:103], a[48:51], a[104:107], v[100:103]
buffer_load_dwordx4 v156, s[16:19], s34 offen offset:0 lds
v_mfma_f32_16x16x32_bf16 v[100:103], a[52:55], a[108:111], v[100:103]
ds_read_b64_tr_b16 a[24:25], v19 offset:0
ds_read_b64_tr_b16 a[26:27], v19 offset:4096
v_mfma_f32_16x16x32_bf16 v[104:107], a[48:51], a[112:115], v[104:107]
ds_read_b64_tr_b16 a[28:29], v19 offset:8192
ds_read_b64_tr_b16 a[30:31], v19 offset:12288
v_mfma_f32_16x16x32_bf16 v[104:107], a[52:55], a[116:119], v[104:107]
v_mfma_f32_16x16x32_bf16 v[108:111], a[48:51], a[120:123], v[108:111]
buffer_load_dwordx4 v157, s[16:19], s34 offen offset:1024 lds
v_mfma_f32_16x16x32_bf16 v[108:111], a[52:55], a[124:127], v[108:111]
v_mfma_f32_16x16x32_bf16 v[112:115], a[56:59], a[96:99], v[112:115]
s_cmp_lg_u32 s28, 3
s_cbranch_scc1 adaLN_cond__mha_block_cached__glu_gated_bilinear__prompt_kernel_ns6
s_load_dword s60, s[42:43], s3 offset:0 glc
s_load_dword s61, s[42:43], s3 offset:512 glc
s_load_dword s62, s[42:43], s3 offset:1024 glc
s_load_dword s63, s[42:43], s3 offset:1536 glc
s_load_dword s84, s[42:43], s3 offset:64 glc
s_load_dword s85, s[42:43], s3 offset:576 glc
s_load_dword s86, s[42:43], s3 offset:1088 glc
s_load_dword s87, s[42:43], s3 offset:1600 glc
adaLN_cond__mha_block_cached__glu_gated_bilinear__prompt_kernel_ns6:
v_mfma_f32_16x16x32_bf16 v[112:115], a[60:63], a[100:103], v[112:115]
v_mfma_f32_16x16x32_bf16 v[116:119], a[56:59], a[104:107], v[116:119]
buffer_load_dwordx4 v158, s[16:19], s34 offen offset:2048 lds
v_mfma_f32_16x16x32_bf16 v[116:119], a[60:63], a[108:111], v[116:119]
v_mfma_f32_16x16x32_bf16 v[120:123], a[56:59], a[112:115], v[120:123]
v_mfma_f32_16x16x32_bf16 v[120:123], a[60:63], a[116:119], v[120:123]
v_mfma_f32_16x16x32_bf16 v[124:127], a[56:59], a[120:123], v[124:127]
buffer_load_dwordx4 v159, s[16:19], s34 offen offset:3072 lds
v_mfma_f32_16x16x32_bf16 v[124:127], a[60:63], a[124:127], v[124:127]
s_waitcnt lgkmcnt(0)
s_cmp_lg_u32 s28, 3
s_cbranch_scc1 adaLN_cond__mha_block_cached__glu_gated_bilinear__prompt_kernel_pd6
s_mov_b32 s53, 0
s_branch adaLN_cond__mha_block_cached__glu_gated_bilinear__prompt_kernel_pc6
adaLN_cond__mha_block_cached__glu_gated_bilinear__prompt_kernel_pl6:
s_load_dword s60, s[42:43], s3 offset:0 glc
s_load_dword s61, s[42:43], s3 offset:512 glc
s_load_dword s62, s[42:43], s3 offset:1024 glc
s_load_dword s63, s[42:43], s3 offset:1536 glc
s_load_dword s84, s[42:43], s3 offset:64 glc
s_load_dword s85, s[42:43], s3 offset:576 glc
s_load_dword s86, s[42:43], s3 offset:1088 glc
s_load_dword s87, s[42:43], s3 offset:1600 glc
s_add_u32 s53, s53, 1
s_cmp_gt_u32 s53, 200000
s_cbranch_scc1 adaLN_cond__mha_block_cached__glu_gated_bilinear__prompt_kernel_pd6
s_waitcnt lgkmcnt(0)
adaLN_cond__mha_block_cached__glu_gated_bilinear__prompt_kernel_pc6:
s_cmp_eq_u32 s60, s39
s_cbranch_scc0 adaLN_cond__mha_block_cached__glu_gated_bilinear__prompt_kernel_pl6
s_cmp_eq_u32 s61, s39
s_cbranch_scc0 adaLN_cond__mha_block_cached__glu_gated_bilinear__prompt_kernel_pl6
s_cmp_eq_u32 s62, s39
s_cbranch_scc0 adaLN_cond__mha_block_cached__glu_gated_bilinear__prompt_kernel_pl6
s_cmp_eq_u32 s63, s39
s_cbranch_scc0 adaLN_cond__mha_block_cached__glu_gated_bilinear__prompt_kernel_pl6
s_cmp_eq_u32 s84, s39
s_cbranch_scc0 adaLN_cond__mha_block_cached__glu_gated_bilinear__prompt_kernel_pl6
s_cmp_eq_u32 s85, s39
s_cbranch_scc0 adaLN_cond__mha_block_cached__glu_gated_bilinear__prompt_kernel_pl6
s_cmp_eq_u32 s86, s39
s_cbranch_scc0 adaLN_cond__mha_block_cached__glu_gated_bilinear__prompt_kernel_pl6
s_cmp_eq_u32 s87, s39
s_cbranch_scc0 adaLN_cond__mha_block_cached__glu_gated_bilinear__prompt_kernel_pl6
adaLN_cond__mha_block_cached__glu_gated_bilinear__prompt_kernel_pd6:
s_waitcnt vmcnt(16) lgkmcnt(0)
s_barrier
v_mfma_f32_16x16x32_bf16 v[64:67], a[0:3], a[64:67], v[64:67]
ds_read_b64_tr_b16 a[32:33], v16 offset:16384
ds_read_b64_tr_b16 a[34:35], v16 offset:20480
v_mfma_f32_16x16x32_bf16 v[64:67], a[4:7], a[68:71], v[64:67]
s_add_u32 m0, s30, 40960
s_mov_b32 s35, 8192
ds_read_b64_tr_b16 a[36:37], v16 offset:24576
ds_read_b64_tr_b16 a[38:39], v16 offset:28672
v_mfma_f32_16x16x32_bf16 v[68:71], a[0:3], a[72:75], v[68:71]
buffer_load_dwordx4 v12, s[12:15], s35 offen offset:0 sc1 lds
v_mfma_f32_16x16x32_bf16 v[68:71], a[4:7], a[76:79], v[68:71]
ds_read_b64_tr_b16 a[96:97], v24 offset:16384
ds_read_b64_tr_b16 a[98:99], v25 offset:16384
v_mfma_f32_16x16x32_bf16 v[72:75], a[0:3], a[80:83], v[72:75]
ds_read_b64_tr_b16 a[100:101], v24 offset:20480
ds_read_b64_tr_b16 a[102:103], v25 offset:20480
v_mfma_f32_16x16x32_bf16 v[72:75], a[4:7], a[84:87], v[72:75]
ds_read_b64_tr_b16 a[104:105], v24 offset:17408
ds_read_b64_tr_b16 a[106:107], v25 offset:17408
v_mfma_f32_16x16x32_bf16 v[76:79], a[0:3], a[88:91], v[76:79]
buffer_load_dwordx4 v12, s[12:15], s35 offen offset:1024 sc1 lds
v_mfma_f32_16x16x32_bf16 v[76:79], a[4:7], a[92:95], v[76:79]
ds_read_b64_tr_b16 a[108:109], v24 offset:21504
ds_read_b64_tr_b16 a[110:111], v25 offset:21504
v_mfma_f32_16x16x32_bf16 v[80:83], a[8:11], a[64:67], v[80:83]
ds_read_b64_tr_b16 a[112:113], v24 offset:18432
ds_read_b64_tr_b16 a[114:115], v25 offset:18432
v_mfma_f32_16x16x32_bf16 v[80:83], a[12:15], a[68:71], v[80:83]
ds_read_b64_tr_b16 a[116:117], v24 offset:22528
ds_read_b64_tr_b16 a[118:119], v25 offset:22528
v_mfma_f32_16x16x32_bf16 v[84:87], a[8:11], a[72:75], v[84:87]
buffer_load_dwordx4 v12, s[12:15], s35 offen offset:2048 sc1 lds
v_mfma_f32_16x16x32_bf16 v[84:87], a[12:15], a[76:79], v[84:87]
ds_read_b64_tr_b16 a[120:121], v24 offset:19456
ds_read_b64_tr_b16 a[122:123], v25 offset:19456
v_mfma_f32_16x16x32_bf16 v[88:91], a[8:11], a[80:83], v[88:91]
ds_read_b64_tr_b16 a[124:125], v24 offset:23552
ds_read_b64_tr_b16 a[126:127], v25 offset:23552
v_mfma_f32_16x16x32_bf16 v[88:91], a[12:15], a[84:87], v[88:91]
ds_read_b64_tr_b16 a[40:41], v17 offset:16384
ds_read_b64_tr_b16 a[42:43], v17 offset:20480
v_mfma_f32_16x16x32_bf16 v[92:95], a[8:11], a[88:91], v[92:95]
buffer_load_dwordx4 v12, s[12:15], s35 offen offset:3072 sc1 lds
v_mfma_f32_16x16x32_bf16 v[92:95], a[12:15], a[92:95], v[92:95]
ds_read_b64_tr_b16 a[44:45], v17 offset:24576
ds_read_b64_tr_b16 a[46:47], v17 offset:28672
v_mfma_f32_16x16x32_bf16 v[96:99], a[16:19], a[64:67], v[96:99]
ds_read_b64_tr_b16 a[48:49], v18 offset:16384
ds_read_b64_tr_b16 a[50:51], v18 offset:20480
v_mfma_f32_16x16x32_bf16 v[96:99], a[20:23], a[68:71], v[96:99]
s_add_u32 m0, s30, 8192
s_mov_b32 s34, 65536
ds_read_b64_tr_b16 a[52:53], v18 offset:24576
ds_read_b64_tr_b16 a[54:55], v18 offset:28672
v_mfma_f32_16x16x32_bf16 v[100:103], a[16:19], a[72:75], v[100:103]
buffer_load_dwordx4 v156, s[16:19], s34 offen offset:0 lds
v_mfma_f32_16x16x32_bf16 v[100:103], a[20:23], a[76:79], v[100:103]
ds_read_b64_tr_b16 a[56:57], v19 offset:16384
ds_read_b64_tr_b16 a[58:59], v19 offset:20480
v_mfma_f32_16x16x32_bf16 v[104:107], a[16:19], a[80:83], v[104:107]
ds_read_b64_tr_b16 a[60:61], v19 offset:24576
ds_read_b64_tr_b16 a[62:63], v19 offset:28672
v_mfma_f32_16x16x32_bf16 v[104:107], a[20:23], a[84:87], v[104:107]
v_mfma_f32_16x16x32_bf16 v[108:111], a[16:19], a[88:91], v[108:111]
buffer_load_dwordx4 v157, s[16:19], s34 offen offset:1024 lds
v_mfma_f32_16x16x32_bf16 v[108:111], a[20:23], a[92:95], v[108:111]
v_mfma_f32_16x16x32_bf16 v[112:115], a[24:27], a[64:67], v[112:115]
v_mfma_f32_16x16x32_bf16 v[112:115], a[28:31], a[68:71], v[112:115]
v_mfma_f32_16x16x32_bf16 v[116:119], a[24:27], a[72:75], v[116:119]
buffer_load_dwordx4 v158, s[16:19], s34 offen offset:2048 lds
v_mfma_f32_16x16x32_bf16 v[116:119], a[28:31], a[76:79], v[116:119]
v_mfma_f32_16x16x32_bf16 v[120:123], a[24:27], a[80:83], v[120:123]
v_mfma_f32_16x16x32_bf16 v[120:123], a[28:31], a[84:87], v[120:123]
v_mfma_f32_16x16x32_bf16 v[124:127], a[24:27], a[88:91], v[124:127]
buffer_load_dwordx4 v159, s[16:19], s34 offen offset:3072 lds
v_mfma_f32_16x16x32_bf16 v[124:127], a[28:31], a[92:95], v[124:127]
s_waitcnt vmcnt(16) lgkmcnt(0)
s_barrier
v_mfma_f32_16x16x32_bf16 v[64:67], a[32:35], a[96:99], v[64:67]
ds_read_b64_tr_b16 a[0:1], v20 offset:0
ds_read_b64_tr_b16 a[2:3], v20 offset:4096
v_mfma_f32_16x16x32_bf16 v[64:67], a[36:39], a[100:103], v[64:67]
s_add_u32 m0, s30, 57344
s_mov_b32 s35, 24576
ds_read_b64_tr_b16 a[4:5], v20 offset:8192
ds_read_b64_tr_b16 a[6:7], v20 offset:12288
v_mfma_f32_16x16x32_bf16 v[68:71], a[32:35], a[104:107], v[68:71]
buffer_load_dwordx4 v12, s[12:15], s35 offen offset:0 sc1 lds
v_mfma_f32_16x16x32_bf16 v[68:71], a[36:39], a[108:111], v[68:71]
ds_read_b64_tr_b16 a[64:65], v26 offset:0
ds_read_b64_tr_b16 a[66:67], v27 offset:0
v_mfma_f32_16x16x32_bf16 v[72:75], a[32:35], a[112:115], v[72:75]
ds_read_b64_tr_b16 a[68:69], v26 offset:4096
ds_read_b64_tr_b16 a[70:71], v27 offset:4096
v_mfma_f32_16x16x32_bf16 v[72:75], a[36:39], a[116:119], v[72:75]
ds_read_b64_tr_b16 a[72:73], v26 offset:1024
ds_read_b64_tr_b16 a[74:75], v27 offset:1024
v_mfma_f32_16x16x32_bf16 v[76:79], a[32:35], a[120:123], v[76:79]
buffer_load_dwordx4 v12, s[12:15], s35 offen offset:1024 sc1 lds
v_mfma_f32_16x16x32_bf16 v[76:79], a[36:39], a[124:127], v[76:79]
ds_read_b64_tr_b16 a[76:77], v26 offset:5120
ds_read_b64_tr_b16 a[78:79], v27 offset:5120
v_mfma_f32_16x16x32_bf16 v[80:83], a[40:43], a[96:99], v[80:83]
ds_read_b64_tr_b16 a[80:81], v26 offset:2048
ds_read_b64_tr_b16 a[82:83], v27 offset:2048
v_mfma_f32_16x16x32_bf16 v[80:83], a[44:47], a[100:103], v[80:83]
ds_read_b64_tr_b16 a[84:85], v26 offset:6144
ds_read_b64_tr_b16 a[86:87], v27 offset:6144
v_mfma_f32_16x16x32_bf16 v[84:87], a[40:43], a[104:107], v[84:87]
buffer_load_dwordx4 v12, s[12:15], s35 offen offset:2048 sc1 lds
v_mfma_f32_16x16x32_bf16 v[84:87], a[44:47], a[108:111], v[84:87]
ds_read_b64_tr_b16 a[88:89], v26 offset:3072
ds_read_b64_tr_b16 a[90:91], v27 offset:3072
v_mfma_f32_16x16x32_bf16 v[88:91], a[40:43], a[112:115], v[88:91]
ds_read_b64_tr_b16 a[92:93], v26 offset:7168
ds_read_b64_tr_b16 a[94:95], v27 offset:7168
v_mfma_f32_16x16x32_bf16 v[88:91], a[44:47], a[116:119], v[88:91]
ds_read_b64_tr_b16 a[8:9], v21 offset:0
ds_read_b64_tr_b16 a[10:11], v21 offset:4096
v_mfma_f32_16x16x32_bf16 v[92:95], a[40:43], a[120:123], v[92:95]
buffer_load_dwordx4 v12, s[12:15], s35 offen offset:3072 sc1 lds
v_mfma_f32_16x16x32_bf16 v[92:95], a[44:47], a[124:127], v[92:95]
ds_read_b64_tr_b16 a[12:13], v21 offset:8192
ds_read_b64_tr_b16 a[14:15], v21 offset:12288
v_mfma_f32_16x16x32_bf16 v[96:99], a[48:51], a[96:99], v[96:99]
ds_read_b64_tr_b16 a[16:17], v22 offset:0
ds_read_b64_tr_b16 a[18:19], v22 offset:4096
v_mfma_f32_16x16x32_bf16 v[96:99], a[52:55], a[100:103], v[96:99]
s_add_u32 m0, s30, 24576
s_mov_b32 s34, 196608
ds_read_b64_tr_b16 a[20:21], v22 offset:8192
ds_read_b64_tr_b16 a[22:23], v22 offset:12288
v_mfma_f32_16x16x32_bf16 v[100:103], a[48:51], a[104:107], v[100:103]
buffer_load_dwordx4 v156, s[16:19], s34 offen offset:0 lds
v_mfma_f32_16x16x32_bf16 v[100:103], a[52:55], a[108:111], v[100:103]
ds_read_b64_tr_b16 a[24:25], v23 offset:0
ds_read_b64_tr_b16 a[26:27], v23 offset:4096
v_mfma_f32_16x16x32_bf16 v[104:107], a[48:51], a[112:115], v[104:107]
ds_read_b64_tr_b16 a[28:29], v23 offset:8192
ds_read_b64_tr_b16 a[30:31], v23 offset:12288
v_mfma_f32_16x16x32_bf16 v[104:107], a[52:55], a[116:119], v[104:107]
v_mfma_f32_16x16x32_bf16 v[108:111], a[48:51], a[120:123], v[108:111]
buffer_load_dwordx4 v157, s[16:19], s34 offen offset:1024 lds
v_mfma_f32_16x16x32_bf16 v[108:111], a[52:55], a[124:127], v[108:111]
v_mfma_f32_16x16x32_bf16 v[112:115], a[56:59], a[96:99], v[112:115]
v_mfma_f32_16x16x32_bf16 v[112:115], a[60:63], a[100:103], v[112:115]
v_mfma_f32_16x16x32_bf16 v[116:119], a[56:59], a[104:107], v[116:119]
buffer_load_dwordx4 v158, s[16:19], s34 offen offset:2048 lds
v_mfma_f32_16x16x32_bf16 v[116:119], a[60:63], a[108:111], v[116:119]
v_mfma_f32_16x16x32_bf16 v[120:123], a[56:59], a[112:115], v[120:123]
v_mfma_f32_16x16x32_bf16 v[120:123], a[60:63], a[116:119], v[120:123]
v_mfma_f32_16x16x32_bf16 v[124:127], a[56:59], a[120:123], v[124:127]
buffer_load_dwordx4 v159, s[16:19], s34 offen offset:3072 lds
v_mfma_f32_16x16x32_bf16 v[124:127], a[60:63], a[124:127], v[124:127]
s_waitcnt vmcnt(16) lgkmcnt(0)
s_barrier
v_mfma_f32_16x16x32_bf16 v[64:67], a[0:3], a[64:67], v[64:67]
ds_read_b64_tr_b16 a[32:33], v20 offset:49152
ds_read_b64_tr_b16 a[34:35], v20 offset:53248
v_mfma_f32_16x16x32_bf16 v[64:67], a[4:7], a[68:71], v[64:67]
s_add_u32 m0, s30, 90112
s_mov_b32 s35, 40960
ds_read_b64_tr_b16 a[36:37], v20 offset:57344
ds_read_b64_tr_b16 a[38:39], v20 offset:61440
v_mfma_f32_16x16x32_bf16 v[68:71], a[0:3], a[72:75], v[68:71]
buffer_load_dwordx4 v12, s[12:15], s35 offen offset:0 sc1 lds
v_mfma_f32_16x16x32_bf16 v[68:71], a[4:7], a[76:79], v[68:71]
ds_read_b64_tr_b16 a[96:97], v26 offset:16384
ds_read_b64_tr_b16 a[98:99], v27 offset:16384
v_mfma_f32_16x16x32_bf16 v[72:75], a[0:3], a[80:83], v[72:75]
ds_read_b64_tr_b16 a[100:101], v26 offset:20480
ds_read_b64_tr_b16 a[102:103], v27 offset:20480
v_mfma_f32_16x16x32_bf16 v[72:75], a[4:7], a[84:87], v[72:75]
ds_read_b64_tr_b16 a[104:105], v26 offset:17408
ds_read_b64_tr_b16 a[106:107], v27 offset:17408
v_mfma_f32_16x16x32_bf16 v[76:79], a[0:3], a[88:91], v[76:79]
buffer_load_dwordx4 v12, s[12:15], s35 offen offset:1024 sc1 lds
v_mfma_f32_16x16x32_bf16 v[76:79], a[4:7], a[92:95], v[76:79]
ds_read_b64_tr_b16 a[108:109], v26 offset:21504
ds_read_b64_tr_b16 a[110:111], v27 offset:21504
v_mfma_f32_16x16x32_bf16 v[80:83], a[8:11], a[64:67], v[80:83]
ds_read_b64_tr_b16 a[112:113], v26 offset:18432
ds_read_b64_tr_b16 a[114:115], v27 offset:18432
v_mfma_f32_16x16x32_bf16 v[80:83], a[12:15], a[68:71], v[80:83]
ds_read_b64_tr_b16 a[116:117], v26 offset:22528
ds_read_b64_tr_b16 a[118:119], v27 offset:22528
v_mfma_f32_16x16x32_bf16 v[84:87], a[8:11], a[72:75], v[84:87]
buffer_load_dwordx4 v12, s[12:15], s35 offen offset:2048 sc1 lds
v_mfma_f32_16x16x32_bf16 v[84:87], a[12:15], a[76:79], v[84:87]
ds_read_b64_tr_b16 a[120:121], v26 offset:19456
ds_read_b64_tr_b16 a[122:123], v27 offset:19456
v_mfma_f32_16x16x32_bf16 v[88:91], a[8:11], a[80:83], v[88:91]
ds_read_b64_tr_b16 a[124:125], v26 offset:23552
ds_read_b64_tr_b16 a[126:127], v27 offset:23552
v_mfma_f32_16x16x32_bf16 v[88:91], a[12:15], a[84:87], v[88:91]
ds_read_b64_tr_b16 a[40:41], v21 offset:49152
ds_read_b64_tr_b16 a[42:43], v21 offset:53248
v_mfma_f32_16x16x32_bf16 v[92:95], a[8:11], a[88:91], v[92:95]
buffer_load_dwordx4 v12, s[12:15], s35 offen offset:3072 sc1 lds
v_mfma_f32_16x16x32_bf16 v[92:95], a[12:15], a[92:95], v[92:95]
ds_read_b64_tr_b16 a[44:45], v21 offset:57344
ds_read_b64_tr_b16 a[46:47], v21 offset:61440
v_mfma_f32_16x16x32_bf16 v[96:99], a[16:19], a[64:67], v[96:99]
ds_read_b64_tr_b16 a[48:49], v22 offset:49152
ds_read_b64_tr_b16 a[50:51], v22 offset:53248
v_mfma_f32_16x16x32_bf16 v[96:99], a[20:23], a[68:71], v[96:99]
s_add_u32 m0, s30, 73728
s_mov_b32 s34, 327680
ds_read_b64_tr_b16 a[52:53], v22 offset:57344
ds_read_b64_tr_b16 a[54:55], v22 offset:61440
v_mfma_f32_16x16x32_bf16 v[100:103], a[16:19], a[72:75], v[100:103]
buffer_load_dwordx4 v156, s[16:19], s34 offen offset:0 lds
v_mfma_f32_16x16x32_bf16 v[100:103], a[20:23], a[76:79], v[100:103]
ds_read_b64_tr_b16 a[56:57], v23 offset:49152
ds_read_b64_tr_b16 a[58:59], v23 offset:53248
v_mfma_f32_16x16x32_bf16 v[104:107], a[16:19], a[80:83], v[104:107]
ds_read_b64_tr_b16 a[60:61], v23 offset:57344
ds_read_b64_tr_b16 a[62:63], v23 offset:61440
v_mfma_f32_16x16x32_bf16 v[104:107], a[20:23], a[84:87], v[104:107]
v_mfma_f32_16x16x32_bf16 v[108:111], a[16:19], a[88:91], v[108:111]
buffer_load_dwordx4 v157, s[16:19], s34 offen offset:1024 lds
v_mfma_f32_16x16x32_bf16 v[108:111], a[20:23], a[92:95], v[108:111]
v_mfma_f32_16x16x32_bf16 v[112:115], a[24:27], a[64:67], v[112:115]
v_mfma_f32_16x16x32_bf16 v[112:115], a[28:31], a[68:71], v[112:115]
v_mfma_f32_16x16x32_bf16 v[116:119], a[24:27], a[72:75], v[116:119]
buffer_load_dwordx4 v158, s[16:19], s34 offen offset:2048 lds
v_mfma_f32_16x16x32_bf16 v[116:119], a[28:31], a[76:79], v[116:119]
v_mfma_f32_16x16x32_bf16 v[120:123], a[24:27], a[80:83], v[120:123]
v_mfma_f32_16x16x32_bf16 v[120:123], a[28:31], a[84:87], v[120:123]
v_mfma_f32_16x16x32_bf16 v[124:127], a[24:27], a[88:91], v[124:127]
buffer_load_dwordx4 v159, s[16:19], s34 offen offset:3072 lds
v_mfma_f32_16x16x32_bf16 v[124:127], a[28:31], a[92:95], v[124:127]
s_waitcnt vmcnt(16) lgkmcnt(0)
s_barrier
v_mfma_f32_16x16x32_bf16 v[64:67], a[32:35], a[96:99], v[64:67]
ds_read_b64_tr_b16 a[0:1], v16 offset:0
ds_read_b64_tr_b16 a[2:3], v16 offset:4096
v_mfma_f32_16x16x32_bf16 v[64:67], a[36:39], a[100:103], v[64:67]
s_add_u32 m0, s30, 106496
s_mov_b32 s35, 57344
ds_read_b64_tr_b16 a[4:5], v16 offset:8192
ds_read_b64_tr_b16 a[6:7], v16 offset:12288
v_mfma_f32_16x16x32_bf16 v[68:71], a[32:35], a[104:107], v[68:71]
buffer_load_dwordx4 v12, s[12:15], s35 offen offset:0 sc1 lds
v_mfma_f32_16x16x32_bf16 v[68:71], a[36:39], a[108:111], v[68:71]
ds_read_b64_tr_b16 a[64:65], v24 offset:0
ds_read_b64_tr_b16 a[66:67], v25 offset:0
v_mfma_f32_16x16x32_bf16 v[72:75], a[32:35], a[112:115], v[72:75]
ds_read_b64_tr_b16 a[68:69], v24 offset:4096
ds_read_b64_tr_b16 a[70:71], v25 offset:4096
v_mfma_f32_16x16x32_bf16 v[72:75], a[36:39], a[116:119], v[72:75]
ds_read_b64_tr_b16 a[72:73], v24 offset:1024
ds_read_b64_tr_b16 a[74:75], v25 offset:1024
v_mfma_f32_16x16x32_bf16 v[76:79], a[32:35], a[120:123], v[76:79]
buffer_load_dwordx4 v12, s[12:15], s35 offen offset:1024 sc1 lds
v_mfma_f32_16x16x32_bf16 v[76:79], a[36:39], a[124:127], v[76:79]
ds_read_b64_tr_b16 a[76:77], v24 offset:5120
ds_read_b64_tr_b16 a[78:79], v25 offset:5120
v_mfma_f32_16x16x32_bf16 v[80:83], a[40:43], a[96:99], v[80:83]
ds_read_b64_tr_b16 a[80:81], v24 offset:2048
ds_read_b64_tr_b16 a[82:83], v25 offset:2048
v_mfma_f32_16x16x32_bf16 v[80:83], a[44:47], a[100:103], v[80:83]
ds_read_b64_tr_b16 a[84:85], v24 offset:6144
ds_read_b64_tr_b16 a[86:87], v25 offset:6144
v_mfma_f32_16x16x32_bf16 v[84:87], a[40:43], a[104:107], v[84:87]
buffer_load_dwordx4 v12, s[12:15], s35 offen offset:2048 sc1 lds
v_mfma_f32_16x16x32_bf16 v[84:87], a[44:47], a[108:111], v[84:87]
ds_read_b64_tr_b16 a[88:89], v24 offset:3072
ds_read_b64_tr_b16 a[90:91], v25 offset:3072
v_mfma_f32_16x16x32_bf16 v[88:91], a[40:43], a[112:115], v[88:91]
ds_read_b64_tr_b16 a[92:93], v24 offset:7168
ds_read_b64_tr_b16 a[94:95], v25 offset:7168
v_mfma_f32_16x16x32_bf16 v[88:91], a[44:47], a[116:119], v[88:91]
ds_read_b64_tr_b16 a[8:9], v17 offset:0
ds_read_b64_tr_b16 a[10:11], v17 offset:4096
v_mfma_f32_16x16x32_bf16 v[92:95], a[40:43], a[120:123], v[92:95]
buffer_load_dwordx4 v12, s[12:15], s35 offen offset:3072 sc1 lds
v_mfma_f32_16x16x32_bf16 v[92:95], a[44:47], a[124:127], v[92:95]
ds_read_b64_tr_b16 a[12:13], v17 offset:8192
ds_read_b64_tr_b16 a[14:15], v17 offset:12288
v_mfma_f32_16x16x32_bf16 v[96:99], a[48:51], a[96:99], v[96:99]
ds_read_b64_tr_b16 a[16:17], v18 offset:0
ds_read_b64_tr_b16 a[18:19], v18 offset:4096
v_mfma_f32_16x16x32_bf16 v[96:99], a[52:55], a[100:103], v[96:99]
s_add_u32 m0, s30, 122880
s_mov_b32 s34, 458752
ds_read_b64_tr_b16 a[20:21], v18 offset:8192
ds_read_b64_tr_b16 a[22:23], v18 offset:12288
v_mfma_f32_16x16x32_bf16 v[100:103], a[48:51], a[104:107], v[100:103]
buffer_load_dwordx4 v156, s[16:19], s34 offen offset:0 lds
v_mfma_f32_16x16x32_bf16 v[100:103], a[52:55], a[108:111], v[100:103]
ds_read_b64_tr_b16 a[24:25], v19 offset:0
ds_read_b64_tr_b16 a[26:27], v19 offset:4096
v_mfma_f32_16x16x32_bf16 v[104:107], a[48:51], a[112:115], v[104:107]
ds_read_b64_tr_b16 a[28:29], v19 offset:8192
ds_read_b64_tr_b16 a[30:31], v19 offset:12288
v_mfma_f32_16x16x32_bf16 v[104:107], a[52:55], a[116:119], v[104:107]
v_mfma_f32_16x16x32_bf16 v[108:111], a[48:51], a[120:123], v[108:111]
buffer_load_dwordx4 v157, s[16:19], s34 offen offset:1024 lds
v_mfma_f32_16x16x32_bf16 v[108:111], a[52:55], a[124:127], v[108:111]
v_mfma_f32_16x16x32_bf16 v[112:115], a[56:59], a[96:99], v[112:115]
v_mfma_f32_16x16x32_bf16 v[112:115], a[60:63], a[100:103], v[112:115]
v_mfma_f32_16x16x32_bf16 v[116:119], a[56:59], a[104:107], v[116:119]
buffer_load_dwordx4 v158, s[16:19], s34 offen offset:2048 lds
v_mfma_f32_16x16x32_bf16 v[116:119], a[60:63], a[108:111], v[116:119]
v_mfma_f32_16x16x32_bf16 v[120:123], a[56:59], a[112:115], v[120:123]
v_mfma_f32_16x16x32_bf16 v[120:123], a[60:63], a[116:119], v[120:123]
v_mfma_f32_16x16x32_bf16 v[124:127], a[56:59], a[120:123], v[124:127]
buffer_load_dwordx4 v159, s[16:19], s34 offen offset:3072 lds
v_mfma_f32_16x16x32_bf16 v[124:127], a[60:63], a[124:127], v[124:127]
s_waitcnt vmcnt(16) lgkmcnt(0)
s_barrier
v_mfma_f32_16x16x32_bf16 v[64:67], a[0:3], a[64:67], v[64:67]
ds_read_b64_tr_b16 a[32:33], v16 offset:16384
ds_read_b64_tr_b16 a[34:35], v16 offset:20480
v_mfma_f32_16x16x32_bf16 v[64:67], a[4:7], a[68:71], v[64:67]
s_add_u32 m0, s30, 40960
s_mov_b32 s35, 73728
ds_read_b64_tr_b16 a[36:37], v16 offset:24576
ds_read_b64_tr_b16 a[38:39], v16 offset:28672
v_mfma_f32_16x16x32_bf16 v[68:71], a[0:3], a[72:75], v[68:71]
buffer_load_dwordx4 v12, s[12:15], s35 offen offset:0 sc1 lds
v_mfma_f32_16x16x32_bf16 v[68:71], a[4:7], a[76:79], v[68:71]
ds_read_b64_tr_b16 a[96:97], v24 offset:16384
ds_read_b64_tr_b16 a[98:99], v25 offset:16384
v_mfma_f32_16x16x32_bf16 v[72:75], a[0:3], a[80:83], v[72:75]
ds_read_b64_tr_b16 a[100:101], v24 offset:20480
ds_read_b64_tr_b16 a[102:103], v25 offset:20480
v_mfma_f32_16x16x32_bf16 v[72:75], a[4:7], a[84:87], v[72:75]
ds_read_b64_tr_b16 a[104:105], v24 offset:17408
ds_read_b64_tr_b16 a[106:107], v25 offset:17408
v_mfma_f32_16x16x32_bf16 v[76:79], a[0:3], a[88:91], v[76:79]
buffer_load_dwordx4 v12, s[12:15], s35 offen offset:1024 sc1 lds
v_mfma_f32_16x16x32_bf16 v[76:79], a[4:7], a[92:95], v[76:79]
ds_read_b64_tr_b16 a[108:109], v24 offset:21504
ds_read_b64_tr_b16 a[110:111], v25 offset:21504
v_mfma_f32_16x16x32_bf16 v[80:83], a[8:11], a[64:67], v[80:83]
ds_read_b64_tr_b16 a[112:113], v24 offset:18432
ds_read_b64_tr_b16 a[114:115], v25 offset:18432
v_mfma_f32_16x16x32_bf16 v[80:83], a[12:15], a[68:71], v[80:83]
ds_read_b64_tr_b16 a[116:117], v24 offset:22528
ds_read_b64_tr_b16 a[118:119], v25 offset:22528
v_mfma_f32_16x16x32_bf16 v[84:87], a[8:11], a[72:75], v[84:87]
buffer_load_dwordx4 v12, s[12:15], s35 offen offset:2048 sc1 lds
v_mfma_f32_16x16x32_bf16 v[84:87], a[12:15], a[76:79], v[84:87]
ds_read_b64_tr_b16 a[120:121], v24 offset:19456
ds_read_b64_tr_b16 a[122:123], v25 offset:19456
v_mfma_f32_16x16x32_bf16 v[88:91], a[8:11], a[80:83], v[88:91]
ds_read_b64_tr_b16 a[124:125], v24 offset:23552
ds_read_b64_tr_b16 a[126:127], v25 offset:23552
v_mfma_f32_16x16x32_bf16 v[88:91], a[12:15], a[84:87], v[88:91]
ds_read_b64_tr_b16 a[40:41], v17 offset:16384
ds_read_b64_tr_b16 a[42:43], v17 offset:20480
v_mfma_f32_16x16x32_bf16 v[92:95], a[8:11], a[88:91], v[92:95]
buffer_load_dwordx4 v12, s[12:15], s35 offen offset:3072 sc1 lds
v_mfma_f32_16x16x32_bf16 v[92:95], a[12:15], a[92:95], v[92:95]
ds_read_b64_tr_b16 a[44:45], v17 offset:24576
ds_read_b64_tr_b16 a[46:47], v17 offset:28672
v_mfma_f32_16x16x32_bf16 v[96:99], a[16:19], a[64:67], v[96:99]
ds_read_b64_tr_b16 a[48:49], v18 offset:16384
ds_read_b64_tr_b16 a[50:51], v18 offset:20480
v_mfma_f32_16x16x32_bf16 v[96:99], a[20:23], a[68:71], v[96:99]
s_add_u32 m0, s30, 8192
s_mov_b32 s34, 589824
ds_read_b64_tr_b16 a[52:53], v18 offset:24576
ds_read_b64_tr_b16 a[54:55], v18 offset:28672
v_mfma_f32_16x16x32_bf16 v[100:103], a[16:19], a[72:75], v[100:103]
buffer_load_dwordx4 v156, s[16:19], s34 offen offset:0 lds
v_mfma_f32_16x16x32_bf16 v[100:103], a[20:23], a[76:79], v[100:103]
ds_read_b64_tr_b16 a[56:57], v19 offset:16384
ds_read_b64_tr_b16 a[58:59], v19 offset:20480
v_mfma_f32_16x16x32_bf16 v[104:107], a[16:19], a[80:83], v[104:107]
ds_read_b64_tr_b16 a[60:61], v19 offset:24576
ds_read_b64_tr_b16 a[62:63], v19 offset:28672
v_mfma_f32_16x16x32_bf16 v[104:107], a[20:23], a[84:87], v[104:107]
v_mfma_f32_16x16x32_bf16 v[108:111], a[16:19], a[88:91], v[108:111]
buffer_load_dwordx4 v157, s[16:19], s34 offen offset:1024 lds
v_mfma_f32_16x16x32_bf16 v[108:111], a[20:23], a[92:95], v[108:111]
v_mfma_f32_16x16x32_bf16 v[112:115], a[24:27], a[64:67], v[112:115]
v_mfma_f32_16x16x32_bf16 v[112:115], a[28:31], a[68:71], v[112:115]
v_mfma_f32_16x16x32_bf16 v[116:119], a[24:27], a[72:75], v[116:119]
buffer_load_dwordx4 v158, s[16:19], s34 offen offset:2048 lds
v_mfma_f32_16x16x32_bf16 v[116:119], a[28:31], a[76:79], v[116:119]
v_mfma_f32_16x16x32_bf16 v[120:123], a[24:27], a[80:83], v[120:123]
v_mfma_f32_16x16x32_bf16 v[120:123], a[28:31], a[84:87], v[120:123]
v_mfma_f32_16x16x32_bf16 v[124:127], a[24:27], a[88:91], v[124:127]
buffer_load_dwordx4 v159, s[16:19], s34 offen offset:3072 lds
v_mfma_f32_16x16x32_bf16 v[124:127], a[28:31], a[92:95], v[124:127]
s_waitcnt vmcnt(16) lgkmcnt(0)
s_barrier
v_mfma_f32_16x16x32_bf16 v[64:67], a[32:35], a[96:99], v[64:67]
ds_read_b64_tr_b16 a[0:1], v20 offset:0
ds_read_b64_tr_b16 a[2:3], v20 offset:4096
v_mfma_f32_16x16x32_bf16 v[64:67], a[36:39], a[100:103], v[64:67]
s_add_u32 m0, s30, 57344
s_mov_b32 s35, 90112
ds_read_b64_tr_b16 a[4:5], v20 offset:8192
ds_read_b64_tr_b16 a[6:7], v20 offset:12288
v_mfma_f32_16x16x32_bf16 v[68:71], a[32:35], a[104:107], v[68:71]
buffer_load_dwordx4 v12, s[12:15], s35 offen offset:0 sc1 lds
v_mfma_f32_16x16x32_bf16 v[68:71], a[36:39], a[108:111], v[68:71]
ds_read_b64_tr_b16 a[64:65], v26 offset:0
ds_read_b64_tr_b16 a[66:67], v27 offset:0
v_mfma_f32_16x16x32_bf16 v[72:75], a[32:35], a[112:115], v[72:75]
ds_read_b64_tr_b16 a[68:69], v26 offset:4096
ds_read_b64_tr_b16 a[70:71], v27 offset:4096
v_mfma_f32_16x16x32_bf16 v[72:75], a[36:39], a[116:119], v[72:75]
ds_read_b64_tr_b16 a[72:73], v26 offset:1024
ds_read_b64_tr_b16 a[74:75], v27 offset:1024
v_mfma_f32_16x16x32_bf16 v[76:79], a[32:35], a[120:123], v[76:79]
buffer_load_dwordx4 v12, s[12:15], s35 offen offset:1024 sc1 lds
v_mfma_f32_16x16x32_bf16 v[76:79], a[36:39], a[124:127], v[76:79]
ds_read_b64_tr_b16 a[76:77], v26 offset:5120
ds_read_b64_tr_b16 a[78:79], v27 offset:5120
v_mfma_f32_16x16x32_bf16 v[80:83], a[40:43], a[96:99], v[80:83]
ds_read_b64_tr_b16 a[80:81], v26 offset:2048
ds_read_b64_tr_b16 a[82:83], v27 offset:2048
v_mfma_f32_16x16x32_bf16 v[80:83], a[44:47], a[100:103], v[80:83]
ds_read_b64_tr_b16 a[84:85], v26 offset:6144
ds_read_b64_tr_b16 a[86:87], v27 offset:6144
v_mfma_f32_16x16x32_bf16 v[84:87], a[40:43], a[104:107], v[84:87]
buffer_load_dwordx4 v12, s[12:15], s35 offen offset:2048 sc1 lds
v_mfma_f32_16x16x32_bf16 v[84:87], a[44:47], a[108:111], v[84:87]
ds_read_b64_tr_b16 a[88:89], v26 offset:3072
ds_read_b64_tr_b16 a[90:91], v27 offset:3072
v_mfma_f32_16x16x32_bf16 v[88:91], a[40:43], a[112:115], v[88:91]
ds_read_b64_tr_b16 a[92:93], v26 offset:7168
ds_read_b64_tr_b16 a[94:95], v27 offset:7168
v_mfma_f32_16x16x32_bf16 v[88:91], a[44:47], a[116:119], v[88:91]
ds_read_b64_tr_b16 a[8:9], v21 offset:0
ds_read_b64_tr_b16 a[10:11], v21 offset:4096
v_mfma_f32_16x16x32_bf16 v[92:95], a[40:43], a[120:123], v[92:95]
buffer_load_dwordx4 v12, s[12:15], s35 offen offset:3072 sc1 lds
v_mfma_f32_16x16x32_bf16 v[92:95], a[44:47], a[124:127], v[92:95]
ds_read_b64_tr_b16 a[12:13], v21 offset:8192
ds_read_b64_tr_b16 a[14:15], v21 offset:12288
v_mfma_f32_16x16x32_bf16 v[96:99], a[48:51], a[96:99], v[96:99]
ds_read_b64_tr_b16 a[16:17], v22 offset:0
ds_read_b64_tr_b16 a[18:19], v22 offset:4096
v_mfma_f32_16x16x32_bf16 v[96:99], a[52:55], a[100:103], v[96:99]
s_add_u32 m0, s30, 24576
s_mov_b32 s34, 720896
ds_read_b64_tr_b16 a[20:21], v22 offset:8192
ds_read_b64_tr_b16 a[22:23], v22 offset:12288
v_mfma_f32_16x16x32_bf16 v[100:103], a[48:51], a[104:107], v[100:103]
buffer_load_dwordx4 v156, s[16:19], s34 offen offset:0 lds
v_mfma_f32_16x16x32_bf16 v[100:103], a[52:55], a[108:111], v[100:103]
ds_read_b64_tr_b16 a[24:25], v23 offset:0
ds_read_b64_tr_b16 a[26:27], v23 offset:4096
v_mfma_f32_16x16x32_bf16 v[104:107], a[48:51], a[112:115], v[104:107]
ds_read_b64_tr_b16 a[28:29], v23 offset:8192
ds_read_b64_tr_b16 a[30:31], v23 offset:12288
v_mfma_f32_16x16x32_bf16 v[104:107], a[52:55], a[116:119], v[104:107]
v_mfma_f32_16x16x32_bf16 v[108:111], a[48:51], a[120:123], v[108:111]
buffer_load_dwordx4 v157, s[16:19], s34 offen offset:1024 lds
v_mfma_f32_16x16x32_bf16 v[108:111], a[52:55], a[124:127], v[108:111]
v_mfma_f32_16x16x32_bf16 v[112:115], a[56:59], a[96:99], v[112:115]
v_mfma_f32_16x16x32_bf16 v[112:115], a[60:63], a[100:103], v[112:115]
v_mfma_f32_16x16x32_bf16 v[116:119], a[56:59], a[104:107], v[116:119]
buffer_load_dwordx4 v158, s[16:19], s34 offen offset:2048 lds
v_mfma_f32_16x16x32_bf16 v[116:119], a[60:63], a[108:111], v[116:119]
v_mfma_f32_16x16x32_bf16 v[120:123], a[56:59], a[112:115], v[120:123]
v_mfma_f32_16x16x32_bf16 v[120:123], a[60:63], a[116:119], v[120:123]
v_mfma_f32_16x16x32_bf16 v[124:127], a[56:59], a[120:123], v[124:127]
buffer_load_dwordx4 v159, s[16:19], s34 offen offset:3072 lds
v_mfma_f32_16x16x32_bf16 v[124:127], a[60:63], a[124:127], v[124:127]
s_waitcnt vmcnt(16) lgkmcnt(0)
s_barrier
v_mfma_f32_16x16x32_bf16 v[64:67], a[0:3], a[64:67], v[64:67]
ds_read_b64_tr_b16 a[32:33], v20 offset:49152
ds_read_b64_tr_b16 a[34:35], v20 offset:53248
v_mfma_f32_16x16x32_bf16 v[64:67], a[4:7], a[68:71], v[64:67]
s_add_u32 m0, s30, 90112
s_mov_b32 s35, 106496
ds_read_b64_tr_b16 a[36:37], v20 offset:57344
ds_read_b64_tr_b16 a[38:39], v20 offset:61440
v_mfma_f32_16x16x32_bf16 v[68:71], a[0:3], a[72:75], v[68:71]
buffer_load_dwordx4 v12, s[12:15], s35 offen offset:0 sc1 lds
v_mfma_f32_16x16x32_bf16 v[68:71], a[4:7], a[76:79], v[68:71]
ds_read_b64_tr_b16 a[96:97], v26 offset:16384
ds_read_b64_tr_b16 a[98:99], v27 offset:16384
v_mfma_f32_16x16x32_bf16 v[72:75], a[0:3], a[80:83], v[72:75]
ds_read_b64_tr_b16 a[100:101], v26 offset:20480
ds_read_b64_tr_b16 a[102:103], v27 offset:20480
v_mfma_f32_16x16x32_bf16 v[72:75], a[4:7], a[84:87], v[72:75]
ds_read_b64_tr_b16 a[104:105], v26 offset:17408
ds_read_b64_tr_b16 a[106:107], v27 offset:17408
v_mfma_f32_16x16x32_bf16 v[76:79], a[0:3], a[88:91], v[76:79]
buffer_load_dwordx4 v12, s[12:15], s35 offen offset:1024 sc1 lds
v_mfma_f32_16x16x32_bf16 v[76:79], a[4:7], a[92:95], v[76:79]
ds_read_b64_tr_b16 a[108:109], v26 offset:21504
ds_read_b64_tr_b16 a[110:111], v27 offset:21504
v_mfma_f32_16x16x32_bf16 v[80:83], a[8:11], a[64:67], v[80:83]
ds_read_b64_tr_b16 a[112:113], v26 offset:18432
ds_read_b64_tr_b16 a[114:115], v27 offset:18432
v_mfma_f32_16x16x32_bf16 v[80:83], a[12:15], a[68:71], v[80:83]
ds_read_b64_tr_b16 a[116:117], v26 offset:22528
ds_read_b64_tr_b16 a[118:119], v27 offset:22528
v_mfma_f32_16x16x32_bf16 v[84:87], a[8:11], a[72:75], v[84:87]
buffer_load_dwordx4 v12, s[12:15], s35 offen offset:2048 sc1 lds
v_mfma_f32_16x16x32_bf16 v[84:87], a[12:15], a[76:79], v[84:87]
ds_read_b64_tr_b16 a[120:121], v26 offset:19456
ds_read_b64_tr_b16 a[122:123], v27 offset:19456
v_mfma_f32_16x16x32_bf16 v[88:91], a[8:11], a[80:83], v[88:91]
ds_read_b64_tr_b16 a[124:125], v26 offset:23552
ds_read_b64_tr_b16 a[126:127], v27 offset:23552
v_mfma_f32_16x16x32_bf16 v[88:91], a[12:15], a[84:87], v[88:91]
ds_read_b64_tr_b16 a[40:41], v21 offset:49152
ds_read_b64_tr_b16 a[42:43], v21 offset:53248
v_mfma_f32_16x16x32_bf16 v[92:95], a[8:11], a[88:91], v[92:95]
buffer_load_dwordx4 v12, s[12:15], s35 offen offset:3072 sc1 lds
v_mfma_f32_16x16x32_bf16 v[92:95], a[12:15], a[92:95], v[92:95]
ds_read_b64_tr_b16 a[44:45], v21 offset:57344
ds_read_b64_tr_b16 a[46:47], v21 offset:61440
v_mfma_f32_16x16x32_bf16 v[96:99], a[16:19], a[64:67], v[96:99]
ds_read_b64_tr_b16 a[48:49], v22 offset:49152
ds_read_b64_tr_b16 a[50:51], v22 offset:53248
v_mfma_f32_16x16x32_bf16 v[96:99], a[20:23], a[68:71], v[96:99]
s_add_u32 m0, s30, 73728
s_mov_b32 s34, 851968
ds_read_b64_tr_b16 a[52:53], v22 offset:57344
ds_read_b64_tr_b16 a[54:55], v22 offset:61440
v_mfma_f32_16x16x32_bf16 v[100:103], a[16:19], a[72:75], v[100:103]
buffer_load_dwordx4 v156, s[16:19], s34 offen offset:0 lds
v_mfma_f32_16x16x32_bf16 v[100:103], a[20:23], a[76:79], v[100:103]
ds_read_b64_tr_b16 a[56:57], v23 offset:49152
ds_read_b64_tr_b16 a[58:59], v23 offset:53248
v_mfma_f32_16x16x32_bf16 v[104:107], a[16:19], a[80:83], v[104:107]
ds_read_b64_tr_b16 a[60:61], v23 offset:57344
ds_read_b64_tr_b16 a[62:63], v23 offset:61440
v_mfma_f32_16x16x32_bf16 v[104:107], a[20:23], a[84:87], v[104:107]
v_mfma_f32_16x16x32_bf16 v[108:111], a[16:19], a[88:91], v[108:111]
buffer_load_dwordx4 v157, s[16:19], s34 offen offset:1024 lds
v_mfma_f32_16x16x32_bf16 v[108:111], a[20:23], a[92:95], v[108:111]
v_mfma_f32_16x16x32_bf16 v[112:115], a[24:27], a[64:67], v[112:115]
v_mfma_f32_16x16x32_bf16 v[112:115], a[28:31], a[68:71], v[112:115]
v_mfma_f32_16x16x32_bf16 v[116:119], a[24:27], a[72:75], v[116:119]
buffer_load_dwordx4 v158, s[16:19], s34 offen offset:2048 lds
v_mfma_f32_16x16x32_bf16 v[116:119], a[28:31], a[76:79], v[116:119]
v_mfma_f32_16x16x32_bf16 v[120:123], a[24:27], a[80:83], v[120:123]
v_mfma_f32_16x16x32_bf16 v[120:123], a[28:31], a[84:87], v[120:123]
v_mfma_f32_16x16x32_bf16 v[124:127], a[24:27], a[88:91], v[124:127]
buffer_load_dwordx4 v159, s[16:19], s34 offen offset:3072 lds
v_mfma_f32_16x16x32_bf16 v[124:127], a[28:31], a[92:95], v[124:127]
s_waitcnt vmcnt(16) lgkmcnt(0)
s_barrier
v_mfma_f32_16x16x32_bf16 v[64:67], a[32:35], a[96:99], v[64:67]
ds_read_b64_tr_b16 a[0:1], v16 offset:0
ds_read_b64_tr_b16 a[2:3], v16 offset:4096
v_mfma_f32_16x16x32_bf16 v[64:67], a[36:39], a[100:103], v[64:67]
s_add_u32 m0, s30, 106496
s_mov_b32 s35, 122880
ds_read_b64_tr_b16 a[4:5], v16 offset:8192
ds_read_b64_tr_b16 a[6:7], v16 offset:12288
v_mfma_f32_16x16x32_bf16 v[68:71], a[32:35], a[104:107], v[68:71]
buffer_load_dwordx4 v12, s[12:15], s35 offen offset:0 sc1 lds
v_mfma_f32_16x16x32_bf16 v[68:71], a[36:39], a[108:111], v[68:71]
ds_read_b64_tr_b16 a[64:65], v24 offset:0
ds_read_b64_tr_b16 a[66:67], v25 offset:0
v_mfma_f32_16x16x32_bf16 v[72:75], a[32:35], a[112:115], v[72:75]
ds_read_b64_tr_b16 a[68:69], v24 offset:4096
ds_read_b64_tr_b16 a[70:71], v25 offset:4096
v_mfma_f32_16x16x32_bf16 v[72:75], a[36:39], a[116:119], v[72:75]
ds_read_b64_tr_b16 a[72:73], v24 offset:1024
ds_read_b64_tr_b16 a[74:75], v25 offset:1024
v_mfma_f32_16x16x32_bf16 v[76:79], a[32:35], a[120:123], v[76:79]
buffer_load_dwordx4 v12, s[12:15], s35 offen offset:1024 sc1 lds
v_mfma_f32_16x16x32_bf16 v[76:79], a[36:39], a[124:127], v[76:79]
ds_read_b64_tr_b16 a[76:77], v24 offset:5120
ds_read_b64_tr_b16 a[78:79], v25 offset:5120
v_mfma_f32_16x16x32_bf16 v[80:83], a[40:43], a[96:99], v[80:83]
ds_read_b64_tr_b16 a[80:81], v24 offset:2048
ds_read_b64_tr_b16 a[82:83], v25 offset:2048
v_mfma_f32_16x16x32_bf16 v[80:83], a[44:47], a[100:103], v[80:83]
ds_read_b64_tr_b16 a[84:85], v24 offset:6144
ds_read_b64_tr_b16 a[86:87], v25 offset:6144
v_mfma_f32_16x16x32_bf16 v[84:87], a[40:43], a[104:107], v[84:87]
buffer_load_dwordx4 v12, s[12:15], s35 offen offset:2048 sc1 lds
v_mfma_f32_16x16x32_bf16 v[84:87], a[44:47], a[108:111], v[84:87]
ds_read_b64_tr_b16 a[88:89], v24 offset:3072
ds_read_b64_tr_b16 a[90:91], v25 offset:3072
v_mfma_f32_16x16x32_bf16 v[88:91], a[40:43], a[112:115], v[88:91]
ds_read_b64_tr_b16 a[92:93], v24 offset:7168
ds_read_b64_tr_b16 a[94:95], v25 offset:7168
v_mfma_f32_16x16x32_bf16 v[88:91], a[44:47], a[116:119], v[88:91]
ds_read_b64_tr_b16 a[8:9], v17 offset:0
ds_read_b64_tr_b16 a[10:11], v17 offset:4096
v_mfma_f32_16x16x32_bf16 v[92:95], a[40:43], a[120:123], v[92:95]
buffer_load_dwordx4 v12, s[12:15], s35 offen offset:3072 sc1 lds
v_mfma_f32_16x16x32_bf16 v[92:95], a[44:47], a[124:127], v[92:95]
ds_read_b64_tr_b16 a[12:13], v17 offset:8192
ds_read_b64_tr_b16 a[14:15], v17 offset:12288
v_mfma_f32_16x16x32_bf16 v[96:99], a[48:51], a[96:99], v[96:99]
ds_read_b64_tr_b16 a[16:17], v18 offset:0
ds_read_b64_tr_b16 a[18:19], v18 offset:4096
v_mfma_f32_16x16x32_bf16 v[96:99], a[52:55], a[100:103], v[96:99]
s_add_u32 m0, s30, 122880
s_mov_b32 s34, 983040
ds_read_b64_tr_b16 a[20:21], v18 offset:8192
ds_read_b64_tr_b16 a[22:23], v18 offset:12288
v_mfma_f32_16x16x32_bf16 v[100:103], a[48:51], a[104:107], v[100:103]
buffer_load_dwordx4 v156, s[16:19], s34 offen offset:0 lds
v_mfma_f32_16x16x32_bf16 v[100:103], a[52:55], a[108:111], v[100:103]
ds_read_b64_tr_b16 a[24:25], v19 offset:0
ds_read_b64_tr_b16 a[26:27], v19 offset:4096
v_mfma_f32_16x16x32_bf16 v[104:107], a[48:51], a[112:115], v[104:107]
ds_read_b64_tr_b16 a[28:29], v19 offset:8192
ds_read_b64_tr_b16 a[30:31], v19 offset:12288
v_mfma_f32_16x16x32_bf16 v[104:107], a[52:55], a[116:119], v[104:107]
v_mfma_f32_16x16x32_bf16 v[108:111], a[48:51], a[120:123], v[108:111]
buffer_load_dwordx4 v157, s[16:19], s34 offen offset:1024 lds
v_mfma_f32_16x16x32_bf16 v[108:111], a[52:55], a[124:127], v[108:111]
v_mfma_f32_16x16x32_bf16 v[112:115], a[56:59], a[96:99], v[112:115]
v_mfma_f32_16x16x32_bf16 v[112:115], a[60:63], a[100:103], v[112:115]
v_mfma_f32_16x16x32_bf16 v[116:119], a[56:59], a[104:107], v[116:119]
buffer_load_dwordx4 v158, s[16:19], s34 offen offset:2048 lds
v_mfma_f32_16x16x32_bf16 v[116:119], a[60:63], a[108:111], v[116:119]
v_mfma_f32_16x16x32_bf16 v[120:123], a[56:59], a[112:115], v[120:123]
v_mfma_f32_16x16x32_bf16 v[120:123], a[60:63], a[116:119], v[120:123]
v_mfma_f32_16x16x32_bf16 v[124:127], a[56:59], a[120:123], v[124:127]
buffer_load_dwordx4 v159, s[16:19], s34 offen offset:3072 lds
v_mfma_f32_16x16x32_bf16 v[124:127], a[60:63], a[124:127], v[124:127]
s_waitcnt vmcnt(16) lgkmcnt(0)
s_barrier
s_lshl_b32 s52, s44, 2
s_add_u32 s52, s52, s46
s_and_b32 s47, s28, 1
s_mul_i32 s47, s47, 448
s_mov_b32 s48, 4682
s_mov_b32 s49, 3584
v_mfma_f32_16x16x32_bf16 v[64:67], a[0:3], a[64:67], v[64:67]
ds_read_b64_tr_b16 a[32:33], v16 offset:16384
ds_read_b64_tr_b16 a[34:35], v16 offset:20480
v_mfma_f32_16x16x32_bf16 v[64:67], a[4:7], a[68:71], v[64:67]
ds_read_b64_tr_b16 a[36:37], v16 offset:24576
ds_read_b64_tr_b16 a[38:39], v16 offset:28672
v_mfma_f32_16x16x32_bf16 v[68:71], a[0:3], a[72:75], v[68:71]
buffer_load_dwordx2 v[144:145], v153, s[20:23], s31 offen offset:0
v_mfma_f32_16x16x32_bf16 v[68:71], a[4:7], a[76:79], v[68:71]
ds_read_b64_tr_b16 a[96:97], v24 offset:16384
ds_read_b64_tr_b16 a[98:99], v25 offset:16384
v_mfma_f32_16x16x32_bf16 v[72:75], a[0:3], a[80:83], v[72:75]
ds_read_b64_tr_b16 a[100:101], v24 offset:20480
ds_read_b64_tr_b16 a[102:103], v25 offset:20480
v_mfma_f32_16x16x32_bf16 v[72:75], a[4:7], a[84:87], v[72:75]
ds_read_b64_tr_b16 a[104:105], v24 offset:17408
ds_read_b64_tr_b16 a[106:107], v25 offset:17408
v_mfma_f32_16x16x32_bf16 v[76:79], a[0:3], a[88:91], v[76:79]
buffer_load_dwordx2 v[146:147], v153, s[20:23], s31 offen offset:32
v_mfma_f32_16x16x32_bf16 v[76:79], a[4:7], a[92:95], v[76:79]
ds_read_b64_tr_b16 a[108:109], v24 offset:21504
ds_read_b64_tr_b16 a[110:111], v25 offset:21504
v_mfma_f32_16x16x32_bf16 v[80:83], a[8:11], a[64:67], v[80:83]
ds_read_b64_tr_b16 a[112:113], v24 offset:18432
ds_read_b64_tr_b16 a[114:115], v25 offset:18432
v_mfma_f32_16x16x32_bf16 v[80:83], a[12:15], a[68:71], v[80:83]
ds_read_b64_tr_b16 a[116:117], v24 offset:22528
ds_read_b64_tr_b16 a[118:119], v25 offset:22528
v_mfma_f32_16x16x32_bf16 v[84:87], a[8:11], a[72:75], v[84:87]
buffer_load_dwordx2 v[148:149], v153, s[20:23], s31 offen offset:128
v_mfma_f32_16x16x32_bf16 v[84:87], a[12:15], a[76:79], v[84:87]
ds_read_b64_tr_b16 a[120:121], v24 offset:19456
ds_read_b64_tr_b16 a[122:123], v25 offset:19456
v_mfma_f32_16x16x32_bf16 v[88:91], a[8:11], a[80:83], v[88:91]
ds_read_b64_tr_b16 a[124:125], v24 offset:23552
ds_read_b64_tr_b16 a[126:127], v25 offset:23552
v_mfma_f32_16x16x32_bf16 v[88:91], a[12:15], a[84:87], v[88:91]
ds_read_b64_tr_b16 a[40:41], v17 offset:16384
ds_read_b64_tr_b16 a[42:43], v17 offset:20480
v_mfma_f32_16x16x32_bf16 v[92:95], a[8:11], a[88:91], v[92:95]
buffer_load_dwordx2 v[150:151], v153, s[20:23], s31 offen offset:160
v_mfma_f32_16x16x32_bf16 v[92:95], a[12:15], a[92:95], v[92:95]
ds_read_b64_tr_b16 a[44:45], v17 offset:24576
ds_read_b64_tr_b16 a[46:47], v17 offset:28672
v_mfma_f32_16x16x32_bf16 v[96:99], a[16:19], a[64:67], v[96:99]
ds_read_b64_tr_b16 a[48:49], v18 offset:16384
ds_read_b64_tr_b16 a[50:51], v18 offset:20480
v_mfma_f32_16x16x32_bf16 v[96:99], a[20:23], a[68:71], v[96:99]
s_mov_b32 s36, 4096
ds_read_b64_tr_b16 a[52:53], v18 offset:24576
ds_read_b64_tr_b16 a[54:55], v18 offset:28672
v_mfma_f32_16x16x32_bf16 v[100:103], a[16:19], a[72:75], v[100:103]
buffer_load_dwordx4 v[160:163], v154, s[24:27], s36 offen offset:0 sc1
v_mfma_f32_16x16x32_bf16 v[100:103], a[20:23], a[76:79], v[100:103]
ds_read_b64_tr_b16 a[56:57], v19 offset:16384
ds_read_b64_tr_b16 a[58:59], v19 offset:20480
v_mfma_f32_16x16x32_bf16 v[104:107], a[16:19], a[80:83], v[104:107]
ds_read_b64_tr_b16 a[60:61], v19 offset:24576
ds_read_b64_tr_b16 a[62:63], v19 offset:28672
v_mfma_f32_16x16x32_bf16 v[104:107], a[20:23], a[84:87], v[104:107]
v_mfma_f32_16x16x32_bf16 v[108:111], a[16:19], a[88:91], v[108:111]
buffer_load_dwordx4 v[164:167], v154, s[24:27], s36 offen offset:64 sc1
v_add_u32 v5, s47, v2
v_add_u32 v6, 0, v5
v_mfma_f32_16x16x32_bf16 v[108:111], a[20:23], a[92:95], v[108:111]
v_mul_lo_u32 v7, v6, s48
v_lshrrev_b32 v7, 16, v7
v_mfma_f32_16x16x32_bf16 v[112:115], a[24:27], a[64:67], v[112:115]
v_mul_u32_u24 v8, 14, v7
v_sub_u32 v8, v6, v8
v_mfma_f32_16x16x32_bf16 v[112:115], a[28:31], a[68:71], v[112:115]
v_mul_lo_u32 v9, v7, s49
v_lshl_add_u32 v9, v8, 4, v9
v_mfma_f32_16x16x32_bf16 v[116:119], a[24:27], a[72:75], v[116:119]
buffer_load_dwordx4 v[168:171], v154, s[24:27], s36 offen offset:256 sc1
v_subrev_u32 v208, 0, v9
v_add_u32 v6, 64, v5
v_mfma_f32_16x16x32_bf16 v[116:119], a[28:31], a[76:79], v[116:119]
v_mul_lo_u32 v7, v6, s48
v_lshrrev_b32 v7, 16, v7
v_mfma_f32_16x16x32_bf16 v[120:123], a[24:27], a[80:83], v[120:123]
v_mul_u32_u24 v8, 14, v7
v_sub_u32 v8, v6, v8
v_mfma_f32_16x16x32_bf16 v[120:123], a[28:31], a[84:87], v[120:123]
v_mul_lo_u32 v9, v7, s49
v_lshl_add_u32 v9, v8, 4, v9
v_mfma_f32_16x16x32_bf16 v[124:127], a[24:27], a[88:91], v[124:127]
buffer_load_dwordx4 v[172:175], v154, s[24:27], s36 offen offset:320 sc1
v_subrev_u32 v209, 1024, v9
v_add_u32 v6, 128, v5
v_mfma_f32_16x16x32_bf16 v[124:127], a[28:31], a[92:95], v[124:127]
v_mul_lo_u32 v7, v6, s48
s_waitcnt vmcnt(16) lgkmcnt(0)
s_barrier
v_mfma_f32_16x16x32_bf16 v[64:67], a[32:35], a[96:99], v[64:67]
ds_read_b64_tr_b16 a[0:1], v20 offset:0
ds_read_b64_tr_b16 a[2:3], v20 offset:4096
v_mfma_f32_16x16x32_bf16 v[64:67], a[36:39], a[100:103], v[64:67]
s_mov_b32 s36, 8192
ds_read_b64_tr_b16 a[4:5], v20 offset:8192
ds_read_b64_tr_b16 a[6:7], v20 offset:12288
v_mfma_f32_16x16x32_bf16 v[68:71], a[32:35], a[104:107], v[68:71]
buffer_load_dwordx4 v[176:179], v154, s[24:27], s36 offen offset:0 sc1
v_mfma_f32_16x16x32_bf16 v[68:71], a[36:39], a[108:111], v[68:71]
ds_read_b64_tr_b16 a[64:65], v26 offset:0
ds_read_b64_tr_b16 a[66:67], v27 offset:0
v_mfma_f32_16x16x32_bf16 v[72:75], a[32:35], a[112:115], v[72:75]
ds_read_b64_tr_b16 a[68:69], v26 offset:4096
ds_read_b64_tr_b16 a[70:71], v27 offset:4096
v_mfma_f32_16x16x32_bf16 v[72:75], a[36:39], a[116:119], v[72:75]
ds_read_b64_tr_b16 a[72:73], v26 offset:1024
ds_read_b64_tr_b16 a[74:75], v27 offset:1024
v_mfma_f32_16x16x32_bf16 v[76:79], a[32:35], a[120:123], v[76:79]
buffer_load_dwordx4 v[180:183], v154, s[24:27], s36 offen offset:64 sc1
v_mfma_f32_16x16x32_bf16 v[76:79], a[36:39], a[124:127], v[76:79]
ds_read_b64_tr_b16 a[76:77], v26 offset:5120
ds_read_b64_tr_b16 a[78:79], v27 offset:5120
v_mfma_f32_16x16x32_bf16 v[80:83], a[40:43], a[96:99], v[80:83]
ds_read_b64_tr_b16 a[80:81], v26 offset:2048
ds_read_b64_tr_b16 a[82:83], v27 offset:2048
v_mfma_f32_16x16x32_bf16 v[80:83], a[44:47], a[100:103], v[80:83]
ds_read_b64_tr_b16 a[84:85], v26 offset:6144
ds_read_b64_tr_b16 a[86:87], v27 offset:6144
v_mfma_f32_16x16x32_bf16 v[84:87], a[40:43], a[104:107], v[84:87]
buffer_load_dwordx4 v[184:187], v154, s[24:27], s36 offen offset:256 sc1
v_mfma_f32_16x16x32_bf16 v[84:87], a[44:47], a[108:111], v[84:87]
ds_read_b64_tr_b16 a[88:89], v26 offset:3072
ds_read_b64_tr_b16 a[90:91], v27 offset:3072
v_mfma_f32_16x16x32_bf16 v[88:91], a[40:43], a[112:115], v[88:91]
ds_read_b64_tr_b16 a[92:93], v26 offset:7168
ds_read_b64_tr_b16 a[94:95], v27 offset:7168
v_mfma_f32_16x16x32_bf16 v[88:91], a[44:47], a[116:119], v[88:91]
ds_read_b64_tr_b16 a[8:9], v21 offset:0
ds_read_b64_tr_b16 a[10:11], v21 offset:4096
v_mfma_f32_16x16x32_bf16 v[92:95], a[40:43], a[120:123], v[92:95]
buffer_load_dwordx4 v[188:191], v154, s[24:27], s36 offen offset:320 sc1
v_mfma_f32_16x16x32_bf16 v[92:95], a[44:47], a[124:127], v[92:95]
ds_read_b64_tr_b16 a[12:13], v21 offset:8192
ds_read_b64_tr_b16 a[14:15], v21 offset:12288
v_mfma_f32_16x16x32_bf16 v[96:99], a[48:51], a[96:99], v[96:99]
ds_read_b64_tr_b16 a[16:17], v22 offset:0
ds_read_b64_tr_b16 a[18:19], v22 offset:4096
v_mfma_f32_16x16x32_bf16 v[96:99], a[52:55], a[100:103], v[96:99]
s_mov_b32 s36, 6144
ds_read_b64_tr_b16 a[20:21], v22 offset:8192
ds_read_b64_tr_b16 a[22:23], v22 offset:12288
v_mfma_f32_16x16x32_bf16 v[100:103], a[48:51], a[104:107], v[100:103]
buffer_load_dwordx4 v[192:195], v154, s[24:27], s36 offen offset:0 sc1
v_mfma_f32_16x16x32_bf16 v[100:103], a[52:55], a[108:111], v[100:103]
ds_read_b64_tr_b16 a[24:25], v23 offset:0
ds_read_b64_tr_b16 a[26:27], v23 offset:4096
v_mfma_f32_16x16x32_bf16 v[104:107], a[48:51], a[112:115], v[104:107]
ds_read_b64_tr_b16 a[28:29], v23 offset:8192
ds_read_b64_tr_b16 a[30:31], v23 offset:12288
v_mfma_f32_16x16x32_bf16 v[104:107], a[52:55], a[116:119], v[104:107]
v_mfma_f32_16x16x32_bf16 v[108:111], a[48:51], a[120:123], v[108:111]
buffer_load_dwordx4 v[196:199], v154, s[24:27], s36 offen offset:64 sc1
v_lshrrev_b32 v7, 16, v7
v_mul_u32_u24 v8, 14, v7
v_mfma_f32_16x16x32_bf16 v[108:111], a[52:55], a[124:127], v[108:111]
v_sub_u32 v8, v6, v8
v_mul_lo_u32 v9, v7, s49
v_mfma_f32_16x16x32_bf16 v[112:115], a[56:59], a[96:99], v[112:115]
v_lshl_add_u32 v9, v8, 4, v9
v_subrev_u32 v210, 2048, v9
v_mfma_f32_16x16x32_bf16 v[112:115], a[60:63], a[100:103], v[112:115]
v_add_u32 v6, 192, v5
v_mul_lo_u32 v7, v6, s48
v_mfma_f32_16x16x32_bf16 v[116:119], a[56:59], a[104:107], v[116:119]
buffer_load_dwordx4 v[200:203], v154, s[24:27], s36 offen offset:256 sc1
v_lshrrev_b32 v7, 16, v7
v_mul_u32_u24 v8, 14, v7
v_mfma_f32_16x16x32_bf16 v[116:119], a[60:63], a[108:111], v[116:119]
v_sub_u32 v8, v6, v8
v_mul_lo_u32 v9, v7, s49
v_mfma_f32_16x16x32_bf16 v[120:123], a[56:59], a[112:115], v[120:123]
v_lshl_add_u32 v9, v8, 4, v9
v_subrev_u32 v211, 3072, v9
v_mfma_f32_16x16x32_bf16 v[120:123], a[60:63], a[116:119], v[120:123]
v_add_u32 v6, 256, v5
v_mul_lo_u32 v7, v6, s48
v_mfma_f32_16x16x32_bf16 v[124:127], a[56:59], a[120:123], v[124:127]
buffer_load_dwordx4 v[204:207], v154, s[24:27], s36 offen offset:320 sc1
v_lshrrev_b32 v7, 16, v7
v_mul_u32_u24 v8, 14, v7
v_mfma_f32_16x16x32_bf16 v[124:127], a[60:63], a[124:127], v[124:127]
v_sub_u32 v8, v6, v8
s_waitcnt vmcnt(16) lgkmcnt(0)
s_barrier
v_mfma_f32_16x16x32_bf16 v[64:67], a[0:3], a[64:67], v[64:67]
ds_read_b64_tr_b16 a[32:33], v20 offset:49152
ds_read_b64_tr_b16 a[34:35], v20 offset:53248
v_mfma_f32_16x16x32_bf16 v[64:67], a[4:7], a[68:71], v[64:67]
ds_read_b64_tr_b16 a[36:37], v20 offset:57344
ds_read_b64_tr_b16 a[38:39], v20 offset:61440
v_mfma_f32_16x16x32_bf16 v[68:71], a[0:3], a[72:75], v[68:71]
ds_read_b64_tr_b16 a[96:97], v26 offset:16384
ds_read_b64_tr_b16 a[98:99], v27 offset:16384
v_mfma_f32_16x16x32_bf16 v[68:71], a[4:7], a[76:79], v[68:71]
ds_read_b64_tr_b16 a[100:101], v26 offset:20480
ds_read_b64_tr_b16 a[102:103], v27 offset:20480
v_mfma_f32_16x16x32_bf16 v[72:75], a[0:3], a[80:83], v[72:75]
ds_read_b64_tr_b16 a[40:41], v21 offset:49152
ds_read_b64_tr_b16 a[42:43], v21 offset:53248
v_mfma_f32_16x16x32_bf16 v[72:75], a[4:7], a[84:87], v[72:75]
ds_read_b64_tr_b16 a[44:45], v21 offset:57344
ds_read_b64_tr_b16 a[46:47], v21 offset:61440
v_mfma_f32_16x16x32_bf16 v[76:79], a[0:3], a[88:91], v[76:79]
ds_read_b64_tr_b16 a[104:105], v26 offset:17408
ds_read_b64_tr_b16 a[106:107], v27 offset:17408
v_mfma_f32_16x16x32_bf16 v[76:79], a[4:7], a[92:95], v[76:79]
ds_read_b64_tr_b16 a[108:109], v26 offset:21504
ds_read_b64_tr_b16 a[110:111], v27 offset:21504
v_mfma_f32_16x16x32_bf16 v[80:83], a[8:11], a[64:67], v[80:83]
ds_read_b64_tr_b16 a[112:113], v26 offset:18432
ds_read_b64_tr_b16 a[114:115], v27 offset:18432
v_mfma_f32_16x16x32_bf16 v[80:83], a[12:15], a[68:71], v[80:83]
ds_read_b64_tr_b16 a[116:117], v26 offset:22528
ds_read_b64_tr_b16 a[118:119], v27 offset:22528
v_mfma_f32_16x16x32_bf16 v[84:87], a[8:11], a[72:75], v[84:87]
ds_read_b64_tr_b16 a[120:121], v26 offset:19456
ds_read_b64_tr_b16 a[122:123], v27 offset:19456
v_mfma_f32_16x16x32_bf16 v[84:87], a[12:15], a[76:79], v[84:87]
ds_read_b64_tr_b16 a[124:125], v26 offset:23552
ds_read_b64_tr_b16 a[126:127], v27 offset:23552
v_mfma_f32_16x16x32_bf16 v[88:91], a[8:11], a[80:83], v[88:91]
ds_read_b64_tr_b16 a[48:49], v22 offset:49152
ds_read_b64_tr_b16 a[50:51], v22 offset:53248
v_mfma_f32_16x16x32_bf16 v[88:91], a[12:15], a[84:87], v[88:91]
ds_read_b64_tr_b16 a[52:53], v22 offset:57344
ds_read_b64_tr_b16 a[54:55], v22 offset:61440
v_mfma_f32_16x16x32_bf16 v[92:95], a[8:11], a[88:91], v[92:95]
ds_read_b64_tr_b16 a[56:57], v23 offset:49152
ds_read_b64_tr_b16 a[58:59], v23 offset:53248
v_mfma_f32_16x16x32_bf16 v[92:95], a[12:15], a[92:95], v[92:95]
s_waitcnt lgkmcnt(10)
ds_read_b64_tr_b16 a[60:61], v23 offset:57344
ds_read_b64_tr_b16 a[62:63], v23 offset:61440
v_mfma_f32_16x16x32_bf16 v[64:67], a[32:35], a[96:99], v[64:67]
s_mov_b32 s36, 147456
v_mul_lo_u32 v9, v7, s49
v_lshl_add_u32 v9, v8, 4, v9
v_mfma_f32_16x16x32_bf16 v[64:67], a[36:39], a[100:103], v[64:67]
buffer_load_dword v28, v142, s[4:7], s36 offen sc1
v_mfma_f32_16x16x32_bf16 v[80:83], a[40:43], a[96:99], v[80:83]
v_subrev_u32 v212, 0, v9
v_add_u32 v6, 320, v5
v_mfma_f32_16x16x32_bf16 v[80:83], a[44:47], a[100:103], v[80:83]
v_mul_lo_u32 v7, v6, s48
v_lshrrev_b32 v7, 16, v7
v_mfma_f32_16x16x32_bf16 v[68:71], a[32:35], a[104:107], v[68:71]
v_mul_u32_u24 v8, 14, v7
v_sub_u32 v8, v6, v8
v_mfma_f32_16x16x32_bf16 v[68:71], a[36:39], a[108:111], v[68:71]
v_mul_lo_u32 v9, v7, s49
v_lshl_add_u32 v9, v8, 4, v9
v_mfma_f32_16x16x32_bf16 v[84:87], a[40:43], a[104:107], v[84:87]
v_subrev_u32 v213, 1024, v9
v_add_u32 v6, 384, v5
v_mfma_f32_16x16x32_bf16 v[84:87], a[44:47], a[108:111], v[84:87]
v_mul_lo_u32 v7, v6, s48
v_lshrrev_b32 v7, 16, v7
v_mfma_f32_16x16x32_bf16 v[72:75], a[32:35], a[112:115], v[72:75]
v_mul_u32_u24 v8, 14, v7
v_sub_u32 v8, v6, v8
v_cvt_pk_bf16_f32 v32, v64, v65
v_cvt_pk_bf16_f32 v33, v66, v67
v_mfma_f32_16x16x32_bf16 v[72:75], a[36:39], a[116:119], v[72:75]
s_mov_b32 s50, 0
v_mul_lo_u32 v9, v7, s49
v_lshl_add_u32 v9, v8, 4, v9
v_cvt_pk_bf16_f32 v34, v80, v81
v_cvt_pk_bf16_f32 v35, v82, v83
v_mfma_f32_16x16x32_bf16 v[88:91], a[40:43], a[112:115], v[88:91]
v_subrev_u32 v214, 2048, v9
buffer_store_dwordx4 v[32:35], v12, s[8:11], s50 offen offset:0 sc1
v_mfma_f32_16x16x32_bf16 v[88:91], a[44:47], a[116:119], v[88:91]
s_waitcnt lgkmcnt(0)
s_waitcnt lgkmcnt(0)
s_barrier
s_cmp_lt_u32 s28, 2
s_cselect_b32 s54, s68, s72
s_cselect_b32 s55, s69, s73
s_mul_i32 s56, s52, 224
s_add_u32 s16, s54, s56
s_addc_u32 s17, s55, 0
s_mov_b32 s18, 0
s_mov_b32 s19, 0x20000
s_sub_u32 s18, 1835008, s56
s_lshr_b32 s56, s28, 1
s_mul_i32 s56, s56, 14336
s_and_b32 s54, s28, 1
s_mul_i32 s54, s54, 7168
s_add_u32 s30, s56, s54
v_mfma_f32_16x16x32_bf16 v[76:79], a[32:35], a[120:123], v[76:79]
v_cvt_pk_bf16_f32 v36, v68, v69
v_cvt_pk_bf16_f32 v37, v70, v71
v_mfma_f32_16x16x32_bf16 v[76:79], a[36:39], a[124:127], v[76:79]
s_mov_b32 s50, 16384
v_cvt_pk_bf16_f32 v38, v84, v85
v_cvt_pk_bf16_f32 v39, v86, v87
v_mfma_f32_16x16x32_bf16 v[92:95], a[40:43], a[120:123], v[92:95]
buffer_store_dwordx4 v[36:39], v12, s[8:11], s50 offen offset:0 sc1
v_mfma_f32_16x16x32_bf16 v[92:95], a[44:47], a[124:127], v[92:95]
v_mfma_f32_16x16x32_bf16 v[96:99], a[16:19], a[64:67], v[96:99]
v_cvt_pk_bf16_f32 v40, v72, v73
v_cvt_pk_bf16_f32 v41, v74, v75
v_mfma_f32_16x16x32_bf16 v[96:99], a[20:23], a[68:71], v[96:99]
s_mov_b32 s50, 32768
v_cvt_pk_bf16_f32 v42, v88, v89
v_cvt_pk_bf16_f32 v43, v90, v91
v_mfma_f32_16x16x32_bf16 v[100:103], a[16:19], a[72:75], v[100:103]
buffer_store_dwordx4 v[40:43], v12, s[8:11], s50 offen offset:0 sc1
v_mfma_f32_16x16x32_bf16 v[100:103], a[20:23], a[76:79], v[100:103]
v_mfma_f32_16x16x32_bf16 v[104:107], a[16:19], a[80:83], v[104:107]
v_cvt_pk_bf16_f32 v44, v76, v77
v_cvt_pk_bf16_f32 v45, v78, v79
v_mfma_f32_16x16x32_bf16 v[104:107], a[20:23], a[84:87], v[104:107]
s_mov_b32 s50, 49152
v_cvt_pk_bf16_f32 v46, v92, v93
v_cvt_pk_bf16_f32 v47, v94, v95
v_mfma_f32_16x16x32_bf16 v[108:111], a[16:19], a[88:91], v[108:111]
buffer_store_dwordx4 v[44:47], v12, s[8:11], s50 offen offset:0 sc1
v_mfma_f32_16x16x32_bf16 v[108:111], a[20:23], a[92:95], v[108:111]
v_mfma_f32_16x16x32_bf16 v[112:115], a[24:27], a[64:67], v[112:115]
v_mfma_f32_16x16x32_bf16 v[112:115], a[28:31], a[68:71], v[112:115]
s_add_u32 m0, s30, 0
s_mov_b32 s34, 0
v_mfma_f32_16x16x32_bf16 v[116:119], a[24:27], a[72:75], v[116:119]
buffer_load_dwordx4 v208, s[16:19], s34 offen offset:0 lds
v_mfma_f32_16x16x32_bf16 v[116:119], a[28:31], a[76:79], v[116:119]
v_mfma_f32_16x16x32_bf16 v[120:123], a[24:27], a[80:83], v[120:123]
v_mfma_f32_16x16x32_bf16 v[120:123], a[28:31], a[84:87], v[120:123]
v_mfma_f32_16x16x32_bf16 v[124:127], a[24:27], a[88:91], v[124:127]
buffer_load_dwordx4 v209, s[16:19], s34 offen offset:1024 lds
v_mfma_f32_16x16x32_bf16 v[124:127], a[28:31], a[92:95], v[124:127]
v_mfma_f32_16x16x32_bf16 v[96:99], a[48:51], a[96:99], v[96:99]
v_mfma_f32_16x16x32_bf16 v[96:99], a[52:55], a[100:103], v[96:99]
v_mfma_f32_16x16x32_bf16 v[112:115], a[56:59], a[96:99], v[112:115]
buffer_load_dwordx4 v210, s[16:19], s34 offen offset:2048 lds
v_mfma_f32_16x16x32_bf16 v[112:115], a[60:63], a[100:103], v[112:115]
v_mfma_f32_16x16x32_bf16 v[100:103], a[48:51], a[104:107], v[100:103]
v_mfma_f32_16x16x32_bf16 v[100:103], a[52:55], a[108:111], v[100:103]
v_mfma_f32_16x16x32_bf16 v[116:119], a[56:59], a[104:107], v[116:119]
buffer_load_dwordx4 v211, s[16:19], s34 offen offset:3072 lds
v_mfma_f32_16x16x32_bf16 v[116:119], a[60:63], a[108:111], v[116:119]
v_mfma_f32_16x16x32_bf16 v[104:107], a[48:51], a[112:115], v[104:107]
v_cvt_pk_bf16_f32 v48, v96, v97
v_cvt_pk_bf16_f32 v49, v98, v99
v_mfma_f32_16x16x32_bf16 v[104:107], a[52:55], a[116:119], v[104:107]
s_mov_b32 s50, 0
v_cvt_pk_bf16_f32 v50, v112, v113
v_cvt_pk_bf16_f32 v51, v114, v115
v_mfma_f32_16x16x32_bf16 v[120:123], a[56:59], a[112:115], v[120:123]
buffer_store_dwordx4 v[48:51], v12, s[8:11], s50 offen offset:1024 sc1
v_mfma_f32_16x16x32_bf16 v[120:123], a[60:63], a[116:119], v[120:123]
v_mfma_f32_16x16x32_bf16 v[108:111], a[48:51], a[120:123], v[108:111]
v_cvt_pk_bf16_f32 v52, v100, v101
v_cvt_pk_bf16_f32 v53, v102, v103
v_mfma_f32_16x16x32_bf16 v[108:111], a[52:55], a[124:127], v[108:111]
s_mov_b32 s50, 16384
v_cvt_pk_bf16_f32 v54, v116, v117
v_cvt_pk_bf16_f32 v55, v118, v119
v_mfma_f32_16x16x32_bf16 v[124:127], a[56:59], a[120:123], v[124:127]
buffer_store_dwordx4 v[52:55], v12, s[8:11], s50 offen offset:1024 sc1
v_mfma_f32_16x16x32_bf16 v[124:127], a[60:63], a[124:127], v[124:127]
adaLN_cond__mha_block_cached__glu_gated_bilinear__prompt_kernel_ovend:
s_nop 1
s_nop 1
v_cvt_pk_bf16_f32 v56, v104, v105
v_cvt_pk_bf16_f32 v57, v106, v107
v_cvt_pk_bf16_f32 v58, v120, v121
v_cvt_pk_bf16_f32 v59, v122, v123
s_mov_b32 s50, 32768
buffer_store_dwordx4 v[56:59], v12, s[8:11], s50 offen offset:1024 sc1
v_cvt_pk_bf16_f32 v60, v108, v109
v_cvt_pk_bf16_f32 v61, v110, v111
v_cvt_pk_bf16_f32 v62, v124, v125
v_cvt_pk_bf16_f32 v63, v126, v127
s_mov_b32 s50, 49152
buffer_store_dwordx4 v[60:63], v12, s[8:11], s50 offen offset:1024 sc1
s_add_u32 m0, s30, 4096
s_mov_b32 s34, 0
buffer_load_dwordx4 v212, s[16:19], s34 offen offset:0 lds
buffer_load_dwordx4 v213, s[16:19], s34 offen offset:1024 lds
buffer_load_dwordx4 v214, s[16:19], s34 offen offset:2048 lds
s_add_u32 s12, s42, 20971520
s_addc_u32 s13, s43, 0
s_mov_b32 s14, 8388608
s_mov_b32 s15, 0x20000
s_add_u32 s20, s42, 29360128
s_addc_u32 s21, s43, 0
s_mov_b32 s22, 4194304
s_mov_b32 s23, 0x20000
s_waitcnt vmcnt(15)
v_cmp_eq_u32 vcc, s39, v28
s_nop 1
s_cmp_eq_u64 vcc, -1
s_cbranch_scc1 adaLN_cond__mha_block_cached__glu_gated_bilinear__prompt_kernel_pd5
s_mov_b32 s53, 0
s_mov_b32 s50, 147456
adaLN_cond__mha_block_cached__glu_gated_bilinear__prompt_kernel_pl5:
buffer_load_dword v5, v142, s[4:7], s50 offen sc1
s_add_u32 s53, s53, 1
s_waitcnt vmcnt(0)
v_cmp_eq_u32 vcc, s39, v5
s_cmp_gt_u32 s53, 200000
s_cbranch_scc1 adaLN_cond__mha_block_cached__glu_gated_bilinear__prompt_kernel_pd5
s_cmp_eq_u64 vcc, -1
s_cbranch_scc0 adaLN_cond__mha_block_cached__glu_gated_bilinear__prompt_kernel_pl5
adaLN_cond__mha_block_cached__glu_gated_bilinear__prompt_kernel_pd5:
v_lshlrev_b32 v64, 16, v144
v_and_b32 v65, 0xffff0000, v144
v_lshlrev_b32 v66, 16, v145
v_and_b32 v67, 0xffff0000, v145
v_lshlrev_b32 v68, 16, v146
v_and_b32 v69, 0xffff0000, v146
v_lshlrev_b32 v70, 16, v147
v_and_b32 v71, 0xffff0000, v147
v_lshlrev_b32 v72, 16, v148
v_and_b32 v73, 0xffff0000, v148
v_lshlrev_b32 v74, 16, v149
v_and_b32 v75, 0xffff0000, v149
v_lshlrev_b32 v76, 16, v150
v_and_b32 v77, 0xffff0000, v150
v_lshlrev_b32 v78, 16, v151
v_and_b32 v79, 0xffff0000, v151
s_mov_b32 s53, 0
adaLN_cond__mha_block_cached__glu_gated_bilinear__prompt_kernel_spp:
s_add_u32 s50, s29, 0
buffer_load_dwordx4 v[16:19], v152, s[12:15], s50 offen offset:0 sc1
buffer_load_dwordx4 v[20:23], v152, s[12:15], s50 offen offset:2048 sc1
s_add_u32 s50, s29, 2097152
buffer_load_dwordx4 v[24:27], v152, s[12:15], s50 offen offset:0 sc1
buffer_load_dwordx4 v[28:31], v152, s[12:15], s50 offen offset:2048 sc1
s_add_u32 s50, s29, 4194304
buffer_load_dwordx4 v[32:35], v152, s[12:15], s50 offen offset:0 sc1
buffer_load_dwordx4 v[36:39], v152, s[12:15], s50 offen offset:2048 sc1
s_add_u32 s50, s29, 6291456
buffer_load_dwordx4 v[40:43], v152, s[12:15], s50 offen offset:0 sc1
buffer_load_dwordx4 v[44:47], v152, s[12:15], s50 offen offset:2048 sc1
s_add_u32 s53, s53, 1
s_waitcnt vmcnt(0)
v_max_u32 v10, v16, v17
v_max3_u32 v10, v10, v18, v19
v_max3_u32 v10, v10, v20, v21
v_max3_u32 v10, v10, v22, v23
v_max3_u32 v10, v10, v24, v25
v_max3_u32 v10, v10, v26, v27
v_max3_u32 v10, v10, v28, v29
v_max3_u32 v10, v10, v30, v31
v_max3_u32 v10, v10, v32, v33
v_max3_u32 v10, v10, v34, v35
v_max3_u32 v10, v10, v36, v37
v_max3_u32 v10, v10, v38, v39
v_max3_u32 v10, v10, v40, v41
v_max3_u32 v10, v10, v42, v43
v_max3_u32 v10, v10, v44, v45
v_max3_u32 v10, v10, v46, v47
v_cmp_eq_u32 vcc, -1, v10
s_cmp_gt_u32 s53, 200000
s_cbranch_scc1 adaLN_cond__mha_block_cached__glu_gated_bilinear__prompt_kernel_sdp
s_cbranch_vccnz adaLN_cond__mha_block_cached__glu_gated_bilinear__prompt_kernel_spp
adaLN_cond__mha_block_cached__glu_gated_bilinear__prompt_kernel_sdp:
v_lshlrev_b32 v48, 16, v16
v_and_b32 v49, 0xffff0000, v16
v_lshlrev_b32 v50, 16, v17
v_and_b32 v51, 0xffff0000, v17
v_lshlrev_b32 v52, 16, v18
v_and_b32 v53, 0xffff0000, v18
v_lshlrev_b32 v54, 16, v19
v_and_b32 v55, 0xffff0000, v19
v_lshlrev_b32 v56, 16, v20
v_and_b32 v57, 0xffff0000, v20
v_lshlrev_b32 v58, 16, v21
v_and_b32 v59, 0xffff0000, v21
v_lshlrev_b32 v60, 16, v22
v_and_b32 v61, 0xffff0000, v22
s_add_u32 m0, s30, 28672
s_mov_b32 s34, 229376
buffer_load_dwordx4 v208, s[16:19], s34 offen offset:0 lds
v_lshlrev_b32 v62, 16, v23
v_and_b32 v63, 0xffff0000, v23
v_lshlrev_b32 v8, 16, v24
v_and_b32 v9, 0xffff0000, v24
v_pk_add_f32 v[48:49], v[48:49], v[8:9]
v_lshlrev_b32 v10, 16, v25
v_and_b32 v11, 0xffff0000, v25
v_pk_add_f32 v[50:51], v[50:51], v[10:11]
v_lshlrev_b32 v8, 16, v26
v_and_b32 v9, 0xffff0000, v26
v_pk_add_f32 v[52:53], v[52:53], v[8:9]
v_lshlrev_b32 v10, 16, v27
v_and_b32 v11, 0xffff0000, v27
v_pk_add_f32 v[54:55], v[54:55], v[10:11]
buffer_load_dwordx4 v209, s[16:19], s34 offen offset:1024 lds
v_lshlrev_b32 v8, 16, v28
v_and_b32 v9, 0xffff0000, v28
v_pk_add_f32 v[56:57], v[56:57], v[8:9]
v_lshlrev_b32 v10, 16, v29
v_and_b32 v11, 0xffff0000, v29
v_pk_add_f32 v[58:59], v[58:59], v[10:11]
v_lshlrev_b32 v8, 16, v30
v_and_b32 v9, 0xffff0000, v30
v_pk_add_f32 v[60:61], v[60:61], v[8:9]
v_lshlrev_b32 v10, 16, v31
v_and_b32 v11, 0xffff0000, v31
v_pk_add_f32 v[62:63], v[62:63], v[10:11]
v_lshlrev_b32 v8, 16, v32
v_and_b32 v9, 0xffff0000, v32
v_pk_add_f32 v[48:49], v[48:49], v[8:9]
buffer_load_dwordx4 v210, s[16:19], s34 offen offset:2048 lds
v_lshlrev_b32 v10, 16, v33
v_and_b32 v11, 0xffff0000, v33
v_pk_add_f32 v[50:51], v[50:51], v[10:11]
v_lshlrev_b32 v8, 16, v34
v_and_b32 v9, 0xffff0000, v34
v_pk_add_f32 v[52:53], v[52:53], v[8:9]
v_lshlrev_b32 v10, 16, v35
v_and_b32 v11, 0xffff0000, v35
v_pk_add_f32 v[54:55], v[54:55], v[10:11]
v_lshlrev_b32 v8, 16, v36
v_and_b32 v9, 0xffff0000, v36
v_pk_add_f32 v[56:57], v[56:57], v[8:9]
v_lshlrev_b32 v10, 16, v37
v_and_b32 v11, 0xffff0000, v37
v_pk_add_f32 v[58:59], v[58:59], v[10:11]
buffer_load_dwordx4 v211, s[16:19], s34 offen offset:3072 lds
v_lshlrev_b32 v8, 16, v38
v_and_b32 v9, 0xffff0000, v38
v_pk_add_f32 v[60:61], v[60:61], v[8:9]
v_lshlrev_b32 v10, 16, v39
v_and_b32 v11, 0xffff0000, v39
v_pk_add_f32 v[62:63], v[62:63], v[10:11]
v_lshlrev_b32 v8, 16, v40
v_and_b32 v9, 0xffff0000, v40
v_pk_add_f32 v[48:49], v[48:49], v[8:9]
v_lshlrev_b32 v10, 16, v41
v_and_b32 v11, 0xffff0000, v41
v_pk_add_f32 v[50:51], v[50:51], v[10:11]
v_lshlrev_b32 v8, 16, v42
v_and_b32 v9, 0xffff0000, v42
v_pk_add_f32 v[52:53], v[52:53], v[8:9]
s_add_u32 m0, s30, 32768
s_mov_b32 s34, 229376
buffer_load_dwordx4 v212, s[16:19], s34 offen offset:0 lds
v_lshlrev_b32 v10, 16, v43
v_and_b32 v11, 0xffff0000, v43
v_pk_add_f32 v[54:55], v[54:55], v[10:11]
v_lshlrev_b32 v8, 16, v44
v_and_b32 v9, 0xffff0000, v44
v_pk_add_f32 v[56:57], v[56:57], v[8:9]
v_lshlrev_b32 v10, 16, v45
v_and_b32 v11, 0xffff0000, v45
v_pk_add_f32 v[58:59], v[58:59], v[10:11]
v_lshlrev_b32 v8, 16, v46
v_and_b32 v9, 0xffff0000, v46
v_pk_add_f32 v[60:61], v[60:61], v[8:9]
v_lshlrev_b32 v10, 16, v47
v_and_b32 v11, 0xffff0000, v47
v_pk_add_f32 v[62:63], v[62:63], v[10:11]
buffer_load_dwordx4 v213, s[16:19], s34 offen offset:1024 lds
v_pk_fma_f32 v[64:65], v[48:49], v[160:161], v[64:65]
v_pk_fma_f32 v[66:67], v[50:51], v[162:163], v[66:67]
v_pk_fma_f32 v[68:69], v[52:53], v[164:165], v[68:69]
v_pk_fma_f32 v[70:71], v[54:55], v[166:167], v[70:71]
v_pk_fma_f32 v[72:73], v[56:57], v[168:169], v[72:73]
v_pk_fma_f32 v[74:75], v[58:59], v[170:171], v[74:75]
v_pk_fma_f32 v[76:77], v[60:61], v[172:173], v[76:77]
v_pk_fma_f32 v[78:79], v[62:63], v[174:175], v[78:79]
v_pk_add_f32 v[8:9], v[64:65], v[66:67]
v_pk_mul_f32 v[14:15], v[64:65], v[64:65]
v_pk_fma_f32 v[14:15], v[66:67], v[66:67], v[14:15]
v_pk_add_f32 v[8:9], v[8:9], v[68:69]
v_pk_fma_f32 v[14:15], v[68:69], v[68:69], v[14:15]
v_pk_add_f32 v[8:9], v[8:9], v[70:71]
v_pk_fma_f32 v[14:15], v[70:71], v[70:71], v[14:15]
buffer_load_dwordx4 v214, s[16:19], s34 offen offset:2048 lds
v_pk_add_f32 v[8:9], v[8:9], v[72:73]
v_pk_fma_f32 v[14:15], v[72:73], v[72:73], v[14:15]
v_pk_add_f32 v[8:9], v[8:9], v[74:75]
v_pk_fma_f32 v[14:15], v[74:75], v[74:75], v[14:15]
v_pk_add_f32 v[8:9], v[8:9], v[76:77]
v_pk_fma_f32 v[14:15], v[76:77], v[76:77], v[14:15]
v_pk_add_f32 v[8:9], v[8:9], v[78:79]
v_pk_fma_f32 v[14:15], v[78:79], v[78:79], v[14:15]
v_add_f32 v10, v8, v9
v_add_f32 v11, v14, v15
s_add_u32 m0, s30, 57344
s_mov_b32 s34, 458752
buffer_load_dwordx4 v208, s[16:19], s34 offen offset:0 lds
buffer_load_dwordx4 v209, s[16:19], s34 offen offset:1024 lds
buffer_load_dwordx4 v210, s[16:19], s34 offen offset:2048 lds
buffer_load_dwordx4 v211, s[16:19], s34 offen offset:3072 lds
s_add_u32 m0, s30, 61440
s_mov_b32 s34, 458752
buffer_load_dwordx4 v212, s[16:19], s34 offen offset:0 lds
buffer_load_dwordx4 v213, s[16:19], s34 offen offset:1024 lds
buffer_load_dwordx4 v214, s[16:19], s34 offen offset:2048 lds
v_mov_b32 v14, v10
v_mov_b32 v15, v11
s_nop 0
v_permlane32_swap_b32 v10, v14
v_permlane32_swap_b32 v11, v15
v_add_f32 v10, v10, v14
v_add_f32 v11, v11, v15
v_mov_b32 v14, v10
v_mov_b32 v15, v11
s_nop 0
v_permlane16_swap_b32 v10, v14
v_permlane16_swap_b32 v11, v15
v_add_f32 v10, v10, v14
v_add_f32 v11, v11, v15
s_lshl_b32 s50, s28, 6
v_add_u32 v13, s50, v155
v_add_f32_dpp v10, v10, v10 row_ror:8 row_mask:0xf bank_mask:0xf
s_nop 0
v_add_f32_dpp v11, v11, v11 row_ror:8 row_mask:0xf bank_mask:0xf
ds_write_b64 v13, v[10:11]
v_cvt_pk_bf16_f32 v144, v64, v65
v_cvt_pk_bf16_f32 v145, v66, v67
v_cvt_pk_bf16_f32 v146, v68, v69
v_cvt_pk_bf16_f32 v147, v70, v71
v_cvt_pk_bf16_f32 v148, v72, v73
v_cvt_pk_bf16_f32 v149, v74, v75
v_cvt_pk_bf16_f32 v150, v76, v77
v_cvt_pk_bf16_f32 v151, v78, v79
s_waitcnt lgkmcnt(0)
s_barrier
ds_read_b64 v[24:25], v155 offset:0
ds_read_b64 v[26:27], v155 offset:64
ds_read_b64 v[28:29], v155 offset:128
ds_read_b64 v[30:31], v155 offset:192
buffer_store_dwordx4 v[144:147], v152, s[20:23], s29 offen offset:0 sc1
buffer_store_dwordx4 v[148:151], v152, s[20:23], s29 offen offset:2048 sc1
s_waitcnt lgkmcnt(0)
v_pk_add_f32 v[24:25], v[24:25], v[26:27]
v_pk_add_f32 v[28:29], v[28:29], v[30:31]
v_pk_add_f32 v[24:25], v[24:25], v[28:29]
v_mul_f32 v24, 0x3b000000, v24
v_mov_b32 v26, 0x3727c5ac
v_fmac_f32 v26, 0x3b000000, v25
v_fma_f32 v26, -v24, v24, v26
v_max_f32 v26, 0x3727c5ac, v26
v_rsq_f32 v25, v26
s_add_u32 s50, s29, 2097152
v_mul_f32 v26, v24, v25
v_mov_b32 v24, v25
v_sub_f32 v26, 0, v26
v_mov_b32 v27, v26
v_pk_fma_f32 v[64:65], v[64:65], v[24:25], v[26:27]
v_pk_fma_f32 v[66:67], v[66:67], v[24:25], v[26:27]
v_pk_fma_f32 v[68:69], v[68:69], v[24:25], v[26:27]
v_pk_fma_f32 v[70:71], v[70:71], v[24:25], v[26:27]
v_pk_fma_f32 v[72:73], v[72:73], v[24:25], v[26:27]
v_pk_fma_f32 v[74:75], v[74:75], v[24:25], v[26:27]
v_pk_fma_f32 v[76:77], v[76:77], v[24:25], v[26:27]
v_pk_fma_f32 v[78:79], v[78:79], v[24:25], v[26:27]
v_pk_fma_f32 v[64:65], v[64:65], v[176:177], v[192:193]
v_pk_fma_f32 v[66:67], v[66:67], v[178:179], v[194:195]
v_pk_fma_f32 v[68:69], v[68:69], v[180:181], v[196:197]
v_pk_fma_f32 v[70:71], v[70:71], v[182:183], v[198:199]
v_pk_fma_f32 v[72:73], v[72:73], v[184:185], v[200:201]
v_pk_fma_f32 v[74:75], v[74:75], v[186:187], v[202:203]
v_pk_fma_f32 v[76:77], v[76:77], v[188:189], v[204:205]
v_pk_fma_f32 v[78:79], v[78:79], v[190:191], v[206:207]
v_cvt_pk_bf16_f32 v16, v64, v65
v_cvt_pk_bf16_f32 v17, v66, v67
v_cvt_pk_bf16_f32 v18, v68, v69
v_cvt_pk_bf16_f32 v19, v70, v71
v_cvt_pk_bf16_f32 v20, v72, v73
v_cvt_pk_bf16_f32 v21, v74, v75
v_cvt_pk_bf16_f32 v22, v76, v77
v_cvt_pk_bf16_f32 v23, v78, v79
buffer_store_dwordx4 v[16:19], v152, s[20:23], s50 offen offset:0 sc1
buffer_store_dwordx4 v[20:23], v152, s[20:23], s50 offen offset:2048 sc1
v_lshrrev_b32 v5, 2, v2
v_mul_u32_u24 v5, 224, v5
v_and_b32 v6, 3, v2
v_lshl_add_u32 v8, v6, 3, v5
v_lshlrev_b32 v7, 4, v2
v_add_u32 v9, 28672, v8
v_add_u32 v10, 57344, v8
v_add_u32 v11, 86016, v8
v_add_u32 v12, 114688, v8
s_lshl_b32 s47, s45, 2
s_add_u32 s47, s47, s28
s_lshl_b32 s48, s47, 15
s_add_u32 s48, s48, 31457280
s_add_u32 s12, s42, s48
s_addc_u32 s13, s43, 0
s_mov_b32 s14, 32768
s_mov_b32 s15, 0x20000
s_mul_i32 s47, s47, 114688
s_mul_i32 s48, s52, 7168
s_add_u32 s47, s47, s48
s_add_u32 s47, s47, 33554432
s_add_u32 s8, s42, s47
s_addc_u32 s9, s43, 0
s_mov_b32 s10, 7168
s_mov_b32 s11, 0x20000
s_waitcnt vmcnt(4)
s_barrier
s_lshl_b32 s54, s45, 1
s_and_b32 s50, s44, 1
s_add_u32 s54, s54, s50
s_lshr_b32 s55, s44, 1
s_lshl_b32 s55, s55, 2
s_add_u32 s55, s55, s46
v_lshrrev_b32 v5, 3, v2
v_lshlrev_b32 v13, 1, v4
v_and_b32 v6, 7, v2
v_xor_b32 v13, v13, v6
v_lshlrev_b32 v13, 4, v13
v_lshl_add_u32 v13, v5, 10, v13
v_add_u32 v133, 0, v13
v_add_u32 v134, 7168, v13
v_add_u32 v135, 14336, v13
v_add_u32 v136, 21504, v13
s_lshl_b32 s50, s55, 7
s_mul_i32 s51, s28, 458752
s_add_u32 s50, s50, s51
s_add_u32 s24, s76, s50
s_addc_u32 s25, s77, 0
s_mov_b32 s26, 0
s_mov_b32 s27, 0x20000
s_sub_u32 s26, 1835008, s50
s_mul_i32 s31, s28, 36864
v_and_b32 v128, 1, v6
v_lshlrev_b32 v128, 9, v128
v_lshl_add_u32 v128, v5, 4, v128
v_bfe_u32 v13, v6, 1, 1
v_lshl_add_u32 v128, v13, 3, v128
v_lshrrev_b32 v13, 2, v6
v_lshl_add_u32 v128, v13, 10, v128
v_lshlrev_b32 v129, 5, v6
v_lshlrev_b32 v130, 10, v5
v_lshl_add_u32 v130, v6, 4, v130
v_mul_u32_u24 v131, 272, v5
v_lshl_add_u32 v131, v6, 5, v131
s_mul_i32 s47, s28, 4352
v_add_u32 v131, s47, v131
v_mul_u32_u24 v132, 272, v3
v_lshl_add_u32 v132, v4, 4, v132
v_add_u32 v132, s31, v132
v_lshrrev_b32 v5, 2, v2
v_and_b32 v6, 3, v2
v_lshlrev_b32 v13, 7, v5
v_lshl_add_u32 v13, v6, 3, v13
v_add_u32 v13, s31, v13
v_bfe_u32 v5, v5, 1, 2
v_xor_b32 v6, 0, v5
v_lshl_add_u32 v137, v6, 5, v13
v_xor_b32 v6, 1, v5
v_lshl_add_u32 v138, v6, 5, v13
v_xor_b32 v6, 2, v5
v_lshl_add_u32 v139, v6, 5, v13
v_xor_b32 v6, 3, v5
v_lshl_add_u32 v140, v6, 5, v13
s_lshl_b32 s47, s54, 2
s_add_u32 s47, s47, s28
s_lshl_b32 s49, s47, 14
s_lshl_b32 s50, s55, 7
s_add_u32 s56, s50, s49
s_lshl_b32 s51, s55, 11
s_add_u32 s57, s51, s49
s_lshl_b32 s58, s55, 8
s_add_u32 s58, s58, 10240
s_mul_i32 s48, s54, 229376
s_mul_i32 s49, s28, 28672
s_add_u32 s48, s48, s49
s_add_u32 s59, s48, 33554432
ds_read_b64_tr_b16 a[128:129], v8 offset:0
ds_read_b64_tr_b16 a[130:131], v8 offset:3584
ds_read_b64_tr_b16 a[132:133], v8 offset:7168
ds_read_b64_tr_b16 a[134:135], v8 offset:10752
ds_read_b64_tr_b16 a[136:137], v8 offset:32
ds_read_b64_tr_b16 a[138:139], v8 offset:3616
ds_read_b64_tr_b16 a[140:141], v8 offset:7200
ds_read_b64_tr_b16 a[142:143], v8 offset:10784
ds_read_b64_tr_b16 a[144:145], v8 offset:64
ds_read_b64_tr_b16 a[146:147], v8 offset:3648
ds_read_b64_tr_b16 a[148:149], v8 offset:7232
ds_read_b64_tr_b16 a[150:151], v8 offset:10816
ds_read_b64_tr_b16 a[152:153], v8 offset:96
ds_read_b64_tr_b16 a[154:155], v8 offset:3680
ds_read_b64_tr_b16 a[156:157], v8 offset:7264
ds_read_b64_tr_b16 a[158:159], v8 offset:10848
s_mov_b32 s53, 0
adaLN_cond__mha_block_cached__glu_gated_bilinear__prompt_kernel_spg:
s_mov_b32 s36, 0
buffer_load_dwordx4 a[0:3], v7, s[12:15], s36 offen offset:0 sc1
s_mov_b32 s36, 16384
buffer_load_dwordx4 a[4:7], v7, s[12:15], s36 offen offset:0 sc1
s_mov_b32 s36, 0
buffer_load_dwordx4 a[8:11], v7, s[12:15], s36 offen offset:1024 sc1
s_mov_b32 s36, 16384
buffer_load_dwordx4 a[12:15], v7, s[12:15], s36 offen offset:1024 sc1
s_add_u32 s53, s53, 1
s_waitcnt vmcnt(0)
v_accvgpr_read_b32 v14, a0
v_accvgpr_read_b32 v15, a1
v_max_u32 v13, v14, v15
v_accvgpr_read_b32 v14, a2
v_accvgpr_read_b32 v15, a3
v_max3_u32 v13, v13, v14, v15
v_accvgpr_read_b32 v14, a4
v_accvgpr_read_b32 v15, a5
v_max3_u32 v13, v13, v14, v15
v_accvgpr_read_b32 v14, a6
v_accvgpr_read_b32 v15, a7
v_max3_u32 v13, v13, v14, v15
v_accvgpr_read_b32 v14, a8
v_accvgpr_read_b32 v15, a9
v_max3_u32 v13, v13, v14, v15
v_accvgpr_read_b32 v14, a10
v_accvgpr_read_b32 v15, a11
v_max3_u32 v13, v13, v14, v15
v_accvgpr_read_b32 v14, a12
v_accvgpr_read_b32 v15, a13
v_max3_u32 v13, v13, v14, v15
v_accvgpr_read_b32 v14, a14
v_accvgpr_read_b32 v15, a15
v_max3_u32 v13, v13, v14, v15
v_cmp_eq_u32 vcc, -1, v13
s_cmp_gt_u32 s53, 200000
s_cbranch_scc1 adaLN_cond__mha_block_cached__glu_gated_bilinear__prompt_kernel_sdg
s_cbranch_vccnz adaLN_cond__mha_block_cached__glu_gated_bilinear__prompt_kernel_spg
adaLN_cond__mha_block_cached__glu_gated_bilinear__prompt_kernel_sdg:
s_mov_b32 s36, 0
buffer_load_dwordx4 a[16:19], v7, s[12:15], s36 offen offset:2048 sc1
s_mov_b32 s36, 16384
buffer_load_dwordx4 a[20:23], v7, s[12:15], s36 offen offset:2048 sc1
s_mov_b32 s36, 0
buffer_load_dwordx4 a[24:27], v7, s[12:15], s36 offen offset:3072 sc1
s_mov_b32 s36, 16384
buffer_load_dwordx4 a[28:31], v7, s[12:15], s36 offen offset:3072 sc1
s_waitcnt lgkmcnt(14)
v_mfma_f32_16x16x32_bf16 v[16:19], a[128:131], a[0:3], 0
s_waitcnt lgkmcnt(12)
s_mov_b32 s36, 4096
ds_read_b64_tr_b16 a[160:161], v8 offset:128
v_mfma_f32_16x16x32_bf16 v[16:19], a[132:135], a[8:11], v[16:19]
ds_read_b64_tr_b16 a[162:163], v8 offset:3712
buffer_load_dwordx4 a[32:35], v7, s[12:15], s36 offen offset:0 sc1
v_mfma_f32_16x16x32_bf16 v[20:23], a[128:131], a[4:7], 0
ds_read_b64_tr_b16 a[164:165], v8 offset:7296
v_mfma_f32_16x16x32_bf16 v[20:23], a[132:135], a[12:15], v[20:23]
s_waitcnt lgkmcnt(13)
ds_read_b64_tr_b16 a[166:167], v8 offset:10880
v_mfma_f32_16x16x32_bf16 v[24:27], a[136:139], a[0:3], 0
s_waitcnt lgkmcnt(12)
ds_read_b64_tr_b16 a[168:169], v8 offset:160
v_mfma_f32_16x16x32_bf16 v[24:27], a[140:143], a[8:11], v[24:27]
ds_read_b64_tr_b16 a[170:171], v8 offset:3744
v_mfma_f32_16x16x32_bf16 v[28:31], a[136:139], a[4:7], 0
ds_read_b64_tr_b16 a[172:173], v8 offset:7328
v_mfma_f32_16x16x32_bf16 v[28:31], a[140:143], a[12:15], v[28:31]
s_waitcnt lgkmcnt(5)
ds_read_b64_tr_b16 a[174:175], v8 offset:10912
v_mfma_f32_16x16x32_bf16 v[32:35], a[144:147], a[0:3], 0
s_mov_b32 s36, 20480
ds_read_b64_tr_b16 a[128:129], v8 offset:192
v_mfma_f32_16x16x32_bf16 v[32:35], a[148:151], a[8:11], v[32:35]
ds_read_b64_tr_b16 a[130:131], v8 offset:3776
buffer_load_dwordx4 a[36:39], v7, s[12:15], s36 offen offset:0 sc1
v_mfma_f32_16x16x32_bf16 v[36:39], a[144:147], a[4:7], 0
ds_read_b64_tr_b16 a[132:133], v8 offset:7360
v_mfma_f32_16x16x32_bf16 v[36:39], a[148:151], a[12:15], v[36:39]
ds_read_b64_tr_b16 a[134:135], v8 offset:10944
v_mfma_f32_16x16x32_bf16 v[40:43], a[152:155], a[0:3], 0
ds_read_b64_tr_b16 a[136:137], v8 offset:14336
v_mfma_f32_16x16x32_bf16 v[40:43], a[156:159], a[8:11], v[40:43]
ds_read_b64_tr_b16 a[138:139], v8 offset:17920
v_mfma_f32_16x16x32_bf16 v[44:47], a[152:155], a[4:7], 0
ds_read_b64_tr_b16 a[140:141], v8 offset:21504
v_mfma_f32_16x16x32_bf16 v[44:47], a[156:159], a[12:15], v[44:47]
ds_read_b64_tr_b16 a[142:143], v8 offset:25088
v_mfma_f32_16x16x32_bf16 v[48:51], a[160:163], a[0:3], 0
s_waitcnt lgkmcnt(5)
s_mov_b32 s36, 4096
ds_read_b64_tr_b16 a[144:145], v8 offset:14368
v_mfma_f32_16x16x32_bf16 v[48:51], a[164:167], a[8:11], v[48:51]
ds_read_b64_tr_b16 a[146:147], v8 offset:17952
buffer_load_dwordx4 a[40:43], v7, s[12:15], s36 offen offset:1024 sc1
v_mfma_f32_16x16x32_bf16 v[52:55], a[160:163], a[4:7], 0
ds_read_b64_tr_b16 a[148:149], v8 offset:21536
v_mfma_f32_16x16x32_bf16 v[52:55], a[164:167], a[12:15], v[52:55]
ds_read_b64_tr_b16 a[150:151], v8 offset:25120
v_mfma_f32_16x16x32_bf16 v[56:59], a[168:171], a[0:3], 0
ds_read_b64_tr_b16 a[152:153], v8 offset:14400
v_mfma_f32_16x16x32_bf16 v[56:59], a[172:175], a[8:11], v[56:59]
ds_read_b64_tr_b16 a[154:155], v8 offset:17984
v_mfma_f32_16x16x32_bf16 v[60:63], a[168:171], a[4:7], 0
ds_read_b64_tr_b16 a[156:157], v8 offset:21568
v_mfma_f32_16x16x32_bf16 v[60:63], a[172:175], a[12:15], v[60:63]
ds_read_b64_tr_b16 a[158:159], v8 offset:25152
v_mfma_f32_16x16x32_bf16 v[64:67], a[128:131], a[0:3], 0
s_waitcnt lgkmcnt(5)
s_mov_b32 s36, 20480
ds_read_b64_tr_b16 a[160:161], v8 offset:14432
v_mfma_f32_16x16x32_bf16 v[64:67], a[132:135], a[8:11], v[64:67]
ds_read_b64_tr_b16 a[162:163], v8 offset:18016
buffer_load_dwordx4 a[44:47], v7, s[12:15], s36 offen offset:1024 sc1
s_waitcnt vmcnt(6)
v_mfma_f32_16x16x32_bf16 v[68:71], a[128:131], a[4:7], 0
ds_read_b64_tr_b16 a[164:165], v8 offset:21600
v_accvgpr_read_b32 v14, a16
v_mfma_f32_16x16x32_bf16 v[68:71], a[132:135], a[12:15], v[68:71]
ds_read_b64_tr_b16 a[166:167], v8 offset:25184
v_accvgpr_read_b32 v15, a17
v_mfma_f32_16x16x32_bf16 v[72:75], a[136:139], a[0:3], 0
ds_read_b64_tr_b16 a[168:169], v8 offset:14464
v_max_u32 v13, v14, v15
v_mfma_f32_16x16x32_bf16 v[72:75], a[140:143], a[8:11], v[72:75]
ds_read_b64_tr_b16 a[170:171], v8 offset:18048
v_accvgpr_read_b32 v14, a18
v_mfma_f32_16x16x32_bf16 v[76:79], a[136:139], a[4:7], 0
ds_read_b64_tr_b16 a[172:173], v8 offset:21632
v_accvgpr_read_b32 v15, a19
v_mfma_f32_16x16x32_bf16 v[76:79], a[140:143], a[12:15], v[76:79]
ds_read_b64_tr_b16 a[174:175], v8 offset:25216
v_max3_u32 v13, v13, v14, v15
v_mfma_f32_16x16x32_bf16 v[80:83], a[144:147], a[0:3], 0
s_waitcnt lgkmcnt(5)
s_mov_b32 s36, 4096
ds_read_b64_tr_b16 a[128:129], v8 offset:14496
v_accvgpr_read_b32 v14, a20
v_mfma_f32_16x16x32_bf16 v[80:83], a[148:151], a[8:11], v[80:83]
ds_read_b64_tr_b16 a[130:131], v8 offset:18080
buffer_load_dwordx4 a[48:51], v7, s[12:15], s36 offen offset:2048 sc1
v_accvgpr_read_b32 v15, a21
v_mfma_f32_16x16x32_bf16 v[84:87], a[144:147], a[4:7], 0
ds_read_b64_tr_b16 a[132:133], v8 offset:21664
v_max3_u32 v13, v13, v14, v15
v_mfma_f32_16x16x32_bf16 v[84:87], a[148:151], a[12:15], v[84:87]
ds_read_b64_tr_b16 a[134:135], v8 offset:25248
v_accvgpr_read_b32 v14, a22
v_mfma_f32_16x16x32_bf16 v[88:91], a[152:155], a[0:3], 0
ds_read_b64_tr_b16 a[136:137], v8 offset:14528
v_accvgpr_read_b32 v15, a23
v_mfma_f32_16x16x32_bf16 v[88:91], a[156:159], a[8:11], v[88:91]
ds_read_b64_tr_b16 a[138:139], v8 offset:18112
v_max3_u32 v13, v13, v14, v15
v_mfma_f32_16x16x32_bf16 v[92:95], a[152:155], a[4:7], 0
ds_read_b64_tr_b16 a[140:141], v8 offset:21696
v_cmp_eq_u32 vcc, -1, v13
s_cbranch_vccnz adaLN_cond__mha_block_cached__glu_gated_bilinear__prompt_kernel_rtg2
adaLN_cond__mha_block_cached__glu_gated_bilinear__prompt_kernel_rbg2:
v_mfma_f32_16x16x32_bf16 v[92:95], a[156:159], a[12:15], v[92:95]
ds_read_b64_tr_b16 a[142:143], v8 offset:25280
s_barrier
v_mfma_f32_16x16x32_bf16 v[96:99], a[160:163], a[0:3], 0
s_waitcnt lgkmcnt(5)
s_mov_b32 s36, 20480
ds_read_b64_tr_b16 a[144:145], v9 offset:0
v_mfma_f32_16x16x32_bf16 v[96:99], a[164:167], a[8:11], v[96:99]
ds_read_b64_tr_b16 a[146:147], v9 offset:3584
buffer_load_dwordx4 a[52:55], v7, s[12:15], s36 offen offset:2048 sc1
s_waitcnt vmcnt(6)
v_mfma_f32_16x16x32_bf16 v[100:103], a[160:163], a[4:7], 0
ds_read_b64_tr_b16 a[148:149], v9 offset:7168
v_accvgpr_read_b32 v14, a24
v_mfma_f32_16x16x32_bf16 v[100:103], a[164:167], a[12:15], v[100:103]
ds_read_b64_tr_b16 a[150:151], v9 offset:10752
v_accvgpr_read_b32 v15, a25
v_mfma_f32_16x16x32_bf16 v[104:107], a[168:171], a[0:3], 0
ds_read_b64_tr_b16 a[152:153], v9 offset:32
v_max_u32 v13, v14, v15
v_mfma_f32_16x16x32_bf16 v[104:107], a[172:175], a[8:11], v[104:107]
ds_read_b64_tr_b16 a[154:155], v9 offset:3616
v_accvgpr_read_b32 v14, a26
v_mfma_f32_16x16x32_bf16 v[108:111], a[168:171], a[4:7], 0
ds_read_b64_tr_b16 a[156:157], v9 offset:7200
v_accvgpr_read_b32 v15, a27
v_mfma_f32_16x16x32_bf16 v[108:111], a[172:175], a[12:15], v[108:111]
ds_read_b64_tr_b16 a[158:159], v9 offset:10784
v_max3_u32 v13, v13, v14, v15
v_mfma_f32_16x16x32_bf16 v[112:115], a[128:131], a[0:3], 0
s_waitcnt lgkmcnt(5)
s_mov_b32 s36, 4096
ds_read_b64_tr_b16 a[160:161], v9 offset:64
v_accvgpr_read_b32 v14, a28
v_mfma_f32_16x16x32_bf16 v[112:115], a[132:135], a[8:11], v[112:115]
ds_read_b64_tr_b16 a[162:163], v9 offset:3648
buffer_load_dwordx4 a[56:59], v7, s[12:15], s36 offen offset:3072 sc1
v_accvgpr_read_b32 v15, a29
v_mfma_f32_16x16x32_bf16 v[116:119], a[128:131], a[4:7], 0
ds_read_b64_tr_b16 a[164:165], v9 offset:7232
v_max3_u32 v13, v13, v14, v15
v_mfma_f32_16x16x32_bf16 v[116:119], a[132:135], a[12:15], v[116:119]
ds_read_b64_tr_b16 a[166:167], v9 offset:10816
v_accvgpr_read_b32 v14, a30
v_mfma_f32_16x16x32_bf16 v[120:123], a[136:139], a[0:3], 0
s_mov_b32 s36, 20480
ds_read_b64_tr_b16 a[168:169], v9 offset:96
v_accvgpr_read_b32 v15, a31
v_mfma_f32_16x16x32_bf16 v[120:123], a[140:143], a[8:11], v[120:123]
ds_read_b64_tr_b16 a[170:171], v9 offset:3680
buffer_load_dwordx4 a[60:63], v7, s[12:15], s36 offen offset:3072 sc1
v_max3_u32 v13, v13, v14, v15
v_mfma_f32_16x16x32_bf16 v[124:127], a[136:139], a[4:7], 0
ds_read_b64_tr_b16 a[172:173], v9 offset:7264
v_cmp_eq_u32 vcc, -1, v13
s_cbranch_vccnz adaLN_cond__mha_block_cached__glu_gated_bilinear__prompt_kernel_rtg3
adaLN_cond__mha_block_cached__glu_gated_bilinear__prompt_kernel_rbg3:
v_mfma_f32_16x16x32_bf16 v[124:127], a[140:143], a[12:15], v[124:127]
ds_read_b64_tr_b16 a[174:175], v9 offset:10848
v_mfma_f32_16x16x32_bf16 v[16:19], a[144:147], a[16:19], v[16:19]
s_waitcnt lgkmcnt(5)
s_add_u32 m0, s30, 86016
s_mov_b32 s34, 688128
ds_read_b64_tr_b16 a[128:129], v9 offset:128
v_mfma_f32_16x16x32_bf16 v[16:19], a[148:151], a[24:27], v[16:19]
ds_read_b64_tr_b16 a[130:131], v9 offset:3712
buffer_load_dwordx4 v208, s[16:19], s34 offen offset:0 lds
v_mfma_f32_16x16x32_bf16 v[20:23], a[144:147], a[20:23], v[20:23]
ds_read_b64_tr_b16 a[132:133], v9 offset:7296
v_mfma_f32_16x16x32_bf16 v[20:23], a[148:151], a[28:31], v[20:23]
ds_read_b64_tr_b16 a[134:135], v9 offset:10880
v_mfma_f32_16x16x32_bf16 v[24:27], a[152:155], a[16:19], v[24:27]
ds_read_b64_tr_b16 a[136:137], v9 offset:160
v_mfma_f32_16x16x32_bf16 v[24:27], a[156:159], a[24:27], v[24:27]
ds_read_b64_tr_b16 a[138:139], v9 offset:3744
buffer_load_dwordx4 v209, s[16:19], s34 offen offset:1024 lds
v_mfma_f32_16x16x32_bf16 v[28:31], a[152:155], a[20:23], v[28:31]
ds_read_b64_tr_b16 a[140:141], v9 offset:7328
v_mfma_f32_16x16x32_bf16 v[28:31], a[156:159], a[28:31], v[28:31]
ds_read_b64_tr_b16 a[142:143], v9 offset:10912
v_mfma_f32_16x16x32_bf16 v[32:35], a[160:163], a[16:19], v[32:35]
s_waitcnt lgkmcnt(5)
ds_read_b64_tr_b16 a[144:145], v9 offset:192
v_mfma_f32_16x16x32_bf16 v[32:35], a[164:167], a[24:27], v[32:35]
ds_read_b64_tr_b16 a[146:147], v9 offset:3776
buffer_load_dwordx4 v210, s[16:19], s34 offen offset:2048 lds
v_mfma_f32_16x16x32_bf16 v[36:39], a[160:163], a[20:23], v[36:39]
ds_read_b64_tr_b16 a[148:149], v9 offset:7360
v_mfma_f32_16x16x32_bf16 v[36:39], a[164:167], a[28:31], v[36:39]
ds_read_b64_tr_b16 a[150:151], v9 offset:10944
v_mfma_f32_16x16x32_bf16 v[40:43], a[168:171], a[16:19], v[40:43]
ds_read_b64_tr_b16 a[152:153], v9 offset:14336
v_mfma_f32_16x16x32_bf16 v[40:43], a[172:175], a[24:27], v[40:43]
ds_read_b64_tr_b16 a[154:155], v9 offset:17920
buffer_load_dwordx4 v211, s[16:19], s34 offen offset:3072 lds
v_mfma_f32_16x16x32_bf16 v[44:47], a[168:171], a[20:23], v[44:47]
ds_read_b64_tr_b16 a[156:157], v9 offset:21504
v_mfma_f32_16x16x32_bf16 v[44:47], a[172:175], a[28:31], v[44:47]
ds_read_b64_tr_b16 a[158:159], v9 offset:25088
v_mfma_f32_16x16x32_bf16 v[48:51], a[128:131], a[16:19], v[48:51]
s_waitcnt lgkmcnt(5)
s_add_u32 m0, s30, 90112
s_mov_b32 s34, 688128
ds_read_b64_tr_b16 a[160:161], v9 offset:14368
v_mfma_f32_16x16x32_bf16 v[48:51], a[132:135], a[24:27], v[48:51]
ds_read_b64_tr_b16 a[162:163], v9 offset:17952
buffer_load_dwordx4 v212, s[16:19], s34 offen offset:0 lds
v_mfma_f32_16x16x32_bf16 v[52:55], a[128:131], a[20:23], v[52:55]
ds_read_b64_tr_b16 a[164:165], v9 offset:21536
v_mfma_f32_16x16x32_bf16 v[52:55], a[132:135], a[28:31], v[52:55]
ds_read_b64_tr_b16 a[166:167], v9 offset:25120
v_mfma_f32_16x16x32_bf16 v[56:59], a[136:139], a[16:19], v[56:59]
ds_read_b64_tr_b16 a[168:169], v9 offset:14400
v_mfma_f32_16x16x32_bf16 v[56:59], a[140:143], a[24:27], v[56:59]
ds_read_b64_tr_b16 a[170:171], v9 offset:17984
buffer_load_dwordx4 v213, s[16:19], s34 offen offset:1024 lds
v_mfma_f32_16x16x32_bf16 v[60:63], a[136:139], a[20:23], v[60:63]
ds_read_b64_tr_b16 a[172:173], v9 offset:21568
v_mfma_f32_16x16x32_bf16 v[60:63], a[140:143], a[28:31], v[60:63]
ds_read_b64_tr_b16 a[174:175], v9 offset:25152
v_mfma_f32_16x16x32_bf16 v[64:67], a[144:147], a[16:19], v[64:67]
s_waitcnt lgkmcnt(5)
ds_read_b64_tr_b16 a[128:129], v9 offset:14432
v_mfma_f32_16x16x32_bf16 v[64:67], a[148:151], a[24:27], v[64:67]
ds_read_b64_tr_b16 a[130:131], v9 offset:18016
buffer_load_dwordx4 v214, s[16:19], s34 offen offset:2048 lds
s_waitcnt vmcnt(13)
v_mfma_f32_16x16x32_bf16 v[68:71], a[144:147], a[20:23], v[68:71]
ds_read_b64_tr_b16 a[132:133], v9 offset:21600
v_accvgpr_read_b32 v14, a32
v_mfma_f32_16x16x32_bf16 v[68:71], a[148:151], a[28:31], v[68:71]
ds_read_b64_tr_b16 a[134:135], v9 offset:25184
v_accvgpr_read_b32 v15, a33
v_mfma_f32_16x16x32_bf16 v[72:75], a[152:155], a[16:19], v[72:75]
ds_read_b64_tr_b16 a[136:137], v9 offset:14464
v_max_u32 v13, v14, v15
v_mfma_f32_16x16x32_bf16 v[72:75], a[156:159], a[24:27], v[72:75]
ds_read_b64_tr_b16 a[138:139], v9 offset:18048
v_accvgpr_read_b32 v14, a34
v_mfma_f32_16x16x32_bf16 v[76:79], a[152:155], a[20:23], v[76:79]
ds_read_b64_tr_b16 a[140:141], v9 offset:21632
v_accvgpr_read_b32 v15, a35
v_mfma_f32_16x16x32_bf16 v[76:79], a[156:159], a[28:31], v[76:79]
ds_read_b64_tr_b16 a[142:143], v9 offset:25216
v_max3_u32 v13, v13, v14, v15
v_mfma_f32_16x16x32_bf16 v[80:83], a[160:163], a[16:19], v[80:83]
s_waitcnt lgkmcnt(5)
s_mov_b32 s36, 8192
ds_read_b64_tr_b16 a[144:145], v9 offset:14496
v_accvgpr_read_b32 v14, a36
v_mfma_f32_16x16x32_bf16 v[80:83], a[164:167], a[24:27], v[80:83]
ds_read_b64_tr_b16 a[146:147], v9 offset:18080
buffer_load_dwordx4 a[64:67], v7, s[12:15], s36 offen offset:0 sc1
v_accvgpr_read_b32 v15, a37
v_mfma_f32_16x16x32_bf16 v[84:87], a[160:163], a[20:23], v[84:87]
ds_read_b64_tr_b16 a[148:149], v9 offset:21664
v_max3_u32 v13, v13, v14, v15
v_mfma_f32_16x16x32_bf16 v[84:87], a[164:167], a[28:31], v[84:87]
ds_read_b64_tr_b16 a[150:151], v9 offset:25248
v_accvgpr_read_b32 v14, a38
v_mfma_f32_16x16x32_bf16 v[88:91], a[168:171], a[16:19], v[88:91]
ds_read_b64_tr_b16 a[152:153], v9 offset:14528
v_accvgpr_read_b32 v15, a39
v_mfma_f32_16x16x32_bf16 v[88:91], a[172:175], a[24:27], v[88:91]
ds_read_b64_tr_b16 a[154:155], v9 offset:18112
v_max3_u32 v13, v13, v14, v15
v_mfma_f32_16x16x32_bf16 v[92:95], a[168:171], a[20:23], v[92:95]
ds_read_b64_tr_b16 a[156:157], v9 offset:21696
v_cmp_eq_u32 vcc, -1, v13
s_cbranch_vccnz adaLN_cond__mha_block_cached__glu_gated_bilinear__prompt_kernel_rtg4
adaLN_cond__mha_block_cached__glu_gated_bilinear__prompt_kernel_rbg4:
v_mfma_f32_16x16x32_bf16 v[92:95], a[172:175], a[28:31], v[92:95]
ds_read_b64_tr_b16 a[158:159], v9 offset:25280
s_barrier
v_mfma_f32_16x16x32_bf16 v[96:99], a[128:131], a[16:19], v[96:99]
s_waitcnt lgkmcnt(5)
s_mov_b32 s36, 24576
ds_read_b64_tr_b16 a[160:161], v10 offset:0
v_mfma_f32_16x16x32_bf16 v[96:99], a[132:135], a[24:27], v[96:99]
ds_read_b64_tr_b16 a[162:163], v10 offset:3584
buffer_load_dwordx4 a[68:71], v7, s[12:15], s36 offen offset:0 sc1
s_waitcnt vmcnt(13)
v_mfma_f32_16x16x32_bf16 v[100:103], a[128:131], a[20:23], v[100:103]
ds_read_b64_tr_b16 a[164:165], v10 offset:7168
v_accvgpr_read_b32 v14, a40
v_mfma_f32_16x16x32_bf16 v[100:103], a[132:135], a[28:31], v[100:103]
ds_read_b64_tr_b16 a[166:167], v10 offset:10752
v_accvgpr_read_b32 v15, a41
v_mfma_f32_16x16x32_bf16 v[104:107], a[136:139], a[16:19], v[104:107]
ds_read_b64_tr_b16 a[168:169], v10 offset:32
v_max_u32 v13, v14, v15
v_mfma_f32_16x16x32_bf16 v[104:107], a[140:143], a[24:27], v[104:107]
ds_read_b64_tr_b16 a[170:171], v10 offset:3616
v_accvgpr_read_b32 v14, a42
v_mfma_f32_16x16x32_bf16 v[108:111], a[136:139], a[20:23], v[108:111]
ds_read_b64_tr_b16 a[172:173], v10 offset:7200
v_accvgpr_read_b32 v15, a43
v_mfma_f32_16x16x32_bf16 v[108:111], a[140:143], a[28:31], v[108:111]
ds_read_b64_tr_b16 a[174:175], v10 offset:10784
v_max3_u32 v13, v13, v14, v15
v_mfma_f32_16x16x32_bf16 v[112:115], a[144:147], a[16:19], v[112:115]
s_waitcnt lgkmcnt(5)
s_mov_b32 s36, 8192
ds_read_b64_tr_b16 a[128:129], v10 offset:64
v_accvgpr_read_b32 v14, a44
v_mfma_f32_16x16x32_bf16 v[112:115], a[148:151], a[24:27], v[112:115]
ds_read_b64_tr_b16 a[130:131], v10 offset:3648
buffer_load_dwordx4 a[72:75], v7, s[12:15], s36 offen offset:1024 sc1
v_accvgpr_read_b32 v15, a45
v_mfma_f32_16x16x32_bf16 v[116:119], a[144:147], a[20:23], v[116:119]
ds_read_b64_tr_b16 a[132:133], v10 offset:7232
v_max3_u32 v13, v13, v14, v15
v_mfma_f32_16x16x32_bf16 v[116:119], a[148:151], a[28:31], v[116:119]
ds_read_b64_tr_b16 a[134:135], v10 offset:10816
v_accvgpr_read_b32 v14, a46
v_mfma_f32_16x16x32_bf16 v[120:123], a[152:155], a[16:19], v[120:123]
s_mov_b32 s36, 24576
ds_read_b64_tr_b16 a[136:137], v10 offset:96
v_accvgpr_read_b32 v15, a47
v_mfma_f32_16x16x32_bf16 v[120:123], a[156:159], a[24:27], v[120:123]
ds_read_b64_tr_b16 a[138:139], v10 offset:3680
buffer_load_dwordx4 a[76:79], v7, s[12:15], s36 offen offset:1024 sc1
v_max3_u32 v13, v13, v14, v15
v_mfma_f32_16x16x32_bf16 v[124:127], a[152:155], a[20:23], v[124:127]
ds_read_b64_tr_b16 a[140:141], v10 offset:7264
v_cmp_eq_u32 vcc, -1, v13
s_cbranch_vccnz adaLN_cond__mha_block_cached__glu_gated_bilinear__prompt_kernel_rtg5
adaLN_cond__mha_block_cached__glu_gated_bilinear__prompt_kernel_rbg5:
v_mfma_f32_16x16x32_bf16 v[124:127], a[156:159], a[28:31], v[124:127]
ds_read_b64_tr_b16 a[142:143], v10 offset:10848
v_mfma_f32_16x16x32_bf16 v[16:19], a[160:163], a[32:35], v[16:19]
s_waitcnt lgkmcnt(5)
s_add_u32 m0, s30, 114688
s_mov_b32 s34, 917504
ds_read_b64_tr_b16 a[144:145], v10 offset:128
v_mfma_f32_16x16x32_bf16 v[16:19], a[164:167], a[40:43], v[16:19]
ds_read_b64_tr_b16 a[146:147], v10 offset:3712
buffer_load_dwordx4 v208, s[16:19], s34 offen offset:0 lds
v_mfma_f32_16x16x32_bf16 v[20:23], a[160:163], a[36:39], v[20:23]
ds_read_b64_tr_b16 a[148:149], v10 offset:7296
v_mfma_f32_16x16x32_bf16 v[20:23], a[164:167], a[44:47], v[20:23]
ds_read_b64_tr_b16 a[150:151], v10 offset:10880
v_mfma_f32_16x16x32_bf16 v[24:27], a[168:171], a[32:35], v[24:27]
ds_read_b64_tr_b16 a[152:153], v10 offset:160
v_mfma_f32_16x16x32_bf16 v[24:27], a[172:175], a[40:43], v[24:27]
ds_read_b64_tr_b16 a[154:155], v10 offset:3744
buffer_load_dwordx4 v209, s[16:19], s34 offen offset:1024 lds
v_mfma_f32_16x16x32_bf16 v[28:31], a[168:171], a[36:39], v[28:31]
ds_read_b64_tr_b16 a[156:157], v10 offset:7328
v_mfma_f32_16x16x32_bf16 v[28:31], a[172:175], a[44:47], v[28:31]
ds_read_b64_tr_b16 a[158:159], v10 offset:10912
v_mfma_f32_16x16x32_bf16 v[32:35], a[128:131], a[32:35], v[32:35]
s_waitcnt lgkmcnt(5)
ds_read_b64_tr_b16 a[160:161], v10 offset:192
v_mfma_f32_16x16x32_bf16 v[32:35], a[132:135], a[40:43], v[32:35]
ds_read_b64_tr_b16 a[162:163], v10 offset:3776
buffer_load_dwordx4 v210, s[16:19], s34 offen offset:2048 lds
v_mfma_f32_16x16x32_bf16 v[36:39], a[128:131], a[36:39], v[36:39]
ds_read_b64_tr_b16 a[164:165], v10 offset:7360
v_mfma_f32_16x16x32_bf16 v[36:39], a[132:135], a[44:47], v[36:39]
ds_read_b64_tr_b16 a[166:167], v10 offset:10944
v_mfma_f32_16x16x32_bf16 v[40:43], a[136:139], a[32:35], v[40:43]
ds_read_b64_tr_b16 a[168:169], v10 offset:14336
v_mfma_f32_16x16x32_bf16 v[40:43], a[140:143], a[40:43], v[40:43]
ds_read_b64_tr_b16 a[170:171], v10 offset:17920
buffer_load_dwordx4 v211, s[16:19], s34 offen offset:3072 lds
v_mfma_f32_16x16x32_bf16 v[44:47], a[136:139], a[36:39], v[44:47]
ds_read_b64_tr_b16 a[172:173], v10 offset:21504
v_mfma_f32_16x16x32_bf16 v[44:47], a[140:143], a[44:47], v[44:47]
ds_read_b64_tr_b16 a[174:175], v10 offset:25088
v_mfma_f32_16x16x32_bf16 v[48:51], a[144:147], a[32:35], v[48:51]
s_waitcnt lgkmcnt(5)
s_add_u32 m0, s30, 118784
s_mov_b32 s34, 917504
ds_read_b64_tr_b16 a[128:129], v10 offset:14368
v_mfma_f32_16x16x32_bf16 v[48:51], a[148:151], a[40:43], v[48:51]
ds_read_b64_tr_b16 a[130:131], v10 offset:17952
buffer_load_dwordx4 v212, s[16:19], s34 offen offset:0 lds
v_mfma_f32_16x16x32_bf16 v[52:55], a[144:147], a[36:39], v[52:55]
ds_read_b64_tr_b16 a[132:133], v10 offset:21536
v_mfma_f32_16x16x32_bf16 v[52:55], a[148:151], a[44:47], v[52:55]
ds_read_b64_tr_b16 a[134:135], v10 offset:25120
v_mfma_f32_16x16x32_bf16 v[56:59], a[152:155], a[32:35], v[56:59]
ds_read_b64_tr_b16 a[136:137], v10 offset:14400
v_mfma_f32_16x16x32_bf16 v[56:59], a[156:159], a[40:43], v[56:59]
ds_read_b64_tr_b16 a[138:139], v10 offset:17984
buffer_load_dwordx4 v213, s[16:19], s34 offen offset:1024 lds
v_mfma_f32_16x16x32_bf16 v[60:63], a[152:155], a[36:39], v[60:63]
ds_read_b64_tr_b16 a[140:141], v10 offset:21568
v_mfma_f32_16x16x32_bf16 v[60:63], a[156:159], a[44:47], v[60:63]
ds_read_b64_tr_b16 a[142:143], v10 offset:25152
v_mfma_f32_16x16x32_bf16 v[64:67], a[160:163], a[32:35], v[64:67]
s_waitcnt lgkmcnt(5)
ds_read_b64_tr_b16 a[144:145], v10 offset:14432
v_mfma_f32_16x16x32_bf16 v[64:67], a[164:167], a[40:43], v[64:67]
ds_read_b64_tr_b16 a[146:147], v10 offset:18016
buffer_load_dwordx4 v214, s[16:19], s34 offen offset:2048 lds
s_waitcnt vmcnt(20)
v_mfma_f32_16x16x32_bf16 v[68:71], a[160:163], a[36:39], v[68:71]
ds_read_b64_tr_b16 a[148:149], v10 offset:21600
v_accvgpr_read_b32 v14, a48
v_mfma_f32_16x16x32_bf16 v[68:71], a[164:167], a[44:47], v[68:71]
ds_read_b64_tr_b16 a[150:151], v10 offset:25184
v_accvgpr_read_b32 v15, a49
v_mfma_f32_16x16x32_bf16 v[72:75], a[168:171], a[32:35], v[72:75]
ds_read_b64_tr_b16 a[152:153], v10 offset:14464
v_max_u32 v13, v14, v15
v_mfma_f32_16x16x32_bf16 v[72:75], a[172:175], a[40:43], v[72:75]
ds_read_b64_tr_b16 a[154:155], v10 offset:18048
v_accvgpr_read_b32 v14, a50
v_mfma_f32_16x16x32_bf16 v[76:79], a[168:171], a[36:39], v[76:79]
ds_read_b64_tr_b16 a[156:157], v10 offset:21632
v_accvgpr_read_b32 v15, a51
v_mfma_f32_16x16x32_bf16 v[76:79], a[172:175], a[44:47], v[76:79]
ds_read_b64_tr_b16 a[158:159], v10 offset:25216
v_max3_u32 v13, v13, v14, v15
v_mfma_f32_16x16x32_bf16 v[80:83], a[128:131], a[32:35], v[80:83]
s_waitcnt lgkmcnt(5)
s_mov_b32 s36, 8192
ds_read_b64_tr_b16 a[160:161], v10 offset:14496
v_accvgpr_read_b32 v14, a52
v_mfma_f32_16x16x32_bf16 v[80:83], a[132:135], a[40:43], v[80:83]
ds_read_b64_tr_b16 a[162:163], v10 offset:18080
buffer_load_dwordx4 a[80:83], v7, s[12:15], s36 offen offset:2048 sc1
v_accvgpr_read_b32 v15, a53
v_mfma_f32_16x16x32_bf16 v[84:87], a[128:131], a[36:39], v[84:87]
ds_read_b64_tr_b16 a[164:165], v10 offset:21664
v_max3_u32 v13, v13, v14, v15
v_mfma_f32_16x16x32_bf16 v[84:87], a[132:135], a[44:47], v[84:87]
ds_read_b64_tr_b16 a[166:167], v10 offset:25248
v_accvgpr_read_b32 v14, a54
v_mfma_f32_16x16x32_bf16 v[88:91], a[136:139], a[32:35], v[88:91]
ds_read_b64_tr_b16 a[168:169], v10 offset:14528
v_accvgpr_read_b32 v15, a55
v_mfma_f32_16x16x32_bf16 v[88:91], a[140:143], a[40:43], v[88:91]
ds_read_b64_tr_b16 a[170:171], v10 offset:18112
v_max3_u32 v13, v13, v14, v15
v_mfma_f32_16x16x32_bf16 v[92:95], a[136:139], a[36:39], v[92:95]
ds_read_b64_tr_b16 a[172:173], v10 offset:21696
v_cmp_eq_u32 vcc, -1, v13
s_cbranch_vccnz adaLN_cond__mha_block_cached__glu_gated_bilinear__prompt_kernel_rtg6
adaLN_cond__mha_block_cached__glu_gated_bilinear__prompt_kernel_rbg6:
v_mfma_f32_16x16x32_bf16 v[92:95], a[140:143], a[44:47], v[92:95]
ds_read_b64_tr_b16 a[174:175], v10 offset:25280
s_waitcnt vmcnt(12)
s_barrier
v_mfma_f32_16x16x32_bf16 v[96:99], a[144:147], a[32:35], v[96:99]
s_waitcnt lgkmcnt(5)
s_mov_b32 s36, 24576
ds_read_b64_tr_b16 a[128:129], v11 offset:0
v_mfma_f32_16x16x32_bf16 v[96:99], a[148:151], a[40:43], v[96:99]
ds_read_b64_tr_b16 a[130:131], v11 offset:3584
buffer_load_dwordx4 a[84:87], v7, s[12:15], s36 offen offset:2048 sc1
v_mfma_f32_16x16x32_bf16 v[100:103], a[144:147], a[36:39], v[100:103]
ds_read_b64_tr_b16 a[132:133], v11 offset:7168
v_accvgpr_read_b32 v14, a56
v_mfma_f32_16x16x32_bf16 v[100:103], a[148:151], a[44:47], v[100:103]
ds_read_b64_tr_b16 a[134:135], v11 offset:10752
v_accvgpr_read_b32 v15, a57
v_mfma_f32_16x16x32_bf16 v[104:107], a[152:155], a[32:35], v[104:107]
ds_read_b64_tr_b16 a[136:137], v11 offset:32
v_max_u32 v13, v14, v15
v_mfma_f32_16x16x32_bf16 v[104:107], a[156:159], a[40:43], v[104:107]
ds_read_b64_tr_b16 a[138:139], v11 offset:3616
v_accvgpr_read_b32 v14, a58
v_mfma_f32_16x16x32_bf16 v[108:111], a[152:155], a[36:39], v[108:111]
ds_read_b64_tr_b16 a[140:141], v11 offset:7200
v_accvgpr_read_b32 v15, a59
v_mfma_f32_16x16x32_bf16 v[108:111], a[156:159], a[44:47], v[108:111]
ds_read_b64_tr_b16 a[142:143], v11 offset:10784
v_max3_u32 v13, v13, v14, v15
v_mfma_f32_16x16x32_bf16 v[112:115], a[160:163], a[32:35], v[112:115]
s_waitcnt lgkmcnt(5)
s_mov_b32 s36, 8192
ds_read_b64_tr_b16 a[144:145], v11 offset:64
v_accvgpr_read_b32 v14, a60
v_mfma_f32_16x16x32_bf16 v[112:115], a[164:167], a[40:43], v[112:115]
ds_read_b64_tr_b16 a[146:147], v11 offset:3648
buffer_load_dwordx4 a[88:91], v7, s[12:15], s36 offen offset:3072 sc1
v_accvgpr_read_b32 v15, a61
v_mfma_f32_16x16x32_bf16 v[116:119], a[160:163], a[36:39], v[116:119]
ds_read_b64_tr_b16 a[148:149], v11 offset:7232
v_max3_u32 v13, v13, v14, v15
v_mfma_f32_16x16x32_bf16 v[116:119], a[164:167], a[44:47], v[116:119]
ds_read_b64_tr_b16 a[150:151], v11 offset:10816
v_accvgpr_read_b32 v14, a62
v_mfma_f32_16x16x32_bf16 v[120:123], a[168:171], a[32:35], v[120:123]
s_mov_b32 s36, 24576
ds_read_b64_tr_b16 a[152:153], v11 offset:96
v_accvgpr_read_b32 v15, a63
v_mfma_f32_16x16x32_bf16 v[120:123], a[172:175], a[40:43], v[120:123]
ds_read_b64_tr_b16 a[154:155], v11 offset:3680
buffer_load_dwordx4 a[92:95], v7, s[12:15], s36 offen offset:3072 sc1
v_max3_u32 v13, v13, v14, v15
v_mfma_f32_16x16x32_bf16 v[124:127], a[168:171], a[36:39], v[124:127]
ds_read_b64_tr_b16 a[156:157], v11 offset:7264
v_cmp_eq_u32 vcc, -1, v13
s_cbranch_vccnz adaLN_cond__mha_block_cached__glu_gated_bilinear__prompt_kernel_rtg7
adaLN_cond__mha_block_cached__glu_gated_bilinear__prompt_kernel_rbg7:
v_mfma_f32_16x16x32_bf16 v[124:127], a[172:175], a[44:47], v[124:127]
ds_read_b64_tr_b16 a[158:159], v11 offset:10848
v_mfma_f32_16x16x32_bf16 v[16:19], a[128:131], a[48:51], v[16:19]
s_waitcnt lgkmcnt(5)
s_add_u32 m0, s30, 0
s_mov_b32 s34, 1146880
ds_read_b64_tr_b16 a[160:161], v11 offset:128
v_mfma_f32_16x16x32_bf16 v[16:19], a[132:135], a[56:59], v[16:19]
ds_read_b64_tr_b16 a[162:163], v11 offset:3712
buffer_load_dwordx4 v208, s[16:19], s34 offen offset:0 lds
v_mfma_f32_16x16x32_bf16 v[20:23], a[128:131], a[52:55], v[20:23]
ds_read_b64_tr_b16 a[164:165], v11 offset:7296
v_mfma_f32_16x16x32_bf16 v[20:23], a[132:135], a[60:63], v[20:23]
ds_read_b64_tr_b16 a[166:167], v11 offset:10880
v_mfma_f32_16x16x32_bf16 v[24:27], a[136:139], a[48:51], v[24:27]
ds_read_b64_tr_b16 a[168:169], v11 offset:160
v_mfma_f32_16x16x32_bf16 v[24:27], a[140:143], a[56:59], v[24:27]
ds_read_b64_tr_b16 a[170:171], v11 offset:3744
buffer_load_dwordx4 v209, s[16:19], s34 offen offset:1024 lds
v_mfma_f32_16x16x32_bf16 v[28:31], a[136:139], a[52:55], v[28:31]
ds_read_b64_tr_b16 a[172:173], v11 offset:7328
v_mfma_f32_16x16x32_bf16 v[28:31], a[140:143], a[60:63], v[28:31]
ds_read_b64_tr_b16 a[174:175], v11 offset:10912
v_mfma_f32_16x16x32_bf16 v[32:35], a[144:147], a[48:51], v[32:35]
s_waitcnt lgkmcnt(5)
ds_read_b64_tr_b16 a[128:129], v11 offset:192
v_mfma_f32_16x16x32_bf16 v[32:35], a[148:151], a[56:59], v[32:35]
ds_read_b64_tr_b16 a[130:131], v11 offset:3776
buffer_load_dwordx4 v210, s[16:19], s34 offen offset:2048 lds
v_mfma_f32_16x16x32_bf16 v[36:39], a[144:147], a[52:55], v[36:39]
ds_read_b64_tr_b16 a[132:133], v11 offset:7360
v_mfma_f32_16x16x32_bf16 v[36:39], a[148:151], a[60:63], v[36:39]
ds_read_b64_tr_b16 a[134:135], v11 offset:10944
v_mfma_f32_16x16x32_bf16 v[40:43], a[152:155], a[48:51], v[40:43]
ds_read_b64_tr_b16 a[136:137], v11 offset:14336
v_mfma_f32_16x16x32_bf16 v[40:43], a[156:159], a[56:59], v[40:43]
ds_read_b64_tr_b16 a[138:139], v11 offset:17920
buffer_load_dwordx4 v211, s[16:19], s34 offen offset:3072 lds
v_mfma_f32_16x16x32_bf16 v[44:47], a[152:155], a[52:55], v[44:47]
ds_read_b64_tr_b16 a[140:141], v11 offset:21504
v_mfma_f32_16x16x32_bf16 v[44:47], a[156:159], a[60:63], v[44:47]
ds_read_b64_tr_b16 a[142:143], v11 offset:25088
v_mfma_f32_16x16x32_bf16 v[48:51], a[160:163], a[48:51], v[48:51]
s_waitcnt lgkmcnt(5)
s_add_u32 m0, s30, 4096
s_mov_b32 s34, 1146880
ds_read_b64_tr_b16 a[144:145], v11 offset:14368
v_mfma_f32_16x16x32_bf16 v[48:51], a[164:167], a[56:59], v[48:51]
ds_read_b64_tr_b16 a[146:147], v11 offset:17952
buffer_load_dwordx4 v212, s[16:19], s34 offen offset:0 lds
v_mfma_f32_16x16x32_bf16 v[52:55], a[160:163], a[52:55], v[52:55]
ds_read_b64_tr_b16 a[148:149], v11 offset:21536
v_mfma_f32_16x16x32_bf16 v[52:55], a[164:167], a[60:63], v[52:55]
ds_read_b64_tr_b16 a[150:151], v11 offset:25120
v_mfma_f32_16x16x32_bf16 v[56:59], a[168:171], a[48:51], v[56:59]
ds_read_b64_tr_b16 a[152:153], v11 offset:14400
v_mfma_f32_16x16x32_bf16 v[56:59], a[172:175], a[56:59], v[56:59]
ds_read_b64_tr_b16 a[154:155], v11 offset:17984
buffer_load_dwordx4 v213, s[16:19], s34 offen offset:1024 lds
v_mfma_f32_16x16x32_bf16 v[60:63], a[168:171], a[52:55], v[60:63]
ds_read_b64_tr_b16 a[156:157], v11 offset:21568
v_mfma_f32_16x16x32_bf16 v[60:63], a[172:175], a[60:63], v[60:63]
ds_read_b64_tr_b16 a[158:159], v11 offset:25152
v_mfma_f32_16x16x32_bf16 v[64:67], a[128:131], a[48:51], v[64:67]
s_waitcnt lgkmcnt(5)
ds_read_b64_tr_b16 a[160:161], v11 offset:14432
v_mfma_f32_16x16x32_bf16 v[64:67], a[132:135], a[56:59], v[64:67]
ds_read_b64_tr_b16 a[162:163], v11 offset:18016
buffer_load_dwordx4 v214, s[16:19], s34 offen offset:2048 lds
s_waitcnt vmcnt(20)
v_mfma_f32_16x16x32_bf16 v[68:71], a[128:131], a[52:55], v[68:71]
ds_read_b64_tr_b16 a[164:165], v11 offset:21600
v_accvgpr_read_b32 v14, a64
v_mfma_f32_16x16x32_bf16 v[68:71], a[132:135], a[60:63], v[68:71]
ds_read_b64_tr_b16 a[166:167], v11 offset:25184
v_accvgpr_read_b32 v15, a65
v_mfma_f32_16x16x32_bf16 v[72:75], a[136:139], a[48:51], v[72:75]
ds_read_b64_tr_b16 a[168:169], v11 offset:14464
v_max_u32 v13, v14, v15
v_mfma_f32_16x16x32_bf16 v[72:75], a[140:143], a[56:59], v[72:75]
ds_read_b64_tr_b16 a[170:171], v11 offset:18048
v_accvgpr_read_b32 v14, a66
v_mfma_f32_16x16x32_bf16 v[76:79], a[136:139], a[52:55], v[76:79]
ds_read_b64_tr_b16 a[172:173], v11 offset:21632
v_accvgpr_read_b32 v15, a67
v_mfma_f32_16x16x32_bf16 v[76:79], a[140:143], a[60:63], v[76:79]
ds_read_b64_tr_b16 a[174:175], v11 offset:25216
v_max3_u32 v13, v13, v14, v15
v_mfma_f32_16x16x32_bf16 v[80:83], a[144:147], a[48:51], v[80:83]
s_waitcnt lgkmcnt(5)
s_mov_b32 s36, 12288
ds_read_b64_tr_b16 a[128:129], v11 offset:14496
v_accvgpr_read_b32 v14, a68
v_mfma_f32_16x16x32_bf16 v[80:83], a[148:151], a[56:59], v[80:83]
ds_read_b64_tr_b16 a[130:131], v11 offset:18080
buffer_load_dwordx4 a[96:99], v7, s[12:15], s36 offen offset:0 sc1
v_accvgpr_read_b32 v15, a69
v_mfma_f32_16x16x32_bf16 v[84:87], a[144:147], a[52:55], v[84:87]
ds_read_b64_tr_b16 a[132:133], v11 offset:21664
v_max3_u32 v13, v13, v14, v15
v_mfma_f32_16x16x32_bf16 v[84:87], a[148:151], a[60:63], v[84:87]
ds_read_b64_tr_b16 a[134:135], v11 offset:25248
v_accvgpr_read_b32 v14, a70
v_mfma_f32_16x16x32_bf16 v[88:91], a[152:155], a[48:51], v[88:91]
ds_read_b64_tr_b16 a[136:137], v11 offset:14528
v_accvgpr_read_b32 v15, a71
v_mfma_f32_16x16x32_bf16 v[88:91], a[156:159], a[56:59], v[88:91]
ds_read_b64_tr_b16 a[138:139], v11 offset:18112
v_max3_u32 v13, v13, v14, v15
v_mfma_f32_16x16x32_bf16 v[92:95], a[152:155], a[52:55], v[92:95]
ds_read_b64_tr_b16 a[140:141], v11 offset:21696
v_cmp_eq_u32 vcc, -1, v13
s_cbranch_vccnz adaLN_cond__mha_block_cached__glu_gated_bilinear__prompt_kernel_rtg8
adaLN_cond__mha_block_cached__glu_gated_bilinear__prompt_kernel_rbg8:
v_mfma_f32_16x16x32_bf16 v[92:95], a[156:159], a[60:63], v[92:95]
ds_read_b64_tr_b16 a[142:143], v11 offset:25280
s_waitcnt vmcnt(12)
s_barrier
v_mfma_f32_16x16x32_bf16 v[96:99], a[160:163], a[48:51], v[96:99]
s_waitcnt lgkmcnt(5)
s_mov_b32 s36, 28672
ds_read_b64_tr_b16 a[144:145], v12 offset:0
v_mfma_f32_16x16x32_bf16 v[96:99], a[164:167], a[56:59], v[96:99]
ds_read_b64_tr_b16 a[146:147], v12 offset:3584
buffer_load_dwordx4 a[100:103], v7, s[12:15], s36 offen offset:0 sc1
v_mfma_f32_16x16x32_bf16 v[100:103], a[160:163], a[52:55], v[100:103]
ds_read_b64_tr_b16 a[148:149], v12 offset:7168
v_accvgpr_read_b32 v14, a72
v_mfma_f32_16x16x32_bf16 v[100:103], a[164:167], a[60:63], v[100:103]
ds_read_b64_tr_b16 a[150:151], v12 offset:10752
v_accvgpr_read_b32 v15, a73
v_mfma_f32_16x16x32_bf16 v[104:107], a[168:171], a[48:51], v[104:107]
ds_read_b64_tr_b16 a[152:153], v12 offset:32
v_max_u32 v13, v14, v15
v_mfma_f32_16x16x32_bf16 v[104:107], a[172:175], a[56:59], v[104:107]
ds_read_b64_tr_b16 a[154:155], v12 offset:3616
v_accvgpr_read_b32 v14, a74
v_mfma_f32_16x16x32_bf16 v[108:111], a[168:171], a[52:55], v[108:111]
ds_read_b64_tr_b16 a[156:157], v12 offset:7200
v_accvgpr_read_b32 v15, a75
v_mfma_f32_16x16x32_bf16 v[108:111], a[172:175], a[60:63], v[108:111]
ds_read_b64_tr_b16 a[158:159], v12 offset:10784
v_max3_u32 v13, v13, v14, v15
v_mfma_f32_16x16x32_bf16 v[112:115], a[128:131], a[48:51], v[112:115]
s_waitcnt lgkmcnt(5)
s_mov_b32 s36, 12288
ds_read_b64_tr_b16 a[160:161], v12 offset:64
v_accvgpr_read_b32 v14, a76
v_mfma_f32_16x16x32_bf16 v[112:115], a[132:135], a[56:59], v[112:115]
ds_read_b64_tr_b16 a[162:163], v12 offset:3648
buffer_load_dwordx4 a[104:107], v7, s[12:15], s36 offen offset:1024 sc1
v_accvgpr_read_b32 v15, a77
v_mfma_f32_16x16x32_bf16 v[116:119], a[128:131], a[52:55], v[116:119]
ds_read_b64_tr_b16 a[164:165], v12 offset:7232
v_max3_u32 v13, v13, v14, v15
v_mfma_f32_16x16x32_bf16 v[116:119], a[132:135], a[60:63], v[116:119]
ds_read_b64_tr_b16 a[166:167], v12 offset:10816
v_accvgpr_read_b32 v14, a78
v_mfma_f32_16x16x32_bf16 v[120:123], a[136:139], a[48:51], v[120:123]
s_mov_b32 s36, 28672
ds_read_b64_tr_b16 a[168:169], v12 offset:96
v_accvgpr_read_b32 v15, a79
v_mfma_f32_16x16x32_bf16 v[120:123], a[140:143], a[56:59], v[120:123]
ds_read_b64_tr_b16 a[170:171], v12 offset:3680
buffer_load_dwordx4 a[108:111], v7, s[12:15], s36 offen offset:1024 sc1
v_max3_u32 v13, v13, v14, v15
v_mfma_f32_16x16x32_bf16 v[124:127], a[136:139], a[52:55], v[124:127]
ds_read_b64_tr_b16 a[172:173], v12 offset:7264
v_cmp_eq_u32 vcc, -1, v13
s_cbranch_vccnz adaLN_cond__mha_block_cached__glu_gated_bilinear__prompt_kernel_rtg9
adaLN_cond__mha_block_cached__glu_gated_bilinear__prompt_kernel_rbg9:
v_mfma_f32_16x16x32_bf16 v[124:127], a[140:143], a[60:63], v[124:127]
ds_read_b64_tr_b16 a[174:175], v12 offset:10848
v_mfma_f32_16x16x32_bf16 v[16:19], a[144:147], a[64:67], v[16:19]
s_waitcnt lgkmcnt(5)
s_add_u32 m0, s30, 28672
s_mov_b32 s34, 1376256
ds_read_b64_tr_b16 a[128:129], v12 offset:128
v_mfma_f32_16x16x32_bf16 v[16:19], a[148:151], a[72:75], v[16:19]
ds_read_b64_tr_b16 a[130:131], v12 offset:3712
buffer_load_dwordx4 v208, s[16:19], s34 offen offset:0 lds
v_mfma_f32_16x16x32_bf16 v[20:23], a[144:147], a[68:71], v[20:23]
ds_read_b64_tr_b16 a[132:133], v12 offset:7296
v_mfma_f32_16x16x32_bf16 v[20:23], a[148:151], a[76:79], v[20:23]
ds_read_b64_tr_b16 a[134:135], v12 offset:10880
v_mfma_f32_16x16x32_bf16 v[24:27], a[152:155], a[64:67], v[24:27]
ds_read_b64_tr_b16 a[136:137], v12 offset:160
v_mfma_f32_16x16x32_bf16 v[24:27], a[156:159], a[72:75], v[24:27]
ds_read_b64_tr_b16 a[138:139], v12 offset:3744
buffer_load_dwordx4 v209, s[16:19], s34 offen offset:1024 lds
v_mfma_f32_16x16x32_bf16 v[28:31], a[152:155], a[68:71], v[28:31]
ds_read_b64_tr_b16 a[140:141], v12 offset:7328
v_mfma_f32_16x16x32_bf16 v[28:31], a[156:159], a[76:79], v[28:31]
ds_read_b64_tr_b16 a[142:143], v12 offset:10912
v_mfma_f32_16x16x32_bf16 v[32:35], a[160:163], a[64:67], v[32:35]
s_waitcnt lgkmcnt(5)
ds_read_b64_tr_b16 a[144:145], v12 offset:192
v_mfma_f32_16x16x32_bf16 v[32:35], a[164:167], a[72:75], v[32:35]
ds_read_b64_tr_b16 a[146:147], v12 offset:3776
buffer_load_dwordx4 v210, s[16:19], s34 offen offset:2048 lds
v_mfma_f32_16x16x32_bf16 v[36:39], a[160:163], a[68:71], v[36:39]
ds_read_b64_tr_b16 a[148:149], v12 offset:7360
v_mfma_f32_16x16x32_bf16 v[36:39], a[164:167], a[76:79], v[36:39]
ds_read_b64_tr_b16 a[150:151], v12 offset:10944
v_mfma_f32_16x16x32_bf16 v[40:43], a[168:171], a[64:67], v[40:43]
ds_read_b64_tr_b16 a[152:153], v12 offset:14336
v_mfma_f32_16x16x32_bf16 v[40:43], a[172:175], a[72:75], v[40:43]
ds_read_b64_tr_b16 a[154:155], v12 offset:17920
buffer_load_dwordx4 v211, s[16:19], s34 offen offset:3072 lds
v_mfma_f32_16x16x32_bf16 v[44:47], a[168:171], a[68:71], v[44:47]
ds_read_b64_tr_b16 a[156:157], v12 offset:21504
v_mfma_f32_16x16x32_bf16 v[44:47], a[172:175], a[76:79], v[44:47]
ds_read_b64_tr_b16 a[158:159], v12 offset:25088
v_mfma_f32_16x16x32_bf16 v[48:51], a[128:131], a[64:67], v[48:51]
s_waitcnt lgkmcnt(5)
s_add_u32 m0, s30, 32768
s_mov_b32 s34, 1376256
ds_read_b64_tr_b16 a[160:161], v12 offset:14368
v_mfma_f32_16x16x32_bf16 v[48:51], a[132:135], a[72:75], v[48:51]
ds_read_b64_tr_b16 a[162:163], v12 offset:17952
buffer_load_dwordx4 v212, s[16:19], s34 offen offset:0 lds
v_mfma_f32_16x16x32_bf16 v[52:55], a[128:131], a[68:71], v[52:55]
ds_read_b64_tr_b16 a[164:165], v12 offset:21536
v_mfma_f32_16x16x32_bf16 v[52:55], a[132:135], a[76:79], v[52:55]
ds_read_b64_tr_b16 a[166:167], v12 offset:25120
v_mfma_f32_16x16x32_bf16 v[56:59], a[136:139], a[64:67], v[56:59]
ds_read_b64_tr_b16 a[168:169], v12 offset:14400
v_mfma_f32_16x16x32_bf16 v[56:59], a[140:143], a[72:75], v[56:59]
ds_read_b64_tr_b16 a[170:171], v12 offset:17984
buffer_load_dwordx4 v213, s[16:19], s34 offen offset:1024 lds
v_mfma_f32_16x16x32_bf16 v[60:63], a[136:139], a[68:71], v[60:63]
ds_read_b64_tr_b16 a[172:173], v12 offset:21568
v_mfma_f32_16x16x32_bf16 v[60:63], a[140:143], a[76:79], v[60:63]
ds_read_b64_tr_b16 a[174:175], v12 offset:25152
v_mfma_f32_16x16x32_bf16 v[64:67], a[144:147], a[64:67], v[64:67]
s_waitcnt lgkmcnt(5)
ds_read_b64_tr_b16 a[128:129], v12 offset:14432
v_mfma_f32_16x16x32_bf16 v[64:67], a[148:151], a[72:75], v[64:67]
ds_read_b64_tr_b16 a[130:131], v12 offset:18016
buffer_load_dwordx4 v214, s[16:19], s34 offen offset:2048 lds
s_waitcnt vmcnt(20)
v_mfma_f32_16x16x32_bf16 v[68:71], a[144:147], a[68:71], v[68:71]
ds_read_b64_tr_b16 a[132:133], v12 offset:21600
v_accvgpr_read_b32 v14, a80
v_mfma_f32_16x16x32_bf16 v[68:71], a[148:151], a[76:79], v[68:71]
ds_read_b64_tr_b16 a[134:135], v12 offset:25184
v_accvgpr_read_b32 v15, a81
v_mfma_f32_16x16x32_bf16 v[72:75], a[152:155], a[64:67], v[72:75]
ds_read_b64_tr_b16 a[136:137], v12 offset:14464
v_max_u32 v13, v14, v15
v_mfma_f32_16x16x32_bf16 v[72:75], a[156:159], a[72:75], v[72:75]
ds_read_b64_tr_b16 a[138:139], v12 offset:18048
v_accvgpr_read_b32 v14, a82
v_mfma_f32_16x16x32_bf16 v[76:79], a[152:155], a[68:71], v[76:79]
ds_read_b64_tr_b16 a[140:141], v12 offset:21632
v_accvgpr_read_b32 v15, a83
v_mfma_f32_16x16x32_bf16 v[76:79], a[156:159], a[76:79], v[76:79]
ds_read_b64_tr_b16 a[142:143], v12 offset:25216
v_max3_u32 v13, v13, v14, v15
v_mfma_f32_16x16x32_bf16 v[80:83], a[160:163], a[64:67], v[80:83]
s_waitcnt lgkmcnt(5)
s_mov_b32 s36, 12288
ds_read_b64_tr_b16 a[144:145], v12 offset:14496
v_accvgpr_read_b32 v14, a84
v_mfma_f32_16x16x32_bf16 v[80:83], a[164:167], a[72:75], v[80:83]
ds_read_b64_tr_b16 a[146:147], v12 offset:18080
buffer_load_dwordx4 a[112:115], v7, s[12:15], s36 offen offset:2048 sc1
v_accvgpr_read_b32 v15, a85
v_mfma_f32_16x16x32_bf16 v[84:87], a[160:163], a[68:71], v[84:87]
ds_read_b64_tr_b16 a[148:149], v12 offset:21664
v_max3_u32 v13, v13, v14, v15
v_mfma_f32_16x16x32_bf16 v[84:87], a[164:167], a[76:79], v[84:87]
ds_read_b64_tr_b16 a[150:151], v12 offset:25248
v_accvgpr_read_b32 v14, a86
v_mfma_f32_16x16x32_bf16 v[88:91], a[168:171], a[64:67], v[88:91]
ds_read_b64_tr_b16 a[152:153], v12 offset:14528
v_accvgpr_read_b32 v15, a87
v_mfma_f32_16x16x32_bf16 v[88:91], a[172:175], a[72:75], v[88:91]
ds_read_b64_tr_b16 a[154:155], v12 offset:18112
v_max3_u32 v13, v13, v14, v15
v_mfma_f32_16x16x32_bf16 v[92:95], a[168:171], a[68:71], v[92:95]
ds_read_b64_tr_b16 a[156:157], v12 offset:21696
v_cmp_eq_u32 vcc, -1, v13
s_cbranch_vccnz adaLN_cond__mha_block_cached__glu_gated_bilinear__prompt_kernel_rtg10
adaLN_cond__mha_block_cached__glu_gated_bilinear__prompt_kernel_rbg10:
v_mfma_f32_16x16x32_bf16 v[92:95], a[172:175], a[76:79], v[92:95]
ds_read_b64_tr_b16 a[158:159], v12 offset:25280
s_waitcnt vmcnt(12)
s_barrier
v_mfma_f32_16x16x32_bf16 v[96:99], a[128:131], a[64:67], v[96:99]
s_waitcnt lgkmcnt(5)
s_mov_b32 s36, 28672
ds_read_b64_tr_b16 a[160:161], v8 offset:0
v_mfma_f32_16x16x32_bf16 v[96:99], a[132:135], a[72:75], v[96:99]
ds_read_b64_tr_b16 a[162:163], v8 offset:3584
buffer_load_dwordx4 a[116:119], v7, s[12:15], s36 offen offset:2048 sc1
v_mfma_f32_16x16x32_bf16 v[100:103], a[128:131], a[68:71], v[100:103]
ds_read_b64_tr_b16 a[164:165], v8 offset:7168
v_accvgpr_read_b32 v14, a88
v_mfma_f32_16x16x32_bf16 v[100:103], a[132:135], a[76:79], v[100:103]
ds_read_b64_tr_b16 a[166:167], v8 offset:10752
v_accvgpr_read_b32 v15, a89
v_mfma_f32_16x16x32_bf16 v[104:107], a[136:139], a[64:67], v[104:107]
ds_read_b64_tr_b16 a[168:169], v8 offset:32
v_max_u32 v13, v14, v15
v_mfma_f32_16x16x32_bf16 v[104:107], a[140:143], a[72:75], v[104:107]
ds_read_b64_tr_b16 a[170:171], v8 offset:3616
v_accvgpr_read_b32 v14, a90
v_mfma_f32_16x16x32_bf16 v[108:111], a[136:139], a[68:71], v[108:111]
ds_read_b64_tr_b16 a[172:173], v8 offset:7200
v_accvgpr_read_b32 v15, a91
v_mfma_f32_16x16x32_bf16 v[108:111], a[140:143], a[76:79], v[108:111]
ds_read_b64_tr_b16 a[174:175], v8 offset:10784
v_max3_u32 v13, v13, v14, v15
v_mfma_f32_16x16x32_bf16 v[112:115], a[144:147], a[64:67], v[112:115]
s_waitcnt lgkmcnt(5)
s_mov_b32 s36, 12288
ds_read_b64_tr_b16 a[128:129], v8 offset:64
v_accvgpr_read_b32 v14, a92
v_mfma_f32_16x16x32_bf16 v[112:115], a[148:151], a[72:75], v[112:115]
ds_read_b64_tr_b16 a[130:131], v8 offset:3648
buffer_load_dwordx4 a[120:123], v7, s[12:15], s36 offen offset:3072 sc1
v_accvgpr_read_b32 v15, a93
v_mfma_f32_16x16x32_bf16 v[116:119], a[144:147], a[68:71], v[116:119]
ds_read_b64_tr_b16 a[132:133], v8 offset:7232
v_max3_u32 v13, v13, v14, v15
v_mfma_f32_16x16x32_bf16 v[116:119], a[148:151], a[76:79], v[116:119]
ds_read_b64_tr_b16 a[134:135], v8 offset:10816
v_accvgpr_read_b32 v14, a94
v_mfma_f32_16x16x32_bf16 v[120:123], a[152:155], a[64:67], v[120:123]
s_mov_b32 s36, 28672
ds_read_b64_tr_b16 a[136:137], v8 offset:96
v_accvgpr_read_b32 v15, a95
v_mfma_f32_16x16x32_bf16 v[120:123], a[156:159], a[72:75], v[120:123]
ds_read_b64_tr_b16 a[138:139], v8 offset:3680
buffer_load_dwordx4 a[124:127], v7, s[12:15], s36 offen offset:3072 sc1
v_max3_u32 v13, v13, v14, v15
v_mfma_f32_16x16x32_bf16 v[124:127], a[152:155], a[68:71], v[124:127]
ds_read_b64_tr_b16 a[140:141], v8 offset:7264
v_cmp_eq_u32 vcc, -1, v13
s_cbranch_vccnz adaLN_cond__mha_block_cached__glu_gated_bilinear__prompt_kernel_rtg11
adaLN_cond__mha_block_cached__glu_gated_bilinear__prompt_kernel_rbg11:
v_mfma_f32_16x16x32_bf16 v[124:127], a[156:159], a[76:79], v[124:127]
ds_read_b64_tr_b16 a[142:143], v8 offset:10848
v_mfma_f32_16x16x32_bf16 v[16:19], a[160:163], a[80:83], v[16:19]
s_waitcnt lgkmcnt(5)
s_add_u32 m0, s30, 57344
s_mov_b32 s34, 1605632
ds_read_b64_tr_b16 a[144:145], v8 offset:128
v_mfma_f32_16x16x32_bf16 v[16:19], a[164:167], a[88:91], v[16:19]
ds_read_b64_tr_b16 a[146:147], v8 offset:3712
buffer_load_dwordx4 v208, s[16:19], s34 offen offset:0 lds
v_mfma_f32_16x16x32_bf16 v[20:23], a[160:163], a[84:87], v[20:23]
ds_read_b64_tr_b16 a[148:149], v8 offset:7296
v_mfma_f32_16x16x32_bf16 v[20:23], a[164:167], a[92:95], v[20:23]
ds_read_b64_tr_b16 a[150:151], v8 offset:10880
v_mfma_f32_16x16x32_bf16 v[24:27], a[168:171], a[80:83], v[24:27]
ds_read_b64_tr_b16 a[152:153], v8 offset:160
v_mfma_f32_16x16x32_bf16 v[24:27], a[172:175], a[88:91], v[24:27]
ds_read_b64_tr_b16 a[154:155], v8 offset:3744
buffer_load_dwordx4 v209, s[16:19], s34 offen offset:1024 lds
v_mfma_f32_16x16x32_bf16 v[28:31], a[168:171], a[84:87], v[28:31]
ds_read_b64_tr_b16 a[156:157], v8 offset:7328
v_mfma_f32_16x16x32_bf16 v[28:31], a[172:175], a[92:95], v[28:31]
ds_read_b64_tr_b16 a[158:159], v8 offset:10912
v_mfma_f32_16x16x32_bf16 v[32:35], a[128:131], a[80:83], v[32:35]
s_waitcnt lgkmcnt(5)
ds_read_b64_tr_b16 a[160:161], v8 offset:192
v_mfma_f32_16x16x32_bf16 v[32:35], a[132:135], a[88:91], v[32:35]
ds_read_b64_tr_b16 a[162:163], v8 offset:3776
buffer_load_dwordx4 v210, s[16:19], s34 offen offset:2048 lds
v_mfma_f32_16x16x32_bf16 v[36:39], a[128:131], a[84:87], v[36:39]
ds_read_b64_tr_b16 a[164:165], v8 offset:7360
v_mfma_f32_16x16x32_bf16 v[36:39], a[132:135], a[92:95], v[36:39]
ds_read_b64_tr_b16 a[166:167], v8 offset:10944
v_mfma_f32_16x16x32_bf16 v[40:43], a[136:139], a[80:83], v[40:43]
ds_read_b64_tr_b16 a[168:169], v8 offset:14336
v_mfma_f32_16x16x32_bf16 v[40:43], a[140:143], a[88:91], v[40:43]
ds_read_b64_tr_b16 a[170:171], v8 offset:17920
buffer_load_dwordx4 v211, s[16:19], s34 offen offset:3072 lds
v_mfma_f32_16x16x32_bf16 v[44:47], a[136:139], a[84:87], v[44:47]
ds_read_b64_tr_b16 a[172:173], v8 offset:21504
v_mfma_f32_16x16x32_bf16 v[44:47], a[140:143], a[92:95], v[44:47]
ds_read_b64_tr_b16 a[174:175], v8 offset:25088
v_mfma_f32_16x16x32_bf16 v[48:51], a[144:147], a[80:83], v[48:51]
s_waitcnt lgkmcnt(5)
s_add_u32 m0, s30, 61440
s_mov_b32 s34, 1605632
ds_read_b64_tr_b16 a[128:129], v8 offset:14368
v_mfma_f32_16x16x32_bf16 v[48:51], a[148:151], a[88:91], v[48:51]
ds_read_b64_tr_b16 a[130:131], v8 offset:17952
buffer_load_dwordx4 v212, s[16:19], s34 offen offset:0 lds
v_mfma_f32_16x16x32_bf16 v[52:55], a[144:147], a[84:87], v[52:55]
ds_read_b64_tr_b16 a[132:133], v8 offset:21536
v_mfma_f32_16x16x32_bf16 v[52:55], a[148:151], a[92:95], v[52:55]
ds_read_b64_tr_b16 a[134:135], v8 offset:25120
v_mfma_f32_16x16x32_bf16 v[56:59], a[152:155], a[80:83], v[56:59]
ds_read_b64_tr_b16 a[136:137], v8 offset:14400
v_mfma_f32_16x16x32_bf16 v[56:59], a[156:159], a[88:91], v[56:59]
ds_read_b64_tr_b16 a[138:139], v8 offset:17984
buffer_load_dwordx4 v213, s[16:19], s34 offen offset:1024 lds
v_mfma_f32_16x16x32_bf16 v[60:63], a[152:155], a[84:87], v[60:63]
ds_read_b64_tr_b16 a[140:141], v8 offset:21568
v_mfma_f32_16x16x32_bf16 v[60:63], a[156:159], a[92:95], v[60:63]
ds_read_b64_tr_b16 a[142:143], v8 offset:25152
v_mfma_f32_16x16x32_bf16 v[64:67], a[160:163], a[80:83], v[64:67]
s_waitcnt lgkmcnt(5)
ds_read_b64_tr_b16 a[144:145], v8 offset:14432
v_mfma_f32_16x16x32_bf16 v[64:67], a[164:167], a[88:91], v[64:67]
ds_read_b64_tr_b16 a[146:147], v8 offset:18016
buffer_load_dwordx4 v214, s[16:19], s34 offen offset:2048 lds
s_waitcnt vmcnt(20)
v_mfma_f32_16x16x32_bf16 v[68:71], a[160:163], a[84:87], v[68:71]
ds_read_b64_tr_b16 a[148:149], v8 offset:21600
v_accvgpr_read_b32 v14, a96
v_mfma_f32_16x16x32_bf16 v[68:71], a[164:167], a[92:95], v[68:71]
ds_read_b64_tr_b16 a[150:151], v8 offset:25184
v_accvgpr_read_b32 v15, a97
v_mfma_f32_16x16x32_bf16 v[72:75], a[168:171], a[80:83], v[72:75]
ds_read_b64_tr_b16 a[152:153], v8 offset:14464
v_max_u32 v13, v14, v15
v_mfma_f32_16x16x32_bf16 v[72:75], a[172:175], a[88:91], v[72:75]
ds_read_b64_tr_b16 a[154:155], v8 offset:18048
v_accvgpr_read_b32 v14, a98
v_mfma_f32_16x16x32_bf16 v[76:79], a[168:171], a[84:87], v[76:79]
ds_read_b64_tr_b16 a[156:157], v8 offset:21632
v_accvgpr_read_b32 v15, a99
v_mfma_f32_16x16x32_bf16 v[76:79], a[172:175], a[92:95], v[76:79]
ds_read_b64_tr_b16 a[158:159], v8 offset:25216
v_max3_u32 v13, v13, v14, v15
v_mfma_f32_16x16x32_bf16 v[80:83], a[128:131], a[80:83], v[80:83]
s_waitcnt lgkmcnt(5)
ds_read_b64_tr_b16 a[160:161], v8 offset:14496
v_accvgpr_read_b32 v14, a100
v_mfma_f32_16x16x32_bf16 v[80:83], a[132:135], a[88:91], v[80:83]
ds_read_b64_tr_b16 a[162:163], v8 offset:18080
v_accvgpr_read_b32 v15, a101
v_mfma_f32_16x16x32_bf16 v[84:87], a[128:131], a[84:87], v[84:87]
ds_read_b64_tr_b16 a[164:165], v8 offset:21664
v_max3_u32 v13, v13, v14, v15
v_mfma_f32_16x16x32_bf16 v[84:87], a[132:135], a[92:95], v[84:87]
ds_read_b64_tr_b16 a[166:167], v8 offset:25248
v_accvgpr_read_b32 v14, a102
v_mfma_f32_16x16x32_bf16 v[88:91], a[136:139], a[80:83], v[88:91]
ds_read_b64_tr_b16 a[168:169], v8 offset:14528
v_accvgpr_read_b32 v15, a103
v_mfma_f32_16x16x32_bf16 v[88:91], a[140:143], a[88:91], v[88:91]
ds_read_b64_tr_b16 a[170:171], v8 offset:18112
v_max3_u32 v13, v13, v14, v15
v_mfma_f32_16x16x32_bf16 v[92:95], a[136:139], a[84:87], v[92:95]
ds_read_b64_tr_b16 a[172:173], v8 offset:21696
v_cmp_eq_u32 vcc, -1, v13
s_cbranch_vccnz adaLN_cond__mha_block_cached__glu_gated_bilinear__prompt_kernel_rtg12
adaLN_cond__mha_block_cached__glu_gated_bilinear__prompt_kernel_rbg12:
v_mfma_f32_16x16x32_bf16 v[92:95], a[140:143], a[92:95], v[92:95]
ds_read_b64_tr_b16 a[174:175], v8 offset:25280
s_waitcnt vmcnt(11)
s_barrier
v_mfma_f32_16x16x32_bf16 v[96:99], a[144:147], a[80:83], v[96:99]
s_waitcnt lgkmcnt(5)
ds_read_b64_tr_b16 a[128:129], v9 offset:0
v_mfma_f32_16x16x32_bf16 v[96:99], a[148:151], a[88:91], v[96:99]
ds_read_b64_tr_b16 a[130:131], v9 offset:3584
v_mfma_f32_16x16x32_bf16 v[100:103], a[144:147], a[84:87], v[100:103]
ds_read_b64_tr_b16 a[132:133], v9 offset:7168
v_accvgpr_read_b32 v14, a104
v_mfma_f32_16x16x32_bf16 v[100:103], a[148:151], a[92:95], v[100:103]
ds_read_b64_tr_b16 a[134:135], v9 offset:10752
v_accvgpr_read_b32 v15, a105
v_mfma_f32_16x16x32_bf16 v[104:107], a[152:155], a[80:83], v[104:107]
ds_read_b64_tr_b16 a[136:137], v9 offset:32
v_max_u32 v13, v14, v15
v_mfma_f32_16x16x32_bf16 v[104:107], a[156:159], a[88:91], v[104:107]
ds_read_b64_tr_b16 a[138:139], v9 offset:3616
v_accvgpr_read_b32 v14, a106
v_mfma_f32_16x16x32_bf16 v[108:111], a[152:155], a[84:87], v[108:111]
ds_read_b64_tr_b16 a[140:141], v9 offset:7200
v_accvgpr_read_b32 v15, a107
v_mfma_f32_16x16x32_bf16 v[108:111], a[156:159], a[92:95], v[108:111]
ds_read_b64_tr_b16 a[142:143], v9 offset:10784
v_max3_u32 v13, v13, v14, v15
v_mfma_f32_16x16x32_bf16 v[112:115], a[160:163], a[80:83], v[112:115]
s_waitcnt lgkmcnt(5)
ds_read_b64_tr_b16 a[144:145], v9 offset:64
v_accvgpr_read_b32 v14, a108
v_mfma_f32_16x16x32_bf16 v[112:115], a[164:167], a[88:91], v[112:115]
ds_read_b64_tr_b16 a[146:147], v9 offset:3648
v_accvgpr_read_b32 v15, a109
v_mfma_f32_16x16x32_bf16 v[116:119], a[160:163], a[84:87], v[116:119]
ds_read_b64_tr_b16 a[148:149], v9 offset:7232
v_max3_u32 v13, v13, v14, v15
v_mfma_f32_16x16x32_bf16 v[116:119], a[164:167], a[92:95], v[116:119]
ds_read_b64_tr_b16 a[150:151], v9 offset:10816
v_accvgpr_read_b32 v14, a110
v_mfma_f32_16x16x32_bf16 v[120:123], a[168:171], a[80:83], v[120:123]
ds_read_b64_tr_b16 a[152:153], v9 offset:96
v_accvgpr_read_b32 v15, a111
v_mfma_f32_16x16x32_bf16 v[120:123], a[172:175], a[88:91], v[120:123]
ds_read_b64_tr_b16 a[154:155], v9 offset:3680
v_max3_u32 v13, v13, v14, v15
v_mfma_f32_16x16x32_bf16 v[124:127], a[168:171], a[84:87], v[124:127]
ds_read_b64_tr_b16 a[156:157], v9 offset:7264
v_cmp_eq_u32 vcc, -1, v13
s_cbranch_vccnz adaLN_cond__mha_block_cached__glu_gated_bilinear__prompt_kernel_rtg13
adaLN_cond__mha_block_cached__glu_gated_bilinear__prompt_kernel_rbg13:
v_mfma_f32_16x16x32_bf16 v[124:127], a[172:175], a[92:95], v[124:127]
ds_read_b64_tr_b16 a[158:159], v9 offset:10848
v_mfma_f32_16x16x32_bf16 v[16:19], a[128:131], a[96:99], v[16:19]
s_waitcnt lgkmcnt(5)
ds_read_b64_tr_b16 a[160:161], v9 offset:128
v_mfma_f32_16x16x32_bf16 v[16:19], a[132:135], a[104:107], v[16:19]
ds_read_b64_tr_b16 a[162:163], v9 offset:3712
v_mfma_f32_16x16x32_bf16 v[20:23], a[128:131], a[100:103], v[20:23]
ds_read_b64_tr_b16 a[164:165], v9 offset:7296
v_mfma_f32_16x16x32_bf16 v[20:23], a[132:135], a[108:111], v[20:23]
ds_read_b64_tr_b16 a[166:167], v9 offset:10880
v_mfma_f32_16x16x32_bf16 v[24:27], a[136:139], a[96:99], v[24:27]
ds_read_b64_tr_b16 a[168:169], v9 offset:160
v_mfma_f32_16x16x32_bf16 v[24:27], a[140:143], a[104:107], v[24:27]
ds_read_b64_tr_b16 a[170:171], v9 offset:3744
v_mfma_f32_16x16x32_bf16 v[28:31], a[136:139], a[100:103], v[28:31]
ds_read_b64_tr_b16 a[172:173], v9 offset:7328
v_mfma_f32_16x16x32_bf16 v[28:31], a[140:143], a[108:111], v[28:31]
ds_read_b64_tr_b16 a[174:175], v9 offset:10912
v_mfma_f32_16x16x32_bf16 v[32:35], a[144:147], a[96:99], v[32:35]
s_waitcnt lgkmcnt(5)
ds_read_b64_tr_b16 a[128:129], v9 offset:192
v_mfma_f32_16x16x32_bf16 v[32:35], a[148:151], a[104:107], v[32:35]
ds_read_b64_tr_b16 a[130:131], v9 offset:3776
v_mfma_f32_16x16x32_bf16 v[36:39], a[144:147], a[100:103], v[36:39]
ds_read_b64_tr_b16 a[132:133], v9 offset:7360
v_mfma_f32_16x16x32_bf16 v[36:39], a[148:151], a[108:111], v[36:39]
ds_read_b64_tr_b16 a[134:135], v9 offset:10944
v_mfma_f32_16x16x32_bf16 v[40:43], a[152:155], a[96:99], v[40:43]
ds_read_b64_tr_b16 a[136:137], v9 offset:14336
v_mfma_f32_16x16x32_bf16 v[40:43], a[156:159], a[104:107], v[40:43]
ds_read_b64_tr_b16 a[138:139], v9 offset:17920
v_mfma_f32_16x16x32_bf16 v[44:47], a[152:155], a[100:103], v[44:47]
ds_read_b64_tr_b16 a[140:141], v9 offset:21504
v_mfma_f32_16x16x32_bf16 v[44:47], a[156:159], a[108:111], v[44:47]
ds_read_b64_tr_b16 a[142:143], v9 offset:25088
v_mfma_f32_16x16x32_bf16 v[48:51], a[160:163], a[96:99], v[48:51]
s_waitcnt lgkmcnt(5)
ds_read_b64_tr_b16 a[144:145], v9 offset:14368
v_mfma_f32_16x16x32_bf16 v[48:51], a[164:167], a[104:107], v[48:51]
ds_read_b64_tr_b16 a[146:147], v9 offset:17952
v_mfma_f32_16x16x32_bf16 v[52:55], a[160:163], a[100:103], v[52:55]
ds_read_b64_tr_b16 a[148:149], v9 offset:21536
v_mfma_f32_16x16x32_bf16 v[52:55], a[164:167], a[108:111], v[52:55]
ds_read_b64_tr_b16 a[150:151], v9 offset:25120
v_mfma_f32_16x16x32_bf16 v[56:59], a[168:171], a[96:99], v[56:59]
ds_read_b64_tr_b16 a[152:153], v9 offset:14400
v_mfma_f32_16x16x32_bf16 v[56:59], a[172:175], a[104:107], v[56:59]
ds_read_b64_tr_b16 a[154:155], v9 offset:17984
v_mfma_f32_16x16x32_bf16 v[60:63], a[168:171], a[100:103], v[60:63]
ds_read_b64_tr_b16 a[156:157], v9 offset:21568
v_mfma_f32_16x16x32_bf16 v[60:63], a[172:175], a[108:111], v[60:63]
ds_read_b64_tr_b16 a[158:159], v9 offset:25152
v_mfma_f32_16x16x32_bf16 v[64:67], a[128:131], a[96:99], v[64:67]
s_waitcnt lgkmcnt(5)
ds_read_b64_tr_b16 a[160:161], v9 offset:14432
v_mfma_f32_16x16x32_bf16 v[64:67], a[132:135], a[104:107], v[64:67]
ds_read_b64_tr_b16 a[162:163], v9 offset:18016
s_waitcnt vmcnt(9)
v_mfma_f32_16x16x32_bf16 v[68:71], a[128:131], a[100:103], v[68:71]
ds_read_b64_tr_b16 a[164:165], v9 offset:21600
v_accvgpr_read_b32 v14, a112
v_mfma_f32_16x16x32_bf16 v[68:71], a[132:135], a[108:111], v[68:71]
ds_read_b64_tr_b16 a[166:167], v9 offset:25184
v_accvgpr_read_b32 v15, a113
v_mfma_f32_16x16x32_bf16 v[72:75], a[136:139], a[96:99], v[72:75]
ds_read_b64_tr_b16 a[168:169], v9 offset:14464
v_max_u32 v13, v14, v15
v_mfma_f32_16x16x32_bf16 v[72:75], a[140:143], a[104:107], v[72:75]
ds_read_b64_tr_b16 a[170:171], v9 offset:18048
v_accvgpr_read_b32 v14, a114
v_mfma_f32_16x16x32_bf16 v[76:79], a[136:139], a[100:103], v[76:79]
ds_read_b64_tr_b16 a[172:173], v9 offset:21632
v_accvgpr_read_b32 v15, a115
v_mfma_f32_16x16x32_bf16 v[76:79], a[140:143], a[108:111], v[76:79]
ds_read_b64_tr_b16 a[174:175], v9 offset:25216
v_max3_u32 v13, v13, v14, v15
v_mfma_f32_16x16x32_bf16 v[80:83], a[144:147], a[96:99], v[80:83]
s_waitcnt lgkmcnt(5)
ds_read_b64_tr_b16 a[128:129], v9 offset:14496
v_accvgpr_read_b32 v14, a116
v_mfma_f32_16x16x32_bf16 v[80:83], a[148:151], a[104:107], v[80:83]
ds_read_b64_tr_b16 a[130:131], v9 offset:18080
v_accvgpr_read_b32 v15, a117
v_mfma_f32_16x16x32_bf16 v[84:87], a[144:147], a[100:103], v[84:87]
ds_read_b64_tr_b16 a[132:133], v9 offset:21664
v_max3_u32 v13, v13, v14, v15
v_mfma_f32_16x16x32_bf16 v[84:87], a[148:151], a[108:111], v[84:87]
ds_read_b64_tr_b16 a[134:135], v9 offset:25248
v_accvgpr_read_b32 v14, a118
v_mfma_f32_16x16x32_bf16 v[88:91], a[152:155], a[96:99], v[88:91]
ds_read_b64_tr_b16 a[136:137], v9 offset:14528
v_accvgpr_read_b32 v15, a119
v_mfma_f32_16x16x32_bf16 v[88:91], a[156:159], a[104:107], v[88:91]
ds_read_b64_tr_b16 a[138:139], v9 offset:18112
v_max3_u32 v13, v13, v14, v15
v_mfma_f32_16x16x32_bf16 v[92:95], a[152:155], a[100:103], v[92:95]
ds_read_b64_tr_b16 a[140:141], v9 offset:21696
v_cmp_eq_u32 vcc, -1, v13
s_cbranch_vccnz adaLN_cond__mha_block_cached__glu_gated_bilinear__prompt_kernel_rtg14
adaLN_cond__mha_block_cached__glu_gated_bilinear__prompt_kernel_rbg14:
v_mfma_f32_16x16x32_bf16 v[92:95], a[156:159], a[108:111], v[92:95]
ds_read_b64_tr_b16 a[142:143], v9 offset:25280
s_waitcnt vmcnt(0)
s_barrier
v_mfma_f32_16x16x32_bf16 v[96:99], a[160:163], a[96:99], v[96:99]
s_waitcnt lgkmcnt(5)
ds_read_b64_tr_b16 a[144:145], v10 offset:0
v_mfma_f32_16x16x32_bf16 v[96:99], a[164:167], a[104:107], v[96:99]
ds_read_b64_tr_b16 a[146:147], v10 offset:3584
v_mfma_f32_16x16x32_bf16 v[100:103], a[160:163], a[100:103], v[100:103]
ds_read_b64_tr_b16 a[148:149], v10 offset:7168
v_accvgpr_read_b32 v14, a120
v_mfma_f32_16x16x32_bf16 v[100:103], a[164:167], a[108:111], v[100:103]
ds_read_b64_tr_b16 a[150:151], v10 offset:10752
v_accvgpr_read_b32 v15, a121
v_mfma_f32_16x16x32_bf16 v[104:107], a[168:171], a[96:99], v[104:107]
ds_read_b64_tr_b16 a[152:153], v10 offset:14336
v_max_u32 v13, v14, v15
v_mfma_f32_16x16x32_bf16 v[104:107], a[172:175], a[104:107], v[104:107]
ds_read_b64_tr_b16 a[154:155], v10 offset:17920
v_accvgpr_read_b32 v14, a122
v_mfma_f32_16x16x32_bf16 v[108:111], a[168:171], a[100:103], v[108:111]
ds_read_b64_tr_b16 a[156:157], v10 offset:21504
v_accvgpr_read_b32 v15, a123
v_mfma_f32_16x16x32_bf16 v[108:111], a[172:175], a[108:111], v[108:111]
ds_read_b64_tr_b16 a[158:159], v10 offset:25088
v_max3_u32 v13, v13, v14, v15
v_mfma_f32_16x16x32_bf16 v[112:115], a[128:131], a[96:99], v[112:115]
s_waitcnt lgkmcnt(5)
ds_read_b64_tr_b16 a[160:161], v10 offset:32
v_accvgpr_read_b32 v14, a124
v_mfma_f32_16x16x32_bf16 v[112:115], a[132:135], a[104:107], v[112:115]
ds_read_b64_tr_b16 a[162:163], v10 offset:3616
v_accvgpr_read_b32 v15, a125
v_mfma_f32_16x16x32_bf16 v[116:119], a[128:131], a[100:103], v[116:119]
ds_read_b64_tr_b16 a[164:165], v10 offset:7200
v_max3_u32 v13, v13, v14, v15
v_mfma_f32_16x16x32_bf16 v[116:119], a[132:135], a[108:111], v[116:119]
ds_read_b64_tr_b16 a[166:167], v10 offset:10784
v_accvgpr_read_b32 v14, a126
v_mfma_f32_16x16x32_bf16 v[120:123], a[136:139], a[96:99], v[120:123]
ds_read_b64_tr_b16 a[168:169], v10 offset:14368
v_accvgpr_read_b32 v15, a127
v_mfma_f32_16x16x32_bf16 v[120:123], a[140:143], a[104:107], v[120:123]
ds_read_b64_tr_b16 a[170:171], v10 offset:17952
v_max3_u32 v13, v13, v14, v15
v_mfma_f32_16x16x32_bf16 v[124:127], a[136:139], a[100:103], v[124:127]
ds_read_b64_tr_b16 a[172:173], v10 offset:21536
v_cmp_eq_u32 vcc, -1, v13
s_cbranch_vccnz adaLN_cond__mha_block_cached__glu_gated_bilinear__prompt_kernel_rtg15
adaLN_cond__mha_block_cached__glu_gated_bilinear__prompt_kernel_rbg15:
v_mfma_f32_16x16x32_bf16 v[124:127], a[140:143], a[108:111], v[124:127]
ds_read_b64_tr_b16 a[174:175], v10 offset:25120
v_mfma_f32_16x16x32_bf16 v[16:19], a[144:147], a[112:115], v[16:19]
s_waitcnt lgkmcnt(5)
ds_read_b64_tr_b16 a[128:129], v10 offset:64
v_mfma_f32_16x16x32_bf16 v[16:19], a[148:151], a[120:123], v[16:19]
ds_read_b64_tr_b16 a[130:131], v10 offset:3648
v_mfma_f32_16x16x32_bf16 v[20:23], a[144:147], a[116:119], v[20:23]
ds_read_b64_tr_b16 a[132:133], v10 offset:7232
v_mfma_f32_16x16x32_bf16 v[20:23], a[148:151], a[124:127], v[20:23]
ds_read_b64_tr_b16 a[134:135], v10 offset:10816
v_mfma_f32_16x16x32_bf16 v[72:75], a[152:155], a[112:115], v[72:75]
ds_read_b64_tr_b16 a[136:137], v10 offset:14400
v_mfma_f32_16x16x32_bf16 v[72:75], a[156:159], a[120:123], v[72:75]
ds_read_b64_tr_b16 a[138:139], v10 offset:17984
v_mfma_f32_16x16x32_bf16 v[76:79], a[152:155], a[116:119], v[76:79]
ds_read_b64_tr_b16 a[140:141], v10 offset:21568
v_mfma_f32_16x16x32_bf16 v[76:79], a[156:159], a[124:127], v[76:79]
ds_read_b64_tr_b16 a[142:143], v10 offset:25152
v_mfma_f32_16x16x32_bf16 v[24:27], a[160:163], a[112:115], v[24:27]
s_waitcnt lgkmcnt(5)
ds_read_b64_tr_b16 a[144:145], v10 offset:96
v_mfma_f32_16x16x32_bf16 v[24:27], a[164:167], a[120:123], v[24:27]
ds_read_b64_tr_b16 a[146:147], v10 offset:3680
v_mfma_f32_16x16x32_bf16 v[28:31], a[160:163], a[116:119], v[28:31]
ds_read_b64_tr_b16 a[148:149], v10 offset:7264
v_mfma_f32_16x16x32_bf16 v[28:31], a[164:167], a[124:127], v[28:31]
ds_read_b64_tr_b16 a[150:151], v10 offset:10848
v_mfma_f32_16x16x32_bf16 v[80:83], a[168:171], a[112:115], v[80:83]
ds_read_b64_tr_b16 a[152:153], v10 offset:14432
v_mul_f32 v16, v16, v72
v_mul_f32 v17, v17, v73
v_mfma_f32_16x16x32_bf16 v[80:83], a[172:175], a[120:123], v[80:83]
ds_read_b64_tr_b16 a[154:155], v10 offset:18016
v_mul_f32 v18, v18, v74
v_mul_f32 v19, v19, v75
v_mfma_f32_16x16x32_bf16 v[84:87], a[168:171], a[116:119], v[84:87]
ds_read_b64_tr_b16 a[156:157], v10 offset:21600
v_mul_f32 v20, v20, v76
v_mul_f32 v21, v21, v77
v_mfma_f32_16x16x32_bf16 v[84:87], a[172:175], a[124:127], v[84:87]
ds_read_b64_tr_b16 a[158:159], v10 offset:25184
v_mul_f32 v22, v22, v78
v_mfma_f32_16x16x32_bf16 v[32:35], a[128:131], a[112:115], v[32:35]
s_waitcnt lgkmcnt(5)
ds_read_b64_tr_b16 a[160:161], v10 offset:128
v_mul_f32 v23, v23, v79
v_cvt_pk_bf16_f32 v16, v16, v17
v_mfma_f32_16x16x32_bf16 v[32:35], a[132:135], a[120:123], v[32:35]
ds_read_b64_tr_b16 a[162:163], v10 offset:3712
v_cvt_pk_bf16_f32 v17, v18, v19
v_cvt_pk_bf16_f32 v18, v20, v21
v_mfma_f32_16x16x32_bf16 v[36:39], a[128:131], a[116:119], v[36:39]
ds_read_b64_tr_b16 a[164:165], v10 offset:7296
v_cvt_pk_bf16_f32 v19, v22, v23
s_mov_b32 s48, 0
v_mfma_f32_16x16x32_bf16 v[36:39], a[132:135], a[124:127], v[36:39]
ds_read_b64_tr_b16 a[166:167], v10 offset:10880
buffer_store_dwordx4 v[16:19], v7, s[8:11], s48 offen offset:0 sc1
v_mfma_f32_16x16x32_bf16 v[88:91], a[136:139], a[112:115], v[88:91]
ds_read_b64_tr_b16 a[168:169], v10 offset:14464
v_mul_f32 v24, v24, v80
v_mul_f32 v25, v25, v81
v_mfma_f32_16x16x32_bf16 v[88:91], a[140:143], a[120:123], v[88:91]
ds_read_b64_tr_b16 a[170:171], v10 offset:18048
v_mul_f32 v26, v26, v82
v_mul_f32 v27, v27, v83
v_mfma_f32_16x16x32_bf16 v[92:95], a[136:139], a[116:119], v[92:95]
ds_read_b64_tr_b16 a[172:173], v10 offset:21632
v_mul_f32 v28, v28, v84
v_mul_f32 v29, v29, v85
v_mfma_f32_16x16x32_bf16 v[92:95], a[140:143], a[124:127], v[92:95]
ds_read_b64_tr_b16 a[174:175], v10 offset:25216
v_mul_f32 v30, v30, v86
v_mfma_f32_16x16x32_bf16 v[40:43], a[144:147], a[112:115], v[40:43]
s_waitcnt lgkmcnt(5)
ds_read_b64_tr_b16 a[128:129], v10 offset:160
v_mul_f32 v31, v31, v87
v_cvt_pk_bf16_f32 v24, v24, v25
v_mfma_f32_16x16x32_bf16 v[40:43], a[148:151], a[120:123], v[40:43]
ds_read_b64_tr_b16 a[130:131], v10 offset:3744
v_cvt_pk_bf16_f32 v25, v26, v27
v_cvt_pk_bf16_f32 v26, v28, v29
v_mfma_f32_16x16x32_bf16 v[44:47], a[144:147], a[116:119], v[44:47]
ds_read_b64_tr_b16 a[132:133], v10 offset:7328
v_cvt_pk_bf16_f32 v27, v30, v31
s_mov_b32 s48, 0
v_mfma_f32_16x16x32_bf16 v[44:47], a[148:151], a[124:127], v[44:47]
ds_read_b64_tr_b16 a[134:135], v10 offset:10912
buffer_store_dwordx4 v[24:27], v7, s[8:11], s48 offen offset:1024 sc1
v_mfma_f32_16x16x32_bf16 v[96:99], a[152:155], a[112:115], v[96:99]
ds_read_b64_tr_b16 a[136:137], v10 offset:14496
v_mul_f32 v32, v32, v88
v_mul_f32 v33, v33, v89
v_mfma_f32_16x16x32_bf16 v[96:99], a[156:159], a[120:123], v[96:99]
ds_read_b64_tr_b16 a[138:139], v10 offset:18080
v_mul_f32 v34, v34, v90
v_mul_f32 v35, v35, v91
v_mfma_f32_16x16x32_bf16 v[100:103], a[152:155], a[116:119], v[100:103]
ds_read_b64_tr_b16 a[140:141], v10 offset:21664
v_mul_f32 v36, v36, v92
v_mul_f32 v37, v37, v93
v_mfma_f32_16x16x32_bf16 v[100:103], a[156:159], a[124:127], v[100:103]
ds_read_b64_tr_b16 a[142:143], v10 offset:25248
v_mul_f32 v38, v38, v94
v_mfma_f32_16x16x32_bf16 v[48:51], a[160:163], a[112:115], v[48:51]
s_waitcnt lgkmcnt(5)
ds_read_b64_tr_b16 a[144:145], v10 offset:192
v_mul_f32 v39, v39, v95
v_cvt_pk_bf16_f32 v32, v32, v33
v_mfma_f32_16x16x32_bf16 v[48:51], a[164:167], a[120:123], v[48:51]
ds_read_b64_tr_b16 a[146:147], v10 offset:3776
v_cvt_pk_bf16_f32 v33, v34, v35
v_cvt_pk_bf16_f32 v34, v36, v37
v_mfma_f32_16x16x32_bf16 v[52:55], a[160:163], a[116:119], v[52:55]
ds_read_b64_tr_b16 a[148:149], v10 offset:7360
v_cvt_pk_bf16_f32 v35, v38, v39
s_mov_b32 s48, 0
v_mfma_f32_16x16x32_bf16 v[52:55], a[164:167], a[124:127], v[52:55]
ds_read_b64_tr_b16 a[150:151], v10 offset:10944
buffer_store_dwordx4 v[32:35], v7, s[8:11], s48 offen offset:2048 sc1
v_mfma_f32_16x16x32_bf16 v[104:107], a[168:171], a[112:115], v[104:107]
ds_read_b64_tr_b16 a[152:153], v10 offset:14528
v_mul_f32 v40, v40, v96
v_mul_f32 v41, v41, v97
v_mfma_f32_16x16x32_bf16 v[104:107], a[172:175], a[120:123], v[104:107]
ds_read_b64_tr_b16 a[154:155], v10 offset:18112
v_mul_f32 v42, v42, v98
v_mul_f32 v43, v43, v99
v_mfma_f32_16x16x32_bf16 v[108:111], a[168:171], a[116:119], v[108:111]
ds_read_b64_tr_b16 a[156:157], v10 offset:21696
v_mul_f32 v44, v44, v100
v_mul_f32 v45, v45, v101
v_mfma_f32_16x16x32_bf16 v[108:111], a[172:175], a[124:127], v[108:111]
ds_read_b64_tr_b16 a[158:159], v10 offset:25280
v_mul_f32 v46, v46, v102
v_mfma_f32_16x16x32_bf16 v[56:59], a[128:131], a[112:115], v[56:59]
s_waitcnt lgkmcnt(5)
v_mul_f32 v47, v47, v103
v_cvt_pk_bf16_f32 v40, v40, v41
v_mfma_f32_16x16x32_bf16 v[56:59], a[132:135], a[120:123], v[56:59]
v_cvt_pk_bf16_f32 v41, v42, v43
v_cvt_pk_bf16_f32 v42, v44, v45
v_mfma_f32_16x16x32_bf16 v[60:63], a[128:131], a[116:119], v[60:63]
v_cvt_pk_bf16_f32 v43, v46, v47
s_mov_b32 s48, 0
v_mfma_f32_16x16x32_bf16 v[60:63], a[132:135], a[124:127], v[60:63]
buffer_store_dwordx4 v[40:43], v7, s[8:11], s48 offen offset:3072 sc1
v_mfma_f32_16x16x32_bf16 v[112:115], a[136:139], a[112:115], v[112:115]
v_mul_f32 v48, v48, v104
v_mul_f32 v49, v49, v105
v_mfma_f32_16x16x32_bf16 v[112:115], a[140:143], a[120:123], v[112:115]
v_mul_f32 v50, v50, v106
v_mul_f32 v51, v51, v107
v_mfma_f32_16x16x32_bf16 v[116:119], a[136:139], a[116:119], v[116:119]
v_mul_f32 v52, v52, v108
v_mul_f32 v53, v53, v109
v_mfma_f32_16x16x32_bf16 v[116:119], a[140:143], a[124:127], v[116:119]
v_mul_f32 v54, v54, v110
v_mfma_f32_16x16x32_bf16 v[64:67], a[144:147], a[112:115], v[64:67]
s_waitcnt lgkmcnt(0)
v_mul_f32 v55, v55, v111
v_cvt_pk_bf16_f32 v48, v48, v49
v_mfma_f32_16x16x32_bf16 v[64:67], a[148:151], a[120:123], v[64:67]
v_cvt_pk_bf16_f32 v49, v50, v51
v_cvt_pk_bf16_f32 v50, v52, v53
v_mfma_f32_16x16x32_bf16 v[68:71], a[144:147], a[116:119], v[68:71]
v_cvt_pk_bf16_f32 v51, v54, v55
s_mov_b32 s48, 4096
v_mfma_f32_16x16x32_bf16 v[68:71], a[148:151], a[124:127], v[68:71]
buffer_store_dwordx4 v[48:51], v7, s[8:11], s48 offen offset:0 sc1
v_mfma_f32_16x16x32_bf16 v[120:123], a[152:155], a[112:115], v[120:123]
v_mfma_f32_16x16x32_bf16 v[120:123], a[156:159], a[120:123], v[120:123]
v_mfma_f32_16x16x32_bf16 v[124:127], a[152:155], a[116:119], v[124:127]
v_mfma_f32_16x16x32_bf16 v[124:127], a[156:159], a[124:127], v[124:127]
s_barrier
s_nop 3
v_pk_mul_f32 v[56:57], v[56:57], v[112:113]
v_pk_mul_f32 v[58:59], v[58:59], v[114:115]
v_pk_mul_f32 v[60:61], v[60:61], v[116:117]
v_pk_mul_f32 v[62:63], v[62:63], v[118:119]
v_cvt_pk_bf16_f32 v56, v56, v57
v_cvt_pk_bf16_f32 v57, v58, v59
v_cvt_pk_bf16_f32 v58, v60, v61
v_cvt_pk_bf16_f32 v59, v62, v63
s_mov_b32 s48, 4096
buffer_store_dwordx4 v[56:59], v7, s[8:11], s48 offen offset:1024 sc1
v_pk_mul_f32 v[64:65], v[64:65], v[120:121]
v_pk_mul_f32 v[66:67], v[66:67], v[122:123]
v_pk_mul_f32 v[68:69], v[68:69], v[124:125]
v_pk_mul_f32 v[70:71], v[70:71], v[126:127]
v_cvt_pk_bf16_f32 v64, v64, v65
v_cvt_pk_bf16_f32 v65, v66, v67
v_cvt_pk_bf16_f32 v66, v68, v69
v_cvt_pk_bf16_f32 v67, v70, v71
s_mov_b32 s48, 4096
buffer_store_dwordx4 v[64:67], v7, s[8:11], s48 offen offset:2048 sc1
s_add_u32 m0, s31, 0
s_mov_b32 s35, 0
buffer_load_dwordx4 v133, s[24:27], s35 offen offset:0 lds
buffer_load_dwordx4 v134, s[24:27], s35 offen offset:1024 lds
buffer_load_dwordx4 v135, s[24:27], s35 offen offset:2048 lds
buffer_load_dwordx4 v136, s[24:27], s35 offen offset:3072 lds
s_add_u32 m0, s31, 4096
s_mov_b32 s35, 32768
buffer_load_dwordx4 v133, s[24:27], s35 offen offset:0 lds
buffer_load_dwordx4 v134, s[24:27], s35 offen offset:1024 lds
buffer_load_dwordx4 v135, s[24:27], s35 offen offset:2048 lds
buffer_load_dwordx4 v136, s[24:27], s35 offen offset:3072 lds
s_add_u32 m0, s31, 8192
s_mov_b32 s35, 65536
buffer_load_dwordx4 v133, s[24:27], s35 offen offset:0 lds
buffer_load_dwordx4 v134, s[24:27], s35 offen offset:1024 lds
buffer_load_dwordx4 v135, s[24:27], s35 offen offset:2048 lds
buffer_load_dwordx4 v136, s[24:27], s35 offen offset:3072 lds
s_add_u32 s12, s42, s59
s_addc_u32 s13, s43, 0
s_mov_b32 s14, 229376
s_mov_b32 s15, 0x20000
s_waitcnt vmcnt(12)
s_barrier
s_and_b32 s3, s2, 225
s_lshl_b32 s3, s3, 6
s_add_u32 s3, s3, 114688
s_add_u32 s60, s42, 114688
s_addc_u32 s61, s43, 0
s_mov_b32 s62, 16384
s_mov_b32 s63, 0x20000
s_cmp_lg_u32 s28, 0
s_cbranch_scc1 adaLN_cond__mha_block_cached__glu_gated_bilinear__prompt_kernel_sg3
s_lshl_b32 s53, s2, 6
s_mov_b64 exec, 1
v_mov_b32 v5, s53
v_mov_b32 v6, s39
buffer_store_dword v6, v5, s[60:63], 0 offen sc1
s_mov_b64 exec, -1
adaLN_cond__mha_block_cached__glu_gated_bilinear__prompt_kernel_sg3:
s_add_u32 m0, s31, 12288
s_mov_b32 s35, 98304
buffer_load_dwordx4 v133, s[24:27], s35 offen offset:0 lds
buffer_load_dwordx4 v134, s[24:27], s35 offen offset:1024 lds
buffer_load_dwordx4 v135, s[24:27], s35 offen offset:2048 lds
buffer_load_dwordx4 v136, s[24:27], s35 offen offset:3072 lds
s_add_u32 m0, s31, 16384
s_mov_b32 s35, 131072
buffer_load_dwordx4 v133, s[24:27], s35 offen offset:0 lds
buffer_load_dwordx4 v134, s[24:27], s35 offen offset:1024 lds
buffer_load_dwordx4 v135, s[24:27], s35 offen offset:2048 lds
buffer_load_dwordx4 v136, s[24:27], s35 offen offset:3072 lds
s_add_u32 m0, s31, 20480
s_mov_b32 s35, 163840
buffer_load_dwordx4 v133, s[24:27], s35 offen offset:0 lds
buffer_load_dwordx4 v134, s[24:27], s35 offen offset:1024 lds
buffer_load_dwordx4 v135, s[24:27], s35 offen offset:2048 lds
buffer_load_dwordx4 v136, s[24:27], s35 offen offset:3072 lds
s_cmp_lg_u32 s28, 3
s_cbranch_scc1 adaLN_cond__mha_block_cached__glu_gated_bilinear__prompt_kernel_pp3
s_load_dword s60, s[42:43], s3 offset:0 glc
s_load_dword s61, s[42:43], s3 offset:512 glc
s_load_dword s62, s[42:43], s3 offset:1024 glc
s_load_dword s63, s[42:43], s3 offset:1536 glc
s_load_dword s84, s[42:43], s3 offset:128 glc
s_load_dword s85, s[42:43], s3 offset:640 glc
s_load_dword s86, s[42:43], s3 offset:1152 glc
s_load_dword s87, s[42:43], s3 offset:1664 glc
s_load_dword s88, s[42:43], s3 offset:256 glc
s_load_dword s89, s[42:43], s3 offset:768 glc
s_load_dword s90, s[42:43], s3 offset:1280 glc
s_load_dword s91, s[42:43], s3 offset:1792 glc
s_load_dword s92, s[42:43], s3 offset:384 glc
s_load_dword s93, s[42:43], s3 offset:896 glc
s_load_dword s100, s[42:43], s3 offset:1408 glc
s_load_dword s101, s[42:43], s3 offset:1920 glc
adaLN_cond__mha_block_cached__glu_gated_bilinear__prompt_kernel_pp3:
s_add_u32 m0, s31, 24576
s_mov_b32 s35, 196608
buffer_load_dwordx4 v133, s[24:27], s35 offen offset:0 lds
buffer_load_dwordx4 v134, s[24:27], s35 offen offset:1024 lds
buffer_load_dwordx4 v135, s[24:27], s35 offen offset:2048 lds
buffer_load_dwordx4 v136, s[24:27], s35 offen offset:3072 lds
s_add_u32 m0, s31, 28672
s_mov_b32 s35, 229376
buffer_load_dwordx4 v133, s[24:27], s35 offen offset:0 lds
buffer_load_dwordx4 v134, s[24:27], s35 offen offset:1024 lds
buffer_load_dwordx4 v135, s[24:27], s35 offen offset:2048 lds
buffer_load_dwordx4 v136, s[24:27], s35 offen offset:3072 lds
s_mov_b32 s16, s42
s_mov_b32 s17, s43
s_mov_b32 s18, 12288
s_mov_b32 s19, 0x20000
s_mov_b32 s8, s82
s_mov_b32 s9, s83
s_mov_b32 s10, 2097152
s_mov_b32 s11, 0x20000
buffer_load_dwordx4 a[104:107], v129, s[16:19], s58 offen offset:0 sc1
buffer_load_dwordx4 a[108:111], v129, s[16:19], s58 offen offset:16 sc1
s_cmp_lg_u32 s28, 3
s_cbranch_scc1 adaLN_cond__mha_block_cached__glu_gated_bilinear__prompt_kernel_pd3
s_mov_b32 s53, 0
s_branch adaLN_cond__mha_block_cached__glu_gated_bilinear__prompt_kernel_pw3
adaLN_cond__mha_block_cached__glu_gated_bilinear__prompt_kernel_pl3:
s_load_dword s60, s[42:43], s3 offset:0 glc
s_load_dword s61, s[42:43], s3 offset:512 glc
s_load_dword s62, s[42:43], s3 offset:1024 glc
s_load_dword s63, s[42:43], s3 offset:1536 glc
s_load_dword s84, s[42:43], s3 offset:128 glc
s_load_dword s85, s[42:43], s3 offset:640 glc
s_load_dword s86, s[42:43], s3 offset:1152 glc
s_load_dword s87, s[42:43], s3 offset:1664 glc
s_load_dword s88, s[42:43], s3 offset:256 glc
s_load_dword s89, s[42:43], s3 offset:768 glc
s_load_dword s90, s[42:43], s3 offset:1280 glc
s_load_dword s91, s[42:43], s3 offset:1792 glc
s_load_dword s92, s[42:43], s3 offset:384 glc
s_load_dword s93, s[42:43], s3 offset:896 glc
s_load_dword s100, s[42:43], s3 offset:1408 glc
s_load_dword s101, s[42:43], s3 offset:1920 glc
s_add_u32 s53, s53, 1
s_cmp_gt_u32 s53, 200000
s_cbranch_scc1 adaLN_cond__mha_block_cached__glu_gated_bilinear__prompt_kernel_pd3
adaLN_cond__mha_block_cached__glu_gated_bilinear__prompt_kernel_pw3:
s_waitcnt lgkmcnt(0)
s_cmp_eq_u32 s60, s39
s_cbranch_scc0 adaLN_cond__mha_block_cached__glu_gated_bilinear__prompt_kernel_pl3
s_cmp_eq_u32 s61, s39
s_cbranch_scc0 adaLN_cond__mha_block_cached__glu_gated_bilinear__prompt_kernel_pl3
s_cmp_eq_u32 s62, s39
s_cbranch_scc0 adaLN_cond__mha_block_cached__glu_gated_bilinear__prompt_kernel_pl3
s_cmp_eq_u32 s63, s39
s_cbranch_scc0 adaLN_cond__mha_block_cached__glu_gated_bilinear__prompt_kernel_pl3
s_cmp_eq_u32 s84, s39
s_cbranch_scc0 adaLN_cond__mha_block_cached__glu_gated_bilinear__prompt_kernel_pl3
s_cmp_eq_u32 s85, s39
s_cbranch_scc0 adaLN_cond__mha_block_cached__glu_gated_bilinear__prompt_kernel_pl3
s_cmp_eq_u32 s86, s39
s_cbranch_scc0 adaLN_cond__mha_block_cached__glu_gated_bilinear__prompt_kernel_pl3
s_cmp_eq_u32 s87, s39
s_cbranch_scc0 adaLN_cond__mha_block_cached__glu_gated_bilinear__prompt_kernel_pl3
s_cmp_eq_u32 s88, s39
s_cbranch_scc0 adaLN_cond__mha_block_cached__glu_gated_bilinear__prompt_kernel_pl3
s_cmp_eq_u32 s89, s39
s_cbranch_scc0 adaLN_cond__mha_block_cached__glu_gated_bilinear__prompt_kernel_pl3
s_cmp_eq_u32 s90, s39
s_cbranch_scc0 adaLN_cond__mha_block_cached__glu_gated_bilinear__prompt_kernel_pl3
s_cmp_eq_u32 s91, s39
s_cbranch_scc0 adaLN_cond__mha_block_cached__glu_gated_bilinear__prompt_kernel_pl3
s_cmp_eq_u32 s92, s39
s_cbranch_scc0 adaLN_cond__mha_block_cached__glu_gated_bilinear__prompt_kernel_pl3
s_cmp_eq_u32 s93, s39
s_cbranch_scc0 adaLN_cond__mha_block_cached__glu_gated_bilinear__prompt_kernel_pl3
s_cmp_eq_u32 s100, s39
s_cbranch_scc0 adaLN_cond__mha_block_cached__glu_gated_bilinear__prompt_kernel_pl3
s_cmp_eq_u32 s101, s39
s_cbranch_scc0 adaLN_cond__mha_block_cached__glu_gated_bilinear__prompt_kernel_pl3
adaLN_cond__mha_block_cached__glu_gated_bilinear__prompt_kernel_pd3:
s_barrier
s_mov_b32 s36, 0
buffer_load_dwordx4 v[16:19], v7, s[12:15], s36 offen offset:0 sc1
buffer_load_dwordx4 v[20:23], v7, s[12:15], s36 offen offset:1024 sc1
s_mov_b32 s36, 114688
buffer_load_dwordx4 v[24:27], v7, s[12:15], s36 offen offset:0 sc1
buffer_load_dwordx4 v[28:31], v7, s[12:15], s36 offen offset:1024 sc1
s_waitcnt vmcnt(34)
ds_read_b64_tr_b16 a[64:65], v137 offset:0
ds_read_b64_tr_b16 a[66:67], v137 offset:2048
ds_read_b64_tr_b16 a[68:69], v138 offset:0
ds_read_b64_tr_b16 a[70:71], v138 offset:2048
ds_read_b64_tr_b16 a[72:73], v139 offset:0
ds_read_b64_tr_b16 a[74:75], v139 offset:2048
ds_read_b64_tr_b16 a[76:77], v140 offset:0
ds_read_b64_tr_b16 a[78:79], v140 offset:2048
s_mov_b32 s36, 2048
buffer_load_dwordx4 v[32:35], v7, s[12:15], s36 offen offset:0 sc1
buffer_load_dwordx4 v[36:39], v7, s[12:15], s36 offen offset:1024 sc1
s_mov_b32 s36, 116736
buffer_load_dwordx4 v[40:43], v7, s[12:15], s36 offen offset:0 sc1
buffer_load_dwordx4 v[44:47], v7, s[12:15], s36 offen offset:1024 sc1
s_mov_b32 s36, 4096
buffer_load_dwordx4 v[48:51], v7, s[12:15], s36 offen offset:0 sc1
buffer_load_dwordx4 v[52:55], v7, s[12:15], s36 offen offset:1024 sc1
s_mov_b32 s36, 118784
buffer_load_dwordx4 v[56:59], v7, s[12:15], s36 offen offset:0 sc1
buffer_load_dwordx4 v[60:63], v7, s[12:15], s36 offen offset:1024 sc1
s_mov_b32 s36, 6144
buffer_load_dwordx4 v[64:67], v7, s[12:15], s36 offen offset:0 sc1
buffer_load_dwordx4 v[68:71], v7, s[12:15], s36 offen offset:1024 sc1
s_mov_b32 s36, 120832
buffer_load_dwordx4 v[72:75], v7, s[12:15], s36 offen offset:0 sc1
buffer_load_dwordx4 v[76:79], v7, s[12:15], s36 offen offset:1024 sc1
s_waitcnt vmcnt(12)
v_swap_b32 v18, v20
v_swap_b32 v19, v21
v_swap_b32 v26, v28
v_swap_b32 v27, v29
s_waitcnt lgkmcnt(0)
v_mfma_f32_16x16x32_bf16 a[0:3], a[64:67], v[16:19], 0
s_mov_b32 s36, 8192
buffer_load_dwordx4 v[80:83], v7, s[12:15], s36 offen offset:0 sc1
v_mfma_f32_16x16x32_bf16 a[4:7], a[64:67], v[20:23], 0
buffer_load_dwordx4 v[84:87], v7, s[12:15], s36 offen offset:1024 sc1
v_mfma_f32_16x16x32_bf16 a[8:11], a[64:67], v[24:27], 0
s_mov_b32 s36, 122880
buffer_load_dwordx4 v[88:91], v7, s[12:15], s36 offen offset:0 sc1
v_mfma_f32_16x16x32_bf16 a[12:15], a[64:67], v[28:31], 0
buffer_load_dwordx4 v[92:95], v7, s[12:15], s36 offen offset:1024 sc1
v_mfma_f32_16x16x32_bf16 a[16:19], a[68:71], v[16:19], 0
s_mov_b32 s36, 10240
buffer_load_dwordx4 v[96:99], v7, s[12:15], s36 offen offset:0 sc1
v_mfma_f32_16x16x32_bf16 a[20:23], a[68:71], v[20:23], 0
buffer_load_dwordx4 v[100:103], v7, s[12:15], s36 offen offset:1024 sc1
v_mfma_f32_16x16x32_bf16 a[24:27], a[68:71], v[24:27], 0
s_mov_b32 s36, 124928
buffer_load_dwordx4 v[104:107], v7, s[12:15], s36 offen offset:0 sc1
v_mfma_f32_16x16x32_bf16 a[28:31], a[68:71], v[28:31], 0
s_waitcnt vmcnt(15)
ds_read_b64_tr_b16 a[80:81], v137 offset:4096
ds_read_b64_tr_b16 a[82:83], v137 offset:6144
v_mfma_f32_16x16x32_bf16 a[32:35], a[72:75], v[16:19], 0
ds_read_b64_tr_b16 a[84:85], v138 offset:4096
ds_read_b64_tr_b16 a[86:87], v138 offset:6144
v_mfma_f32_16x16x32_bf16 a[36:39], a[72:75], v[20:23], 0
ds_read_b64_tr_b16 a[88:89], v139 offset:4096
ds_read_b64_tr_b16 a[90:91], v139 offset:6144
v_mfma_f32_16x16x32_bf16 a[40:43], a[72:75], v[24:27], 0
ds_read_b64_tr_b16 a[92:93], v140 offset:4096
ds_read_b64_tr_b16 a[94:95], v140 offset:6144
v_mfma_f32_16x16x32_bf16 a[44:47], a[72:75], v[28:31], 0
v_swap_b32 v34, v36
v_swap_b32 v35, v37
v_mfma_f32_16x16x32_bf16 a[48:51], a[76:79], v[16:19], 0
v_swap_b32 v42, v44
v_swap_b32 v43, v45
v_mfma_f32_16x16x32_bf16 a[52:55], a[76:79], v[20:23], 0
buffer_load_dwordx4 v[108:111], v7, s[12:15], s36 offen offset:1024 sc1
v_mfma_f32_16x16x32_bf16 a[56:59], a[76:79], v[24:27], 0
v_mfma_f32_16x16x32_bf16 a[60:63], a[76:79], v[28:31], 0
s_waitcnt lgkmcnt(0)
v_mfma_f32_16x16x32_bf16 a[0:3], a[80:83], v[32:35], a[0:3]
s_mov_b32 s36, 12288
buffer_load_dwordx4 v[112:115], v7, s[12:15], s36 offen offset:0 sc1
v_mfma_f32_16x16x32_bf16 a[4:7], a[80:83], v[36:39], a[4:7]
buffer_load_dwordx4 v[116:119], v7, s[12:15], s36 offen offset:1024 sc1
v_mfma_f32_16x16x32_bf16 a[8:11], a[80:83], v[40:43], a[8:11]
s_mov_b32 s36, 126976
buffer_load_dwordx4 v[120:123], v7, s[12:15], s36 offen offset:0 sc1
v_mfma_f32_16x16x32_bf16 a[12:15], a[80:83], v[44:47], a[12:15]
buffer_load_dwordx4 v[124:127], v7, s[12:15], s36 offen offset:1024 sc1
v_mfma_f32_16x16x32_bf16 a[16:19], a[84:87], v[32:35], a[16:19]
s_add_u32 m0, s31, 32768
s_mov_b32 s35, 262144
buffer_load_dwordx4 v133, s[24:27], s35 offen offset:0 lds
v_mfma_f32_16x16x32_bf16 a[20:23], a[84:87], v[36:39], a[20:23]
buffer_load_dwordx4 v134, s[24:27], s35 offen offset:1024 lds
v_mfma_f32_16x16x32_bf16 a[24:27], a[84:87], v[40:43], a[24:27]
buffer_load_dwordx4 v135, s[24:27], s35 offen offset:2048 lds
v_mfma_f32_16x16x32_bf16 a[28:31], a[84:87], v[44:47], a[28:31]
s_waitcnt vmcnt(19)
ds_read_b64_tr_b16 a[64:65], v137 offset:8192
ds_read_b64_tr_b16 a[66:67], v137 offset:10240
v_mfma_f32_16x16x32_bf16 a[32:35], a[88:91], v[32:35], a[32:35]
ds_read_b64_tr_b16 a[68:69], v138 offset:8192
ds_read_b64_tr_b16 a[70:71], v138 offset:10240
v_mfma_f32_16x16x32_bf16 a[36:39], a[88:91], v[36:39], a[36:39]
ds_read_b64_tr_b16 a[72:73], v139 offset:8192
ds_read_b64_tr_b16 a[74:75], v139 offset:10240
v_mfma_f32_16x16x32_bf16 a[40:43], a[88:91], v[40:43], a[40:43]
ds_read_b64_tr_b16 a[76:77], v140 offset:8192
ds_read_b64_tr_b16 a[78:79], v140 offset:10240
v_mfma_f32_16x16x32_bf16 a[44:47], a[88:91], v[44:47], a[44:47]
v_swap_b32 v50, v52
v_swap_b32 v51, v53
v_mfma_f32_16x16x32_bf16 a[48:51], a[92:95], v[32:35], a[48:51]
v_swap_b32 v58, v60
v_swap_b32 v59, v61
v_mfma_f32_16x16x32_bf16 a[52:55], a[92:95], v[36:39], a[52:55]
buffer_load_dwordx4 v136, s[24:27], s35 offen offset:3072 lds
v_mfma_f32_16x16x32_bf16 a[56:59], a[92:95], v[40:43], a[56:59]
v_mfma_f32_16x16x32_bf16 a[60:63], a[92:95], v[44:47], a[60:63]
s_waitcnt lgkmcnt(0)
v_mfma_f32_16x16x32_bf16 a[0:3], a[64:67], v[48:51], a[0:3]
s_mov_b32 s36, 14336
buffer_load_dwordx4 v[144:147], v7, s[12:15], s36 offen offset:0 sc1
v_mfma_f32_16x16x32_bf16 a[4:7], a[64:67], v[52:55], a[4:7]
buffer_load_dwordx4 v[148:151], v7, s[12:15], s36 offen offset:1024 sc1
v_mfma_f32_16x16x32_bf16 a[8:11], a[64:67], v[56:59], a[8:11]
s_mov_b32 s36, 129024
buffer_load_dwordx4 v[152:155], v7, s[12:15], s36 offen offset:0 sc1
v_mfma_f32_16x16x32_bf16 a[12:15], a[64:67], v[60:63], a[12:15]
buffer_load_dwordx4 v[156:159], v7, s[12:15], s36 offen offset:1024 sc1
v_mfma_f32_16x16x32_bf16 a[16:19], a[68:71], v[48:51], a[16:19]
s_add_u32 m0, s31, 0
s_mov_b32 s35, 294912
buffer_load_dwordx4 v133, s[24:27], s35 offen offset:0 lds
v_mfma_f32_16x16x32_bf16 a[20:23], a[68:71], v[52:55], a[20:23]
buffer_load_dwordx4 v134, s[24:27], s35 offen offset:1024 lds
v_mfma_f32_16x16x32_bf16 a[24:27], a[68:71], v[56:59], a[24:27]
buffer_load_dwordx4 v135, s[24:27], s35 offen offset:2048 lds
v_mfma_f32_16x16x32_bf16 a[28:31], a[68:71], v[60:63], a[28:31]
s_waitcnt vmcnt(23)
ds_read_b64_tr_b16 a[80:81], v137 offset:12288
ds_read_b64_tr_b16 a[82:83], v137 offset:14336
v_mfma_f32_16x16x32_bf16 a[32:35], a[72:75], v[48:51], a[32:35]
ds_read_b64_tr_b16 a[84:85], v138 offset:12288
ds_read_b64_tr_b16 a[86:87], v138 offset:14336
v_mfma_f32_16x16x32_bf16 a[36:39], a[72:75], v[52:55], a[36:39]
ds_read_b64_tr_b16 a[88:89], v139 offset:12288
ds_read_b64_tr_b16 a[90:91], v139 offset:14336
v_mfma_f32_16x16x32_bf16 a[40:43], a[72:75], v[56:59], a[40:43]
ds_read_b64_tr_b16 a[92:93], v140 offset:12288
ds_read_b64_tr_b16 a[94:95], v140 offset:14336
v_mfma_f32_16x16x32_bf16 a[44:47], a[72:75], v[60:63], a[44:47]
v_swap_b32 v66, v68
v_swap_b32 v67, v69
v_mfma_f32_16x16x32_bf16 a[48:51], a[76:79], v[48:51], a[48:51]
v_swap_b32 v74, v76
v_swap_b32 v75, v77
v_mfma_f32_16x16x32_bf16 a[52:55], a[76:79], v[52:55], a[52:55]
buffer_load_dwordx4 v136, s[24:27], s35 offen offset:3072 lds
v_mfma_f32_16x16x32_bf16 a[56:59], a[76:79], v[56:59], a[56:59]
v_mfma_f32_16x16x32_bf16 a[60:63], a[76:79], v[60:63], a[60:63]
s_waitcnt lgkmcnt(0)
v_mfma_f32_16x16x32_bf16 a[0:3], a[80:83], v[64:67], a[0:3]
s_mov_b32 s36, 16384
buffer_load_dwordx4 v[160:163], v7, s[12:15], s36 offen offset:0 sc1
v_mfma_f32_16x16x32_bf16 a[4:7], a[80:83], v[68:71], a[4:7]
buffer_load_dwordx4 v[164:167], v7, s[12:15], s36 offen offset:1024 sc1
v_mfma_f32_16x16x32_bf16 a[8:11], a[80:83], v[72:75], a[8:11]
s_mov_b32 s36, 131072
buffer_load_dwordx4 v[168:171], v7, s[12:15], s36 offen offset:0 sc1
v_mfma_f32_16x16x32_bf16 a[12:15], a[80:83], v[76:79], a[12:15]
buffer_load_dwordx4 v[172:175], v7, s[12:15], s36 offen offset:1024 sc1
v_mfma_f32_16x16x32_bf16 a[16:19], a[84:87], v[64:67], a[16:19]
s_add_u32 m0, s31, 4096
s_mov_b32 s35, 327680
buffer_load_dwordx4 v133, s[24:27], s35 offen offset:0 lds
v_mfma_f32_16x16x32_bf16 a[20:23], a[84:87], v[68:71], a[20:23]
buffer_load_dwordx4 v134, s[24:27], s35 offen offset:1024 lds
v_mfma_f32_16x16x32_bf16 a[24:27], a[84:87], v[72:75], a[24:27]
buffer_load_dwordx4 v135, s[24:27], s35 offen offset:2048 lds
v_mfma_f32_16x16x32_bf16 a[28:31], a[84:87], v[76:79], a[28:31]
s_waitcnt vmcnt(27)
ds_read_b64_tr_b16 a[64:65], v137 offset:16384
ds_read_b64_tr_b16 a[66:67], v137 offset:18432
v_mfma_f32_16x16x32_bf16 a[32:35], a[88:91], v[64:67], a[32:35]
ds_read_b64_tr_b16 a[68:69], v138 offset:16384
ds_read_b64_tr_b16 a[70:71], v138 offset:18432
v_mfma_f32_16x16x32_bf16 a[36:39], a[88:91], v[68:71], a[36:39]
ds_read_b64_tr_b16 a[72:73], v139 offset:16384
ds_read_b64_tr_b16 a[74:75], v139 offset:18432
v_mfma_f32_16x16x32_bf16 a[40:43], a[88:91], v[72:75], a[40:43]
ds_read_b64_tr_b16 a[76:77], v140 offset:16384
ds_read_b64_tr_b16 a[78:79], v140 offset:18432
v_mfma_f32_16x16x32_bf16 a[44:47], a[88:91], v[76:79], a[44:47]
v_swap_b32 v82, v84
v_swap_b32 v83, v85
v_mfma_f32_16x16x32_bf16 a[48:51], a[92:95], v[64:67], a[48:51]
v_swap_b32 v90, v92
v_swap_b32 v91, v93
v_mfma_f32_16x16x32_bf16 a[52:55], a[92:95], v[68:71], a[52:55]
buffer_load_dwordx4 v136, s[24:27], s35 offen offset:3072 lds
v_mfma_f32_16x16x32_bf16 a[56:59], a[92:95], v[72:75], a[56:59]
v_mfma_f32_16x16x32_bf16 a[60:63], a[92:95], v[76:79], a[60:63]
s_waitcnt lgkmcnt(0)
v_mfma_f32_16x16x32_bf16 a[0:3], a[64:67], v[80:83], a[0:3]
s_mov_b32 s36, 18432
buffer_load_dwordx4 v[176:179], v7, s[12:15], s36 offen offset:0 sc1
v_mfma_f32_16x16x32_bf16 a[4:7], a[64:67], v[84:87], a[4:7]
buffer_load_dwordx4 v[180:183], v7, s[12:15], s36 offen offset:1024 sc1
v_mfma_f32_16x16x32_bf16 a[8:11], a[64:67], v[88:91], a[8:11]
s_mov_b32 s36, 133120
buffer_load_dwordx4 v[184:187], v7, s[12:15], s36 offen offset:0 sc1
v_mfma_f32_16x16x32_bf16 a[12:15], a[64:67], v[92:95], a[12:15]
buffer_load_dwordx4 v[188:191], v7, s[12:15], s36 offen offset:1024 sc1
v_mfma_f32_16x16x32_bf16 a[16:19], a[68:71], v[80:83], a[16:19]
s_add_u32 m0, s31, 8192
s_mov_b32 s35, 360448
buffer_load_dwordx4 v133, s[24:27], s35 offen offset:0 lds
v_mfma_f32_16x16x32_bf16 a[20:23], a[68:71], v[84:87], a[20:23]
buffer_load_dwordx4 v134, s[24:27], s35 offen offset:1024 lds
v_mfma_f32_16x16x32_bf16 a[24:27], a[68:71], v[88:91], a[24:27]
buffer_load_dwordx4 v135, s[24:27], s35 offen offset:2048 lds
v_mfma_f32_16x16x32_bf16 a[28:31], a[68:71], v[92:95], a[28:31]
s_waitcnt vmcnt(31)
ds_read_b64_tr_b16 a[80:81], v137 offset:20480
ds_read_b64_tr_b16 a[82:83], v137 offset:22528
v_mfma_f32_16x16x32_bf16 a[32:35], a[72:75], v[80:83], a[32:35]
ds_read_b64_tr_b16 a[84:85], v138 offset:20480
ds_read_b64_tr_b16 a[86:87], v138 offset:22528
v_mfma_f32_16x16x32_bf16 a[36:39], a[72:75], v[84:87], a[36:39]
ds_read_b64_tr_b16 a[88:89], v139 offset:20480
ds_read_b64_tr_b16 a[90:91], v139 offset:22528
v_mfma_f32_16x16x32_bf16 a[40:43], a[72:75], v[88:91], a[40:43]
ds_read_b64_tr_b16 a[92:93], v140 offset:20480
ds_read_b64_tr_b16 a[94:95], v140 offset:22528
v_mfma_f32_16x16x32_bf16 a[44:47], a[72:75], v[92:95], a[44:47]
v_swap_b32 v98, v100
v_swap_b32 v99, v101
v_mfma_f32_16x16x32_bf16 a[48:51], a[76:79], v[80:83], a[48:51]
v_swap_b32 v106, v108
v_swap_b32 v107, v109
v_mfma_f32_16x16x32_bf16 a[52:55], a[76:79], v[84:87], a[52:55]
buffer_load_dwordx4 v136, s[24:27], s35 offen offset:3072 lds
v_mfma_f32_16x16x32_bf16 a[56:59], a[76:79], v[88:91], a[56:59]
v_mfma_f32_16x16x32_bf16 a[60:63], a[76:79], v[92:95], a[60:63]
s_waitcnt lgkmcnt(0)
v_mfma_f32_16x16x32_bf16 a[0:3], a[80:83], v[96:99], a[0:3]
s_mov_b32 s36, 20480
buffer_load_dwordx4 v[192:195], v7, s[12:15], s36 offen offset:0 sc1
v_mfma_f32_16x16x32_bf16 a[4:7], a[80:83], v[100:103], a[4:7]
buffer_load_dwordx4 v[196:199], v7, s[12:15], s36 offen offset:1024 sc1
v_mfma_f32_16x16x32_bf16 a[8:11], a[80:83], v[104:107], a[8:11]
s_mov_b32 s36, 135168
buffer_load_dwordx4 v[200:203], v7, s[12:15], s36 offen offset:0 sc1
v_mfma_f32_16x16x32_bf16 a[12:15], a[80:83], v[108:111], a[12:15]
buffer_load_dwordx4 v[204:207], v7, s[12:15], s36 offen offset:1024 sc1
v_mfma_f32_16x16x32_bf16 a[16:19], a[84:87], v[96:99], a[16:19]
s_add_u32 m0, s31, 12288
s_mov_b32 s35, 393216
buffer_load_dwordx4 v133, s[24:27], s35 offen offset:0 lds
v_mfma_f32_16x16x32_bf16 a[20:23], a[84:87], v[100:103], a[20:23]
buffer_load_dwordx4 v134, s[24:27], s35 offen offset:1024 lds
v_mfma_f32_16x16x32_bf16 a[24:27], a[84:87], v[104:107], a[24:27]
buffer_load_dwordx4 v135, s[24:27], s35 offen offset:2048 lds
v_mfma_f32_16x16x32_bf16 a[28:31], a[84:87], v[108:111], a[28:31]
s_waitcnt vmcnt(35)
ds_read_b64_tr_b16 a[64:65], v137 offset:24576
ds_read_b64_tr_b16 a[66:67], v137 offset:26624
v_mfma_f32_16x16x32_bf16 a[32:35], a[88:91], v[96:99], a[32:35]
ds_read_b64_tr_b16 a[68:69], v138 offset:24576
ds_read_b64_tr_b16 a[70:71], v138 offset:26624
v_mfma_f32_16x16x32_bf16 a[36:39], a[88:91], v[100:103], a[36:39]
ds_read_b64_tr_b16 a[72:73], v139 offset:24576
ds_read_b64_tr_b16 a[74:75], v139 offset:26624
v_mfma_f32_16x16x32_bf16 a[40:43], a[88:91], v[104:107], a[40:43]
ds_read_b64_tr_b16 a[76:77], v140 offset:24576
ds_read_b64_tr_b16 a[78:79], v140 offset:26624
v_mfma_f32_16x16x32_bf16 a[44:47], a[88:91], v[108:111], a[44:47]
v_swap_b32 v114, v116
v_swap_b32 v115, v117
v_mfma_f32_16x16x32_bf16 a[48:51], a[92:95], v[96:99], a[48:51]
v_swap_b32 v122, v124
v_swap_b32 v123, v125
v_mfma_f32_16x16x32_bf16 a[52:55], a[92:95], v[100:103], a[52:55]
buffer_load_dwordx4 v136, s[24:27], s35 offen offset:3072 lds
v_mfma_f32_16x16x32_bf16 a[56:59], a[92:95], v[104:107], a[56:59]
v_mfma_f32_16x16x32_bf16 a[60:63], a[92:95], v[108:111], a[60:63]
s_waitcnt lgkmcnt(0)
v_mfma_f32_16x16x32_bf16 a[0:3], a[64:67], v[112:115], a[0:3]
s_mov_b32 s36, 22528
buffer_load_dwordx4 v[208:211], v7, s[12:15], s36 offen offset:0 sc1
v_mfma_f32_16x16x32_bf16 a[4:7], a[64:67], v[116:119], a[4:7]
buffer_load_dwordx4 v[212:215], v7, s[12:15], s36 offen offset:1024 sc1
v_mfma_f32_16x16x32_bf16 a[8:11], a[64:67], v[120:123], a[8:11]
s_mov_b32 s36, 137216
buffer_load_dwordx4 v[216:219], v7, s[12:15], s36 offen offset:0 sc1
v_mfma_f32_16x16x32_bf16 a[12:15], a[64:67], v[124:127], a[12:15]
buffer_load_dwordx4 v[220:223], v7, s[12:15], s36 offen offset:1024 sc1
v_mfma_f32_16x16x32_bf16 a[16:19], a[68:71], v[112:115], a[16:19]
s_add_u32 m0, s31, 16384
s_mov_b32 s35, 425984
buffer_load_dwordx4 v133, s[24:27], s35 offen offset:0 lds
v_mfma_f32_16x16x32_bf16 a[20:23], a[68:71], v[116:119], a[20:23]
buffer_load_dwordx4 v134, s[24:27], s35 offen offset:1024 lds
v_mfma_f32_16x16x32_bf16 a[24:27], a[68:71], v[120:123], a[24:27]
buffer_load_dwordx4 v135, s[24:27], s35 offen offset:2048 lds
v_mfma_f32_16x16x32_bf16 a[28:31], a[68:71], v[124:127], a[28:31]
s_waitcnt vmcnt(35)
ds_read_b64_tr_b16 a[80:81], v137 offset:28672
ds_read_b64_tr_b16 a[82:83], v137 offset:30720
v_mfma_f32_16x16x32_bf16 a[32:35], a[72:75], v[112:115], a[32:35]
ds_read_b64_tr_b16 a[84:85], v138 offset:28672
ds_read_b64_tr_b16 a[86:87], v138 offset:30720
v_mfma_f32_16x16x32_bf16 a[36:39], a[72:75], v[116:119], a[36:39]
ds_read_b64_tr_b16 a[88:89], v139 offset:28672
ds_read_b64_tr_b16 a[90:91], v139 offset:30720
v_mfma_f32_16x16x32_bf16 a[40:43], a[72:75], v[120:123], a[40:43]
ds_read_b64_tr_b16 a[92:93], v140 offset:28672
ds_read_b64_tr_b16 a[94:95], v140 offset:30720
v_mfma_f32_16x16x32_bf16 a[44:47], a[72:75], v[124:127], a[44:47]
v_swap_b32 v146, v148
v_swap_b32 v147, v149
v_mfma_f32_16x16x32_bf16 a[48:51], a[76:79], v[112:115], a[48:51]
v_swap_b32 v154, v156
v_swap_b32 v155, v157
v_mfma_f32_16x16x32_bf16 a[52:55], a[76:79], v[116:119], a[52:55]
buffer_load_dwordx4 v136, s[24:27], s35 offen offset:3072 lds
v_mfma_f32_16x16x32_bf16 a[56:59], a[76:79], v[120:123], a[56:59]
v_mfma_f32_16x16x32_bf16 a[60:63], a[76:79], v[124:127], a[60:63]
s_waitcnt lgkmcnt(0)
v_mfma_f32_16x16x32_bf16 a[0:3], a[80:83], v[144:147], a[0:3]
s_mov_b32 s36, 24576
buffer_load_dwordx4 v[224:227], v7, s[12:15], s36 offen offset:0 sc1
v_mfma_f32_16x16x32_bf16 a[4:7], a[80:83], v[148:151], a[4:7]
buffer_load_dwordx4 v[228:231], v7, s[12:15], s36 offen offset:1024 sc1
v_mfma_f32_16x16x32_bf16 a[8:11], a[80:83], v[152:155], a[8:11]
s_mov_b32 s36, 139264
buffer_load_dwordx4 v[232:235], v7, s[12:15], s36 offen offset:0 sc1
v_mfma_f32_16x16x32_bf16 a[12:15], a[80:83], v[156:159], a[12:15]
buffer_load_dwordx4 v[236:239], v7, s[12:15], s36 offen offset:1024 sc1
v_mfma_f32_16x16x32_bf16 a[16:19], a[84:87], v[144:147], a[16:19]
s_mov_b32 s36, 26624
buffer_load_dwordx4 v[240:243], v7, s[12:15], s36 offen offset:0 sc1
v_mfma_f32_16x16x32_bf16 a[20:23], a[84:87], v[148:151], a[20:23]
buffer_load_dwordx4 v[244:247], v7, s[12:15], s36 offen offset:1024 sc1
v_mfma_f32_16x16x32_bf16 a[24:27], a[84:87], v[152:155], a[24:27]
s_mov_b32 s36, 141312
buffer_load_dwordx4 v[248:251], v7, s[12:15], s36 offen offset:0 sc1
v_mfma_f32_16x16x32_bf16 a[28:31], a[84:87], v[156:159], a[28:31]
s_waitcnt vmcnt(35)
ds_read_b64_tr_b16 a[64:65], v137 offset:32768
ds_read_b64_tr_b16 a[66:67], v137 offset:34816
v_mfma_f32_16x16x32_bf16 a[32:35], a[88:91], v[144:147], a[32:35]
ds_read_b64_tr_b16 a[68:69], v138 offset:32768
ds_read_b64_tr_b16 a[70:71], v138 offset:34816
v_mfma_f32_16x16x32_bf16 a[36:39], a[88:91], v[148:151], a[36:39]
ds_read_b64_tr_b16 a[72:73], v139 offset:32768
ds_read_b64_tr_b16 a[74:75], v139 offset:34816
v_mfma_f32_16x16x32_bf16 a[40:43], a[88:91], v[152:155], a[40:43]
ds_read_b64_tr_b16 a[76:77], v140 offset:32768
ds_read_b64_tr_b16 a[78:79], v140 offset:34816
v_mfma_f32_16x16x32_bf16 a[44:47], a[88:91], v[156:159], a[44:47]
v_swap_b32 v162, v164
v_swap_b32 v163, v165
v_mfma_f32_16x16x32_bf16 a[48:51], a[92:95], v[144:147], a[48:51]
v_swap_b32 v170, v172
v_swap_b32 v171, v173
v_mfma_f32_16x16x32_bf16 a[52:55], a[92:95], v[148:151], a[52:55]
buffer_load_dwordx4 v[252:255], v7, s[12:15], s36 offen offset:1024 sc1
v_mfma_f32_16x16x32_bf16 a[56:59], a[92:95], v[152:155], a[56:59]
v_mfma_f32_16x16x32_bf16 a[60:63], a[92:95], v[156:159], a[60:63]
s_waitcnt lgkmcnt(0)
v_mfma_f32_16x16x32_bf16 a[0:3], a[64:67], v[160:163], a[0:3]
v_mfma_f32_16x16x32_bf16 a[4:7], a[64:67], v[164:167], a[4:7]
v_mfma_f32_16x16x32_bf16 a[8:11], a[64:67], v[168:171], a[8:11]
v_mfma_f32_16x16x32_bf16 a[12:15], a[64:67], v[172:175], a[12:15]
v_mfma_f32_16x16x32_bf16 a[16:19], a[68:71], v[160:163], a[16:19]
v_mfma_f32_16x16x32_bf16 a[20:23], a[68:71], v[164:167], a[20:23]
v_mfma_f32_16x16x32_bf16 a[24:27], a[68:71], v[168:171], a[24:27]
v_mfma_f32_16x16x32_bf16 a[28:31], a[68:71], v[172:175], a[28:31]
s_waitcnt vmcnt(28)
ds_read_b64_tr_b16 a[80:81], v137 offset:0
ds_read_b64_tr_b16 a[82:83], v137 offset:2048
v_mfma_f32_16x16x32_bf16 a[32:35], a[72:75], v[160:163], a[32:35]
ds_read_b64_tr_b16 a[84:85], v138 offset:0
ds_read_b64_tr_b16 a[86:87], v138 offset:2048
v_mfma_f32_16x16x32_bf16 a[36:39], a[72:75], v[164:167], a[36:39]
ds_read_b64_tr_b16 a[88:89], v139 offset:0
ds_read_b64_tr_b16 a[90:91], v139 offset:2048
v_mfma_f32_16x16x32_bf16 a[40:43], a[72:75], v[168:171], a[40:43]
ds_read_b64_tr_b16 a[92:93], v140 offset:0
ds_read_b64_tr_b16 a[94:95], v140 offset:2048
v_mfma_f32_16x16x32_bf16 a[44:47], a[72:75], v[172:175], a[44:47]
v_swap_b32 v178, v180
v_swap_b32 v179, v181
v_mfma_f32_16x16x32_bf16 a[48:51], a[76:79], v[160:163], a[48:51]
v_swap_b32 v186, v188
v_swap_b32 v187, v189
v_mfma_f32_16x16x32_bf16 a[52:55], a[76:79], v[164:167], a[52:55]
v_mfma_f32_16x16x32_bf16 a[56:59], a[76:79], v[168:171], a[56:59]
v_mfma_f32_16x16x32_bf16 a[60:63], a[76:79], v[172:175], a[60:63]
s_waitcnt lgkmcnt(0)
v_mfma_f32_16x16x32_bf16 a[0:3], a[80:83], v[176:179], a[0:3]
v_mfma_f32_16x16x32_bf16 a[4:7], a[80:83], v[180:183], a[4:7]
v_mfma_f32_16x16x32_bf16 a[8:11], a[80:83], v[184:187], a[8:11]
v_mfma_f32_16x16x32_bf16 a[12:15], a[80:83], v[188:191], a[12:15]
v_mfma_f32_16x16x32_bf16 a[16:19], a[84:87], v[176:179], a[16:19]
v_mfma_f32_16x16x32_bf16 a[20:23], a[84:87], v[180:183], a[20:23]
v_mfma_f32_16x16x32_bf16 a[24:27], a[84:87], v[184:187], a[24:27]
v_mfma_f32_16x16x32_bf16 a[28:31], a[84:87], v[188:191], a[28:31]
s_waitcnt vmcnt(20)
ds_read_b64_tr_b16 a[64:65], v137 offset:4096
ds_read_b64_tr_b16 a[66:67], v137 offset:6144
v_mfma_f32_16x16x32_bf16 a[32:35], a[88:91], v[176:179], a[32:35]
ds_read_b64_tr_b16 a[68:69], v138 offset:4096
ds_read_b64_tr_b16 a[70:71], v138 offset:6144
v_mfma_f32_16x16x32_bf16 a[36:39], a[88:91], v[180:183], a[36:39]
ds_read_b64_tr_b16 a[72:73], v139 offset:4096
ds_read_b64_tr_b16 a[74:75], v139 offset:6144
v_mfma_f32_16x16x32_bf16 a[40:43], a[88:91], v[184:187], a[40:43]
ds_read_b64_tr_b16 a[76:77], v140 offset:4096
ds_read_b64_tr_b16 a[78:79], v140 offset:6144
v_mfma_f32_16x16x32_bf16 a[44:47], a[88:91], v[188:191], a[44:47]
v_swap_b32 v194, v196
v_swap_b32 v195, v197
v_mfma_f32_16x16x32_bf16 a[48:51], a[92:95], v[176:179], a[48:51]
v_swap_b32 v202, v204
v_swap_b32 v203, v205
v_mfma_f32_16x16x32_bf16 a[52:55], a[92:95], v[180:183], a[52:55]
v_mfma_f32_16x16x32_bf16 a[56:59], a[92:95], v[184:187], a[56:59]
v_mfma_f32_16x16x32_bf16 a[60:63], a[92:95], v[188:191], a[60:63]
s_waitcnt lgkmcnt(0)
v_mfma_f32_16x16x32_bf16 a[0:3], a[64:67], v[192:195], a[0:3]
buffer_load_dwordx2 a[96:97], v128, s[20:23], s57 offen offset:0 sc1
v_mfma_f32_16x16x32_bf16 a[4:7], a[64:67], v[196:199], a[4:7]
buffer_load_dwordx2 a[98:99], v128, s[20:23], s57 offen offset:256 sc1
v_mfma_f32_16x16x32_bf16 a[8:11], a[64:67], v[200:203], a[8:11]
buffer_load_dwordx2 a[100:101], v128, s[20:23], s57 offen offset:128 sc1
v_mfma_f32_16x16x32_bf16 a[12:15], a[64:67], v[204:207], a[12:15]
buffer_load_dwordx2 a[102:103], v128, s[20:23], s57 offen offset:384 sc1
v_mfma_f32_16x16x32_bf16 a[16:19], a[68:71], v[192:195], a[16:19]
v_mfma_f32_16x16x32_bf16 a[20:23], a[68:71], v[196:199], a[20:23]
v_mfma_f32_16x16x32_bf16 a[24:27], a[68:71], v[200:203], a[24:27]
v_mfma_f32_16x16x32_bf16 a[28:31], a[68:71], v[204:207], a[28:31]
s_waitcnt vmcnt(16)
ds_read_b64_tr_b16 a[80:81], v137 offset:8192
ds_read_b64_tr_b16 a[82:83], v137 offset:10240
v_mfma_f32_16x16x32_bf16 a[32:35], a[72:75], v[192:195], a[32:35]
ds_read_b64_tr_b16 a[84:85], v138 offset:8192
ds_read_b64_tr_b16 a[86:87], v138 offset:10240
v_mfma_f32_16x16x32_bf16 a[36:39], a[72:75], v[196:199], a[36:39]
ds_read_b64_tr_b16 a[88:89], v139 offset:8192
ds_read_b64_tr_b16 a[90:91], v139 offset:10240
v_mfma_f32_16x16x32_bf16 a[40:43], a[72:75], v[200:203], a[40:43]
ds_read_b64_tr_b16 a[92:93], v140 offset:8192
ds_read_b64_tr_b16 a[94:95], v140 offset:10240
v_mfma_f32_16x16x32_bf16 a[44:47], a[72:75], v[204:207], a[44:47]
v_swap_b32 v210, v212
v_swap_b32 v211, v213
v_mfma_f32_16x16x32_bf16 a[48:51], a[76:79], v[192:195], a[48:51]
v_swap_b32 v218, v220
v_swap_b32 v219, v221
v_mfma_f32_16x16x32_bf16 a[52:55], a[76:79], v[196:199], a[52:55]
v_mfma_f32_16x16x32_bf16 a[56:59], a[76:79], v[200:203], a[56:59]
v_mfma_f32_16x16x32_bf16 a[60:63], a[76:79], v[204:207], a[60:63]
s_waitcnt lgkmcnt(0)
v_mfma_f32_16x16x32_bf16 a[0:3], a[80:83], v[208:211], a[0:3]
v_mfma_f32_16x16x32_bf16 a[4:7], a[80:83], v[212:215], a[4:7]
v_mfma_f32_16x16x32_bf16 a[8:11], a[80:83], v[216:219], a[8:11]
v_mfma_f32_16x16x32_bf16 a[12:15], a[80:83], v[220:223], a[12:15]
v_mfma_f32_16x16x32_bf16 a[16:19], a[84:87], v[208:211], a[16:19]
v_mfma_f32_16x16x32_bf16 a[20:23], a[84:87], v[212:215], a[20:23]
v_mfma_f32_16x16x32_bf16 a[24:27], a[84:87], v[216:219], a[24:27]
v_mfma_f32_16x16x32_bf16 a[28:31], a[84:87], v[220:223], a[28:31]
s_waitcnt vmcnt(8)
ds_read_b64_tr_b16 a[64:65], v137 offset:12288
ds_read_b64_tr_b16 a[66:67], v137 offset:14336
v_mfma_f32_16x16x32_bf16 a[32:35], a[88:91], v[208:211], a[32:35]
ds_read_b64_tr_b16 a[68:69], v138 offset:12288
ds_read_b64_tr_b16 a[70:71], v138 offset:14336
v_mfma_f32_16x16x32_bf16 a[36:39], a[88:91], v[212:215], a[36:39]
ds_read_b64_tr_b16 a[72:73], v139 offset:12288
ds_read_b64_tr_b16 a[74:75], v139 offset:14336
v_mfma_f32_16x16x32_bf16 a[40:43], a[88:91], v[216:219], a[40:43]
ds_read_b64_tr_b16 a[76:77], v140 offset:12288
ds_read_b64_tr_b16 a[78:79], v140 offset:14336
v_mfma_f32_16x16x32_bf16 a[44:47], a[88:91], v[220:223], a[44:47]
v_swap_b32 v226, v228
v_swap_b32 v227, v229
v_mfma_f32_16x16x32_bf16 a[48:51], a[92:95], v[208:211], a[48:51]
v_swap_b32 v234, v236
v_swap_b32 v235, v237
v_mfma_f32_16x16x32_bf16 a[52:55], a[92:95], v[212:215], a[52:55]
v_mfma_f32_16x16x32_bf16 a[56:59], a[92:95], v[216:219], a[56:59]
v_mfma_f32_16x16x32_bf16 a[60:63], a[92:95], v[220:223], a[60:63]
s_waitcnt lgkmcnt(0)
v_mfma_f32_16x16x32_bf16 a[0:3], a[64:67], v[224:227], a[0:3]
v_mfma_f32_16x16x32_bf16 a[4:7], a[64:67], v[228:231], a[4:7]
v_mfma_f32_16x16x32_bf16 a[8:11], a[64:67], v[232:235], a[8:11]
v_mfma_f32_16x16x32_bf16 a[12:15], a[64:67], v[236:239], a[12:15]
v_mfma_f32_16x16x32_bf16 a[16:19], a[68:71], v[224:227], a[16:19]
v_mfma_f32_16x16x32_bf16 a[20:23], a[68:71], v[228:231], a[20:23]
v_mfma_f32_16x16x32_bf16 a[24:27], a[68:71], v[232:235], a[24:27]
v_mfma_f32_16x16x32_bf16 a[28:31], a[68:71], v[236:239], a[28:31]
s_waitcnt vmcnt(4)
ds_read_b64_tr_b16 a[80:81], v137 offset:16384
ds_read_b64_tr_b16 a[82:83], v137 offset:18432
v_mfma_f32_16x16x32_bf16 a[32:35], a[72:75], v[224:227], a[32:35]
ds_read_b64_tr_b16 a[84:85], v138 offset:16384
ds_read_b64_tr_b16 a[86:87], v138 offset:18432
v_mfma_f32_16x16x32_bf16 a[36:39], a[72:75], v[228:231], a[36:39]
ds_read_b64_tr_b16 a[88:89], v139 offset:16384
ds_read_b64_tr_b16 a[90:91], v139 offset:18432
v_mfma_f32_16x16x32_bf16 a[40:43], a[72:75], v[232:235], a[40:43]
ds_read_b64_tr_b16 a[92:93], v140 offset:16384
ds_read_b64_tr_b16 a[94:95], v140 offset:18432
v_mfma_f32_16x16x32_bf16 a[44:47], a[72:75], v[236:239], a[44:47]
v_swap_b32 v242, v244
v_swap_b32 v243, v245
v_mfma_f32_16x16x32_bf16 a[48:51], a[76:79], v[224:227], a[48:51]
v_swap_b32 v250, v252
v_swap_b32 v251, v253
v_mfma_f32_16x16x32_bf16 a[52:55], a[76:79], v[228:231], a[52:55]
v_mfma_f32_16x16x32_bf16 a[56:59], a[76:79], v[232:235], a[56:59]
v_mfma_f32_16x16x32_bf16 a[60:63], a[76:79], v[236:239], a[60:63]
s_waitcnt lgkmcnt(0)
v_mfma_f32_16x16x32_bf16 a[0:3], a[80:83], v[240:243], a[0:3]
s_waitcnt vmcnt(0)
v_accvgpr_read_b32 v112, a96
v_accvgpr_read_b32 v113, a97
v_mfma_f32_16x16x32_bf16 a[4:7], a[80:83], v[244:247], a[4:7]
v_accvgpr_read_b32 v114, a98
v_accvgpr_read_b32 v115, a99
v_mfma_f32_16x16x32_bf16 a[8:11], a[80:83], v[248:251], a[8:11]
v_accvgpr_read_b32 v116, a100
v_accvgpr_read_b32 v117, a101
v_mfma_f32_16x16x32_bf16 a[12:15], a[80:83], v[252:255], a[12:15]
v_accvgpr_read_b32 v118, a102
v_accvgpr_read_b32 v119, a103
v_mfma_f32_16x16x32_bf16 a[16:19], a[84:87], v[240:243], a[16:19]
v_accvgpr_read_b32 v120, a104
v_accvgpr_read_b32 v121, a105
v_mfma_f32_16x16x32_bf16 a[20:23], a[84:87], v[244:247], a[20:23]
v_accvgpr_read_b32 v122, a106
v_accvgpr_read_b32 v123, a107
v_mfma_f32_16x16x32_bf16 a[24:27], a[84:87], v[248:251], a[24:27]
v_accvgpr_read_b32 v124, a108
v_accvgpr_read_b32 v125, a109
v_mfma_f32_16x16x32_bf16 a[28:31], a[84:87], v[252:255], a[28:31]
v_accvgpr_read_b32 v126, a110
v_accvgpr_read_b32 v127, a111
v_mfma_f32_16x16x32_bf16 a[32:35], a[88:91], v[240:243], a[32:35]
ds_write_b128 v132, a[0:3] offset:0
v_mfma_f32_16x16x32_bf16 a[36:39], a[88:91], v[244:247], a[36:39]
ds_write_b128 v132, a[4:7] offset:4352
v_mfma_f32_16x16x32_bf16 a[40:43], a[88:91], v[248:251], a[40:43]
ds_write_b128 v132, a[8:11] offset:8704
v_mfma_f32_16x16x32_bf16 a[44:47], a[88:91], v[252:255], a[44:47]
ds_write_b128 v132, a[12:15] offset:13056
v_mfma_f32_16x16x32_bf16 a[48:51], a[92:95], v[240:243], a[48:51]
ds_write_b128 v132, a[16:19] offset:64
v_mfma_f32_16x16x32_bf16 a[52:55], a[92:95], v[244:247], a[52:55]
ds_write_b128 v132, a[20:23] offset:4416
v_mfma_f32_16x16x32_bf16 a[56:59], a[92:95], v[248:251], a[56:59]
ds_write_b128 v132, a[24:27] offset:8768
v_mfma_f32_16x16x32_bf16 a[60:63], a[92:95], v[252:255], a[60:63]
ds_write_b128 v132, a[28:31] offset:13120
v_lshlrev_b32 v96, 16, v112
ds_write_b128 v132, a[32:35] offset:128
v_and_b32 v97, 0xffff0000, v112
v_lshlrev_b32 v98, 16, v113
ds_write_b128 v132, a[36:39] offset:4480
v_and_b32 v99, 0xffff0000, v113
v_lshlrev_b32 v100, 16, v114
ds_write_b128 v132, a[40:43] offset:8832
v_and_b32 v101, 0xffff0000, v114
v_lshlrev_b32 v102, 16, v115
ds_write_b128 v132, a[44:47] offset:13184
v_and_b32 v103, 0xffff0000, v115
v_lshlrev_b32 v104, 16, v116
ds_write_b128 v132, a[48:51] offset:192
v_and_b32 v105, 0xffff0000, v116
v_lshlrev_b32 v106, 16, v117
ds_write_b128 v132, a[52:55] offset:4544
v_and_b32 v107, 0xffff0000, v117
v_lshlrev_b32 v108, 16, v118
ds_write_b128 v132, a[56:59] offset:8896
v_and_b32 v109, 0xffff0000, v118
v_lshlrev_b32 v110, 16, v119
ds_write_b128 v132, a[60:63] offset:13248
v_and_b32 v111, 0xffff0000, v119
v_add_u32 v13, 73728, v131
s_waitcnt lgkmcnt(0)
s_barrier
ds_read_b128 v[32:35], v131 offset:0
ds_read_b128 v[36:39], v131 offset:16
ds_read_b128 v[40:43], v131 offset:36864
ds_read_b128 v[44:47], v131 offset:36880
ds_read_b128 v[48:51], v13 offset:0
ds_read_b128 v[52:55], v13 offset:16
ds_read_b128 v[56:59], v13 offset:36864
ds_read_b128 v[60:63], v13 offset:36880
ds_read_b128 v[64:67], v131 offset:2176
ds_read_b128 v[68:71], v131 offset:2192
ds_read_b128 v[72:75], v131 offset:39040
ds_read_b128 v[76:79], v131 offset:39056
ds_read_b128 v[80:83], v13 offset:2176
ds_read_b128 v[84:87], v13 offset:2192
ds_read_b128 v[88:91], v13 offset:39040
ds_read_b128 v[92:95], v13 offset:39056
s_waitcnt lgkmcnt(12)
v_pk_add_f32 v[32:33], v[32:33], v[40:41]
v_pk_add_f32 v[34:35], v[34:35], v[42:43]
v_pk_add_f32 v[36:37], v[36:37], v[44:45]
v_pk_add_f32 v[38:39], v[38:39], v[46:47]
s_waitcnt lgkmcnt(8)
v_pk_add_f32 v[48:49], v[48:49], v[56:57]
v_pk_add_f32 v[50:51], v[50:51], v[58:59]
v_pk_add_f32 v[52:53], v[52:53], v[60:61]
v_pk_add_f32 v[54:55], v[54:55], v[62:63]
v_pk_add_f32 v[32:33], v[32:33], v[48:49]
v_pk_add_f32 v[34:35], v[34:35], v[50:51]
v_pk_add_f32 v[36:37], v[36:37], v[52:53]
v_pk_add_f32 v[38:39], v[38:39], v[54:55]
v_pk_fma_f32 v[96:97], v[32:33], v[120:121], v[96:97]
v_pk_fma_f32 v[98:99], v[34:35], v[122:123], v[98:99]
v_pk_fma_f32 v[100:101], v[36:37], v[124:125], v[100:101]
v_pk_fma_f32 v[102:103], v[38:39], v[126:127], v[102:103]
v_cvt_pk_bf16_f32 v32, v96, v97
v_cvt_pk_bf16_f32 v33, v98, v99
v_cvt_pk_bf16_f32 v34, v100, v101
v_cvt_pk_bf16_f32 v35, v102, v103
buffer_store_dwordx4 v[32:35], v130, s[8:11], s56 offen
s_waitcnt lgkmcnt(4)
v_pk_add_f32 v[64:65], v[64:65], v[72:73]
v_pk_add_f32 v[66:67], v[66:67], v[74:75]
v_pk_add_f32 v[68:69], v[68:69], v[76:77]
v_pk_add_f32 v[70:71], v[70:71], v[78:79]
s_waitcnt lgkmcnt(0)
v_pk_add_f32 v[80:81], v[80:81], v[88:89]
v_pk_add_f32 v[82:83], v[82:83], v[90:91]
v_pk_add_f32 v[84:85], v[84:85], v[92:93]
v_pk_add_f32 v[86:87], v[86:87], v[94:95]
v_pk_add_f32 v[64:65], v[64:65], v[80:81]
v_pk_add_f32 v[66:67], v[66:67], v[82:83]
v_pk_add_f32 v[68:69], v[68:69], v[84:85]
v_pk_add_f32 v[70:71], v[70:71], v[86:87]
v_pk_fma_f32 v[104:105], v[64:65], v[120:121], v[104:105]
v_pk_fma_f32 v[106:107], v[66:67], v[122:123], v[106:107]
v_pk_fma_f32 v[108:109], v[68:69], v[124:125], v[108:109]
v_pk_fma_f32 v[110:111], v[70:71], v[126:127], v[110:111]
v_cvt_pk_bf16_f32 v64, v104, v105
v_cvt_pk_bf16_f32 v65, v106, v107
v_cvt_pk_bf16_f32 v66, v108, v109
v_cvt_pk_bf16_f32 v67, v110, v111
s_add_u32 s56, s56, 8192
buffer_store_dwordx4 v[64:67], v130, s[8:11], s56 offen
adaLN_cond__mha_block_cached__glu_gated_bilinear__prompt_kernel_end:
s_endpgm
adaLN_cond__mha_block_cached__glu_gated_bilinear__prompt_kernel_rtg2:
s_mov_b32 s53, 0
adaLN_cond__mha_block_cached__glu_gated_bilinear__prompt_kernel_rlg2:
s_mov_b32 s37, 0
buffer_load_dwordx4 a[16:19], v7, s[12:15], s37 offen offset:2048 sc1
s_mov_b32 s37, 16384
buffer_load_dwordx4 a[20:23], v7, s[12:15], s37 offen offset:2048 sc1
s_add_u32 s53, s53, 1
s_waitcnt vmcnt(0)
v_accvgpr_read_b32 v14, a16
v_accvgpr_read_b32 v15, a17
v_max_u32 v13, v14, v15
v_accvgpr_read_b32 v14, a18
v_accvgpr_read_b32 v15, a19
v_max3_u32 v13, v13, v14, v15
v_accvgpr_read_b32 v14, a20
v_accvgpr_read_b32 v15, a21
v_max3_u32 v13, v13, v14, v15
v_accvgpr_read_b32 v14, a22
v_accvgpr_read_b32 v15, a23
v_max3_u32 v13, v13, v14, v15
v_cmp_eq_u32 vcc, -1, v13
s_cmp_gt_u32 s53, 200000
s_cbranch_scc1 adaLN_cond__mha_block_cached__glu_gated_bilinear__prompt_kernel_rbg2
s_cbranch_vccnz adaLN_cond__mha_block_cached__glu_gated_bilinear__prompt_kernel_rlg2
s_branch adaLN_cond__mha_block_cached__glu_gated_bilinear__prompt_kernel_rbg2
adaLN_cond__mha_block_cached__glu_gated_bilinear__prompt_kernel_rtg3:
s_mov_b32 s53, 0
adaLN_cond__mha_block_cached__glu_gated_bilinear__prompt_kernel_rlg3:
s_mov_b32 s37, 0
buffer_load_dwordx4 a[24:27], v7, s[12:15], s37 offen offset:3072 sc1
s_mov_b32 s37, 16384
buffer_load_dwordx4 a[28:31], v7, s[12:15], s37 offen offset:3072 sc1
s_add_u32 s53, s53, 1
s_waitcnt vmcnt(0)
v_accvgpr_read_b32 v14, a24
v_accvgpr_read_b32 v15, a25
v_max_u32 v13, v14, v15
v_accvgpr_read_b32 v14, a26
v_accvgpr_read_b32 v15, a27
v_max3_u32 v13, v13, v14, v15
v_accvgpr_read_b32 v14, a28
v_accvgpr_read_b32 v15, a29
v_max3_u32 v13, v13, v14, v15
v_accvgpr_read_b32 v14, a30
v_accvgpr_read_b32 v15, a31
v_max3_u32 v13, v13, v14, v15
v_cmp_eq_u32 vcc, -1, v13
s_cmp_gt_u32 s53, 200000
s_cbranch_scc1 adaLN_cond__mha_block_cached__glu_gated_bilinear__prompt_kernel_rbg3
s_cbranch_vccnz adaLN_cond__mha_block_cached__glu_gated_bilinear__prompt_kernel_rlg3
s_branch adaLN_cond__mha_block_cached__glu_gated_bilinear__prompt_kernel_rbg3
adaLN_cond__mha_block_cached__glu_gated_bilinear__prompt_kernel_rtg4:
s_mov_b32 s53, 0
adaLN_cond__mha_block_cached__glu_gated_bilinear__prompt_kernel_rlg4:
s_mov_b32 s37, 4096
buffer_load_dwordx4 a[32:35], v7, s[12:15], s37 offen offset:0 sc1
s_mov_b32 s37, 20480
buffer_load_dwordx4 a[36:39], v7, s[12:15], s37 offen offset:0 sc1
s_add_u32 s53, s53, 1
s_waitcnt vmcnt(0)
v_accvgpr_read_b32 v14, a32
v_accvgpr_read_b32 v15, a33
v_max_u32 v13, v14, v15
v_accvgpr_read_b32 v14, a34
v_accvgpr_read_b32 v15, a35
v_max3_u32 v13, v13, v14, v15
v_accvgpr_read_b32 v14, a36
v_accvgpr_read_b32 v15, a37
v_max3_u32 v13, v13, v14, v15
v_accvgpr_read_b32 v14, a38
v_accvgpr_read_b32 v15, a39
v_max3_u32 v13, v13, v14, v15
v_cmp_eq_u32 vcc, -1, v13
s_cmp_gt_u32 s53, 200000
s_cbranch_scc1 adaLN_cond__mha_block_cached__glu_gated_bilinear__prompt_kernel_rbg4
s_cbranch_vccnz adaLN_cond__mha_block_cached__glu_gated_bilinear__prompt_kernel_rlg4
s_branch adaLN_cond__mha_block_cached__glu_gated_bilinear__prompt_kernel_rbg4
adaLN_cond__mha_block_cached__glu_gated_bilinear__prompt_kernel_rtg5:
s_mov_b32 s53, 0
adaLN_cond__mha_block_cached__glu_gated_bilinear__prompt_kernel_rlg5:
s_mov_b32 s37, 4096
buffer_load_dwordx4 a[40:43], v7, s[12:15], s37 offen offset:1024 sc1
s_mov_b32 s37, 20480
buffer_load_dwordx4 a[44:47], v7, s[12:15], s37 offen offset:1024 sc1
s_add_u32 s53, s53, 1
s_waitcnt vmcnt(0)
v_accvgpr_read_b32 v14, a40
v_accvgpr_read_b32 v15, a41
v_max_u32 v13, v14, v15
v_accvgpr_read_b32 v14, a42
v_accvgpr_read_b32 v15, a43
v_max3_u32 v13, v13, v14, v15
v_accvgpr_read_b32 v14, a44
v_accvgpr_read_b32 v15, a45
v_max3_u32 v13, v13, v14, v15
v_accvgpr_read_b32 v14, a46
v_accvgpr_read_b32 v15, a47
v_max3_u32 v13, v13, v14, v15
v_cmp_eq_u32 vcc, -1, v13
s_cmp_gt_u32 s53, 200000
s_cbranch_scc1 adaLN_cond__mha_block_cached__glu_gated_bilinear__prompt_kernel_rbg5
s_cbranch_vccnz adaLN_cond__mha_block_cached__glu_gated_bilinear__prompt_kernel_rlg5
s_branch adaLN_cond__mha_block_cached__glu_gated_bilinear__prompt_kernel_rbg5
adaLN_cond__mha_block_cached__glu_gated_bilinear__prompt_kernel_rtg6:
s_mov_b32 s53, 0
adaLN_cond__mha_block_cached__glu_gated_bilinear__prompt_kernel_rlg6:
s_mov_b32 s37, 4096
buffer_load_dwordx4 a[48:51], v7, s[12:15], s37 offen offset:2048 sc1
s_mov_b32 s37, 20480
buffer_load_dwordx4 a[52:55], v7, s[12:15], s37 offen offset:2048 sc1
s_add_u32 s53, s53, 1
s_waitcnt vmcnt(0)
v_accvgpr_read_b32 v14, a48
v_accvgpr_read_b32 v15, a49
v_max_u32 v13, v14, v15
v_accvgpr_read_b32 v14, a50
v_accvgpr_read_b32 v15, a51
v_max3_u32 v13, v13, v14, v15
v_accvgpr_read_b32 v14, a52
v_accvgpr_read_b32 v15, a53
v_max3_u32 v13, v13, v14, v15
v_accvgpr_read_b32 v14, a54
v_accvgpr_read_b32 v15, a55
v_max3_u32 v13, v13, v14, v15
v_cmp_eq_u32 vcc, -1, v13
s_cmp_gt_u32 s53, 200000
s_cbranch_scc1 adaLN_cond__mha_block_cached__glu_gated_bilinear__prompt_kernel_rbg6
s_cbranch_vccnz adaLN_cond__mha_block_cached__glu_gated_bilinear__prompt_kernel_rlg6
s_branch adaLN_cond__mha_block_cached__glu_gated_bilinear__prompt_kernel_rbg6
adaLN_cond__mha_block_cached__glu_gated_bilinear__prompt_kernel_rtg7:
s_mov_b32 s53, 0
adaLN_cond__mha_block_cached__glu_gated_bilinear__prompt_kernel_rlg7:
s_mov_b32 s37, 4096
buffer_load_dwordx4 a[56:59], v7, s[12:15], s37 offen offset:3072 sc1
s_mov_b32 s37, 20480
buffer_load_dwordx4 a[60:63], v7, s[12:15], s37 offen offset:3072 sc1
s_add_u32 s53, s53, 1
s_waitcnt vmcnt(0)
v_accvgpr_read_b32 v14, a56
v_accvgpr_read_b32 v15, a57
v_max_u32 v13, v14, v15
v_accvgpr_read_b32 v14, a58
v_accvgpr_read_b32 v15, a59
v_max3_u32 v13, v13, v14, v15
v_accvgpr_read_b32 v14, a60
v_accvgpr_read_b32 v15, a61
v_max3_u32 v13, v13, v14, v15
v_accvgpr_read_b32 v14, a62
v_accvgpr_read_b32 v15, a63
v_max3_u32 v13, v13, v14, v15
v_cmp_eq_u32 vcc, -1, v13
s_cmp_gt_u32 s53, 200000
s_cbranch_scc1 adaLN_cond__mha_block_cached__glu_gated_bilinear__prompt_kernel_rbg7
s_cbranch_vccnz adaLN_cond__mha_block_cached__glu_gated_bilinear__prompt_kernel_rlg7
s_branch adaLN_cond__mha_block_cached__glu_gated_bilinear__prompt_kernel_rbg7
adaLN_cond__mha_block_cached__glu_gated_bilinear__prompt_kernel_rtg8:
s_mov_b32 s53, 0
adaLN_cond__mha_block_cached__glu_gated_bilinear__prompt_kernel_rlg8:
s_mov_b32 s37, 8192
buffer_load_dwordx4 a[64:67], v7, s[12:15], s37 offen offset:0 sc1
s_mov_b32 s37, 24576
buffer_load_dwordx4 a[68:71], v7, s[12:15], s37 offen offset:0 sc1
s_add_u32 s53, s53, 1
s_waitcnt vmcnt(0)
v_accvgpr_read_b32 v14, a64
v_accvgpr_read_b32 v15, a65
v_max_u32 v13, v14, v15
v_accvgpr_read_b32 v14, a66
v_accvgpr_read_b32 v15, a67
v_max3_u32 v13, v13, v14, v15
v_accvgpr_read_b32 v14, a68
v_accvgpr_read_b32 v15, a69
v_max3_u32 v13, v13, v14, v15
v_accvgpr_read_b32 v14, a70
v_accvgpr_read_b32 v15, a71
v_max3_u32 v13, v13, v14, v15
v_cmp_eq_u32 vcc, -1, v13
s_cmp_gt_u32 s53, 200000
s_cbranch_scc1 adaLN_cond__mha_block_cached__glu_gated_bilinear__prompt_kernel_rbg8
s_cbranch_vccnz adaLN_cond__mha_block_cached__glu_gated_bilinear__prompt_kernel_rlg8
s_branch adaLN_cond__mha_block_cached__glu_gated_bilinear__prompt_kernel_rbg8
adaLN_cond__mha_block_cached__glu_gated_bilinear__prompt_kernel_rtg9:
s_mov_b32 s53, 0
adaLN_cond__mha_block_cached__glu_gated_bilinear__prompt_kernel_rlg9:
s_mov_b32 s37, 8192
buffer_load_dwordx4 a[72:75], v7, s[12:15], s37 offen offset:1024 sc1
s_mov_b32 s37, 24576
buffer_load_dwordx4 a[76:79], v7, s[12:15], s37 offen offset:1024 sc1
s_add_u32 s53, s53, 1
s_waitcnt vmcnt(0)
v_accvgpr_read_b32 v14, a72
v_accvgpr_read_b32 v15, a73
v_max_u32 v13, v14, v15
v_accvgpr_read_b32 v14, a74
v_accvgpr_read_b32 v15, a75
v_max3_u32 v13, v13, v14, v15
v_accvgpr_read_b32 v14, a76
v_accvgpr_read_b32 v15, a77
v_max3_u32 v13, v13, v14, v15
v_accvgpr_read_b32 v14, a78
v_accvgpr_read_b32 v15, a79
v_max3_u32 v13, v13, v14, v15
v_cmp_eq_u32 vcc, -1, v13
s_cmp_gt_u32 s53, 200000
s_cbranch_scc1 adaLN_cond__mha_block_cached__glu_gated_bilinear__prompt_kernel_rbg9
s_cbranch_vccnz adaLN_cond__mha_block_cached__glu_gated_bilinear__prompt_kernel_rlg9
s_branch adaLN_cond__mha_block_cached__glu_gated_bilinear__prompt_kernel_rbg9
adaLN_cond__mha_block_cached__glu_gated_bilinear__prompt_kernel_rtg10:
s_mov_b32 s53, 0
adaLN_cond__mha_block_cached__glu_gated_bilinear__prompt_kernel_rlg10:
s_mov_b32 s37, 8192
buffer_load_dwordx4 a[80:83], v7, s[12:15], s37 offen offset:2048 sc1
s_mov_b32 s37, 24576
buffer_load_dwordx4 a[84:87], v7, s[12:15], s37 offen offset:2048 sc1
s_add_u32 s53, s53, 1
s_waitcnt vmcnt(0)
v_accvgpr_read_b32 v14, a80
v_accvgpr_read_b32 v15, a81
v_max_u32 v13, v14, v15
v_accvgpr_read_b32 v14, a82
v_accvgpr_read_b32 v15, a83
v_max3_u32 v13, v13, v14, v15
v_accvgpr_read_b32 v14, a84
v_accvgpr_read_b32 v15, a85
v_max3_u32 v13, v13, v14, v15
v_accvgpr_read_b32 v14, a86
v_accvgpr_read_b32 v15, a87
v_max3_u32 v13, v13, v14, v15
v_cmp_eq_u32 vcc, -1, v13
s_cmp_gt_u32 s53, 200000
s_cbranch_scc1 adaLN_cond__mha_block_cached__glu_gated_bilinear__prompt_kernel_rbg10
s_cbranch_vccnz adaLN_cond__mha_block_cached__glu_gated_bilinear__prompt_kernel_rlg10
s_branch adaLN_cond__mha_block_cached__glu_gated_bilinear__prompt_kernel_rbg10
adaLN_cond__mha_block_cached__glu_gated_bilinear__prompt_kernel_rtg11:
s_mov_b32 s53, 0
adaLN_cond__mha_block_cached__glu_gated_bilinear__prompt_kernel_rlg11:
s_mov_b32 s37, 8192
buffer_load_dwordx4 a[88:91], v7, s[12:15], s37 offen offset:3072 sc1
s_mov_b32 s37, 24576
buffer_load_dwordx4 a[92:95], v7, s[12:15], s37 offen offset:3072 sc1
s_add_u32 s53, s53, 1
s_waitcnt vmcnt(0)
v_accvgpr_read_b32 v14, a88
v_accvgpr_read_b32 v15, a89
v_max_u32 v13, v14, v15
v_accvgpr_read_b32 v14, a90
v_accvgpr_read_b32 v15, a91
v_max3_u32 v13, v13, v14, v15
v_accvgpr_read_b32 v14, a92
v_accvgpr_read_b32 v15, a93
v_max3_u32 v13, v13, v14, v15
v_accvgpr_read_b32 v14, a94
v_accvgpr_read_b32 v15, a95
v_max3_u32 v13, v13, v14, v15
v_cmp_eq_u32 vcc, -1, v13
s_cmp_gt_u32 s53, 200000
s_cbranch_scc1 adaLN_cond__mha_block_cached__glu_gated_bilinear__prompt_kernel_rbg11
s_cbranch_vccnz adaLN_cond__mha_block_cached__glu_gated_bilinear__prompt_kernel_rlg11
s_branch adaLN_cond__mha_block_cached__glu_gated_bilinear__prompt_kernel_rbg11
adaLN_cond__mha_block_cached__glu_gated_bilinear__prompt_kernel_rtg12:
s_mov_b32 s53, 0
adaLN_cond__mha_block_cached__glu_gated_bilinear__prompt_kernel_rlg12:
s_mov_b32 s37, 12288
buffer_load_dwordx4 a[96:99], v7, s[12:15], s37 offen offset:0 sc1
s_mov_b32 s37, 28672
buffer_load_dwordx4 a[100:103], v7, s[12:15], s37 offen offset:0 sc1
s_add_u32 s53, s53, 1
s_waitcnt vmcnt(0)
v_accvgpr_read_b32 v14, a96
v_accvgpr_read_b32 v15, a97
v_max_u32 v13, v14, v15
v_accvgpr_read_b32 v14, a98
v_accvgpr_read_b32 v15, a99
v_max3_u32 v13, v13, v14, v15
v_accvgpr_read_b32 v14, a100
v_accvgpr_read_b32 v15, a101
v_max3_u32 v13, v13, v14, v15
v_accvgpr_read_b32 v14, a102
v_accvgpr_read_b32 v15, a103
v_max3_u32 v13, v13, v14, v15
v_cmp_eq_u32 vcc, -1, v13
s_cmp_gt_u32 s53, 200000
s_cbranch_scc1 adaLN_cond__mha_block_cached__glu_gated_bilinear__prompt_kernel_rbg12
s_cbranch_vccnz adaLN_cond__mha_block_cached__glu_gated_bilinear__prompt_kernel_rlg12
s_branch adaLN_cond__mha_block_cached__glu_gated_bilinear__prompt_kernel_rbg12
adaLN_cond__mha_block_cached__glu_gated_bilinear__prompt_kernel_rtg13:
s_mov_b32 s53, 0
adaLN_cond__mha_block_cached__glu_gated_bilinear__prompt_kernel_rlg13:
s_mov_b32 s37, 12288
buffer_load_dwordx4 a[104:107], v7, s[12:15], s37 offen offset:1024 sc1
s_mov_b32 s37, 28672
buffer_load_dwordx4 a[108:111], v7, s[12:15], s37 offen offset:1024 sc1
s_add_u32 s53, s53, 1
s_waitcnt vmcnt(0)
v_accvgpr_read_b32 v14, a104
v_accvgpr_read_b32 v15, a105
v_max_u32 v13, v14, v15
v_accvgpr_read_b32 v14, a106
v_accvgpr_read_b32 v15, a107
v_max3_u32 v13, v13, v14, v15
v_accvgpr_read_b32 v14, a108
v_accvgpr_read_b32 v15, a109
v_max3_u32 v13, v13, v14, v15
v_accvgpr_read_b32 v14, a110
v_accvgpr_read_b32 v15, a111
v_max3_u32 v13, v13, v14, v15
v_cmp_eq_u32 vcc, -1, v13
s_cmp_gt_u32 s53, 200000
s_cbranch_scc1 adaLN_cond__mha_block_cached__glu_gated_bilinear__prompt_kernel_rbg13
s_cbranch_vccnz adaLN_cond__mha_block_cached__glu_gated_bilinear__prompt_kernel_rlg13
s_branch adaLN_cond__mha_block_cached__glu_gated_bilinear__prompt_kernel_rbg13
adaLN_cond__mha_block_cached__glu_gated_bilinear__prompt_kernel_rtg14:
s_mov_b32 s53, 0
adaLN_cond__mha_block_cached__glu_gated_bilinear__prompt_kernel_rlg14:
s_mov_b32 s37, 12288
buffer_load_dwordx4 a[112:115], v7, s[12:15], s37 offen offset:2048 sc1
s_mov_b32 s37, 28672
buffer_load_dwordx4 a[116:119], v7, s[12:15], s37 offen offset:2048 sc1
s_add_u32 s53, s53, 1
s_waitcnt vmcnt(0)
v_accvgpr_read_b32 v14, a112
v_accvgpr_read_b32 v15, a113
v_max_u32 v13, v14, v15
v_accvgpr_read_b32 v14, a114
v_accvgpr_read_b32 v15, a115
v_max3_u32 v13, v13, v14, v15
v_accvgpr_read_b32 v14, a116
v_accvgpr_read_b32 v15, a117
v_max3_u32 v13, v13, v14, v15
v_accvgpr_read_b32 v14, a118
v_accvgpr_read_b32 v15, a119
v_max3_u32 v13, v13, v14, v15
v_cmp_eq_u32 vcc, -1, v13
s_cmp_gt_u32 s53, 200000
s_cbranch_scc1 adaLN_cond__mha_block_cached__glu_gated_bilinear__prompt_kernel_rbg14
s_cbranch_vccnz adaLN_cond__mha_block_cached__glu_gated_bilinear__prompt_kernel_rlg14
s_branch adaLN_cond__mha_block_cached__glu_gated_bilinear__prompt_kernel_rbg14
adaLN_cond__mha_block_cached__glu_gated_bilinear__prompt_kernel_rtg15:
s_mov_b32 s53, 0
adaLN_cond__mha_block_cached__glu_gated_bilinear__prompt_kernel_rlg15:
s_mov_b32 s37, 12288
buffer_load_dwordx4 a[120:123], v7, s[12:15], s37 offen offset:3072 sc1
s_mov_b32 s37, 28672
buffer_load_dwordx4 a[124:127], v7, s[12:15], s37 offen offset:3072 sc1
s_add_u32 s53, s53, 1
s_waitcnt vmcnt(0)
v_accvgpr_read_b32 v14, a120
v_accvgpr_read_b32 v15, a121
v_max_u32 v13, v14, v15
v_accvgpr_read_b32 v14, a122
v_accvgpr_read_b32 v15, a123
v_max3_u32 v13, v13, v14, v15
v_accvgpr_read_b32 v14, a124
v_accvgpr_read_b32 v15, a125
v_max3_u32 v13, v13, v14, v15
v_accvgpr_read_b32 v14, a126
v_accvgpr_read_b32 v15, a127
v_max3_u32 v13, v13, v14, v15
v_cmp_eq_u32 vcc, -1, v13
s_cmp_gt_u32 s53, 200000
s_cbranch_scc1 adaLN_cond__mha_block_cached__glu_gated_bilinear__prompt_kernel_rbg15
s_cbranch_vccnz adaLN_cond__mha_block_cached__glu_gated_bilinear__prompt_kernel_rlg15
s_branch adaLN_cond__mha_block_cached__glu_gated_bilinear__prompt_kernel_rbg15
adaLN_cond__mha_block_cached__glu_gated_bilinear__prompt_kernel_cold:
adaLN_cond__mha_block_cached__glu_gated_bilinear__prompt_kernel_slow:
v_lshlrev_b32 v5, 4, v4
s_mov_b32 s48, 40960
s_cmp_eq_u32 s28, 1
s_cselect_b32 s48, 65536, s48
s_cmp_eq_u32 s28, 2
s_cselect_b32 s48, 139264, s48
s_cmp_eq_u32 s28, 3
s_cselect_b32 s48, 147456, s48
s_waitcnt vmcnt(0)
v_accvgpr_write_b32 a0, 0
v_accvgpr_write_b32 a1, 0
v_accvgpr_write_b32 a2, 0
v_accvgpr_write_b32 a3, 0
v_accvgpr_write_b32 a4, 0
v_accvgpr_write_b32 a5, 0
v_accvgpr_write_b32 a6, 0
v_accvgpr_write_b32 a7, 0
v_accvgpr_write_b32 a8, 0
v_accvgpr_write_b32 a9, 0
v_accvgpr_write_b32 a10, 0
v_accvgpr_write_b32 a11, 0
v_accvgpr_write_b32 a12, 0
v_accvgpr_write_b32 a13, 0
v_accvgpr_write_b32 a14, 0
v_accvgpr_write_b32 a15, 0
v_accvgpr_write_b32 a16, 0
v_accvgpr_write_b32 a17, 0
v_accvgpr_write_b32 a18, 0
v_accvgpr_write_b32 a19, 0
v_accvgpr_write_b32 a20, 0
v_accvgpr_write_b32 a21, 0
v_accvgpr_write_b32 a22, 0
v_accvgpr_write_b32 a23, 0
v_accvgpr_write_b32 a24, 0
v_accvgpr_write_b32 a25, 0
v_accvgpr_write_b32 a26, 0
v_accvgpr_write_b32 a27, 0
v_accvgpr_write_b32 a28, 0
v_accvgpr_write_b32 a29, 0
v_accvgpr_write_b32 a30, 0
v_accvgpr_write_b32 a31, 0
v_accvgpr_write_b32 a32, 0
v_accvgpr_write_b32 a33, 0
v_accvgpr_write_b32 a34, 0
v_accvgpr_write_b32 a35, 0
v_accvgpr_write_b32 a36, 0
v_accvgpr_write_b32 a37, 0
v_accvgpr_write_b32 a38, 0
v_accvgpr_write_b32 a39, 0
v_accvgpr_write_b32 a40, 0
v_accvgpr_write_b32 a41, 0
v_accvgpr_write_b32 a42, 0
v_accvgpr_write_b32 a43, 0
v_accvgpr_write_b32 a44, 0
v_accvgpr_write_b32 a45, 0
v_accvgpr_write_b32 a46, 0
v_accvgpr_write_b32 a47, 0
v_accvgpr_write_b32 a48, 0
v_accvgpr_write_b32 a49, 0
v_accvgpr_write_b32 a50, 0
v_accvgpr_write_b32 a51, 0
v_accvgpr_write_b32 a52, 0
v_accvgpr_write_b32 a53, 0
v_accvgpr_write_b32 a54, 0
v_accvgpr_write_b32 a55, 0
v_accvgpr_write_b32 a56, 0
v_accvgpr_write_b32 a57, 0
v_accvgpr_write_b32 a58, 0
v_accvgpr_write_b32 a59, 0
v_accvgpr_write_b32 a60, 0
v_accvgpr_write_b32 a61, 0
v_accvgpr_write_b32 a62, 0
v_accvgpr_write_b32 a63, 0
v_accvgpr_write_b32 a64, 0
v_accvgpr_write_b32 a65, 0
v_accvgpr_write_b32 a66, 0
v_accvgpr_write_b32 a67, 0
v_accvgpr_write_b32 a68, 0
v_accvgpr_write_b32 a69, 0
v_accvgpr_write_b32 a70, 0
v_accvgpr_write_b32 a71, 0
v_accvgpr_write_b32 a72, 0
v_accvgpr_write_b32 a73, 0
v_accvgpr_write_b32 a74, 0
v_accvgpr_write_b32 a75, 0
v_accvgpr_write_b32 a76, 0
v_accvgpr_write_b32 a77, 0
v_accvgpr_write_b32 a78, 0
v_accvgpr_write_b32 a79, 0
v_accvgpr_write_b32 a80, 0
v_accvgpr_write_b32 a81, 0
v_accvgpr_write_b32 a82, 0
v_accvgpr_write_b32 a83, 0
v_accvgpr_write_b32 a84, 0
v_accvgpr_write_b32 a85, 0
v_accvgpr_write_b32 a86, 0
v_accvgpr_write_b32 a87, 0
v_accvgpr_write_b32 a88, 0
v_accvgpr_write_b32 a89, 0
v_accvgpr_write_b32 a90, 0
v_accvgpr_write_b32 a91, 0
v_accvgpr_write_b32 a92, 0
v_accvgpr_write_b32 a93, 0
v_accvgpr_write_b32 a94, 0
v_accvgpr_write_b32 a95, 0
v_accvgpr_write_b32 a96, 0
v_accvgpr_write_b32 a97, 0
v_accvgpr_write_b32 a98, 0
v_accvgpr_write_b32 a99, 0
v_accvgpr_write_b32 a100, 0
v_accvgpr_write_b32 a101, 0
v_accvgpr_write_b32 a102, 0
v_accvgpr_write_b32 a103, 0
v_accvgpr_write_b32 a104, 0
v_accvgpr_write_b32 a105, 0
v_accvgpr_write_b32 a106, 0
v_accvgpr_write_b32 a107, 0
v_accvgpr_write_b32 a108, 0
v_accvgpr_write_b32 a109, 0
v_accvgpr_write_b32 a110, 0
v_accvgpr_write_b32 a111, 0
v_accvgpr_write_b32 a112, 0
v_accvgpr_write_b32 a113, 0
v_accvgpr_write_b32 a114, 0
v_accvgpr_write_b32 a115, 0
v_accvgpr_write_b32 a116, 0
v_accvgpr_write_b32 a117, 0
v_accvgpr_write_b32 a118, 0
v_accvgpr_write_b32 a119, 0
v_accvgpr_write_b32 a120, 0
v_accvgpr_write_b32 a121, 0
v_accvgpr_write_b32 a122, 0
v_accvgpr_write_b32 a123, 0
v_accvgpr_write_b32 a124, 0
v_accvgpr_write_b32 a125, 0
v_accvgpr_write_b32 a126, 0
v_accvgpr_write_b32 a127, 0
v_mov_b32 v112, 0xff7fffff
v_mov_b32 v116, 0
v_mov_b32 v113, 0xff7fffff
v_mov_b32 v117, 0
v_mov_b32 v114, 0xff7fffff
v_mov_b32 v118, 0
v_mov_b32 v115, 0xff7fffff
v_mov_b32 v119, 0
v_add_u32 v128, s48, v128
v_add_u32 v129, s48, v129
v_add_u32 v130, s48, v130
v_add_u32 v131, s48, v131
v_add_u32 v132, s48, v132
v_add_u32 v133, s48, v133
v_add_u32 v134, s48, v134
v_add_u32 v135, s48, v135
v_lshlrev_b32 v7, 8, v3
v_lshl_add_u32 v7, v4, 4, v7
s_mov_b32 s54, 0
adaLN_cond__mha_block_cached__glu_gated_bilinear__prompt_kernel_fb:
s_add_u32 s55, s54, 4096
buffer_load_dwordx4 a[192:195], v7, s[8:11], s54 offen offset:0
buffer_load_dwordx4 a[196:199], v7, s[8:11], s54 offen offset:64
buffer_load_dwordx4 a[200:203], v7, s[8:11], s54 offen offset:128
buffer_load_dwordx4 a[204:207], v7, s[8:11], s54 offen offset:192
buffer_load_dwordx4 a[208:211], v7, s[8:11], s55 offen offset:0
buffer_load_dwordx4 a[212:215], v7, s[8:11], s55 offen offset:64
buffer_load_dwordx4 a[216:219], v7, s[8:11], s55 offen offset:128
buffer_load_dwordx4 a[220:223], v7, s[8:11], s55 offen offset:192
s_mov_b32 m0, s48
s_nop 0
buffer_load_dwordx4 v160, s[12:15], s54 offen offset:0 nt lds
buffer_load_dwordx4 v161, s[12:15], s54 offen offset:1024 nt lds
buffer_load_dwordx4 v160, s[12:15], s54 offen offset:2048 nt lds
buffer_load_dwordx4 v161, s[12:15], s54 offen offset:3072 nt lds
s_add_u32 m0, s48, 4096
s_nop 0
buffer_load_dwordx4 v160, s[12:15], s55 offen offset:0 nt lds
buffer_load_dwordx4 v161, s[12:15], s55 offen offset:1024 nt lds
buffer_load_dwordx4 v160, s[12:15], s55 offen offset:2048 nt lds
buffer_load_dwordx4 v161, s[12:15], s55 offen offset:3072 nt lds
s_waitcnt vmcnt(0)
ds_read_b64_tr_b16 a[224:225], v128 offset:0
ds_read_b64_tr_b16 a[226:227], v128 offset:4096
ds_read_b64_tr_b16 a[228:229], v129 offset:0
ds_read_b64_tr_b16 a[230:231], v129 offset:4096
ds_read_b64_tr_b16 a[232:233], v130 offset:0
ds_read_b64_tr_b16 a[234:235], v130 offset:4096
ds_read_b64_tr_b16 a[236:237], v131 offset:0
ds_read_b64_tr_b16 a[238:239], v131 offset:4096
ds_read_b64_tr_b16 a[240:241], v132 offset:0
ds_read_b64_tr_b16 a[242:243], v132 offset:4096
ds_read_b64_tr_b16 a[244:245], v133 offset:0
ds_read_b64_tr_b16 a[246:247], v133 offset:4096
ds_read_b64_tr_b16 a[248:249], v134 offset:0
ds_read_b64_tr_b16 a[250:251], v134 offset:4096
ds_read_b64_tr_b16 a[252:253], v135 offset:0
ds_read_b64_tr_b16 a[254:255], v135 offset:4096
v_mfma_f32_16x16x32_bf16 v[16:19], a[192:195], v[192:195], 0
v_mfma_f32_16x16x32_bf16 v[16:19], a[196:199], v[196:199], v[16:19]
v_mfma_f32_16x16x32_bf16 v[16:19], a[200:203], v[200:203], v[16:19]
v_mfma_f32_16x16x32_bf16 v[16:19], a[204:207], v[204:207], v[16:19]
v_mfma_f32_16x16x32_bf16 v[24:27], a[192:195], v[208:211], 0
v_mfma_f32_16x16x32_bf16 v[24:27], a[196:199], v[212:215], v[24:27]
v_mfma_f32_16x16x32_bf16 v[24:27], a[200:203], v[216:219], v[24:27]
v_mfma_f32_16x16x32_bf16 v[24:27], a[204:207], v[220:223], v[24:27]
v_mfma_f32_16x16x32_bf16 v[32:35], a[192:195], v[224:227], 0
v_mfma_f32_16x16x32_bf16 v[32:35], a[196:199], v[228:231], v[32:35]
v_mfma_f32_16x16x32_bf16 v[32:35], a[200:203], v[232:235], v[32:35]
v_mfma_f32_16x16x32_bf16 v[32:35], a[204:207], v[236:239], v[32:35]
v_mfma_f32_16x16x32_bf16 v[40:43], a[192:195], v[240:243], 0
v_mfma_f32_16x16x32_bf16 v[40:43], a[196:199], v[244:247], v[40:43]
v_mfma_f32_16x16x32_bf16 v[40:43], a[200:203], v[248:251], v[40:43]
v_mfma_f32_16x16x32_bf16 v[40:43], a[204:207], v[252:255], v[40:43]
v_mfma_f32_16x16x32_bf16 v[20:23], a[208:211], v[192:195], 0
v_mfma_f32_16x16x32_bf16 v[20:23], a[212:215], v[196:199], v[20:23]
v_mfma_f32_16x16x32_bf16 v[20:23], a[216:219], v[200:203], v[20:23]
v_mfma_f32_16x16x32_bf16 v[20:23], a[220:223], v[204:207], v[20:23]
v_mfma_f32_16x16x32_bf16 v[28:31], a[208:211], v[208:211], 0
v_mfma_f32_16x16x32_bf16 v[28:31], a[212:215], v[212:215], v[28:31]
v_mfma_f32_16x16x32_bf16 v[28:31], a[216:219], v[216:219], v[28:31]
v_mfma_f32_16x16x32_bf16 v[28:31], a[220:223], v[220:223], v[28:31]
v_mfma_f32_16x16x32_bf16 v[36:39], a[208:211], v[224:227], 0
v_mfma_f32_16x16x32_bf16 v[36:39], a[212:215], v[228:231], v[36:39]
v_mfma_f32_16x16x32_bf16 v[36:39], a[216:219], v[232:235], v[36:39]
v_mfma_f32_16x16x32_bf16 v[36:39], a[220:223], v[236:239], v[36:39]
v_mfma_f32_16x16x32_bf16 v[44:47], a[208:211], v[240:243], 0
v_mfma_f32_16x16x32_bf16 v[44:47], a[212:215], v[244:247], v[44:47]
v_mfma_f32_16x16x32_bf16 v[44:47], a[216:219], v[248:251], v[44:47]
v_mfma_f32_16x16x32_bf16 v[44:47], a[220:223], v[252:255], v[44:47]
s_nop 7
s_nop 3
v_max3_f32 v8, v16, v17, v18
v_max3_f32 v8, v8, v19, v20
v_max3_f32 v8, v8, v21, v22
v_max3_f32 v8, v8, v23, v112
v_mov_b32 v9, v8
s_nop 1
v_permlane32_swap_b32 v8, v9
s_nop 1
v_max_f32 v8, v8, v9
v_mov_b32 v9, v8
s_nop 1
v_permlane16_swap_b32 v8, v9
s_nop 1
v_max_f32 v8, v8, v9
v_sub_f32 v120, v112, v8
v_exp_f32 v120, v120
v_mov_b32 v112, v8
v_sub_f32 v16, v16, v8
v_sub_f32 v17, v17, v8
v_sub_f32 v18, v18, v8
v_sub_f32 v19, v19, v8
v_sub_f32 v20, v20, v8
v_sub_f32 v21, v21, v8
v_sub_f32 v22, v22, v8
v_sub_f32 v23, v23, v8
v_exp_f32 v16, v16
v_exp_f32 v17, v17
v_exp_f32 v18, v18
v_exp_f32 v19, v19
v_exp_f32 v20, v20
v_exp_f32 v21, v21
v_exp_f32 v22, v22
v_exp_f32 v23, v23
v_mul_f32 v116, v116, v120
v_add_f32 v116, v116, v16
v_add_f32 v116, v116, v17
v_add_f32 v116, v116, v18
v_add_f32 v116, v116, v19
v_add_f32 v116, v116, v20
v_add_f32 v116, v116, v21
v_add_f32 v116, v116, v22
v_add_f32 v116, v116, v23
v_cvt_pk_bf16_f32 v80, v16, v17
v_cvt_pk_bf16_f32 v81, v18, v19
v_cvt_pk_bf16_f32 v82, v20, v21
v_cvt_pk_bf16_f32 v83, v22, v23
ds_bpermute_b32 v96, v5, v120 offset:0
ds_bpermute_b32 v97, v5, v120 offset:4
ds_bpermute_b32 v98, v5, v120 offset:8
ds_bpermute_b32 v99, v5, v120 offset:12
v_max3_f32 v8, v24, v25, v26
v_max3_f32 v8, v8, v27, v28
v_max3_f32 v8, v8, v29, v30
v_max3_f32 v8, v8, v31, v113
v_mov_b32 v9, v8
s_nop 1
v_permlane32_swap_b32 v8, v9
s_nop 1
v_max_f32 v8, v8, v9
v_mov_b32 v9, v8
s_nop 1
v_permlane16_swap_b32 v8, v9
s_nop 1
v_max_f32 v8, v8, v9
v_sub_f32 v121, v113, v8
v_exp_f32 v121, v121
v_mov_b32 v113, v8
v_sub_f32 v24, v24, v8
v_sub_f32 v25, v25, v8
v_sub_f32 v26, v26, v8
v_sub_f32 v27, v27, v8
v_sub_f32 v28, v28, v8
v_sub_f32 v29, v29, v8
v_sub_f32 v30, v30, v8
v_sub_f32 v31, v31, v8
v_exp_f32 v24, v24
v_exp_f32 v25, v25
v_exp_f32 v26, v26
v_exp_f32 v27, v27
v_exp_f32 v28, v28
v_exp_f32 v29, v29
v_exp_f32 v30, v30
v_exp_f32 v31, v31
v_mul_f32 v117, v117, v121
v_add_f32 v117, v117, v24
v_add_f32 v117, v117, v25
v_add_f32 v117, v117, v26
v_add_f32 v117, v117, v27
v_add_f32 v117, v117, v28
v_add_f32 v117, v117, v29
v_add_f32 v117, v117, v30
v_add_f32 v117, v117, v31
v_cvt_pk_bf16_f32 v84, v24, v25
v_cvt_pk_bf16_f32 v85, v26, v27
v_cvt_pk_bf16_f32 v86, v28, v29
v_cvt_pk_bf16_f32 v87, v30, v31
ds_bpermute_b32 v100, v5, v121 offset:0
ds_bpermute_b32 v101, v5, v121 offset:4
ds_bpermute_b32 v102, v5, v121 offset:8
ds_bpermute_b32 v103, v5, v121 offset:12
v_max3_f32 v8, v32, v33, v34
v_max3_f32 v8, v8, v35, v36
v_max3_f32 v8, v8, v37, v38
v_max3_f32 v8, v8, v39, v114
v_mov_b32 v9, v8
s_nop 1
v_permlane32_swap_b32 v8, v9
s_nop 1
v_max_f32 v8, v8, v9
v_mov_b32 v9, v8
s_nop 1
v_permlane16_swap_b32 v8, v9
s_nop 1
v_max_f32 v8, v8, v9
v_sub_f32 v122, v114, v8
v_exp_f32 v122, v122
v_mov_b32 v114, v8
v_sub_f32 v32, v32, v8
v_sub_f32 v33, v33, v8
v_sub_f32 v34, v34, v8
v_sub_f32 v35, v35, v8
v_sub_f32 v36, v36, v8
v_sub_f32 v37, v37, v8
v_sub_f32 v38, v38, v8
v_sub_f32 v39, v39, v8
v_exp_f32 v32, v32
v_exp_f32 v33, v33
v_exp_f32 v34, v34
v_exp_f32 v35, v35
v_exp_f32 v36, v36
v_exp_f32 v37, v37
v_exp_f32 v38, v38
v_exp_f32 v39, v39
v_mul_f32 v118, v118, v122
v_add_f32 v118, v118, v32
v_add_f32 v118, v118, v33
v_add_f32 v118, v118, v34
v_add_f32 v118, v118, v35
v_add_f32 v118, v118, v36
v_add_f32 v118, v118, v37
v_add_f32 v118, v118, v38
v_add_f32 v118, v118, v39
v_cvt_pk_bf16_f32 v88, v32, v33
v_cvt_pk_bf16_f32 v89, v34, v35
v_cvt_pk_bf16_f32 v90, v36, v37
v_cvt_pk_bf16_f32 v91, v38, v39
ds_bpermute_b32 v104, v5, v122 offset:0
ds_bpermute_b32 v105, v5, v122 offset:4
ds_bpermute_b32 v106, v5, v122 offset:8
ds_bpermute_b32 v107, v5, v122 offset:12
v_max3_f32 v8, v40, v41, v42
v_max3_f32 v8, v8, v43, v44
v_max3_f32 v8, v8, v45, v46
v_max3_f32 v8, v8, v47, v115
v_mov_b32 v9, v8
s_nop 1
v_permlane32_swap_b32 v8, v9
s_nop 1
v_max_f32 v8, v8, v9
v_mov_b32 v9, v8
s_nop 1
v_permlane16_swap_b32 v8, v9
s_nop 1
v_max_f32 v8, v8, v9
v_sub_f32 v123, v115, v8
v_exp_f32 v123, v123
v_mov_b32 v115, v8
v_sub_f32 v40, v40, v8
v_sub_f32 v41, v41, v8
v_sub_f32 v42, v42, v8
v_sub_f32 v43, v43, v8
v_sub_f32 v44, v44, v8
v_sub_f32 v45, v45, v8
v_sub_f32 v46, v46, v8
v_sub_f32 v47, v47, v8
v_exp_f32 v40, v40
v_exp_f32 v41, v41
v_exp_f32 v42, v42
v_exp_f32 v43, v43
v_exp_f32 v44, v44
v_exp_f32 v45, v45
v_exp_f32 v46, v46
v_exp_f32 v47, v47
v_mul_f32 v119, v119, v123
v_add_f32 v119, v119, v40
v_add_f32 v119, v119, v41
v_add_f32 v119, v119, v42
v_add_f32 v119, v119, v43
v_add_f32 v119, v119, v44
v_add_f32 v119, v119, v45
v_add_f32 v119, v119, v46
v_add_f32 v119, v119, v47
v_cvt_pk_bf16_f32 v92, v40, v41
v_cvt_pk_bf16_f32 v93, v42, v43
v_cvt_pk_bf16_f32 v94, v44, v45
v_cvt_pk_bf16_f32 v95, v46, v47
ds_bpermute_b32 v108, v5, v123 offset:0
ds_bpermute_b32 v109, v5, v123 offset:4
ds_bpermute_b32 v110, v5, v123 offset:8
ds_bpermute_b32 v111, v5, v123 offset:12
s_waitcnt lgkmcnt(0)
v_accvgpr_read_b32 v8, a0
v_mul_f32 v8, v8, v96
v_accvgpr_write_b32 a0, v8
v_accvgpr_read_b32 v8, a1
v_mul_f32 v8, v8, v97
v_accvgpr_write_b32 a1, v8
v_accvgpr_read_b32 v8, a2
v_mul_f32 v8, v8, v98
v_accvgpr_write_b32 a2, v8
v_accvgpr_read_b32 v8, a3
v_mul_f32 v8, v8, v99
v_accvgpr_write_b32 a3, v8
v_accvgpr_read_b32 v8, a4
v_mul_f32 v8, v8, v100
v_accvgpr_write_b32 a4, v8
v_accvgpr_read_b32 v8, a5
v_mul_f32 v8, v8, v101
v_accvgpr_write_b32 a5, v8
v_accvgpr_read_b32 v8, a6
v_mul_f32 v8, v8, v102
v_accvgpr_write_b32 a6, v8
v_accvgpr_read_b32 v8, a7
v_mul_f32 v8, v8, v103
v_accvgpr_write_b32 a7, v8
v_accvgpr_read_b32 v8, a8
v_mul_f32 v8, v8, v104
v_accvgpr_write_b32 a8, v8
v_accvgpr_read_b32 v8, a9
v_mul_f32 v8, v8, v105
v_accvgpr_write_b32 a9, v8
v_accvgpr_read_b32 v8, a10
v_mul_f32 v8, v8, v106
v_accvgpr_write_b32 a10, v8
v_accvgpr_read_b32 v8, a11
v_mul_f32 v8, v8, v107
v_accvgpr_write_b32 a11, v8
v_accvgpr_read_b32 v8, a12
v_mul_f32 v8, v8, v108
v_accvgpr_write_b32 a12, v8
v_accvgpr_read_b32 v8, a13
v_mul_f32 v8, v8, v109
v_accvgpr_write_b32 a13, v8
v_accvgpr_read_b32 v8, a14
v_mul_f32 v8, v8, v110
v_accvgpr_write_b32 a14, v8
v_accvgpr_read_b32 v8, a15
v_mul_f32 v8, v8, v111
v_accvgpr_write_b32 a15, v8
v_accvgpr_read_b32 v8, a16
v_mul_f32 v8, v8, v96
v_accvgpr_write_b32 a16, v8
v_accvgpr_read_b32 v8, a17
v_mul_f32 v8, v8, v97
v_accvgpr_write_b32 a17, v8
v_accvgpr_read_b32 v8, a18
v_mul_f32 v8, v8, v98
v_accvgpr_write_b32 a18, v8
v_accvgpr_read_b32 v8, a19
v_mul_f32 v8, v8, v99
v_accvgpr_write_b32 a19, v8
v_accvgpr_read_b32 v8, a20
v_mul_f32 v8, v8, v100
v_accvgpr_write_b32 a20, v8
v_accvgpr_read_b32 v8, a21
v_mul_f32 v8, v8, v101
v_accvgpr_write_b32 a21, v8
v_accvgpr_read_b32 v8, a22
v_mul_f32 v8, v8, v102
v_accvgpr_write_b32 a22, v8
v_accvgpr_read_b32 v8, a23
v_mul_f32 v8, v8, v103
v_accvgpr_write_b32 a23, v8
v_accvgpr_read_b32 v8, a24
v_mul_f32 v8, v8, v104
v_accvgpr_write_b32 a24, v8
v_accvgpr_read_b32 v8, a25
v_mul_f32 v8, v8, v105
v_accvgpr_write_b32 a25, v8
v_accvgpr_read_b32 v8, a26
v_mul_f32 v8, v8, v106
v_accvgpr_write_b32 a26, v8
v_accvgpr_read_b32 v8, a27
v_mul_f32 v8, v8, v107
v_accvgpr_write_b32 a27, v8
v_accvgpr_read_b32 v8, a28
v_mul_f32 v8, v8, v108
v_accvgpr_write_b32 a28, v8
v_accvgpr_read_b32 v8, a29
v_mul_f32 v8, v8, v109
v_accvgpr_write_b32 a29, v8
v_accvgpr_read_b32 v8, a30
v_mul_f32 v8, v8, v110
v_accvgpr_write_b32 a30, v8
v_accvgpr_read_b32 v8, a31
v_mul_f32 v8, v8, v111
v_accvgpr_write_b32 a31, v8
v_accvgpr_read_b32 v8, a32
v_mul_f32 v8, v8, v96
v_accvgpr_write_b32 a32, v8
v_accvgpr_read_b32 v8, a33
v_mul_f32 v8, v8, v97
v_accvgpr_write_b32 a33, v8
v_accvgpr_read_b32 v8, a34
v_mul_f32 v8, v8, v98
v_accvgpr_write_b32 a34, v8
v_accvgpr_read_b32 v8, a35
v_mul_f32 v8, v8, v99
v_accvgpr_write_b32 a35, v8
v_accvgpr_read_b32 v8, a36
v_mul_f32 v8, v8, v100
v_accvgpr_write_b32 a36, v8
v_accvgpr_read_b32 v8, a37
v_mul_f32 v8, v8, v101
v_accvgpr_write_b32 a37, v8
v_accvgpr_read_b32 v8, a38
v_mul_f32 v8, v8, v102
v_accvgpr_write_b32 a38, v8
v_accvgpr_read_b32 v8, a39
v_mul_f32 v8, v8, v103
v_accvgpr_write_b32 a39, v8
v_accvgpr_read_b32 v8, a40
v_mul_f32 v8, v8, v104
v_accvgpr_write_b32 a40, v8
v_accvgpr_read_b32 v8, a41
v_mul_f32 v8, v8, v105
v_accvgpr_write_b32 a41, v8
v_accvgpr_read_b32 v8, a42
v_mul_f32 v8, v8, v106
v_accvgpr_write_b32 a42, v8
v_accvgpr_read_b32 v8, a43
v_mul_f32 v8, v8, v107
v_accvgpr_write_b32 a43, v8
v_accvgpr_read_b32 v8, a44
v_mul_f32 v8, v8, v108
v_accvgpr_write_b32 a44, v8
v_accvgpr_read_b32 v8, a45
v_mul_f32 v8, v8, v109
v_accvgpr_write_b32 a45, v8
v_accvgpr_read_b32 v8, a46
v_mul_f32 v8, v8, v110
v_accvgpr_write_b32 a46, v8
v_accvgpr_read_b32 v8, a47
v_mul_f32 v8, v8, v111
v_accvgpr_write_b32 a47, v8
v_accvgpr_read_b32 v8, a48
v_mul_f32 v8, v8, v96
v_accvgpr_write_b32 a48, v8
v_accvgpr_read_b32 v8, a49
v_mul_f32 v8, v8, v97
v_accvgpr_write_b32 a49, v8
v_accvgpr_read_b32 v8, a50
v_mul_f32 v8, v8, v98
v_accvgpr_write_b32 a50, v8
v_accvgpr_read_b32 v8, a51
v_mul_f32 v8, v8, v99
v_accvgpr_write_b32 a51, v8
v_accvgpr_read_b32 v8, a52
v_mul_f32 v8, v8, v100
v_accvgpr_write_b32 a52, v8
v_accvgpr_read_b32 v8, a53
v_mul_f32 v8, v8, v101
v_accvgpr_write_b32 a53, v8
v_accvgpr_read_b32 v8, a54
v_mul_f32 v8, v8, v102
v_accvgpr_write_b32 a54, v8
v_accvgpr_read_b32 v8, a55
v_mul_f32 v8, v8, v103
v_accvgpr_write_b32 a55, v8
v_accvgpr_read_b32 v8, a56
v_mul_f32 v8, v8, v104
v_accvgpr_write_b32 a56, v8
v_accvgpr_read_b32 v8, a57
v_mul_f32 v8, v8, v105
v_accvgpr_write_b32 a57, v8
v_accvgpr_read_b32 v8, a58
v_mul_f32 v8, v8, v106
v_accvgpr_write_b32 a58, v8
v_accvgpr_read_b32 v8, a59
v_mul_f32 v8, v8, v107
v_accvgpr_write_b32 a59, v8
v_accvgpr_read_b32 v8, a60
v_mul_f32 v8, v8, v108
v_accvgpr_write_b32 a60, v8
v_accvgpr_read_b32 v8, a61
v_mul_f32 v8, v8, v109
v_accvgpr_write_b32 a61, v8
v_accvgpr_read_b32 v8, a62
v_mul_f32 v8, v8, v110
v_accvgpr_write_b32 a62, v8
v_accvgpr_read_b32 v8, a63
v_mul_f32 v8, v8, v111
v_accvgpr_write_b32 a63, v8
v_accvgpr_read_b32 v8, a64
v_mul_f32 v8, v8, v96
v_accvgpr_write_b32 a64, v8
v_accvgpr_read_b32 v8, a65
v_mul_f32 v8, v8, v97
v_accvgpr_write_b32 a65, v8
v_accvgpr_read_b32 v8, a66
v_mul_f32 v8, v8, v98
v_accvgpr_write_b32 a66, v8
v_accvgpr_read_b32 v8, a67
v_mul_f32 v8, v8, v99
v_accvgpr_write_b32 a67, v8
v_accvgpr_read_b32 v8, a68
v_mul_f32 v8, v8, v100
v_accvgpr_write_b32 a68, v8
v_accvgpr_read_b32 v8, a69
v_mul_f32 v8, v8, v101
v_accvgpr_write_b32 a69, v8
v_accvgpr_read_b32 v8, a70
v_mul_f32 v8, v8, v102
v_accvgpr_write_b32 a70, v8
v_accvgpr_read_b32 v8, a71
v_mul_f32 v8, v8, v103
v_accvgpr_write_b32 a71, v8
v_accvgpr_read_b32 v8, a72
v_mul_f32 v8, v8, v104
v_accvgpr_write_b32 a72, v8
v_accvgpr_read_b32 v8, a73
v_mul_f32 v8, v8, v105
v_accvgpr_write_b32 a73, v8
v_accvgpr_read_b32 v8, a74
v_mul_f32 v8, v8, v106
v_accvgpr_write_b32 a74, v8
v_accvgpr_read_b32 v8, a75
v_mul_f32 v8, v8, v107
v_accvgpr_write_b32 a75, v8
v_accvgpr_read_b32 v8, a76
v_mul_f32 v8, v8, v108
v_accvgpr_write_b32 a76, v8
v_accvgpr_read_b32 v8, a77
v_mul_f32 v8, v8, v109
v_accvgpr_write_b32 a77, v8
v_accvgpr_read_b32 v8, a78
v_mul_f32 v8, v8, v110
v_accvgpr_write_b32 a78, v8
v_accvgpr_read_b32 v8, a79
v_mul_f32 v8, v8, v111
v_accvgpr_write_b32 a79, v8
v_accvgpr_read_b32 v8, a80
v_mul_f32 v8, v8, v96
v_accvgpr_write_b32 a80, v8
v_accvgpr_read_b32 v8, a81
v_mul_f32 v8, v8, v97
v_accvgpr_write_b32 a81, v8
v_accvgpr_read_b32 v8, a82
v_mul_f32 v8, v8, v98
v_accvgpr_write_b32 a82, v8
v_accvgpr_read_b32 v8, a83
v_mul_f32 v8, v8, v99
v_accvgpr_write_b32 a83, v8
v_accvgpr_read_b32 v8, a84
v_mul_f32 v8, v8, v100
v_accvgpr_write_b32 a84, v8
v_accvgpr_read_b32 v8, a85
v_mul_f32 v8, v8, v101
v_accvgpr_write_b32 a85, v8
v_accvgpr_read_b32 v8, a86
v_mul_f32 v8, v8, v102
v_accvgpr_write_b32 a86, v8
v_accvgpr_read_b32 v8, a87
v_mul_f32 v8, v8, v103
v_accvgpr_write_b32 a87, v8
v_accvgpr_read_b32 v8, a88
v_mul_f32 v8, v8, v104
v_accvgpr_write_b32 a88, v8
v_accvgpr_read_b32 v8, a89
v_mul_f32 v8, v8, v105
v_accvgpr_write_b32 a89, v8
v_accvgpr_read_b32 v8, a90
v_mul_f32 v8, v8, v106
v_accvgpr_write_b32 a90, v8
v_accvgpr_read_b32 v8, a91
v_mul_f32 v8, v8, v107
v_accvgpr_write_b32 a91, v8
v_accvgpr_read_b32 v8, a92
v_mul_f32 v8, v8, v108
v_accvgpr_write_b32 a92, v8
v_accvgpr_read_b32 v8, a93
v_mul_f32 v8, v8, v109
v_accvgpr_write_b32 a93, v8
v_accvgpr_read_b32 v8, a94
v_mul_f32 v8, v8, v110
v_accvgpr_write_b32 a94, v8
v_accvgpr_read_b32 v8, a95
v_mul_f32 v8, v8, v111
v_accvgpr_write_b32 a95, v8
v_accvgpr_read_b32 v8, a96
v_mul_f32 v8, v8, v96
v_accvgpr_write_b32 a96, v8
v_accvgpr_read_b32 v8, a97
v_mul_f32 v8, v8, v97
v_accvgpr_write_b32 a97, v8
v_accvgpr_read_b32 v8, a98
v_mul_f32 v8, v8, v98
v_accvgpr_write_b32 a98, v8
v_accvgpr_read_b32 v8, a99
v_mul_f32 v8, v8, v99
v_accvgpr_write_b32 a99, v8
v_accvgpr_read_b32 v8, a100
v_mul_f32 v8, v8, v100
v_accvgpr_write_b32 a100, v8
v_accvgpr_read_b32 v8, a101
v_mul_f32 v8, v8, v101
v_accvgpr_write_b32 a101, v8
v_accvgpr_read_b32 v8, a102
v_mul_f32 v8, v8, v102
v_accvgpr_write_b32 a102, v8
v_accvgpr_read_b32 v8, a103
v_mul_f32 v8, v8, v103
v_accvgpr_write_b32 a103, v8
v_accvgpr_read_b32 v8, a104
v_mul_f32 v8, v8, v104
v_accvgpr_write_b32 a104, v8
v_accvgpr_read_b32 v8, a105
v_mul_f32 v8, v8, v105
v_accvgpr_write_b32 a105, v8
v_accvgpr_read_b32 v8, a106
v_mul_f32 v8, v8, v106
v_accvgpr_write_b32 a106, v8
v_accvgpr_read_b32 v8, a107
v_mul_f32 v8, v8, v107
v_accvgpr_write_b32 a107, v8
v_accvgpr_read_b32 v8, a108
v_mul_f32 v8, v8, v108
v_accvgpr_write_b32 a108, v8
v_accvgpr_read_b32 v8, a109
v_mul_f32 v8, v8, v109
v_accvgpr_write_b32 a109, v8
v_accvgpr_read_b32 v8, a110
v_mul_f32 v8, v8, v110
v_accvgpr_write_b32 a110, v8
v_accvgpr_read_b32 v8, a111
v_mul_f32 v8, v8, v111
v_accvgpr_write_b32 a111, v8
v_accvgpr_read_b32 v8, a112
v_mul_f32 v8, v8, v96
v_accvgpr_write_b32 a112, v8
v_accvgpr_read_b32 v8, a113
v_mul_f32 v8, v8, v97
v_accvgpr_write_b32 a113, v8
v_accvgpr_read_b32 v8, a114
v_mul_f32 v8, v8, v98
v_accvgpr_write_b32 a114, v8
v_accvgpr_read_b32 v8, a115
v_mul_f32 v8, v8, v99
v_accvgpr_write_b32 a115, v8
v_accvgpr_read_b32 v8, a116
v_mul_f32 v8, v8, v100
v_accvgpr_write_b32 a116, v8
v_accvgpr_read_b32 v8, a117
v_mul_f32 v8, v8, v101
v_accvgpr_write_b32 a117, v8
v_accvgpr_read_b32 v8, a118
v_mul_f32 v8, v8, v102
v_accvgpr_write_b32 a118, v8
v_accvgpr_read_b32 v8, a119
v_mul_f32 v8, v8, v103
v_accvgpr_write_b32 a119, v8
v_accvgpr_read_b32 v8, a120
v_mul_f32 v8, v8, v104
v_accvgpr_write_b32 a120, v8
v_accvgpr_read_b32 v8, a121
v_mul_f32 v8, v8, v105
v_accvgpr_write_b32 a121, v8
v_accvgpr_read_b32 v8, a122
v_mul_f32 v8, v8, v106
v_accvgpr_write_b32 a122, v8
v_accvgpr_read_b32 v8, a123
v_mul_f32 v8, v8, v107
v_accvgpr_write_b32 a123, v8
v_accvgpr_read_b32 v8, a124
v_mul_f32 v8, v8, v108
v_accvgpr_write_b32 a124, v8
v_accvgpr_read_b32 v8, a125
v_mul_f32 v8, v8, v109
v_accvgpr_write_b32 a125, v8
v_accvgpr_read_b32 v8, a126
v_mul_f32 v8, v8, v110
v_accvgpr_write_b32 a126, v8
v_accvgpr_read_b32 v8, a127
v_mul_f32 v8, v8, v111
v_accvgpr_write_b32 a127, v8
s_nop 1
v_mfma_f32_16x16x32_bf16 a[0:3], v[80:83], a[224:227], a[0:3]
v_mfma_f32_16x16x32_bf16 a[4:7], v[84:87], a[224:227], a[4:7]
v_mfma_f32_16x16x32_bf16 a[8:11], v[88:91], a[224:227], a[8:11]
v_mfma_f32_16x16x32_bf16 a[12:15], v[92:95], a[224:227], a[12:15]
v_mfma_f32_16x16x32_bf16 a[16:19], v[80:83], a[228:231], a[16:19]
v_mfma_f32_16x16x32_bf16 a[20:23], v[84:87], a[228:231], a[20:23]
v_mfma_f32_16x16x32_bf16 a[24:27], v[88:91], a[228:231], a[24:27]
v_mfma_f32_16x16x32_bf16 a[28:31], v[92:95], a[228:231], a[28:31]
v_mfma_f32_16x16x32_bf16 a[32:35], v[80:83], a[232:235], a[32:35]
v_mfma_f32_16x16x32_bf16 a[36:39], v[84:87], a[232:235], a[36:39]
v_mfma_f32_16x16x32_bf16 a[40:43], v[88:91], a[232:235], a[40:43]
v_mfma_f32_16x16x32_bf16 a[44:47], v[92:95], a[232:235], a[44:47]
v_mfma_f32_16x16x32_bf16 a[48:51], v[80:83], a[236:239], a[48:51]
v_mfma_f32_16x16x32_bf16 a[52:55], v[84:87], a[236:239], a[52:55]
v_mfma_f32_16x16x32_bf16 a[56:59], v[88:91], a[236:239], a[56:59]
v_mfma_f32_16x16x32_bf16 a[60:63], v[92:95], a[236:239], a[60:63]
v_mfma_f32_16x16x32_bf16 a[64:67], v[80:83], a[240:243], a[64:67]
v_mfma_f32_16x16x32_bf16 a[68:71], v[84:87], a[240:243], a[68:71]
v_mfma_f32_16x16x32_bf16 a[72:75], v[88:91], a[240:243], a[72:75]
v_mfma_f32_16x16x32_bf16 a[76:79], v[92:95], a[240:243], a[76:79]
v_mfma_f32_16x16x32_bf16 a[80:83], v[80:83], a[244:247], a[80:83]
v_mfma_f32_16x16x32_bf16 a[84:87], v[84:87], a[244:247], a[84:87]
v_mfma_f32_16x16x32_bf16 a[88:91], v[88:91], a[244:247], a[88:91]
v_mfma_f32_16x16x32_bf16 a[92:95], v[92:95], a[244:247], a[92:95]
v_mfma_f32_16x16x32_bf16 a[96:99], v[80:83], a[248:251], a[96:99]
v_mfma_f32_16x16x32_bf16 a[100:103], v[84:87], a[248:251], a[100:103]
v_mfma_f32_16x16x32_bf16 a[104:107], v[88:91], a[248:251], a[104:107]
v_mfma_f32_16x16x32_bf16 a[108:111], v[92:95], a[248:251], a[108:111]
v_mfma_f32_16x16x32_bf16 a[112:115], v[80:83], a[252:255], a[112:115]
v_mfma_f32_16x16x32_bf16 a[116:119], v[84:87], a[252:255], a[116:119]
v_mfma_f32_16x16x32_bf16 a[120:123], v[88:91], a[252:255], a[120:123]
v_mfma_f32_16x16x32_bf16 a[124:127], v[92:95], a[252:255], a[124:127]
s_nop 7
s_nop 3
s_add_u32 s54, s54, 8192
s_cmp_lt_u32 s54, 524288
s_cbranch_scc1 adaLN_cond__mha_block_cached__glu_gated_bilinear__prompt_kernel_fb
v_mov_b32 v6, v116
s_nop 1
v_permlane32_swap_b32 v116, v6
s_nop 1
v_add_f32 v116, v116, v6
v_mov_b32 v6, v116
s_nop 1
v_permlane16_swap_b32 v116, v6
s_nop 1
v_add_f32 v116, v116, v6
ds_bpermute_b32 v176, v5, v116 offset:0
ds_bpermute_b32 v177, v5, v116 offset:4
ds_bpermute_b32 v178, v5, v116 offset:8
ds_bpermute_b32 v179, v5, v116 offset:12
v_mov_b32 v6, v117
s_nop 1
v_permlane32_swap_b32 v117, v6
s_nop 1
v_add_f32 v117, v117, v6
v_mov_b32 v6, v117
s_nop 1
v_permlane16_swap_b32 v117, v6
s_nop 1
v_add_f32 v117, v117, v6
ds_bpermute_b32 v180, v5, v117 offset:0
ds_bpermute_b32 v181, v5, v117 offset:4
ds_bpermute_b32 v182, v5, v117 offset:8
ds_bpermute_b32 v183, v5, v117 offset:12
v_mov_b32 v6, v118
s_nop 1
v_permlane32_swap_b32 v118, v6
s_nop 1
v_add_f32 v118, v118, v6
v_mov_b32 v6, v118
s_nop 1
v_permlane16_swap_b32 v118, v6
s_nop 1
v_add_f32 v118, v118, v6
ds_bpermute_b32 v184, v5, v118 offset:0
ds_bpermute_b32 v185, v5, v118 offset:4
ds_bpermute_b32 v186, v5, v118 offset:8
ds_bpermute_b32 v187, v5, v118 offset:12
v_mov_b32 v6, v119
s_nop 1
v_permlane32_swap_b32 v119, v6
s_nop 1
v_add_f32 v119, v119, v6
v_mov_b32 v6, v119
s_nop 1
v_permlane16_swap_b32 v119, v6
s_nop 1
v_add_f32 v119, v119, v6
ds_bpermute_b32 v188, v5, v119 offset:0
ds_bpermute_b32 v189, v5, v119 offset:4
ds_bpermute_b32 v190, v5, v119 offset:8
ds_bpermute_b32 v191, v5, v119 offset:12
s_waitcnt lgkmcnt(0)
v_rcp_f32 v176, v176
v_rcp_f32 v177, v177
v_rcp_f32 v178, v178
v_rcp_f32 v179, v179
v_rcp_f32 v180, v180
v_rcp_f32 v181, v181
v_rcp_f32 v182, v182
v_rcp_f32 v183, v183
v_rcp_f32 v184, v184
v_rcp_f32 v185, v185
v_rcp_f32 v186, v186
v_rcp_f32 v187, v187
v_rcp_f32 v188, v188
v_rcp_f32 v189, v189
v_rcp_f32 v190, v190
v_rcp_f32 v191, v191
v_lshlrev_b32 v9, 2, v4
v_xor_b32 v9, v9, v2
v_lshlrev_b32 v9, 4, v9
v_accvgpr_read_b32 v16, a0
v_accvgpr_read_b32 v17, a1
v_accvgpr_read_b32 v18, a2
v_accvgpr_read_b32 v19, a3
v_accvgpr_read_b32 v20, a16
v_accvgpr_read_b32 v21, a17
v_accvgpr_read_b32 v22, a18
v_accvgpr_read_b32 v23, a19
v_maximum3_f32 v112, abs(v16), abs(v20), 0
v_maximum3_f32 v113, abs(v17), abs(v21), 0
v_maximum3_f32 v114, abs(v18), abs(v22), 0
v_maximum3_f32 v115, abs(v19), abs(v23), 0
v_pk_mul_f32 v[16:17], v[16:17], v[176:177]
v_pk_mul_f32 v[18:19], v[18:19], v[178:179]
v_pk_mul_f32 v[20:21], v[20:21], v[176:177]
v_pk_mul_f32 v[22:23], v[22:23], v[178:179]
v_cvt_pk_bf16_f32 v80, v16, v17
v_cvt_pk_bf16_f32 v81, v18, v19
v_cvt_pk_bf16_f32 v82, v20, v21
v_cvt_pk_bf16_f32 v83, v22, v23
s_mov_b32 s54, 0
buffer_store_dwordx4 v[80:83], v9, s[24:27], s54 offen offset:0 sc1
v_accvgpr_read_b32 v24, a32
v_accvgpr_read_b32 v25, a33
v_accvgpr_read_b32 v26, a34
v_accvgpr_read_b32 v27, a35
v_accvgpr_read_b32 v28, a48
v_accvgpr_read_b32 v29, a49
v_accvgpr_read_b32 v30, a50
v_accvgpr_read_b32 v31, a51
v_maximum3_f32 v112, abs(v24), abs(v28), v112
v_maximum3_f32 v113, abs(v25), abs(v29), v113
v_maximum3_f32 v114, abs(v26), abs(v30), v114
v_maximum3_f32 v115, abs(v27), abs(v31), v115
v_pk_mul_f32 v[24:25], v[24:25], v[176:177]
v_pk_mul_f32 v[26:27], v[26:27], v[178:179]
v_pk_mul_f32 v[28:29], v[28:29], v[176:177]
v_pk_mul_f32 v[30:31], v[30:31], v[178:179]
v_cvt_pk_bf16_f32 v84, v24, v25
v_cvt_pk_bf16_f32 v85, v26, v27
v_cvt_pk_bf16_f32 v86, v28, v29
v_cvt_pk_bf16_f32 v87, v30, v31
s_mov_b32 s54, 4096
buffer_store_dwordx4 v[84:87], v9, s[24:27], s54 offen offset:0 sc1
v_accvgpr_read_b32 v32, a64
v_accvgpr_read_b32 v33, a65
v_accvgpr_read_b32 v34, a66
v_accvgpr_read_b32 v35, a67
v_accvgpr_read_b32 v36, a80
v_accvgpr_read_b32 v37, a81
v_accvgpr_read_b32 v38, a82
v_accvgpr_read_b32 v39, a83
v_maximum3_f32 v112, abs(v32), abs(v36), v112
v_maximum3_f32 v113, abs(v33), abs(v37), v113
v_maximum3_f32 v114, abs(v34), abs(v38), v114
v_maximum3_f32 v115, abs(v35), abs(v39), v115
v_pk_mul_f32 v[32:33], v[32:33], v[176:177]
v_pk_mul_f32 v[34:35], v[34:35], v[178:179]
v_pk_mul_f32 v[36:37], v[36:37], v[176:177]
v_pk_mul_f32 v[38:39], v[38:39], v[178:179]
v_cvt_pk_bf16_f32 v88, v32, v33
v_cvt_pk_bf16_f32 v89, v34, v35
v_cvt_pk_bf16_f32 v90, v36, v37
v_cvt_pk_bf16_f32 v91, v38, v39
s_mov_b32 s54, 8192
buffer_store_dwordx4 v[88:91], v9, s[24:27], s54 offen offset:0 sc1
v_accvgpr_read_b32 v40, a96
v_accvgpr_read_b32 v41, a97
v_accvgpr_read_b32 v42, a98
v_accvgpr_read_b32 v43, a99
v_accvgpr_read_b32 v44, a112
v_accvgpr_read_b32 v45, a113
v_accvgpr_read_b32 v46, a114
v_accvgpr_read_b32 v47, a115
v_maximum3_f32 v112, abs(v40), abs(v44), v112
v_maximum3_f32 v113, abs(v41), abs(v45), v113
v_maximum3_f32 v114, abs(v42), abs(v46), v114
v_maximum3_f32 v115, abs(v43), abs(v47), v115
v_pk_mul_f32 v[40:41], v[40:41], v[176:177]
v_pk_mul_f32 v[42:43], v[42:43], v[178:179]
v_pk_mul_f32 v[44:45], v[44:45], v[176:177]
v_pk_mul_f32 v[46:47], v[46:47], v[178:179]
v_cvt_pk_bf16_f32 v92, v40, v41
v_cvt_pk_bf16_f32 v93, v42, v43
v_cvt_pk_bf16_f32 v94, v44, v45
v_cvt_pk_bf16_f32 v95, v46, v47
s_mov_b32 s54, 12288
buffer_store_dwordx4 v[92:95], v9, s[24:27], s54 offen offset:0 sc1
v_accvgpr_read_b32 v48, a4
v_accvgpr_read_b32 v49, a5
v_accvgpr_read_b32 v50, a6
v_accvgpr_read_b32 v51, a7
v_accvgpr_read_b32 v52, a20
v_accvgpr_read_b32 v53, a21
v_accvgpr_read_b32 v54, a22
v_accvgpr_read_b32 v55, a23
v_maximum3_f32 v116, abs(v48), abs(v52), 0
v_maximum3_f32 v117, abs(v49), abs(v53), 0
v_maximum3_f32 v118, abs(v50), abs(v54), 0
v_maximum3_f32 v119, abs(v51), abs(v55), 0
v_pk_mul_f32 v[48:49], v[48:49], v[180:181]
v_pk_mul_f32 v[50:51], v[50:51], v[182:183]
v_pk_mul_f32 v[52:53], v[52:53], v[180:181]
v_pk_mul_f32 v[54:55], v[54:55], v[182:183]
v_cvt_pk_bf16_f32 v80, v48, v49
v_cvt_pk_bf16_f32 v81, v50, v51
v_cvt_pk_bf16_f32 v82, v52, v53
v_cvt_pk_bf16_f32 v83, v54, v55
s_mov_b32 s54, 0
buffer_store_dwordx4 v[80:83], v9, s[24:27], s54 offen offset:1024 sc1
v_accvgpr_read_b32 v56, a36
v_accvgpr_read_b32 v57, a37
v_accvgpr_read_b32 v58, a38
v_accvgpr_read_b32 v59, a39
v_accvgpr_read_b32 v60, a52
v_accvgpr_read_b32 v61, a53
v_accvgpr_read_b32 v62, a54
v_accvgpr_read_b32 v63, a55
v_maximum3_f32 v116, abs(v56), abs(v60), v116
v_maximum3_f32 v117, abs(v57), abs(v61), v117
v_maximum3_f32 v118, abs(v58), abs(v62), v118
v_maximum3_f32 v119, abs(v59), abs(v63), v119
v_pk_mul_f32 v[56:57], v[56:57], v[180:181]
v_pk_mul_f32 v[58:59], v[58:59], v[182:183]
v_pk_mul_f32 v[60:61], v[60:61], v[180:181]
v_pk_mul_f32 v[62:63], v[62:63], v[182:183]
v_cvt_pk_bf16_f32 v84, v56, v57
v_cvt_pk_bf16_f32 v85, v58, v59
v_cvt_pk_bf16_f32 v86, v60, v61
v_cvt_pk_bf16_f32 v87, v62, v63
s_mov_b32 s54, 4096
buffer_store_dwordx4 v[84:87], v9, s[24:27], s54 offen offset:1024 sc1
v_accvgpr_read_b32 v64, a68
v_accvgpr_read_b32 v65, a69
v_accvgpr_read_b32 v66, a70
v_accvgpr_read_b32 v67, a71
v_accvgpr_read_b32 v68, a84
v_accvgpr_read_b32 v69, a85
v_accvgpr_read_b32 v70, a86
v_accvgpr_read_b32 v71, a87
v_maximum3_f32 v116, abs(v64), abs(v68), v116
v_maximum3_f32 v117, abs(v65), abs(v69), v117
v_maximum3_f32 v118, abs(v66), abs(v70), v118
v_maximum3_f32 v119, abs(v67), abs(v71), v119
v_pk_mul_f32 v[64:65], v[64:65], v[180:181]
v_pk_mul_f32 v[66:67], v[66:67], v[182:183]
v_pk_mul_f32 v[68:69], v[68:69], v[180:181]
v_pk_mul_f32 v[70:71], v[70:71], v[182:183]
v_cvt_pk_bf16_f32 v88, v64, v65
v_cvt_pk_bf16_f32 v89, v66, v67
v_cvt_pk_bf16_f32 v90, v68, v69
v_cvt_pk_bf16_f32 v91, v70, v71
s_mov_b32 s54, 8192
buffer_store_dwordx4 v[88:91], v9, s[24:27], s54 offen offset:1024 sc1
v_accvgpr_read_b32 v72, a100
v_accvgpr_read_b32 v73, a101
v_accvgpr_read_b32 v74, a102
v_accvgpr_read_b32 v75, a103
v_accvgpr_read_b32 v76, a116
v_accvgpr_read_b32 v77, a117
v_accvgpr_read_b32 v78, a118
v_accvgpr_read_b32 v79, a119
v_maximum3_f32 v116, abs(v72), abs(v76), v116
v_maximum3_f32 v117, abs(v73), abs(v77), v117
v_maximum3_f32 v118, abs(v74), abs(v78), v118
v_maximum3_f32 v119, abs(v75), abs(v79), v119
v_pk_mul_f32 v[72:73], v[72:73], v[180:181]
v_pk_mul_f32 v[74:75], v[74:75], v[182:183]
v_pk_mul_f32 v[76:77], v[76:77], v[180:181]
v_pk_mul_f32 v[78:79], v[78:79], v[182:183]
v_cvt_pk_bf16_f32 v92, v72, v73
v_cvt_pk_bf16_f32 v93, v74, v75
v_cvt_pk_bf16_f32 v94, v76, v77
v_cvt_pk_bf16_f32 v95, v78, v79
s_mov_b32 s54, 12288
buffer_store_dwordx4 v[92:95], v9, s[24:27], s54 offen offset:1024 sc1
v_accvgpr_read_b32 v16, a8
v_accvgpr_read_b32 v17, a9
v_accvgpr_read_b32 v18, a10
v_accvgpr_read_b32 v19, a11
v_accvgpr_read_b32 v20, a24
v_accvgpr_read_b32 v21, a25
v_accvgpr_read_b32 v22, a26
v_accvgpr_read_b32 v23, a27
v_maximum3_f32 v120, abs(v16), abs(v20), 0
v_maximum3_f32 v121, abs(v17), abs(v21), 0
v_maximum3_f32 v122, abs(v18), abs(v22), 0
v_maximum3_f32 v123, abs(v19), abs(v23), 0
v_pk_mul_f32 v[16:17], v[16:17], v[184:185]
v_pk_mul_f32 v[18:19], v[18:19], v[186:187]
v_pk_mul_f32 v[20:21], v[20:21], v[184:185]
v_pk_mul_f32 v[22:23], v[22:23], v[186:187]
v_cvt_pk_bf16_f32 v80, v16, v17
v_cvt_pk_bf16_f32 v81, v18, v19
v_cvt_pk_bf16_f32 v82, v20, v21
v_cvt_pk_bf16_f32 v83, v22, v23
s_mov_b32 s54, 0
buffer_store_dwordx4 v[80:83], v9, s[24:27], s54 offen offset:2048 sc1
v_accvgpr_read_b32 v24, a40
v_accvgpr_read_b32 v25, a41
v_accvgpr_read_b32 v26, a42
v_accvgpr_read_b32 v27, a43
v_accvgpr_read_b32 v28, a56
v_accvgpr_read_b32 v29, a57
v_accvgpr_read_b32 v30, a58
v_accvgpr_read_b32 v31, a59
v_maximum3_f32 v120, abs(v24), abs(v28), v120
v_maximum3_f32 v121, abs(v25), abs(v29), v121
v_maximum3_f32 v122, abs(v26), abs(v30), v122
v_maximum3_f32 v123, abs(v27), abs(v31), v123
v_pk_mul_f32 v[24:25], v[24:25], v[184:185]
v_pk_mul_f32 v[26:27], v[26:27], v[186:187]
v_pk_mul_f32 v[28:29], v[28:29], v[184:185]
v_pk_mul_f32 v[30:31], v[30:31], v[186:187]
v_cvt_pk_bf16_f32 v84, v24, v25
v_cvt_pk_bf16_f32 v85, v26, v27
v_cvt_pk_bf16_f32 v86, v28, v29
v_cvt_pk_bf16_f32 v87, v30, v31
s_mov_b32 s54, 4096
buffer_store_dwordx4 v[84:87], v9, s[24:27], s54 offen offset:2048 sc1
v_accvgpr_read_b32 v32, a72
v_accvgpr_read_b32 v33, a73
v_accvgpr_read_b32 v34, a74
v_accvgpr_read_b32 v35, a75
v_accvgpr_read_b32 v36, a88
v_accvgpr_read_b32 v37, a89
v_accvgpr_read_b32 v38, a90
v_accvgpr_read_b32 v39, a91
v_maximum3_f32 v120, abs(v32), abs(v36), v120
v_maximum3_f32 v121, abs(v33), abs(v37), v121
v_maximum3_f32 v122, abs(v34), abs(v38), v122
v_maximum3_f32 v123, abs(v35), abs(v39), v123
v_pk_mul_f32 v[32:33], v[32:33], v[184:185]
v_pk_mul_f32 v[34:35], v[34:35], v[186:187]
v_pk_mul_f32 v[36:37], v[36:37], v[184:185]
v_pk_mul_f32 v[38:39], v[38:39], v[186:187]
v_cvt_pk_bf16_f32 v88, v32, v33
v_cvt_pk_bf16_f32 v89, v34, v35
v_cvt_pk_bf16_f32 v90, v36, v37
v_cvt_pk_bf16_f32 v91, v38, v39
s_mov_b32 s54, 8192
buffer_store_dwordx4 v[88:91], v9, s[24:27], s54 offen offset:2048 sc1
v_accvgpr_read_b32 v40, a104
v_accvgpr_read_b32 v41, a105
v_accvgpr_read_b32 v42, a106
v_accvgpr_read_b32 v43, a107
v_accvgpr_read_b32 v44, a120
v_accvgpr_read_b32 v45, a121
v_accvgpr_read_b32 v46, a122
v_accvgpr_read_b32 v47, a123
v_maximum3_f32 v120, abs(v40), abs(v44), v120
v_maximum3_f32 v121, abs(v41), abs(v45), v121
v_maximum3_f32 v122, abs(v42), abs(v46), v122
v_maximum3_f32 v123, abs(v43), abs(v47), v123
v_pk_mul_f32 v[40:41], v[40:41], v[184:185]
v_pk_mul_f32 v[42:43], v[42:43], v[186:187]
v_pk_mul_f32 v[44:45], v[44:45], v[184:185]
v_pk_mul_f32 v[46:47], v[46:47], v[186:187]
v_cvt_pk_bf16_f32 v92, v40, v41
v_cvt_pk_bf16_f32 v93, v42, v43
v_cvt_pk_bf16_f32 v94, v44, v45
v_cvt_pk_bf16_f32 v95, v46, v47
s_mov_b32 s54, 12288
buffer_store_dwordx4 v[92:95], v9, s[24:27], s54 offen offset:2048 sc1
v_accvgpr_read_b32 v48, a12
v_accvgpr_read_b32 v49, a13
v_accvgpr_read_b32 v50, a14
v_accvgpr_read_b32 v51, a15
v_accvgpr_read_b32 v52, a28
v_accvgpr_read_b32 v53, a29
v_accvgpr_read_b32 v54, a30
v_accvgpr_read_b32 v55, a31
v_maximum3_f32 v124, abs(v48), abs(v52), 0
v_maximum3_f32 v125, abs(v49), abs(v53), 0
v_maximum3_f32 v126, abs(v50), abs(v54), 0
v_maximum3_f32 v127, abs(v51), abs(v55), 0
v_pk_mul_f32 v[48:49], v[48:49], v[188:189]
v_pk_mul_f32 v[50:51], v[50:51], v[190:191]
v_pk_mul_f32 v[52:53], v[52:53], v[188:189]
v_pk_mul_f32 v[54:55], v[54:55], v[190:191]
v_cvt_pk_bf16_f32 v80, v48, v49
v_cvt_pk_bf16_f32 v81, v50, v51
v_cvt_pk_bf16_f32 v82, v52, v53
v_cvt_pk_bf16_f32 v83, v54, v55
s_mov_b32 s54, 0
buffer_store_dwordx4 v[80:83], v9, s[24:27], s54 offen offset:3072 sc1
v_accvgpr_read_b32 v56, a44
v_accvgpr_read_b32 v57, a45
v_accvgpr_read_b32 v58, a46
v_accvgpr_read_b32 v59, a47
v_accvgpr_read_b32 v60, a60
v_accvgpr_read_b32 v61, a61
v_accvgpr_read_b32 v62, a62
v_accvgpr_read_b32 v63, a63
v_maximum3_f32 v124, abs(v56), abs(v60), v124
v_maximum3_f32 v125, abs(v57), abs(v61), v125
v_maximum3_f32 v126, abs(v58), abs(v62), v126
v_maximum3_f32 v127, abs(v59), abs(v63), v127
v_pk_mul_f32 v[56:57], v[56:57], v[188:189]
v_pk_mul_f32 v[58:59], v[58:59], v[190:191]
v_pk_mul_f32 v[60:61], v[60:61], v[188:189]
v_pk_mul_f32 v[62:63], v[62:63], v[190:191]
v_cvt_pk_bf16_f32 v84, v56, v57
v_cvt_pk_bf16_f32 v85, v58, v59
v_cvt_pk_bf16_f32 v86, v60, v61
v_cvt_pk_bf16_f32 v87, v62, v63
s_mov_b32 s54, 4096
buffer_store_dwordx4 v[84:87], v9, s[24:27], s54 offen offset:3072 sc1
v_accvgpr_read_b32 v64, a76
v_accvgpr_read_b32 v65, a77
v_accvgpr_read_b32 v66, a78
v_accvgpr_read_b32 v67, a79
v_accvgpr_read_b32 v68, a92
v_accvgpr_read_b32 v69, a93
v_accvgpr_read_b32 v70, a94
v_accvgpr_read_b32 v71, a95
v_maximum3_f32 v124, abs(v64), abs(v68), v124
v_maximum3_f32 v125, abs(v65), abs(v69), v125
v_maximum3_f32 v126, abs(v66), abs(v70), v126
v_maximum3_f32 v127, abs(v67), abs(v71), v127
v_pk_mul_f32 v[64:65], v[64:65], v[188:189]
v_pk_mul_f32 v[66:67], v[66:67], v[190:191]
v_pk_mul_f32 v[68:69], v[68:69], v[188:189]
v_pk_mul_f32 v[70:71], v[70:71], v[190:191]
v_cvt_pk_bf16_f32 v88, v64, v65
v_cvt_pk_bf16_f32 v89, v66, v67
v_cvt_pk_bf16_f32 v90, v68, v69
v_cvt_pk_bf16_f32 v91, v70, v71
s_mov_b32 s54, 8192
buffer_store_dwordx4 v[88:91], v9, s[24:27], s54 offen offset:3072 sc1
v_accvgpr_read_b32 v72, a108
v_accvgpr_read_b32 v73, a109
v_accvgpr_read_b32 v74, a110
v_accvgpr_read_b32 v75, a111
v_accvgpr_read_b32 v76, a124
v_accvgpr_read_b32 v77, a125
v_accvgpr_read_b32 v78, a126
v_accvgpr_read_b32 v79, a127
v_maximum3_f32 v124, abs(v72), abs(v76), v124
v_maximum3_f32 v125, abs(v73), abs(v77), v125
v_maximum3_f32 v126, abs(v74), abs(v78), v126
v_maximum3_f32 v127, abs(v75), abs(v79), v127
v_pk_mul_f32 v[72:73], v[72:73], v[188:189]
v_pk_mul_f32 v[74:75], v[74:75], v[190:191]
v_pk_mul_f32 v[76:77], v[76:77], v[188:189]
v_pk_mul_f32 v[78:79], v[78:79], v[190:191]
v_cvt_pk_bf16_f32 v92, v72, v73
v_cvt_pk_bf16_f32 v93, v74, v75
v_cvt_pk_bf16_f32 v94, v76, v77
v_cvt_pk_bf16_f32 v95, v78, v79
s_mov_b32 s54, 12288
buffer_store_dwordx4 v[92:95], v9, s[24:27], s54 offen offset:3072 sc1
s_waitcnt vmcnt(0)
s_mov_b32 s29, 1
s_branch adaLN_cond__mha_block_cached__glu_gated_bilinear__prompt_kernel_fin
code_end:
.section .rodata,"a"
.p2align 6
.amdhsa_kernel adaLN_cond__mha_block_cached__glu_gated_bilinear__prompt_kernel
  .amdhsa_next_free_vgpr 512
  .amdhsa_next_free_sgpr 102
  .amdhsa_accum_offset 256
  .amdhsa_group_segment_fixed_size 0
  .amdhsa_kernarg_size 112
  .amdhsa_user_sgpr_count 2
  .amdhsa_user_sgpr_kernarg_segment_ptr 1
  .amdhsa_system_sgpr_workgroup_id_x 1
.end_amdhsa_kernel
```
